```python
import torch

def _softmax(x, axis=-1):
    return torch.softmax(x, dim=axis)
def _gelu(x):
    return torch.nn.functional.gelu(x, approximate="tanh")
def _silu(x):
    return torch.nn.functional.silu(x)
def _sigmoid(x):
    return torch.sigmoid(x)
def _layernorm(x, axis=-1, eps=1e-5):
    m = x.mean(dim=axis, keepdim=True)
    v = x.var(dim=axis, keepdim=True, unbiased=False)
    return (x - m) / torch.sqrt(v + eps)
def _scatter_add(tgt, idx, src, axis=0):
    return tgt.clone().index_add_(axis, idx, src)
def _segment_sum(src, seg, n):
    out = torch.zeros((n,) + src.shape[1:], dtype=src.dtype)
    return out.index_add_(0, seg, src)
def _pad(x, pw):
    flat = tuple(v for pair in reversed(pw) for v in pair)
    return torch.nn.functional.pad(x, flat)

kernel_name = 'sequential_preLN__compressed_kv_cla__dense_activation_silu__prompt'

def setup_inputs():

    _w = (lambda a: (lambda t: t.to(torch.bfloat16) if t.is_floating_point() else t)(torch.as_tensor(a)))
    def _A_setup():
        B, H, Sq, Sk, D, M = 1, 32, 2048, 2048, 128, 1024
        Dc = 4 * D
        return {
            "x": _w((lambda *s: torch.randn(*s, dtype=torch.bfloat16) * 0.05)(B, Sq, M)),
            "c_kv": _w((lambda *s: torch.randn(*s, dtype=torch.bfloat16) * 0.4)(B, Sk, Dc)),
            "w_q": _w((lambda *s: torch.randn(*s, dtype=torch.bfloat16) * 1.6)(M, H, D) * (M ** -0.5)),
            "w_uk": _w((lambda *s: torch.randn(*s, dtype=torch.bfloat16) * 1.6)(Dc, H, D) * (Dc ** -0.5)),
            "w_uv": _w((lambda *s: torch.randn(*s, dtype=torch.bfloat16) * 0.4)(Dc, H, D) * (Dc ** -0.5)),
            "w_o": _w((lambda *s: torch.randn(*s, dtype=torch.bfloat16) * 0.4)(H, D, M) * ((H * D) ** -0.5)),
        }
    _A_in = _A_setup()

    def _B_setup():
        B, S, D, F = 1, 2048, 1024, 3584
        return {
            "x": _w((lambda *s: torch.randn(*s, dtype=torch.bfloat16) * 0.05)(B, S, D)),
            "w1": _w((lambda *s: torch.randn(*s, dtype=torch.bfloat16) * 0.8)(D, F) * (D ** -0.5)),
            "w2": _w((lambda *s: torch.randn(*s, dtype=torch.bfloat16) * 0.1)(F, D) * (F ** -0.5)),
        }
    _B_in = _B_setup()

    return {
        "A_x": _A_in["x"],
        "A_c_kv": _A_in["c_kv"],
        "A_w_q": _A_in["w_q"],
        "A_w_uk": _A_in["w_uk"],
        "A_w_uv": _A_in["w_uv"],
        "A_w_o": _A_in["w_o"],
        "B_x": _B_in["x"],
        "B_w1": _B_in["w1"],
        "B_w2": _B_in["w2"],
    }

def reference(A_x, A_c_kv, A_w_q, A_w_uk, A_w_uv, A_w_o, B_x, B_w1, B_w2):
    def _A_ref(x, c_kv, w_q, w_uk, w_uv, w_o):
        B, Sq, M = x.shape[0], x.shape[1], x.shape[2]
        Sk = c_kv.shape[1]
        H, D = w_q.shape[1], w_q.shape[2]
        q = torch.einsum("bqm,mhd->bhqd", x, w_q)
        k = torch.einsum("bkc,chd->bhkd", c_kv, w_uk)
        v = torch.einsum("bkc,chd->bhkd", c_kv, w_uv)
        scores = torch.einsum("bhqd,bhkd->bhqk", q, k) * (D ** -0.5)
        off = Sk - Sq
        qi = torch.arange(Sq)[:, None]
        kj = torch.arange(Sk)[None, :]
        cmask = kj <= (qi + off)
        scores = torch.where(cmask[None, None], scores, -1e9)
        p = _softmax(scores, axis=-1)
        ctx = torch.einsum("bhqk,bhkd->bhqd", p, v)
        return torch.einsum("bhqd,hdm->bqm", ctx, w_o)

    def _B_ref(x, w1, w2):
        h = torch.einsum("bsd,df->bsf", x, w1)
        h = _silu(h)
        out = torch.einsum("bsf,fd->bsd", h, w2)
        return out

    x = A_x
    h = x + _A_ref(_layernorm(x, axis=-1), A_c_kv, A_w_q, A_w_uk, A_w_uv, A_w_o)
    h2 = h + _B_ref(_layernorm(h, axis=-1), B_w1, B_w2)
    return h2
```

```asm
; @launch grid=(256,1,1) block=(256,1,1) lds=163840
.amdgcn_target "amdgcn-amd-amdhsa--gfx950"
.text
.globl sequential_preLN__compressed_kv_cla__dense_activation_silu__prompt_kernel
.p2align 8
.type sequential_preLN__compressed_kv_cla__dense_activation_silu__prompt_kernel,@function
sequential_preLN__compressed_kv_cla__dense_activation_silu__prompt_kernel:
    s_cmp_ge_u32 s2, 256
    s_cbranch_scc1 fk_end
    s_load_dwordx16 s[48:63], s[0:1], 0
    s_load_dwordx8 s[64:71], s[0:1], 64
    s_getpc_b64 s[4:5]
fk_pca:
    s_add_u32 s4, s4, fk_pca-fk_pca
    s_addc_u32 s5, s5, 0
    s_lshr_b32 s3, s2, 3
    s_lshl_b32 s3, s3, 12
    v_and_b32 v58, 31, v0
    v_lshl_add_u32 v58, v58, 7, s3
    v_min_u32 v58, all_code_end-fk_pca-4, v58
    global_load_dword v59, v58, s[4:5]
    v_and_b32 v1, 63, v0
    v_lshrrev_b32 v2, 6, v0
    s_lshr_b32 s4, s2, 3
    s_and_b32 s3, s2, 7
    v_readfirstlane_b32 s32, v2
    s_lshl_b32 s7, s3, 10
    s_mul_i32 s76, s3, 1
    s_lshl_b32 s5, s4, 16
    v_lshlrev_b32 v39, 10, v1
    v_add_u32 v39, s5, v39
    s_add_u32 s5, s76, s32
    s_add_u32 s5, s5, 0
    s_and_b32 s5, s5, 7
    s_lshl_b32 s77, s5, 7
    s_add_u32 s5, s76, s32
    s_add_u32 s5, s5, 2
    s_and_b32 s5, s5, 7
    s_lshl_b32 s78, s5, 7
    s_add_u32 s5, s76, s32
    s_add_u32 s5, s5, 6
    s_and_b32 s5, s5, 7
    s_lshl_b32 s79, s5, 7
    v_lshrrev_b32 v2, 4, v1
    v_add_u32 v2, s76, v2
    v_and_b32 v2, 7, v2
    v_lshlrev_b32 v2, 6, v2
    v_bfe_u32 v3, v1, 3, 1
    v_add_u32 v2, v2, v3
    s_lshl_b32 s6, s4, 1
    v_add_u32 v2, s6, v2
    v_lshlrev_b32 v2, 13, v2
    v_and_b32 v3, 7, v1
    v_lshl_add_u32 v2, v3, 7, v2
    v_add_u32 v38, s7, v2
    v_xor_b32 v40, 0x200000, v38
    s_and_b32 s38, s4, 7
    s_bfe_u32 s5, s4, 0x10003
    s_lshl_b32 s6, s3, 1
    s_add_u32 s39, s5, s6
    v_lshrrev_b32 v2, 3, v1
    v_lshrrev_b32 v3, 4, v1
    v_and_b32 v4, 7, v1
    v_xor_b32 v4, v4, v3
    s_and_b32 s5, s32, 1
    s_lshl_b32 s5, s5, 2
    s_lshr_b32 s6, s32, 1
    s_add_u32 s5, s5, s6
    s_lshl_b32 s5, s5, 3
    s_add_u32 s5, s5, s38
    s_lshl_b32 s5, s5, 5
    v_add_u32 v2, s5, v2
    v_lshlrev_b32 v2, 10, v2
    v_lshl_add_u32 v5, v4, 4, v2
    v_xor_b32 v4, 4, v4
    v_lshl_add_u32 v6, v4, 4, v2
    v_add_u32 v8, 0, v5
    v_add_u32 v9, 7168, v6
    v_add_u32 v10, 14336, v5
    v_add_u32 v11, 21504, v6
    v_add_u32 v12, 524288, v5
    v_add_u32 v13, 531456, v6
    v_add_u32 v14, 538624, v5
    v_add_u32 v15, 545792, v6
    v_lshrrev_b32 v2, 5, v1
    v_and_b32 v4, 31, v1
    v_lshlrev_b32 v3, 1, v2
    v_xor_b32 v4, v4, v3
    s_lshl_b32 s5, s32, 4
    v_add_u32 v2, s5, v2
    v_lshlrev_b32 v2, 13, v2
    s_lshl_b32 s5, s39, 9
    v_add_u32 v2, s5, v2
    v_xor_b32 v5, 0, v4
    v_lshl_add_u32 v5, v5, 4, v2
    v_add_u32 v16, 0, v5
    v_xor_b32 v5, 4, v4
    v_lshl_add_u32 v5, v5, 4, v2
    v_add_u32 v17, 15360, v5
    v_xor_b32 v5, 0, v4
    v_lshl_add_u32 v5, v5, 4, v2
    v_add_u32 v18, 30720, v5
    v_xor_b32 v5, 4, v4
    v_lshl_add_u32 v5, v5, 4, v2
    v_add_u32 v19, 46080, v5
    v_xor_b32 v5, 8, v4
    v_lshl_add_u32 v5, v5, 4, v2
    v_add_u32 v20, 65536, v5
    v_xor_b32 v5, 12, v4
    v_lshl_add_u32 v5, v5, 4, v2
    v_add_u32 v21, 80896, v5
    v_xor_b32 v5, 8, v4
    v_lshl_add_u32 v5, v5, 4, v2
    v_add_u32 v22, 96256, v5
    v_xor_b32 v5, 12, v4
    v_lshl_add_u32 v5, v5, 4, v2
    v_add_u32 v23, 111616, v5
    s_waitcnt lgkmcnt(0)
    s_mov_b32 s8, s50
    s_and_b32 s9, s51, 0xffff
    s_mov_b32 s10, 0x200000
    s_mov_b32 s11, 0x20000
    s_cmp_eq_u32 s32, 2
    s_cselect_b32 s5, s54, s56
    s_cselect_b32 s6, s55, s57
    s_mov_b32 s72, s5
    s_and_b32 s73, s6, 0xffff
    s_mov_b32 s74, 0x400000
    s_mov_b32 s75, 0x20000
    s_cmp_lt_u32 s32, 2
    s_cbranch_scc1 fk_ta
    buffer_load_dword v36, v38, s[72:75], 0 offen
    s_branch fk_ua
fk_ta:
    buffer_load_dword v36, v39, s[8:11], s77 offen
fk_ua:
    s_mov_b32 s16, s70
    s_and_b32 s17, s71, 0xffff
    s_mov_b32 s18, 0x5000000
    s_mov_b32 s19, 0x20000
    s_mov_b32 s28, s68
    s_and_b32 s29, s69, 0xffff
    s_mov_b32 s30, 0x100
    s_mov_b32 s31, 0x20000
    s_mov_b64 s[44:45], s[64:65]
    s_lshr_b32 s5, s4, 4
    s_cmp_eq_u32 s5, 0
    s_cselect_b32 s54, s54, s56
    s_cselect_b32 s55, s55, s57
    s_mov_b32 s12, s54
    s_and_b32 s13, s55, 0xffff
    s_mov_b32 s14, 0x400000
    s_mov_b32 s15, 0x20000
    s_mov_b32 s68, s5
    s_lshl_b32 s64, s32, 13
    s_add_u32 s65, s64, 65536
    s_lshl_b32 s66, s76, 7
    s_lshl_b32 s67, s76, 19
    s_add_u32 m0, s64, 32768
    s_nop 0
    buffer_load_dwordx4 v8, s[8:11], s66 offen offset:0 lds
    buffer_load_dwordx4 v9, s[8:11], s66 offen offset:1024 lds
    buffer_load_dwordx4 v10, s[8:11], s66 offen offset:2048 lds
    buffer_load_dwordx4 v11, s[8:11], s66 offen offset:3072 lds
    s_add_u32 m0, s64, 36864
    s_nop 0
    buffer_load_dwordx4 v12, s[8:11], s66 offen offset:0 lds
    buffer_load_dwordx4 v13, s[8:11], s66 offen offset:1024 lds
    buffer_load_dwordx4 v14, s[8:11], s66 offen offset:2048 lds
    buffer_load_dwordx4 v15, s[8:11], s66 offen offset:3072 lds
    s_add_u32 s66, s66, 128
    s_and_b32 s66, s66, 0x3ff
    s_add_u32 m0, s64, 65536
    s_nop 0
    buffer_load_dwordx4 v16, s[12:15], s67 offen offset:0 lds
    buffer_load_dwordx4 v17, s[12:15], s67 offen offset:1024 lds
    buffer_load_dwordx4 v18, s[12:15], s67 offen offset:2048 lds
    buffer_load_dwordx4 v19, s[12:15], s67 offen offset:3072 lds
    s_add_u32 m0, s64, 69632
    s_nop 0
    buffer_load_dwordx4 v20, s[12:15], s67 offen offset:0 lds
    buffer_load_dwordx4 v21, s[12:15], s67 offen offset:1024 lds
    buffer_load_dwordx4 v22, s[12:15], s67 offen offset:2048 lds
    buffer_load_dwordx4 v23, s[12:15], s67 offen offset:3072 lds
    s_add_u32 s67, s67, 524288
    s_and_b32 s67, s67, 0x3fffff
    s_add_u32 m0, s64, 0
    s_nop 0
    buffer_load_dwordx4 v8, s[8:11], s66 offen offset:0 lds
    buffer_load_dwordx4 v9, s[8:11], s66 offen offset:1024 lds
    buffer_load_dwordx4 v10, s[8:11], s66 offen offset:2048 lds
    buffer_load_dwordx4 v11, s[8:11], s66 offen offset:3072 lds
    s_add_u32 m0, s64, 4096
    s_nop 0
    buffer_load_dwordx4 v12, s[8:11], s66 offen offset:0 lds
    buffer_load_dwordx4 v13, s[8:11], s66 offen offset:1024 lds
    buffer_load_dwordx4 v14, s[8:11], s66 offen offset:2048 lds
    buffer_load_dwordx4 v15, s[8:11], s66 offen offset:3072 lds
    s_add_u32 s66, s66, 128
    s_and_b32 s66, s66, 0x3ff
    s_add_u32 m0, s64, 98304
    s_nop 0
    buffer_load_dwordx4 v16, s[12:15], s67 offen offset:0 lds
    buffer_load_dwordx4 v17, s[12:15], s67 offen offset:1024 lds
    buffer_load_dwordx4 v18, s[12:15], s67 offen offset:2048 lds
    buffer_load_dwordx4 v19, s[12:15], s67 offen offset:3072 lds
    s_add_u32 m0, s64, 102400
    s_nop 0
    buffer_load_dwordx4 v20, s[12:15], s67 offen offset:0 lds
    buffer_load_dwordx4 v21, s[12:15], s67 offen offset:1024 lds
    buffer_load_dwordx4 v22, s[12:15], s67 offen offset:2048 lds
    buffer_load_dwordx4 v23, s[12:15], s67 offen offset:3072 lds
    s_add_u32 s67, s67, 524288
    s_and_b32 s67, s67, 0x3fffff
    s_lshl_b32 s5, s2, 14
    s_lshl_b32 s6, s32, 9
    s_add_u32 s5, s5, s6
    v_and_b32 v52, 7, v1
    v_lshrrev_b32 v53, 3, v1
    v_lshlrev_b32 v7, 11, v52
    v_lshl_add_u32 v7, v53, 4, v7
    v_add_u32 v7, s5, v7
    s_mov_b32 s20, s48
    s_and_b32 s21, s49, 0xffff
    s_mov_b32 s22, 0x400000
    s_mov_b32 s23, 0x20000
    s_mov_b32 s24, s52
    s_and_b32 s25, s53, 0xffff
    s_mov_b32 s26, 0x800000
    s_mov_b32 s27, 0x20000
    s_mov_b64 s[40:41], s[58:59]
    s_mov_b64 s[42:43], s[62:63]
    s_lshr_b32 s5, s4, 3
    s_lshl_b32 s6, s3, 2
    s_add_u32 s33, s5, s6
    s_lshl_b32 s5, s38, 2
    s_add_u32 s34, s5, 4
    s_sub_u32 s35, 64, s5
    s_add_u32 s36, s5, s32
    s_sub_u32 s37, s35, 4
    s_add_u32 s37, s37, s32
    s_and_b32 s5, s32, 1
    s_lshl_b32 s6, s39, 1
    s_add_u32 s5, s5, s6
    s_lshl_b32 s5, s5, 6
    s_add_u32 s5, s5, s38
    s_lshr_b32 s6, s32, 1
    s_lshl_b32 s6, s6, 3
    s_add_u32 s5, s5, s6
    s_lshl_b32 s5, s5, 13
    s_mul_i32 s6, s68, 16777216
    s_add_u32 s5, s5, s6
    s_add_u32 s99, s5, 4194304
    s_lshl_b32 s5, s4, 5
    s_lshl_b32 s6, s32, 3
    s_add_u32 s5, s5, s6
    v_lshrrev_b32 v2, 3, v1
    v_and_b32 v2, 3, v2
    v_add_u32 v2, s5, v2
    v_lshlrev_b32 v2, 13, v2
    v_and_b32 v3, 7, v1
    v_lshl_add_u32 v2, v3, 7, v2
    v_add_u32 v41, s7, v2
    v_mov_b32 v42, s2
    v_mov_b32 v2, 0x10000000
    v_cmp_eq_u32 vcc, 0, v0
    v_mov_b32 v46, 1
    s_lshl_b32 s5, s2, 7
    s_add_u32 s5, s5, 74252288
    v_mov_b32 v43, s5
    v_cndmask_b32 v42, v2, v42, vcc
    v_cndmask_b32 v43, v2, v43, vcc
    v_lshlrev_b32 v44, 2, v1
    s_bfe_u32 s5, s33, 0x10001
    s_lshl_b32 s5, s5, 6
    s_lshr_b32 s6, s33, 2
    s_add_u32 s5, s5, s6
    v_and_b32 v45, 7, v1
    v_lshlrev_b32 v45, 3, v45
    v_and_b32 v2, 8, v1
    v_lshl_add_u32 v45, v2, 4, v45
    v_add_u32 v45, s5, v45
    v_lshlrev_b32 v45, 7, v45
    v_add_u32 v45, 74252288, v45
    v_and_b32 v2, 15, v1
    v_lshrrev_b32 v3, 4, v1
    v_bfe_u32 v4, v1, 1, 3
    s_lshr_b32 s5, s32, 1
    s_lshl_b32 s5, s5, 14
    v_lshlrev_b32 v2, 7, v2
    v_add_u32 v2, s5, v2
    v_xor_b32 v3, v3, v4
    v_xor_b32 v5, 0, v3
    v_lshl_add_u32 v48, v5, 4, v2
    v_add_u32 v50, 131072, v48
    v_xor_b32 v5, 4, v3
    v_lshl_add_u32 v49, v5, 4, v2
    v_add_u32 v51, 131072, v49
    v_bfe_u32 v2, v1, 2, 3
    v_bfe_u32 v4, v1, 2, 2
    v_lshrrev_b32 v3, 4, v1
    v_lshl_add_u32 v3, v3, 3, v4
    v_lshlrev_b32 v3, 9, v3
    v_and_b32 v4, 3, v1
    v_lshl_add_u32 v3, v4, 3, v3
    s_and_b32 s5, s32, 1
    s_lshl_b32 s5, s5, 8
    s_add_u32 s5, s5, 65536
    v_add_u32 v3, s5, v3
    v_xor_b32 v5, 0, v2
    v_lshl_add_u32 v24, v5, 5, v3
    v_xor_b32 v5, 1, v2
    v_lshl_add_u32 v25, v5, 5, v3
    v_xor_b32 v5, 2, v2
    v_lshl_add_u32 v26, v5, 5, v3
    v_xor_b32 v5, 3, v2
    v_lshl_add_u32 v27, v5, 5, v3
    v_xor_b32 v5, 4, v2
    v_lshl_add_u32 v28, v5, 5, v3
    v_xor_b32 v5, 5, v2
    v_lshl_add_u32 v29, v5, 5, v3
    v_xor_b32 v5, 6, v2
    v_lshl_add_u32 v30, v5, 5, v3
    v_xor_b32 v5, 7, v2
    v_lshl_add_u32 v31, v5, 5, v3
    s_lshl_b32 s5, s4, 2
    s_add_u32 s5, s5, s32
    s_lshl_b32 s5, s5, 4
    v_and_b32 v57, 15, v1
    v_add_u32 v57, s5, v57
    v_lshlrev_b32 v57, 16, v57
    s_lshl_b32 s5, s2, 8
    s_add_u32 s5, s5, 73924608
    v_lshlrev_b32 v54, 5, v52
    v_add_u32 v54, s5, v54
    s_lshl_b32 s5, s32, 3
    v_lshlrev_b32 v55, 27, v53
    v_add3_u32 v55, v55, s5, v54
    s_lshr_b32 s5, s2, 2
    s_mul_i32 s5, s5, 65536
    s_and_b32 s6, s2, 3
    s_lshl_b32 s6, s6, 7
    s_add_u32 s5, s5, s6
    s_lshl_b32 s6, s32, 14
    s_add_u32 s5, s5, s6
    s_add_u32 s5, s5, 0
    v_lshlrev_b32 v56, 9, v53
    v_lshl_add_u32 v56, v52, 4, v56
    v_add_u32 v56, s5, v56
    s_mov_b64 s[6:7], s[48:49]
    buffer_load_dwordx4 v[160:163], v7, s[20:23], 0 offen offset:0
    buffer_load_dwordx4 v[164:167], v7, s[20:23], 0 offen offset:128
    buffer_load_dwordx4 v[168:171], v7, s[20:23], 0 offen offset:256
    buffer_load_dwordx4 v[172:175], v7, s[20:23], 0 offen offset:384
    s_waitcnt vmcnt(20)
    s_barrier
    ds_read_b64_tr_b16 v[64:65], v24 offset:0
    ds_read_b64_tr_b16 v[66:67], v24 offset:2048
    ds_read_b128 v[96:99], v48 offset:32768
    ds_read_b128 v[100:103], v48 offset:34816
    ds_read_b128 v[104:107], v48 offset:36864
    ds_read_b128 v[108:111], v48 offset:38912
    ds_read_b128 v[112:115], v48 offset:40960
    ds_read_b128 v[116:119], v48 offset:43008
    ds_read_b128 v[120:123], v48 offset:45056
    ds_read_b128 v[124:127], v48 offset:47104
    ds_read_b64_tr_b16 v[68:69], v25 offset:0
    ds_read_b64_tr_b16 v[70:71], v25 offset:2048
    ds_read_b64_tr_b16 v[72:73], v26 offset:0
    ds_read_b64_tr_b16 v[74:75], v26 offset:2048
    ds_read_b64_tr_b16 v[76:77], v27 offset:0
    ds_read_b64_tr_b16 v[78:79], v27 offset:2048
    ds_read_b64_tr_b16 v[80:81], v28 offset:0
    ds_read_b64_tr_b16 v[82:83], v28 offset:2048
    ds_read_b64_tr_b16 v[84:85], v29 offset:0
    ds_read_b64_tr_b16 v[86:87], v29 offset:2048
    ds_read_b64_tr_b16 v[88:89], v30 offset:0
    ds_read_b64_tr_b16 v[90:91], v30 offset:2048
    ds_read_b64_tr_b16 v[92:93], v31 offset:0
    ds_read_b64_tr_b16 v[94:95], v31 offset:2048
    s_cmp_eq_u32 s68, 1
    s_cbranch_scc1 fk_v
    s_waitcnt lgkmcnt(15)
    v_mfma_f32_16x16x32_bf16 a[0:3], v[64:67], v[96:99], 0
    v_mfma_f32_16x16x32_bf16 a[8:11], v[64:67], v[100:103], 0
    v_mfma_f32_16x16x32_bf16 a[64:67], v[64:67], v[104:107], 0
    v_mfma_f32_16x16x32_bf16 a[72:75], v[64:67], v[108:111], 0
    v_mfma_f32_16x16x32_bf16 a[128:131], v[64:67], v[112:115], 0
    v_mfma_f32_16x16x32_bf16 a[136:139], v[64:67], v[116:119], 0
    v_mfma_f32_16x16x32_bf16 a[192:195], v[64:67], v[120:123], 0
    s_waitcnt lgkmcnt(12)
    v_mfma_f32_16x16x32_bf16 a[200:203], v[64:67], v[124:127], 0
    v_mfma_f32_16x16x32_bf16 a[4:7], v[68:71], v[96:99], 0
    ds_read_b64_tr_b16 v[64:65], v24 offset:16384
    v_mfma_f32_16x16x32_bf16 a[12:15], v[68:71], v[100:103], 0
    ds_read_b64_tr_b16 v[66:67], v24 offset:18432
    v_mfma_f32_16x16x32_bf16 a[68:71], v[68:71], v[104:107], 0
    v_mfma_f32_16x16x32_bf16 a[76:79], v[68:71], v[108:111], 0
    ds_read_b128 v[128:131], v49 offset:32768
    v_mfma_f32_16x16x32_bf16 a[132:135], v[68:71], v[112:115], 0
    v_mfma_f32_16x16x32_bf16 a[140:143], v[68:71], v[116:119], 0
    v_mfma_f32_16x16x32_bf16 a[196:199], v[68:71], v[120:123], 0
    s_waitcnt lgkmcnt(13)
    v_mfma_f32_16x16x32_bf16 a[204:207], v[68:71], v[124:127], 0
    v_mfma_f32_16x16x32_bf16 a[16:19], v[72:75], v[96:99], 0
    ds_read_b64_tr_b16 v[68:69], v25 offset:16384
    v_mfma_f32_16x16x32_bf16 a[24:27], v[72:75], v[100:103], 0
    ds_read_b64_tr_b16 v[70:71], v25 offset:18432
    ds_read_b128 v[132:135], v49 offset:34816
    v_mfma_f32_16x16x32_bf16 a[80:83], v[72:75], v[104:107], 0
    v_mfma_f32_16x16x32_bf16 a[88:91], v[72:75], v[108:111], 0
    v_mfma_f32_16x16x32_bf16 a[144:147], v[72:75], v[112:115], 0
    v_mfma_f32_16x16x32_bf16 a[152:155], v[72:75], v[116:119], 0
    v_mfma_f32_16x16x32_bf16 a[208:211], v[72:75], v[120:123], 0
    s_waitcnt lgkmcnt(14)
    v_mfma_f32_16x16x32_bf16 a[216:219], v[72:75], v[124:127], 0
    ds_read_b128 v[136:139], v49 offset:36864
    v_mfma_f32_16x16x32_bf16 a[20:23], v[76:79], v[96:99], 0
    ds_read_b64_tr_b16 v[72:73], v26 offset:16384
    v_mfma_f32_16x16x32_bf16 a[28:31], v[76:79], v[100:103], 0
    ds_read_b64_tr_b16 v[74:75], v26 offset:18432
    v_mfma_f32_16x16x32_bf16 a[84:87], v[76:79], v[104:107], 0
    v_mfma_f32_16x16x32_bf16 a[92:95], v[76:79], v[108:111], 0
    v_mfma_f32_16x16x32_bf16 a[148:151], v[76:79], v[112:115], 0
    v_mfma_f32_16x16x32_bf16 a[156:159], v[76:79], v[116:119], 0
    ds_read_b128 v[140:143], v49 offset:38912
    v_mfma_f32_16x16x32_bf16 a[212:215], v[76:79], v[120:123], 0
    s_waitcnt lgkmcnt(15)
    v_mfma_f32_16x16x32_bf16 a[220:223], v[76:79], v[124:127], 0
    v_mfma_f32_16x16x32_bf16 a[32:35], v[80:83], v[96:99], 0
    ds_read_b64_tr_b16 v[76:77], v27 offset:16384
    v_mfma_f32_16x16x32_bf16 a[40:43], v[80:83], v[100:103], 0
    s_add_u32 m0, s64, 131072
    ds_read_b64_tr_b16 v[78:79], v27 offset:18432
    v_mfma_f32_16x16x32_bf16 a[96:99], v[80:83], v[104:107], 0
    buffer_load_dwordx4 v8, s[8:11], s66 offen offset:0 lds
    v_mfma_f32_16x16x32_bf16 a[104:107], v[80:83], v[108:111], 0
    ds_read_b128 v[144:147], v49 offset:40960
    v_mfma_f32_16x16x32_bf16 a[160:163], v[80:83], v[112:115], 0
    v_mfma_f32_16x16x32_bf16 a[168:171], v[80:83], v[116:119], 0
    buffer_load_dwordx4 v9, s[8:11], s66 offen offset:1024 lds
    v_mfma_f32_16x16x32_bf16 a[224:227], v[80:83], v[120:123], 0
    s_waitcnt lgkmcnt(15)
    v_mfma_f32_16x16x32_bf16 a[232:235], v[80:83], v[124:127], 0
    v_mfma_f32_16x16x32_bf16 a[36:39], v[84:87], v[96:99], 0
    ds_read_b64_tr_b16 v[80:81], v28 offset:16384
    v_mfma_f32_16x16x32_bf16 a[44:47], v[84:87], v[100:103], 0
    ds_read_b64_tr_b16 v[82:83], v28 offset:18432
    ds_read_b128 v[148:151], v49 offset:43008
    v_mfma_f32_16x16x32_bf16 a[100:103], v[84:87], v[104:107], 0
    buffer_load_dwordx4 v10, s[8:11], s66 offen offset:2048 lds
    v_mfma_f32_16x16x32_bf16 a[108:111], v[84:87], v[108:111], 0
    v_mfma_f32_16x16x32_bf16 a[164:167], v[84:87], v[112:115], 0
    buffer_load_dwordx4 v11, s[8:11], s66 offen offset:3072 lds
    v_mfma_f32_16x16x32_bf16 a[172:175], v[84:87], v[116:119], 0
    v_mfma_f32_16x16x32_bf16 a[228:231], v[84:87], v[120:123], 0
    v_mfma_f32_16x16x32_bf16 a[236:239], v[84:87], v[124:127], 0
    ds_read_b128 v[152:155], v49 offset:45056
    v_mfma_f32_16x16x32_bf16 a[48:51], v[88:91], v[96:99], 0
    ds_read_b64_tr_b16 v[84:85], v29 offset:16384
    v_mfma_f32_16x16x32_bf16 a[56:59], v[88:91], v[100:103], 0
    s_add_u32 m0, s64, 135168
    ds_read_b64_tr_b16 v[86:87], v29 offset:18432
    v_mfma_f32_16x16x32_bf16 a[112:115], v[88:91], v[104:107], 0
    buffer_load_dwordx4 v12, s[8:11], s66 offen offset:0 lds
    v_mfma_f32_16x16x32_bf16 a[120:123], v[88:91], v[108:111], 0
    v_mfma_f32_16x16x32_bf16 a[176:179], v[88:91], v[112:115], 0
    buffer_load_dwordx4 v13, s[8:11], s66 offen offset:1024 lds
    v_mfma_f32_16x16x32_bf16 a[184:187], v[88:91], v[116:119], 0
    ds_read_b128 v[156:159], v49 offset:47104
    v_mfma_f32_16x16x32_bf16 a[240:243], v[88:91], v[120:123], 0
    s_waitcnt lgkmcnt(15)
    v_mfma_f32_16x16x32_bf16 a[248:251], v[88:91], v[124:127], 0
    buffer_load_dwordx4 v14, s[8:11], s66 offen offset:2048 lds
    v_mfma_f32_16x16x32_bf16 a[52:55], v[92:95], v[96:99], 0
    ds_read_b64_tr_b16 v[88:89], v30 offset:16384
    v_mfma_f32_16x16x32_bf16 a[60:63], v[92:95], v[100:103], 0
    ds_read_b64_tr_b16 v[90:91], v30 offset:18432
    v_mfma_f32_16x16x32_bf16 a[116:119], v[92:95], v[104:107], 0
    v_mfma_f32_16x16x32_bf16 a[124:127], v[92:95], v[108:111], 0
    buffer_load_dwordx4 v15, s[8:11], s66 offen offset:3072 lds
    v_mfma_f32_16x16x32_bf16 a[180:183], v[92:95], v[112:115], 0
    s_add_u32 s66, s66, 128
    s_and_b32 s66, s66, 0x3ff
    v_mfma_f32_16x16x32_bf16 a[188:191], v[92:95], v[116:119], 0
    v_mfma_f32_16x16x32_bf16 a[244:247], v[92:95], v[120:123], 0
    s_waitcnt lgkmcnt(2)
    v_mfma_f32_16x16x32_bf16 a[252:255], v[92:95], v[124:127], 0
    ds_read_b64_tr_b16 v[92:93], v31 offset:16384
    ds_read_b64_tr_b16 v[94:95], v31 offset:18432
    v_mfma_f32_16x16x32_bf16 a[0:3], v[64:67], v[128:131], a[0:3]
    s_waitcnt vmcnt(11)
    v_lshlrev_b32 v184, 16, v160
    v_and_b32 v185, 0xffff0000, v160
    v_lshlrev_b32 v186, 16, v161
    v_mfma_f32_16x16x32_bf16 a[8:11], v[64:67], v[132:135], a[8:11]
    v_and_b32 v187, 0xffff0000, v161
    v_lshlrev_b32 v188, 16, v162
    v_mfma_f32_16x16x32_bf16 a[64:67], v[64:67], v[136:139], a[64:67]
    v_and_b32 v189, 0xffff0000, v162
    v_lshlrev_b32 v190, 16, v163
    v_and_b32 v191, 0xffff0000, v163
    v_mfma_f32_16x16x32_bf16 a[72:75], v[64:67], v[140:143], a[72:75]
    s_waitcnt vmcnt(10)
    v_lshlrev_b32 v192, 16, v164
    v_and_b32 v193, 0xffff0000, v164
    v_lshlrev_b32 v194, 16, v165
    v_mfma_f32_16x16x32_bf16 a[128:131], v[64:67], v[144:147], a[128:131]
    v_and_b32 v195, 0xffff0000, v165
    v_lshlrev_b32 v196, 16, v166
    v_mfma_f32_16x16x32_bf16 a[136:139], v[64:67], v[148:151], a[136:139]
    v_and_b32 v197, 0xffff0000, v166
    v_lshlrev_b32 v198, 16, v167
    v_and_b32 v199, 0xffff0000, v167
    v_mfma_f32_16x16x32_bf16 a[192:195], v[64:67], v[152:155], a[192:195]
    s_waitcnt vmcnt(9)
    v_lshlrev_b32 v200, 16, v168
    v_and_b32 v201, 0xffff0000, v168
    v_mfma_f32_16x16x32_bf16 a[200:203], v[64:67], v[156:159], a[200:203]
    v_lshlrev_b32 v202, 16, v169
    s_waitcnt lgkmcnt(0)
    s_barrier
    v_mfma_f32_16x16x32_bf16 a[4:7], v[68:71], v[128:131], a[4:7]
    ds_read_b64_tr_b16 v[64:65], v24 offset:32768
    v_and_b32 v203, 0xffff0000, v169
    v_lshlrev_b32 v204, 16, v170
    v_mfma_f32_16x16x32_bf16 a[12:15], v[68:71], v[132:135], a[12:15]
    s_add_u32 m0, s64, 65536
    ds_read_b64_tr_b16 v[66:67], v24 offset:34816
    v_and_b32 v205, 0xffff0000, v170
    v_mfma_f32_16x16x32_bf16 a[68:71], v[68:71], v[136:139], a[68:71]
    buffer_load_dwordx4 v16, s[12:15], s67 offen offset:0 lds
    v_mfma_f32_16x16x32_bf16 a[76:79], v[68:71], v[140:143], a[76:79]
    ds_read_b128 v[96:99], v48 offset:0
    v_lshlrev_b32 v206, 16, v171
    v_mfma_f32_16x16x32_bf16 a[132:135], v[68:71], v[144:147], a[132:135]
    buffer_load_dwordx4 v17, s[12:15], s67 offen offset:1024 lds
    v_mfma_f32_16x16x32_bf16 a[140:143], v[68:71], v[148:151], a[140:143]
    v_and_b32 v207, 0xffff0000, v171
    v_mfma_f32_16x16x32_bf16 a[196:199], v[68:71], v[152:155], a[196:199]
    s_waitcnt vmcnt(10)
    v_lshlrev_b32 v208, 16, v172
    v_and_b32 v209, 0xffff0000, v172
    v_lshlrev_b32 v210, 16, v173
    v_mfma_f32_16x16x32_bf16 a[204:207], v[68:71], v[156:159], a[204:207]
    buffer_load_dwordx4 v18, s[12:15], s67 offen offset:2048 lds
    v_mfma_f32_16x16x32_bf16 a[16:19], v[72:75], v[128:131], a[16:19]
    ds_read_b64_tr_b16 v[68:69], v25 offset:32768
    v_mfma_f32_16x16x32_bf16 a[24:27], v[72:75], v[132:135], a[24:27]
    ds_read_b64_tr_b16 v[70:71], v25 offset:34816
    ds_read_b128 v[100:103], v48 offset:2048
    v_and_b32 v211, 0xffff0000, v173
    v_mfma_f32_16x16x32_bf16 a[80:83], v[72:75], v[136:139], a[80:83]
    buffer_load_dwordx4 v19, s[12:15], s67 offen offset:3072 lds
    v_mfma_f32_16x16x32_bf16 a[88:91], v[72:75], v[140:143], a[88:91]
    s_add_u32 m0, s64, 69632
    v_lshlrev_b32 v212, 16, v174
    v_and_b32 v213, 0xffff0000, v174
    v_mfma_f32_16x16x32_bf16 a[144:147], v[72:75], v[144:147], a[144:147]
    buffer_load_dwordx4 v20, s[12:15], s67 offen offset:0 lds
    v_mfma_f32_16x16x32_bf16 a[152:155], v[72:75], v[148:151], a[152:155]
    v_lshlrev_b32 v214, 16, v175
    v_mfma_f32_16x16x32_bf16 a[208:211], v[72:75], v[152:155], a[208:211]
    v_and_b32 v215, 0xffff0000, v175
    v_add_f32 v216, v184, v185
    v_mul_f32 v217, v184, v184
    v_mfma_f32_16x16x32_bf16 a[216:219], v[72:75], v[156:159], a[216:219]
    ds_read_b128 v[104:107], v48 offset:4096
    v_fmac_f32 v217, v185, v185
    v_mfma_f32_16x16x32_bf16 a[20:23], v[76:79], v[128:131], a[20:23]
    ds_read_b64_tr_b16 v[72:73], v26 offset:32768
    v_add_f32 v216, v216, v186
    v_fmac_f32 v217, v186, v186
    v_mfma_f32_16x16x32_bf16 a[28:31], v[76:79], v[132:135], a[28:31]
    ds_read_b64_tr_b16 v[74:75], v26 offset:34816
    v_add_f32 v216, v216, v187
    v_fmac_f32 v217, v187, v187
    v_mfma_f32_16x16x32_bf16 a[84:87], v[76:79], v[136:139], a[84:87]
    buffer_load_dwordx4 v21, s[12:15], s67 offen offset:1024 lds
    v_mfma_f32_16x16x32_bf16 a[92:95], v[76:79], v[140:143], a[92:95]
    buffer_load_dwordx4 v22, s[12:15], s67 offen offset:2048 lds
    v_mfma_f32_16x16x32_bf16 a[148:151], v[76:79], v[144:147], a[148:151]
    buffer_load_dwordx4 v23, s[12:15], s67 offen offset:3072 lds
    v_mfma_f32_16x16x32_bf16 a[156:159], v[76:79], v[148:151], a[156:159]
    s_add_u32 s67, s67, 524288
    s_and_b32 s67, s67, 0x3fffff
    ds_read_b128 v[108:111], v48 offset:6144
    v_mfma_f32_16x16x32_bf16 a[212:215], v[76:79], v[152:155], a[212:215]
    v_mfma_f32_16x16x32_bf16 a[220:223], v[76:79], v[156:159], a[220:223]
    v_add_f32 v216, v216, v188
    v_fmac_f32 v217, v188, v188
    v_mfma_f32_16x16x32_bf16 a[32:35], v[80:83], v[128:131], a[32:35]
    ds_read_b64_tr_b16 v[76:77], v27 offset:32768
    v_add_f32 v216, v216, v189
    v_fmac_f32 v217, v189, v189
    v_mfma_f32_16x16x32_bf16 a[40:43], v[80:83], v[132:135], a[40:43]
    ds_read_b64_tr_b16 v[78:79], v27 offset:34816
    v_add_f32 v216, v216, v190
    v_fmac_f32 v217, v190, v190
    v_mfma_f32_16x16x32_bf16 a[96:99], v[80:83], v[136:139], a[96:99]
    buffer_load_dword v37, v39, s[8:11], s78 offen
    v_mfma_f32_16x16x32_bf16 a[104:107], v[80:83], v[140:143], a[104:107]
    ds_read_b128 v[112:115], v48 offset:8192
    v_mfma_f32_16x16x32_bf16 a[160:163], v[80:83], v[144:147], a[160:163]
    s_add_u32 m0, s64, 32768
    v_add_f32 v216, v216, v191
    v_fmac_f32 v217, v191, v191
    v_add_f32 v216, v216, v192
    v_mfma_f32_16x16x32_bf16 a[168:171], v[80:83], v[148:151], a[168:171]
    buffer_load_dwordx4 v8, s[8:11], s66 offen offset:0 lds
    v_mfma_f32_16x16x32_bf16 a[224:227], v[80:83], v[152:155], a[224:227]
    v_fmac_f32 v217, v192, v192
    v_add_f32 v216, v216, v193
    v_mfma_f32_16x16x32_bf16 a[232:235], v[80:83], v[156:159], a[232:235]
    v_fmac_f32 v217, v193, v193
    v_add_f32 v216, v216, v194
    v_fmac_f32 v217, v194, v194
    v_mfma_f32_16x16x32_bf16 a[36:39], v[84:87], v[128:131], a[36:39]
    ds_read_b64_tr_b16 v[80:81], v28 offset:32768
    v_add_f32 v216, v216, v195
    v_fmac_f32 v217, v195, v195
    v_mfma_f32_16x16x32_bf16 a[44:47], v[84:87], v[132:135], a[44:47]
    ds_read_b64_tr_b16 v[82:83], v28 offset:34816
    ds_read_b128 v[116:119], v48 offset:10240
    v_add_f32 v216, v216, v196
    v_mfma_f32_16x16x32_bf16 a[100:103], v[84:87], v[136:139], a[100:103]
    buffer_load_dwordx4 v9, s[8:11], s66 offen offset:1024 lds
    v_mfma_f32_16x16x32_bf16 a[108:111], v[84:87], v[140:143], a[108:111]
    buffer_load_dwordx4 v10, s[8:11], s66 offen offset:2048 lds
    v_mfma_f32_16x16x32_bf16 a[164:167], v[84:87], v[144:147], a[164:167]
    v_mfma_f32_16x16x32_bf16 a[172:175], v[84:87], v[148:151], a[172:175]
    v_fmac_f32 v217, v196, v196
    v_add_f32 v216, v216, v197
    v_fmac_f32 v217, v197, v197
    v_mfma_f32_16x16x32_bf16 a[228:231], v[84:87], v[152:155], a[228:231]
    buffer_load_dwordx4 v11, s[8:11], s66 offen offset:3072 lds
    v_mfma_f32_16x16x32_bf16 a[236:239], v[84:87], v[156:159], a[236:239]
    ds_read_b128 v[120:123], v48 offset:12288
    v_add_f32 v216, v216, v198
    v_mfma_f32_16x16x32_bf16 a[48:51], v[88:91], v[128:131], a[48:51]
    ds_read_b64_tr_b16 v[84:85], v29 offset:32768
    v_fmac_f32 v217, v198, v198
    v_add_f32 v216, v216, v199
    v_mfma_f32_16x16x32_bf16 a[56:59], v[88:91], v[132:135], a[56:59]
    s_add_u32 m0, s64, 36864
    ds_read_b64_tr_b16 v[86:87], v29 offset:34816
    v_fmac_f32 v217, v199, v199
    v_add_f32 v216, v216, v200
    v_mfma_f32_16x16x32_bf16 a[112:115], v[88:91], v[136:139], a[112:115]
    buffer_load_dwordx4 v12, s[8:11], s66 offen offset:0 lds
    v_mfma_f32_16x16x32_bf16 a[120:123], v[88:91], v[140:143], a[120:123]
    v_fmac_f32 v217, v200, v200
    v_add_f32 v216, v216, v201
    v_mfma_f32_16x16x32_bf16 a[176:179], v[88:91], v[144:147], a[176:179]
    v_fmac_f32 v217, v201, v201
    v_add_f32 v216, v216, v202
    v_mfma_f32_16x16x32_bf16 a[184:187], v[88:91], v[148:151], a[184:187]
    ds_read_b128 v[124:127], v48 offset:14336
    v_fmac_f32 v217, v202, v202
    v_add_f32 v216, v216, v203
    v_mfma_f32_16x16x32_bf16 a[240:243], v[88:91], v[152:155], a[240:243]
    buffer_load_dwordx4 v13, s[8:11], s66 offen offset:1024 lds
    v_mfma_f32_16x16x32_bf16 a[248:251], v[88:91], v[156:159], a[248:251]
    v_fmac_f32 v217, v203, v203
    v_add_f32 v216, v216, v204
    v_mfma_f32_16x16x32_bf16 a[52:55], v[92:95], v[128:131], a[52:55]
    ds_read_b64_tr_b16 v[88:89], v30 offset:32768
    v_fmac_f32 v217, v204, v204
    v_add_f32 v216, v216, v205
    v_mfma_f32_16x16x32_bf16 a[60:63], v[92:95], v[132:135], a[60:63]
    ds_read_b64_tr_b16 v[90:91], v30 offset:34816
    v_fmac_f32 v217, v205, v205
    v_add_f32 v216, v216, v206
    v_mfma_f32_16x16x32_bf16 a[116:119], v[92:95], v[136:139], a[116:119]
    buffer_load_dwordx4 v14, s[8:11], s66 offen offset:2048 lds
    v_mfma_f32_16x16x32_bf16 a[124:127], v[92:95], v[140:143], a[124:127]
    buffer_load_dwordx4 v15, s[8:11], s66 offen offset:3072 lds
    v_mfma_f32_16x16x32_bf16 a[180:183], v[92:95], v[144:147], a[180:183]
    s_add_u32 s66, s66, 128
    s_and_b32 s66, s66, 0x3ff
    v_mfma_f32_16x16x32_bf16 a[188:191], v[92:95], v[148:151], a[188:191]
    v_fmac_f32 v217, v206, v206
    v_add_f32 v216, v216, v207
    v_mfma_f32_16x16x32_bf16 a[244:247], v[92:95], v[152:155], a[244:247]
    s_waitcnt lgkmcnt(2)
    v_fmac_f32 v217, v207, v207
    v_add_f32 v216, v216, v208
    v_fmac_f32 v217, v208, v208
    v_mfma_f32_16x16x32_bf16 a[252:255], v[92:95], v[156:159], a[252:255]
    ds_read_b64_tr_b16 v[92:93], v31 offset:32768
    ds_read_b64_tr_b16 v[94:95], v31 offset:34816
    v_add_f32 v216, v216, v209
    v_mfma_f32_16x16x32_bf16 a[0:3], v[64:67], v[96:99], a[0:3]
    v_fmac_f32 v217, v209, v209
    v_add_f32 v216, v216, v210
    v_mfma_f32_16x16x32_bf16 a[8:11], v[64:67], v[100:103], a[8:11]
    v_fmac_f32 v217, v210, v210
    v_add_f32 v216, v216, v211
    v_mfma_f32_16x16x32_bf16 a[64:67], v[64:67], v[104:107], a[64:67]
    v_fmac_f32 v217, v211, v211
    v_mfma_f32_16x16x32_bf16 a[72:75], v[64:67], v[108:111], a[72:75]
    v_add_f32 v216, v216, v212
    v_fmac_f32 v217, v212, v212
    v_mfma_f32_16x16x32_bf16 a[128:131], v[64:67], v[112:115], a[128:131]
    v_add_f32 v216, v216, v213
    v_fmac_f32 v217, v213, v213
    v_mfma_f32_16x16x32_bf16 a[136:139], v[64:67], v[116:119], a[136:139]
    v_add_f32 v216, v216, v214
    v_fmac_f32 v217, v214, v214
    v_mfma_f32_16x16x32_bf16 a[192:195], v[64:67], v[120:123], a[192:195]
    v_add_f32 v216, v216, v215
    v_fmac_f32 v217, v215, v215
    v_mfma_f32_16x16x32_bf16 a[200:203], v[64:67], v[124:127], a[200:203]
    s_nop 1
    v_mfma_f32_16x16x32_bf16 a[4:7], v[68:71], v[96:99], a[4:7]
    ds_read_b64_tr_b16 v[64:65], v24 offset:49152
    v_mfma_f32_16x16x32_bf16 a[12:15], v[68:71], v[100:103], a[12:15]
    ds_read_b64_tr_b16 v[66:67], v24 offset:51200
    v_add_f32_dpp v216, v216, v216 row_ror:8 row_mask:0xf bank_mask:0xf
    v_mfma_f32_16x16x32_bf16 a[68:71], v[68:71], v[104:107], a[68:71]
    v_add_f32_dpp v217, v217, v217 row_ror:8 row_mask:0xf bank_mask:0xf
    v_mov_b32 v218, v216
    v_mfma_f32_16x16x32_bf16 a[76:79], v[68:71], v[108:111], a[76:79]
    ds_read_b128 v[128:131], v49 offset:0
    v_mov_b32 v219, v217
    v_mfma_f32_16x16x32_bf16 a[132:135], v[68:71], v[112:115], a[132:135]
    s_nop 0
    v_mfma_f32_16x16x32_bf16 a[140:143], v[68:71], v[116:119], a[140:143]
    v_permlane16_swap_b32 v216, v218
    s_nop 0
    v_mfma_f32_16x16x32_bf16 a[196:199], v[68:71], v[120:123], a[196:199]
    v_permlane16_swap_b32 v217, v219
    v_add_f32 v216, v216, v218
    v_mfma_f32_16x16x32_bf16 a[204:207], v[68:71], v[124:127], a[204:207]
    v_add_f32 v217, v217, v219
    v_mov_b32 v218, v216
    v_mfma_f32_16x16x32_bf16 a[16:19], v[72:75], v[96:99], a[16:19]
    ds_read_b64_tr_b16 v[68:69], v25 offset:49152
    v_mov_b32 v219, v217
    v_mfma_f32_16x16x32_bf16 a[24:27], v[72:75], v[100:103], a[24:27]
    ds_read_b64_tr_b16 v[70:71], v25 offset:51200
    ds_read_b128 v[132:135], v49 offset:2048
    v_mfma_f32_16x16x32_bf16 a[80:83], v[72:75], v[104:107], a[80:83]
    s_nop 0
    v_mfma_f32_16x16x32_bf16 a[88:91], v[72:75], v[108:111], a[88:91]
    v_permlane32_swap_b32 v216, v218
    s_nop 0
    v_mfma_f32_16x16x32_bf16 a[144:147], v[72:75], v[112:115], a[144:147]
    v_permlane32_swap_b32 v217, v219
    v_add_f32 v216, v216, v218
    v_mfma_f32_16x16x32_bf16 a[152:155], v[72:75], v[116:119], a[152:155]
    v_add_f32 v217, v217, v219
    s_lshl_b32 s5, s2, 7
    v_mfma_f32_16x16x32_bf16 a[208:211], v[72:75], v[120:123], a[208:211]
    s_add_u32 s5, s5, 74186752
    v_mfma_f32_16x16x32_bf16 a[216:219], v[72:75], v[124:127], a[216:219]
    ds_read_b128 v[136:139], v49 offset:4096
    v_lshrrev_b32 v59, 2, v0
    v_mfma_f32_16x16x32_bf16 a[20:23], v[76:79], v[96:99], a[20:23]
    ds_read_b64_tr_b16 v[72:73], v26 offset:49152
    v_min_u32 v59, 1, v59
    v_mfma_f32_16x16x32_bf16 a[28:31], v[76:79], v[100:103], a[28:31]
    ds_read_b64_tr_b16 v[74:75], v26 offset:51200
    v_lshlrev_b32 v59, 30, v59
    v_mfma_f32_16x16x32_bf16 a[84:87], v[76:79], v[104:107], a[84:87]
    v_lshl_add_u32 v58, v0, 15, v59
    v_mov_b32 v59, 0
    v_mfma_f32_16x16x32_bf16 a[92:95], v[76:79], v[108:111], a[92:95]
    v_mfma_f32_16x16x32_bf16 a[148:151], v[76:79], v[112:115], a[148:151]
    buffer_store_dword v59, v58, s[16:19], s5 offen sc1
    v_mfma_f32_16x16x32_bf16 a[156:159], v[76:79], v[116:119], a[156:159]
    ds_read_b128 v[140:143], v49 offset:6144
    v_mfma_f32_16x16x32_bf16 a[212:215], v[76:79], v[120:123], a[212:215]
    buffer_store_dwordx2 v[216:217], v55, s[16:19], 0 offen
    v_mfma_f32_16x16x32_bf16 a[220:223], v[76:79], v[124:127], a[220:223]
    v_mfma_f32_16x16x32_bf16 a[32:35], v[80:83], v[96:99], a[32:35]
    ds_read_b64_tr_b16 v[76:77], v27 offset:49152
    v_mfma_f32_16x16x32_bf16 a[40:43], v[80:83], v[100:103], a[40:43]
    ds_read_b64_tr_b16 v[78:79], v27 offset:51200
    v_mfma_f32_16x16x32_bf16 a[96:99], v[80:83], v[104:107], a[96:99]
    v_mfma_f32_16x16x32_bf16 a[104:107], v[80:83], v[108:111], a[104:107]
    ds_read_b128 v[144:147], v49 offset:8192
    v_mfma_f32_16x16x32_bf16 a[160:163], v[80:83], v[112:115], a[160:163]
    v_mfma_f32_16x16x32_bf16 a[168:171], v[80:83], v[116:119], a[168:171]
    v_mfma_f32_16x16x32_bf16 a[224:227], v[80:83], v[120:123], a[224:227]
    v_mfma_f32_16x16x32_bf16 a[232:235], v[80:83], v[124:127], a[232:235]
    v_mfma_f32_16x16x32_bf16 a[36:39], v[84:87], v[96:99], a[36:39]
    ds_read_b64_tr_b16 v[80:81], v28 offset:49152
    v_mfma_f32_16x16x32_bf16 a[44:47], v[84:87], v[100:103], a[44:47]
    ds_read_b64_tr_b16 v[82:83], v28 offset:51200
    ds_read_b128 v[148:151], v49 offset:10240
    v_mfma_f32_16x16x32_bf16 a[100:103], v[84:87], v[104:107], a[100:103]
    v_mfma_f32_16x16x32_bf16 a[108:111], v[84:87], v[108:111], a[108:111]
    v_mfma_f32_16x16x32_bf16 a[164:167], v[84:87], v[112:115], a[164:167]
    v_mfma_f32_16x16x32_bf16 a[172:175], v[84:87], v[116:119], a[172:175]
    v_mfma_f32_16x16x32_bf16 a[228:231], v[84:87], v[120:123], a[228:231]
    s_waitcnt lgkmcnt(15)
    v_mfma_f32_16x16x32_bf16 a[236:239], v[84:87], v[124:127], a[236:239]
    ds_read_b128 v[152:155], v49 offset:12288
    v_mfma_f32_16x16x32_bf16 a[48:51], v[88:91], v[96:99], a[48:51]
    ds_read_b64_tr_b16 v[84:85], v29 offset:49152
    v_mfma_f32_16x16x32_bf16 a[56:59], v[88:91], v[100:103], a[56:59]
    ds_read_b64_tr_b16 v[86:87], v29 offset:51200
    v_mfma_f32_16x16x32_bf16 a[112:115], v[88:91], v[104:107], a[112:115]
    v_mfma_f32_16x16x32_bf16 a[120:123], v[88:91], v[108:111], a[120:123]
    v_mfma_f32_16x16x32_bf16 a[176:179], v[88:91], v[112:115], a[176:179]
    v_mfma_f32_16x16x32_bf16 a[184:187], v[88:91], v[116:119], a[184:187]
    ds_read_b128 v[156:159], v49 offset:14336
    v_mfma_f32_16x16x32_bf16 a[240:243], v[88:91], v[120:123], a[240:243]
    v_mfma_f32_16x16x32_bf16 a[248:251], v[88:91], v[124:127], a[248:251]
    v_mfma_f32_16x16x32_bf16 a[52:55], v[92:95], v[96:99], a[52:55]
    ds_read_b64_tr_b16 v[88:89], v30 offset:49152
    v_mfma_f32_16x16x32_bf16 a[60:63], v[92:95], v[100:103], a[60:63]
    ds_read_b64_tr_b16 v[90:91], v30 offset:51200
    v_mfma_f32_16x16x32_bf16 a[116:119], v[92:95], v[104:107], a[116:119]
    v_mfma_f32_16x16x32_bf16 a[124:127], v[92:95], v[108:111], a[124:127]
    v_mfma_f32_16x16x32_bf16 a[180:183], v[92:95], v[112:115], a[180:183]
    v_mfma_f32_16x16x32_bf16 a[188:191], v[92:95], v[116:119], a[188:191]
    v_mfma_f32_16x16x32_bf16 a[244:247], v[92:95], v[120:123], a[244:247]
    s_waitcnt lgkmcnt(2)
    v_mfma_f32_16x16x32_bf16 a[252:255], v[92:95], v[124:127], a[252:255]
    ds_read_b64_tr_b16 v[92:93], v31 offset:49152
    ds_read_b64_tr_b16 v[94:95], v31 offset:51200
    v_mfma_f32_16x16x32_bf16 a[0:3], v[64:67], v[128:131], a[0:3]
    v_mfma_f32_16x16x32_bf16 a[8:11], v[64:67], v[132:135], a[8:11]
    v_mfma_f32_16x16x32_bf16 a[64:67], v[64:67], v[136:139], a[64:67]
    v_mfma_f32_16x16x32_bf16 a[72:75], v[64:67], v[140:143], a[72:75]
    v_mfma_f32_16x16x32_bf16 a[128:131], v[64:67], v[144:147], a[128:131]
    v_mfma_f32_16x16x32_bf16 a[136:139], v[64:67], v[148:151], a[136:139]
    v_mfma_f32_16x16x32_bf16 a[192:195], v[64:67], v[152:155], a[192:195]
    v_mfma_f32_16x16x32_bf16 a[200:203], v[64:67], v[156:159], a[200:203]
    s_waitcnt vmcnt(0) lgkmcnt(0)
    s_barrier
    v_mfma_f32_16x16x32_bf16 a[4:7], v[68:71], v[128:131], a[4:7]
    ds_read_b64_tr_b16 v[64:65], v24 offset:0
    v_mfma_f32_16x16x32_bf16 a[12:15], v[68:71], v[132:135], a[12:15]
    s_add_u32 m0, s64, 98304
    ds_read_b64_tr_b16 v[66:67], v24 offset:2048
    v_mfma_f32_16x16x32_bf16 a[68:71], v[68:71], v[136:139], a[68:71]
    buffer_load_dwordx4 v16, s[12:15], s67 offen offset:0 lds
    v_mfma_f32_16x16x32_bf16 a[76:79], v[68:71], v[140:143], a[76:79]
    ds_read_b128 v[96:99], v50 offset:0
    v_mfma_f32_16x16x32_bf16 a[132:135], v[68:71], v[144:147], a[132:135]
    buffer_load_dwordx4 v17, s[12:15], s67 offen offset:1024 lds
    v_mfma_f32_16x16x32_bf16 a[140:143], v[68:71], v[148:151], a[140:143]
    v_mfma_f32_16x16x32_bf16 a[196:199], v[68:71], v[152:155], a[196:199]
    v_mfma_f32_16x16x32_bf16 a[204:207], v[68:71], v[156:159], a[204:207]
    buffer_load_dwordx4 v18, s[12:15], s67 offen offset:2048 lds
    v_mfma_f32_16x16x32_bf16 a[16:19], v[72:75], v[128:131], a[16:19]
    ds_read_b64_tr_b16 v[68:69], v25 offset:0
    v_mfma_f32_16x16x32_bf16 a[24:27], v[72:75], v[132:135], a[24:27]
    ds_read_b64_tr_b16 v[70:71], v25 offset:2048
    ds_read_b128 v[100:103], v50 offset:2048
    v_mfma_f32_16x16x32_bf16 a[80:83], v[72:75], v[136:139], a[80:83]
    buffer_load_dwordx4 v19, s[12:15], s67 offen offset:3072 lds
    v_mfma_f32_16x16x32_bf16 a[88:91], v[72:75], v[140:143], a[88:91]
    s_add_u32 m0, s64, 102400
    v_mfma_f32_16x16x32_bf16 a[144:147], v[72:75], v[144:147], a[144:147]
    buffer_load_dwordx4 v20, s[12:15], s67 offen offset:0 lds
    v_mfma_f32_16x16x32_bf16 a[152:155], v[72:75], v[148:151], a[152:155]
    v_mfma_f32_16x16x32_bf16 a[208:211], v[72:75], v[152:155], a[208:211]
    v_mfma_f32_16x16x32_bf16 a[216:219], v[72:75], v[156:159], a[216:219]
    ds_read_b128 v[104:107], v50 offset:4096
    v_mfma_f32_16x16x32_bf16 a[20:23], v[76:79], v[128:131], a[20:23]
    ds_read_b64_tr_b16 v[72:73], v26 offset:0
    v_mfma_f32_16x16x32_bf16 a[28:31], v[76:79], v[132:135], a[28:31]
    ds_read_b64_tr_b16 v[74:75], v26 offset:2048
    v_mfma_f32_16x16x32_bf16 a[84:87], v[76:79], v[136:139], a[84:87]
    buffer_load_dwordx4 v21, s[12:15], s67 offen offset:1024 lds
    v_mfma_f32_16x16x32_bf16 a[92:95], v[76:79], v[140:143], a[92:95]
    buffer_load_dwordx4 v22, s[12:15], s67 offen offset:2048 lds
    v_mfma_f32_16x16x32_bf16 a[148:151], v[76:79], v[144:147], a[148:151]
    buffer_load_dwordx4 v23, s[12:15], s67 offen offset:3072 lds
    v_mfma_f32_16x16x32_bf16 a[156:159], v[76:79], v[148:151], a[156:159]
    s_add_u32 s67, s67, 524288
    s_and_b32 s67, s67, 0x3fffff
    ds_read_b128 v[108:111], v50 offset:6144
    v_mfma_f32_16x16x32_bf16 a[212:215], v[76:79], v[152:155], a[212:215]
    v_mfma_f32_16x16x32_bf16 a[220:223], v[76:79], v[156:159], a[220:223]
    v_mfma_f32_16x16x32_bf16 a[32:35], v[80:83], v[128:131], a[32:35]
    ds_read_b64_tr_b16 v[76:77], v27 offset:0
    v_mfma_f32_16x16x32_bf16 a[40:43], v[80:83], v[132:135], a[40:43]
    ds_read_b64_tr_b16 v[78:79], v27 offset:2048
    v_mfma_f32_16x16x32_bf16 a[96:99], v[80:83], v[136:139], a[96:99]
    buffer_load_dwordx4 v[176:179], v54, s[16:19], 0 offen offset:0 sc1
    v_mfma_f32_16x16x32_bf16 a[104:107], v[80:83], v[140:143], a[104:107]
    ds_read_b128 v[112:115], v50 offset:8192
    v_mfma_f32_16x16x32_bf16 a[160:163], v[80:83], v[144:147], a[160:163]
    buffer_load_dwordx4 v[180:183], v54, s[16:19], 0 offen offset:16 sc1
    v_mfma_f32_16x16x32_bf16 a[168:171], v[80:83], v[148:151], a[168:171]
    v_mfma_f32_16x16x32_bf16 a[224:227], v[80:83], v[152:155], a[224:227]
    s_add_u32 m0, s64, 0
    v_mfma_f32_16x16x32_bf16 a[232:235], v[80:83], v[156:159], a[232:235]
    buffer_load_dwordx4 v8, s[8:11], s66 offen offset:0 lds
    v_mfma_f32_16x16x32_bf16 a[36:39], v[84:87], v[128:131], a[36:39]
    ds_read_b64_tr_b16 v[80:81], v28 offset:0
    v_mfma_f32_16x16x32_bf16 a[44:47], v[84:87], v[132:135], a[44:47]
    ds_read_b64_tr_b16 v[82:83], v28 offset:2048
    ds_read_b128 v[116:119], v50 offset:10240
    v_mfma_f32_16x16x32_bf16 a[100:103], v[84:87], v[136:139], a[100:103]
    buffer_load_dwordx4 v9, s[8:11], s66 offen offset:1024 lds
    v_mfma_f32_16x16x32_bf16 a[108:111], v[84:87], v[140:143], a[108:111]
    v_mfma_f32_16x16x32_bf16 a[164:167], v[84:87], v[144:147], a[164:167]
    buffer_load_dwordx4 v10, s[8:11], s66 offen offset:2048 lds
    v_mfma_f32_16x16x32_bf16 a[172:175], v[84:87], v[148:151], a[172:175]
    v_mfma_f32_16x16x32_bf16 a[228:231], v[84:87], v[152:155], a[228:231]
    v_mfma_f32_16x16x32_bf16 a[236:239], v[84:87], v[156:159], a[236:239]
    ds_read_b128 v[120:123], v50 offset:12288
    v_mfma_f32_16x16x32_bf16 a[48:51], v[88:91], v[128:131], a[48:51]
    ds_read_b64_tr_b16 v[84:85], v29 offset:0
    v_mfma_f32_16x16x32_bf16 a[56:59], v[88:91], v[132:135], a[56:59]
    ds_read_b64_tr_b16 v[86:87], v29 offset:2048
    v_mfma_f32_16x16x32_bf16 a[112:115], v[88:91], v[136:139], a[112:115]
    buffer_load_dwordx4 v11, s[8:11], s66 offen offset:3072 lds
    v_mfma_f32_16x16x32_bf16 a[120:123], v[88:91], v[140:143], a[120:123]
    s_add_u32 m0, s64, 4096
    s_nop 0
    buffer_load_dwordx4 v12, s[8:11], s66 offen offset:0 lds
    v_mfma_f32_16x16x32_bf16 a[176:179], v[88:91], v[144:147], a[176:179]
    buffer_load_dwordx4 v13, s[8:11], s66 offen offset:1024 lds
    v_mfma_f32_16x16x32_bf16 a[184:187], v[88:91], v[148:151], a[184:187]
    ds_read_b128 v[124:127], v50 offset:14336
    v_mfma_f32_16x16x32_bf16 a[240:243], v[88:91], v[152:155], a[240:243]
    v_mfma_f32_16x16x32_bf16 a[248:251], v[88:91], v[156:159], a[248:251]
    buffer_load_dwordx4 v14, s[8:11], s66 offen offset:2048 lds
    v_mfma_f32_16x16x32_bf16 a[52:55], v[92:95], v[128:131], a[52:55]
    ds_read_b64_tr_b16 v[88:89], v30 offset:0
    v_mfma_f32_16x16x32_bf16 a[60:63], v[92:95], v[132:135], a[60:63]
    ds_read_b64_tr_b16 v[90:91], v30 offset:2048
    v_mfma_f32_16x16x32_bf16 a[116:119], v[92:95], v[136:139], a[116:119]
    buffer_load_dwordx4 v15, s[8:11], s66 offen offset:3072 lds
    v_mfma_f32_16x16x32_bf16 a[124:127], v[92:95], v[140:143], a[124:127]
    s_add_u32 s66, s66, 128
    s_and_b32 s66, s66, 0x3ff
    v_mfma_f32_16x16x32_bf16 a[180:183], v[92:95], v[144:147], a[180:183]
    s_cmp_lt_u32 s32, 2
    s_cbranch_scc1 fk_tc0
    buffer_load_dword v36, v40, s[72:75], 0 offen
    s_branch fk_uc0
fk_tc0:
    buffer_load_dword v36, v39, s[8:11], s79 offen
fk_uc0:
    v_mfma_f32_16x16x32_bf16 a[188:191], v[92:95], v[148:151], a[188:191]
    v_mfma_f32_16x16x32_bf16 a[244:247], v[92:95], v[152:155], a[244:247]
    s_waitcnt lgkmcnt(2)
    v_mfma_f32_16x16x32_bf16 a[252:255], v[92:95], v[156:159], a[252:255]
    ds_read_b64_tr_b16 v[92:93], v31 offset:0
    ds_read_b64_tr_b16 v[94:95], v31 offset:2048
    v_mfma_f32_16x16x32_bf16 a[0:3], v[64:67], v[96:99], a[0:3]
    v_mfma_f32_16x16x32_bf16 a[8:11], v[64:67], v[100:103], a[8:11]
    v_mfma_f32_16x16x32_bf16 a[64:67], v[64:67], v[104:107], a[64:67]
    v_mfma_f32_16x16x32_bf16 a[72:75], v[64:67], v[108:111], a[72:75]
    v_mfma_f32_16x16x32_bf16 a[128:131], v[64:67], v[112:115], a[128:131]
    v_mfma_f32_16x16x32_bf16 a[136:139], v[64:67], v[116:119], a[136:139]
    v_mfma_f32_16x16x32_bf16 a[192:195], v[64:67], v[120:123], a[192:195]
    v_mfma_f32_16x16x32_bf16 a[200:203], v[64:67], v[124:127], a[200:203]
    v_mfma_f32_16x16x32_bf16 a[4:7], v[68:71], v[96:99], a[4:7]
    ds_read_b64_tr_b16 v[64:65], v24 offset:16384
    v_mfma_f32_16x16x32_bf16 a[12:15], v[68:71], v[100:103], a[12:15]
    ds_read_b64_tr_b16 v[66:67], v24 offset:18432
    v_mfma_f32_16x16x32_bf16 a[68:71], v[68:71], v[104:107], a[68:71]
    v_mfma_f32_16x16x32_bf16 a[76:79], v[68:71], v[108:111], a[76:79]
    ds_read_b128 v[128:131], v51 offset:0
    v_mfma_f32_16x16x32_bf16 a[132:135], v[68:71], v[112:115], a[132:135]
    v_mfma_f32_16x16x32_bf16 a[140:143], v[68:71], v[116:119], a[140:143]
    v_mfma_f32_16x16x32_bf16 a[196:199], v[68:71], v[120:123], a[196:199]
    v_mfma_f32_16x16x32_bf16 a[204:207], v[68:71], v[124:127], a[204:207]
    v_mfma_f32_16x16x32_bf16 a[16:19], v[72:75], v[96:99], a[16:19]
    ds_read_b64_tr_b16 v[68:69], v25 offset:16384
    v_mfma_f32_16x16x32_bf16 a[24:27], v[72:75], v[100:103], a[24:27]
    ds_read_b64_tr_b16 v[70:71], v25 offset:18432
    ds_read_b128 v[132:135], v51 offset:2048
    v_mfma_f32_16x16x32_bf16 a[80:83], v[72:75], v[104:107], a[80:83]
    v_mfma_f32_16x16x32_bf16 a[88:91], v[72:75], v[108:111], a[88:91]
    v_mfma_f32_16x16x32_bf16 a[144:147], v[72:75], v[112:115], a[144:147]
    v_mfma_f32_16x16x32_bf16 a[152:155], v[72:75], v[116:119], a[152:155]
    v_mfma_f32_16x16x32_bf16 a[208:211], v[72:75], v[120:123], a[208:211]
    v_mfma_f32_16x16x32_bf16 a[216:219], v[72:75], v[124:127], a[216:219]
    ds_read_b128 v[136:139], v51 offset:4096
    v_mfma_f32_16x16x32_bf16 a[20:23], v[76:79], v[96:99], a[20:23]
    ds_read_b64_tr_b16 v[72:73], v26 offset:16384
    v_mfma_f32_16x16x32_bf16 a[28:31], v[76:79], v[100:103], a[28:31]
    ds_read_b64_tr_b16 v[74:75], v26 offset:18432
    v_mfma_f32_16x16x32_bf16 a[84:87], v[76:79], v[104:107], a[84:87]
    v_mfma_f32_16x16x32_bf16 a[92:95], v[76:79], v[108:111], a[92:95]
    v_mfma_f32_16x16x32_bf16 a[148:151], v[76:79], v[112:115], a[148:151]
    v_mfma_f32_16x16x32_bf16 a[156:159], v[76:79], v[116:119], a[156:159]
    ds_read_b128 v[140:143], v51 offset:6144
    v_mfma_f32_16x16x32_bf16 a[212:215], v[76:79], v[120:123], a[212:215]
    v_mfma_f32_16x16x32_bf16 a[220:223], v[76:79], v[124:127], a[220:223]
    v_mfma_f32_16x16x32_bf16 a[32:35], v[80:83], v[96:99], a[32:35]
    ds_read_b64_tr_b16 v[76:77], v27 offset:16384
    v_mfma_f32_16x16x32_bf16 a[40:43], v[80:83], v[100:103], a[40:43]
    ds_read_b64_tr_b16 v[78:79], v27 offset:18432
    v_mfma_f32_16x16x32_bf16 a[96:99], v[80:83], v[104:107], a[96:99]
    s_waitcnt vmcnt(10)
    v_add_f32 v216, v176, v178
    s_waitcnt vmcnt(9)
    v_add_f32 v218, v180, v182
    v_mfma_f32_16x16x32_bf16 a[104:107], v[80:83], v[108:111], a[104:107]
    ds_read_b128 v[144:147], v51 offset:8192
    v_mfma_f32_16x16x32_bf16 a[160:163], v[80:83], v[112:115], a[160:163]
    v_add_f32 v217, v177, v179
    v_mfma_f32_16x16x32_bf16 a[168:171], v[80:83], v[116:119], a[168:171]
    v_add_f32 v219, v181, v183
    v_mfma_f32_16x16x32_bf16 a[224:227], v[80:83], v[120:123], a[224:227]
    v_add_f32 v216, v216, v218
    v_add_f32 v217, v217, v219
    v_mfma_f32_16x16x32_bf16 a[232:235], v[80:83], v[124:127], a[232:235]
    v_mul_f32 v216, 0x3a800000, v216
    v_mfma_f32_16x16x32_bf16 a[36:39], v[84:87], v[96:99], a[36:39]
    ds_read_b64_tr_b16 v[80:81], v28 offset:16384
    v_mfma_f32_16x16x32_bf16 a[44:47], v[84:87], v[100:103], a[44:47]
    ds_read_b64_tr_b16 v[82:83], v28 offset:18432
    ds_read_b128 v[148:151], v51 offset:10240
    v_mfma_f32_16x16x32_bf16 a[100:103], v[84:87], v[104:107], a[100:103]
    v_mfma_f32_16x16x32_bf16 a[108:111], v[84:87], v[108:111], a[108:111]
    v_mul_f32 v217, 0x3a800000, v217
    v_fma_f32 v217, -v216, v216, v217
    v_mfma_f32_16x16x32_bf16 a[164:167], v[84:87], v[112:115], a[164:167]
    v_max_f32 v217, 0, v217
    v_mfma_f32_16x16x32_bf16 a[172:175], v[84:87], v[116:119], a[172:175]
    v_add_f32 v217, 0x3727c5ac, v217
    v_mfma_f32_16x16x32_bf16 a[228:231], v[84:87], v[120:123], a[228:231]
    s_waitcnt lgkmcnt(15)
    v_rsq_f32 v217, v217
    v_mfma_f32_16x16x32_bf16 a[236:239], v[84:87], v[124:127], a[236:239]
    ds_read_b128 v[152:155], v51 offset:12288
    v_mfma_f32_16x16x32_bf16 a[48:51], v[88:91], v[96:99], a[48:51]
    ds_read_b64_tr_b16 v[84:85], v29 offset:16384
    v_mfma_f32_16x16x32_bf16 a[56:59], v[88:91], v[100:103], a[56:59]
    ds_read_b64_tr_b16 v[86:87], v29 offset:18432
    v_mfma_f32_16x16x32_bf16 a[112:115], v[88:91], v[104:107], a[112:115]
    s_nop 0
    v_mfma_f32_16x16x32_bf16 a[120:123], v[88:91], v[108:111], a[120:123]
    v_mul_f32 v217, 0x3e0293ee, v217
    v_mfma_f32_16x16x32_bf16 a[176:179], v[88:91], v[112:115], a[176:179]
    v_mul_f32 v216, v216, v217
    v_fma_f32 v184, v184, v217, -v216
    v_mfma_f32_16x16x32_bf16 a[184:187], v[88:91], v[116:119], a[184:187]
    ds_read_b128 v[156:159], v51 offset:14336
    v_mfma_f32_16x16x32_bf16 a[240:243], v[88:91], v[120:123], a[240:243]
    v_fma_f32 v185, v185, v217, -v216
    v_mfma_f32_16x16x32_bf16 a[248:251], v[88:91], v[124:127], a[248:251]
    v_cvt_pk_bf16_f32 v160, v184, v185
    v_mfma_f32_16x16x32_bf16 a[52:55], v[92:95], v[96:99], a[52:55]
    ds_read_b64_tr_b16 v[88:89], v30 offset:16384
    v_mfma_f32_16x16x32_bf16 a[60:63], v[92:95], v[100:103], a[60:63]
    ds_read_b64_tr_b16 v[90:91], v30 offset:18432
    v_fma_f32 v186, v186, v217, -v216
    v_mfma_f32_16x16x32_bf16 a[116:119], v[92:95], v[104:107], a[116:119]
    v_fma_f32 v187, v187, v217, -v216
    v_mfma_f32_16x16x32_bf16 a[124:127], v[92:95], v[108:111], a[124:127]
    v_cvt_pk_bf16_f32 v161, v186, v187
    v_mfma_f32_16x16x32_bf16 a[180:183], v[92:95], v[112:115], a[180:183]
    v_fma_f32 v188, v188, v217, -v216
    v_mfma_f32_16x16x32_bf16 a[188:191], v[92:95], v[116:119], a[188:191]
    v_fma_f32 v189, v189, v217, -v216
    v_cvt_pk_bf16_f32 v162, v188, v189
    v_mfma_f32_16x16x32_bf16 a[244:247], v[92:95], v[120:123], a[244:247]
    s_waitcnt lgkmcnt(2)
    v_mfma_f32_16x16x32_bf16 a[252:255], v[92:95], v[124:127], a[252:255]
    ds_read_b64_tr_b16 v[92:93], v31 offset:16384
    ds_read_b64_tr_b16 v[94:95], v31 offset:18432
    v_mfma_f32_16x16x32_bf16 a[0:3], v[64:67], v[128:131], a[0:3]
    v_fma_f32 v190, v190, v217, -v216
    v_fma_f32 v191, v191, v217, -v216
    v_mfma_f32_16x16x32_bf16 a[8:11], v[64:67], v[132:135], a[8:11]
    v_cvt_pk_bf16_f32 v163, v190, v191
    s_mov_b32 s5, 0
    v_mfma_f32_16x16x32_bf16 a[64:67], v[64:67], v[136:139], a[64:67]
    buffer_store_dwordx4 v[160:163], v56, s[16:19], s5 offen sc1
    v_mfma_f32_16x16x32_bf16 a[72:75], v[64:67], v[140:143], a[72:75]
    v_fma_f32 v192, v192, v217, -v216
    v_mfma_f32_16x16x32_bf16 a[128:131], v[64:67], v[144:147], a[128:131]
    v_fma_f32 v193, v193, v217, -v216
    v_cvt_pk_bf16_f32 v164, v192, v193
    v_fma_f32 v194, v194, v217, -v216
    v_mfma_f32_16x16x32_bf16 a[136:139], v[64:67], v[148:151], a[136:139]
    v_fma_f32 v195, v195, v217, -v216
    v_cvt_pk_bf16_f32 v165, v194, v195
    v_mfma_f32_16x16x32_bf16 a[192:195], v[64:67], v[152:155], a[192:195]
    v_fma_f32 v196, v196, v217, -v216
    v_fma_f32 v197, v197, v217, -v216
    v_mfma_f32_16x16x32_bf16 a[200:203], v[64:67], v[156:159], a[200:203]
    s_waitcnt lgkmcnt(0)
    s_barrier
    v_mfma_f32_16x16x32_bf16 a[4:7], v[68:71], v[128:131], a[4:7]
    ds_read_b64_tr_b16 v[64:65], v24 offset:32768
    v_cvt_pk_bf16_f32 v166, v196, v197
    v_fma_f32 v198, v198, v217, -v216
    v_mfma_f32_16x16x32_bf16 a[12:15], v[68:71], v[132:135], a[12:15]
    s_add_u32 m0, s64, 65536
    ds_read_b64_tr_b16 v[66:67], v24 offset:34816
    v_fma_f32 v199, v199, v217, -v216
    v_mfma_f32_16x16x32_bf16 a[68:71], v[68:71], v[136:139], a[68:71]
    buffer_load_dwordx4 v16, s[12:15], s67 offen offset:0 lds
    v_mfma_f32_16x16x32_bf16 a[76:79], v[68:71], v[140:143], a[76:79]
    ds_read_b128 v[96:99], v48 offset:32768
    v_mfma_f32_16x16x32_bf16 a[132:135], v[68:71], v[144:147], a[132:135]
    buffer_load_dwordx4 v17, s[12:15], s67 offen offset:1024 lds
    v_mfma_f32_16x16x32_bf16 a[140:143], v[68:71], v[148:151], a[140:143]
    v_mfma_f32_16x16x32_bf16 a[196:199], v[68:71], v[152:155], a[196:199]
    v_cvt_pk_bf16_f32 v167, v198, v199
    s_mov_b32 s5, 4096
    v_mfma_f32_16x16x32_bf16 a[204:207], v[68:71], v[156:159], a[204:207]
    buffer_load_dwordx4 v18, s[12:15], s67 offen offset:2048 lds
    v_mfma_f32_16x16x32_bf16 a[16:19], v[72:75], v[128:131], a[16:19]
    ds_read_b64_tr_b16 v[68:69], v25 offset:32768
    v_mfma_f32_16x16x32_bf16 a[24:27], v[72:75], v[132:135], a[24:27]
    ds_read_b64_tr_b16 v[70:71], v25 offset:34816
    ds_read_b128 v[100:103], v48 offset:34816
    v_mfma_f32_16x16x32_bf16 a[80:83], v[72:75], v[136:139], a[80:83]
    buffer_load_dwordx4 v19, s[12:15], s67 offen offset:3072 lds
    v_mfma_f32_16x16x32_bf16 a[88:91], v[72:75], v[140:143], a[88:91]
    s_add_u32 m0, s64, 69632
    v_mfma_f32_16x16x32_bf16 a[144:147], v[72:75], v[144:147], a[144:147]
    buffer_load_dwordx4 v20, s[12:15], s67 offen offset:0 lds
    v_mfma_f32_16x16x32_bf16 a[152:155], v[72:75], v[148:151], a[152:155]
    buffer_store_dwordx4 v[164:167], v56, s[16:19], s5 offen sc1
    v_mfma_f32_16x16x32_bf16 a[208:211], v[72:75], v[152:155], a[208:211]
    v_fma_f32 v200, v200, v217, -v216
    v_mfma_f32_16x16x32_bf16 a[216:219], v[72:75], v[156:159], a[216:219]
    ds_read_b128 v[104:107], v48 offset:36864
    v_fma_f32 v201, v201, v217, -v216
    v_mfma_f32_16x16x32_bf16 a[20:23], v[76:79], v[128:131], a[20:23]
    ds_read_b64_tr_b16 v[72:73], v26 offset:32768
    v_cvt_pk_bf16_f32 v168, v200, v201
    v_mfma_f32_16x16x32_bf16 a[28:31], v[76:79], v[132:135], a[28:31]
    ds_read_b64_tr_b16 v[74:75], v26 offset:34816
    v_fma_f32 v202, v202, v217, -v216
    v_fma_f32 v203, v203, v217, -v216
    v_mfma_f32_16x16x32_bf16 a[84:87], v[76:79], v[136:139], a[84:87]
    buffer_load_dwordx4 v21, s[12:15], s67 offen offset:1024 lds
    v_mfma_f32_16x16x32_bf16 a[92:95], v[76:79], v[140:143], a[92:95]
    buffer_load_dwordx4 v22, s[12:15], s67 offen offset:2048 lds
    v_mfma_f32_16x16x32_bf16 a[148:151], v[76:79], v[144:147], a[148:151]
    buffer_load_dwordx4 v23, s[12:15], s67 offen offset:3072 lds
    v_mfma_f32_16x16x32_bf16 a[156:159], v[76:79], v[148:151], a[156:159]
    s_add_u32 s67, s67, 524288
    s_and_b32 s67, s67, 0x3fffff
    ds_read_b128 v[108:111], v48 offset:38912
    v_mfma_f32_16x16x32_bf16 a[212:215], v[76:79], v[152:155], a[212:215]
    v_mfma_f32_16x16x32_bf16 a[220:223], v[76:79], v[156:159], a[220:223]
    v_mfma_f32_16x16x32_bf16 a[32:35], v[80:83], v[128:131], a[32:35]
    ds_read_b64_tr_b16 v[76:77], v27 offset:32768
    v_cvt_pk_bf16_f32 v169, v202, v203
    v_mfma_f32_16x16x32_bf16 a[40:43], v[80:83], v[132:135], a[40:43]
    s_add_u32 m0, s64, 131072
    ds_read_b64_tr_b16 v[78:79], v27 offset:34816
    v_fma_f32 v204, v204, v217, -v216
    v_fma_f32 v205, v205, v217, -v216
    v_mfma_f32_16x16x32_bf16 a[96:99], v[80:83], v[136:139], a[96:99]
    buffer_load_dwordx4 v8, s[8:11], s66 offen offset:0 lds
    v_mfma_f32_16x16x32_bf16 a[104:107], v[80:83], v[140:143], a[104:107]
    ds_read_b128 v[112:115], v48 offset:40960
    v_mfma_f32_16x16x32_bf16 a[160:163], v[80:83], v[144:147], a[160:163]
    v_cvt_pk_bf16_f32 v170, v204, v205
    v_fma_f32 v206, v206, v217, -v216
    v_mfma_f32_16x16x32_bf16 a[168:171], v[80:83], v[148:151], a[168:171]
    buffer_load_dwordx4 v9, s[8:11], s66 offen offset:1024 lds
    v_mfma_f32_16x16x32_bf16 a[224:227], v[80:83], v[152:155], a[224:227]
    v_fma_f32 v207, v207, v217, -v216
    v_mfma_f32_16x16x32_bf16 a[232:235], v[80:83], v[156:159], a[232:235]
    v_cvt_pk_bf16_f32 v171, v206, v207
    s_mov_b32 s5, 8192
    v_mfma_f32_16x16x32_bf16 a[36:39], v[84:87], v[128:131], a[36:39]
    ds_read_b64_tr_b16 v[80:81], v28 offset:32768
    v_mfma_f32_16x16x32_bf16 a[44:47], v[84:87], v[132:135], a[44:47]
    ds_read_b64_tr_b16 v[82:83], v28 offset:34816
    ds_read_b128 v[116:119], v48 offset:43008
    v_mfma_f32_16x16x32_bf16 a[100:103], v[84:87], v[136:139], a[100:103]
    buffer_load_dwordx4 v10, s[8:11], s66 offen offset:2048 lds
    v_mfma_f32_16x16x32_bf16 a[108:111], v[84:87], v[140:143], a[108:111]
    buffer_store_dwordx4 v[168:171], v56, s[16:19], s5 offen sc1
    v_mfma_f32_16x16x32_bf16 a[164:167], v[84:87], v[144:147], a[164:167]
    buffer_load_dwordx4 v11, s[8:11], s66 offen offset:3072 lds
    v_mfma_f32_16x16x32_bf16 a[172:175], v[84:87], v[148:151], a[172:175]
    v_mfma_f32_16x16x32_bf16 a[228:231], v[84:87], v[152:155], a[228:231]
    v_fma_f32 v208, v208, v217, -v216
    v_fma_f32 v209, v209, v217, -v216
    v_mfma_f32_16x16x32_bf16 a[236:239], v[84:87], v[156:159], a[236:239]
    ds_read_b128 v[120:123], v48 offset:45056
    v_cvt_pk_bf16_f32 v172, v208, v209
    v_mfma_f32_16x16x32_bf16 a[48:51], v[88:91], v[128:131], a[48:51]
    ds_read_b64_tr_b16 v[84:85], v29 offset:32768
    v_fma_f32 v210, v210, v217, -v216
    v_mfma_f32_16x16x32_bf16 a[56:59], v[88:91], v[132:135], a[56:59]
    s_add_u32 m0, s64, 135168
    ds_read_b64_tr_b16 v[86:87], v29 offset:34816
    v_fma_f32 v211, v211, v217, -v216
    v_cvt_pk_bf16_f32 v173, v210, v211
    v_mfma_f32_16x16x32_bf16 a[112:115], v[88:91], v[136:139], a[112:115]
    buffer_load_dwordx4 v12, s[8:11], s66 offen offset:0 lds
    v_mfma_f32_16x16x32_bf16 a[120:123], v[88:91], v[140:143], a[120:123]
    v_mfma_f32_16x16x32_bf16 a[176:179], v[88:91], v[144:147], a[176:179]
    buffer_load_dwordx4 v13, s[8:11], s66 offen offset:1024 lds
    v_mfma_f32_16x16x32_bf16 a[184:187], v[88:91], v[148:151], a[184:187]
    ds_read_b128 v[124:127], v48 offset:47104
    v_mfma_f32_16x16x32_bf16 a[240:243], v[88:91], v[152:155], a[240:243]
    v_fma_f32 v212, v212, v217, -v216
    v_fma_f32 v213, v213, v217, -v216
    v_cvt_pk_bf16_f32 v174, v212, v213
    v_mfma_f32_16x16x32_bf16 a[248:251], v[88:91], v[156:159], a[248:251]
    buffer_load_dwordx4 v14, s[8:11], s66 offen offset:2048 lds
    v_mfma_f32_16x16x32_bf16 a[52:55], v[92:95], v[128:131], a[52:55]
    ds_read_b64_tr_b16 v[88:89], v30 offset:32768
    v_mfma_f32_16x16x32_bf16 a[60:63], v[92:95], v[132:135], a[60:63]
    ds_read_b64_tr_b16 v[90:91], v30 offset:34816
    v_fma_f32 v214, v214, v217, -v216
    v_mfma_f32_16x16x32_bf16 a[116:119], v[92:95], v[136:139], a[116:119]
    v_fma_f32 v215, v215, v217, -v216
    v_cvt_pk_bf16_f32 v175, v214, v215
    v_mfma_f32_16x16x32_bf16 a[124:127], v[92:95], v[140:143], a[124:127]
    buffer_load_dwordx4 v15, s[8:11], s66 offen offset:3072 lds
    v_mfma_f32_16x16x32_bf16 a[180:183], v[92:95], v[144:147], a[180:183]
    s_add_u32 s66, s66, 128
    s_and_b32 s66, s66, 0x3ff
    v_mfma_f32_16x16x32_bf16 a[188:191], v[92:95], v[148:151], a[188:191]
    s_mov_b32 s5, 12288
    v_mfma_f32_16x16x32_bf16 a[244:247], v[92:95], v[152:155], a[244:247]
    s_waitcnt lgkmcnt(2)
    buffer_store_dwordx4 v[172:175], v56, s[16:19], s5 offen sc1
    v_mfma_f32_16x16x32_bf16 a[252:255], v[92:95], v[156:159], a[252:255]
    ds_read_b64_tr_b16 v[92:93], v31 offset:32768
    ds_read_b64_tr_b16 v[94:95], v31 offset:34816
    v_mfma_f32_16x16x32_bf16 a[0:3], v[64:67], v[96:99], a[0:3]
    v_mfma_f32_16x16x32_bf16 a[8:11], v[64:67], v[100:103], a[8:11]
    v_mfma_f32_16x16x32_bf16 a[64:67], v[64:67], v[104:107], a[64:67]
    v_mfma_f32_16x16x32_bf16 a[72:75], v[64:67], v[108:111], a[72:75]
    v_mfma_f32_16x16x32_bf16 a[128:131], v[64:67], v[112:115], a[128:131]
    v_mfma_f32_16x16x32_bf16 a[136:139], v[64:67], v[116:119], a[136:139]
    v_mfma_f32_16x16x32_bf16 a[192:195], v[64:67], v[120:123], a[192:195]
    v_mfma_f32_16x16x32_bf16 a[200:203], v[64:67], v[124:127], a[200:203]
    v_mfma_f32_16x16x32_bf16 a[4:7], v[68:71], v[96:99], a[4:7]
    ds_read_b64_tr_b16 v[64:65], v24 offset:49152
    v_mfma_f32_16x16x32_bf16 a[12:15], v[68:71], v[100:103], a[12:15]
    ds_read_b64_tr_b16 v[66:67], v24 offset:51200
    v_mfma_f32_16x16x32_bf16 a[68:71], v[68:71], v[104:107], a[68:71]
    v_mfma_f32_16x16x32_bf16 a[76:79], v[68:71], v[108:111], a[76:79]
    ds_read_b128 v[128:131], v49 offset:32768
    v_mfma_f32_16x16x32_bf16 a[132:135], v[68:71], v[112:115], a[132:135]
    v_mfma_f32_16x16x32_bf16 a[140:143], v[68:71], v[116:119], a[140:143]
    v_mfma_f32_16x16x32_bf16 a[196:199], v[68:71], v[120:123], a[196:199]
    v_mfma_f32_16x16x32_bf16 a[204:207], v[68:71], v[124:127], a[204:207]
    v_mfma_f32_16x16x32_bf16 a[16:19], v[72:75], v[96:99], a[16:19]
    ds_read_b64_tr_b16 v[68:69], v25 offset:49152
    v_mfma_f32_16x16x32_bf16 a[24:27], v[72:75], v[100:103], a[24:27]
    ds_read_b64_tr_b16 v[70:71], v25 offset:51200
    ds_read_b128 v[132:135], v49 offset:34816
    v_mfma_f32_16x16x32_bf16 a[80:83], v[72:75], v[104:107], a[80:83]
    v_mfma_f32_16x16x32_bf16 a[88:91], v[72:75], v[108:111], a[88:91]
    v_mfma_f32_16x16x32_bf16 a[144:147], v[72:75], v[112:115], a[144:147]
    v_mfma_f32_16x16x32_bf16 a[152:155], v[72:75], v[116:119], a[152:155]
    v_mfma_f32_16x16x32_bf16 a[208:211], v[72:75], v[120:123], a[208:211]
    v_mfma_f32_16x16x32_bf16 a[216:219], v[72:75], v[124:127], a[216:219]
    ds_read_b128 v[136:139], v49 offset:36864
    v_mfma_f32_16x16x32_bf16 a[20:23], v[76:79], v[96:99], a[20:23]
    ds_read_b64_tr_b16 v[72:73], v26 offset:49152
    v_mfma_f32_16x16x32_bf16 a[28:31], v[76:79], v[100:103], a[28:31]
    ds_read_b64_tr_b16 v[74:75], v26 offset:51200
    v_mfma_f32_16x16x32_bf16 a[84:87], v[76:79], v[104:107], a[84:87]
    v_mfma_f32_16x16x32_bf16 a[92:95], v[76:79], v[108:111], a[92:95]
    v_mfma_f32_16x16x32_bf16 a[148:151], v[76:79], v[112:115], a[148:151]
    v_mfma_f32_16x16x32_bf16 a[156:159], v[76:79], v[116:119], a[156:159]
    ds_read_b128 v[140:143], v49 offset:38912
    v_mfma_f32_16x16x32_bf16 a[212:215], v[76:79], v[120:123], a[212:215]
    v_mfma_f32_16x16x32_bf16 a[220:223], v[76:79], v[124:127], a[220:223]
    v_mfma_f32_16x16x32_bf16 a[32:35], v[80:83], v[96:99], a[32:35]
    ds_read_b64_tr_b16 v[76:77], v27 offset:49152
    v_mfma_f32_16x16x32_bf16 a[40:43], v[80:83], v[100:103], a[40:43]
    ds_read_b64_tr_b16 v[78:79], v27 offset:51200
    v_mfma_f32_16x16x32_bf16 a[96:99], v[80:83], v[104:107], a[96:99]
    v_mfma_f32_16x16x32_bf16 a[104:107], v[80:83], v[108:111], a[104:107]
    ds_read_b128 v[144:147], v49 offset:40960
    v_mfma_f32_16x16x32_bf16 a[160:163], v[80:83], v[112:115], a[160:163]
    v_mfma_f32_16x16x32_bf16 a[168:171], v[80:83], v[116:119], a[168:171]
    v_mfma_f32_16x16x32_bf16 a[224:227], v[80:83], v[120:123], a[224:227]
    v_mfma_f32_16x16x32_bf16 a[232:235], v[80:83], v[124:127], a[232:235]
    v_mfma_f32_16x16x32_bf16 a[36:39], v[84:87], v[96:99], a[36:39]
    ds_read_b64_tr_b16 v[80:81], v28 offset:49152
    v_mfma_f32_16x16x32_bf16 a[44:47], v[84:87], v[100:103], a[44:47]
    ds_read_b64_tr_b16 v[82:83], v28 offset:51200
    ds_read_b128 v[148:151], v49 offset:43008
    v_mfma_f32_16x16x32_bf16 a[100:103], v[84:87], v[104:107], a[100:103]
    v_mfma_f32_16x16x32_bf16 a[108:111], v[84:87], v[108:111], a[108:111]
    v_mfma_f32_16x16x32_bf16 a[164:167], v[84:87], v[112:115], a[164:167]
    v_mfma_f32_16x16x32_bf16 a[172:175], v[84:87], v[116:119], a[172:175]
    v_mfma_f32_16x16x32_bf16 a[228:231], v[84:87], v[120:123], a[228:231]
    s_waitcnt lgkmcnt(15)
    v_mfma_f32_16x16x32_bf16 a[236:239], v[84:87], v[124:127], a[236:239]
    ds_read_b128 v[152:155], v49 offset:45056
    v_mfma_f32_16x16x32_bf16 a[48:51], v[88:91], v[96:99], a[48:51]
    ds_read_b64_tr_b16 v[84:85], v29 offset:49152
    v_mfma_f32_16x16x32_bf16 a[56:59], v[88:91], v[100:103], a[56:59]
    ds_read_b64_tr_b16 v[86:87], v29 offset:51200
    v_mfma_f32_16x16x32_bf16 a[112:115], v[88:91], v[104:107], a[112:115]
    v_mfma_f32_16x16x32_bf16 a[120:123], v[88:91], v[108:111], a[120:123]
    v_mfma_f32_16x16x32_bf16 a[176:179], v[88:91], v[112:115], a[176:179]
    v_mfma_f32_16x16x32_bf16 a[184:187], v[88:91], v[116:119], a[184:187]
    ds_read_b128 v[156:159], v49 offset:47104
    v_mfma_f32_16x16x32_bf16 a[240:243], v[88:91], v[120:123], a[240:243]
    v_mfma_f32_16x16x32_bf16 a[248:251], v[88:91], v[124:127], a[248:251]
    v_mfma_f32_16x16x32_bf16 a[52:55], v[92:95], v[96:99], a[52:55]
    ds_read_b64_tr_b16 v[88:89], v30 offset:49152
    v_mfma_f32_16x16x32_bf16 a[60:63], v[92:95], v[100:103], a[60:63]
    ds_read_b64_tr_b16 v[90:91], v30 offset:51200
    v_mfma_f32_16x16x32_bf16 a[116:119], v[92:95], v[104:107], a[116:119]
    v_mfma_f32_16x16x32_bf16 a[124:127], v[92:95], v[108:111], a[124:127]
    v_mfma_f32_16x16x32_bf16 a[180:183], v[92:95], v[112:115], a[180:183]
    v_mfma_f32_16x16x32_bf16 a[188:191], v[92:95], v[116:119], a[188:191]
    v_mfma_f32_16x16x32_bf16 a[244:247], v[92:95], v[120:123], a[244:247]
    s_waitcnt lgkmcnt(2)
    v_mfma_f32_16x16x32_bf16 a[252:255], v[92:95], v[124:127], a[252:255]
    ds_read_b64_tr_b16 v[92:93], v31 offset:49152
    ds_read_b64_tr_b16 v[94:95], v31 offset:51200
    v_mfma_f32_16x16x32_bf16 a[0:3], v[64:67], v[128:131], a[0:3]
    v_mfma_f32_16x16x32_bf16 a[8:11], v[64:67], v[132:135], a[8:11]
    v_mfma_f32_16x16x32_bf16 a[64:67], v[64:67], v[136:139], a[64:67]
    v_mfma_f32_16x16x32_bf16 a[72:75], v[64:67], v[140:143], a[72:75]
    v_mfma_f32_16x16x32_bf16 a[128:131], v[64:67], v[144:147], a[128:131]
    v_mfma_f32_16x16x32_bf16 a[136:139], v[64:67], v[148:151], a[136:139]
    v_mfma_f32_16x16x32_bf16 a[192:195], v[64:67], v[152:155], a[192:195]
    v_mfma_f32_16x16x32_bf16 a[200:203], v[64:67], v[156:159], a[200:203]
    s_waitcnt vmcnt(0) lgkmcnt(0)
    s_barrier
    v_mfma_f32_16x16x32_bf16 a[4:7], v[68:71], v[128:131], a[4:7]
    ds_read_b64_tr_b16 v[64:65], v24 offset:0
    v_mfma_f32_16x16x32_bf16 a[12:15], v[68:71], v[132:135], a[12:15]
    s_add_u32 m0, s64, 98304
    ds_read_b64_tr_b16 v[66:67], v24 offset:2048
    v_mfma_f32_16x16x32_bf16 a[68:71], v[68:71], v[136:139], a[68:71]
    buffer_load_dwordx4 v16, s[12:15], s67 offen offset:0 lds
    v_mfma_f32_16x16x32_bf16 a[76:79], v[68:71], v[140:143], a[76:79]
    ds_read_b128 v[96:99], v48 offset:0
    v_mfma_f32_16x16x32_bf16 a[132:135], v[68:71], v[144:147], a[132:135]
    buffer_load_dwordx4 v17, s[12:15], s67 offen offset:1024 lds
    v_mfma_f32_16x16x32_bf16 a[140:143], v[68:71], v[148:151], a[140:143]
    v_mfma_f32_16x16x32_bf16 a[196:199], v[68:71], v[152:155], a[196:199]
    v_mfma_f32_16x16x32_bf16 a[204:207], v[68:71], v[156:159], a[204:207]
    buffer_load_dwordx4 v18, s[12:15], s67 offen offset:2048 lds
    v_mfma_f32_16x16x32_bf16 a[16:19], v[72:75], v[128:131], a[16:19]
    ds_read_b64_tr_b16 v[68:69], v25 offset:0
    v_mfma_f32_16x16x32_bf16 a[24:27], v[72:75], v[132:135], a[24:27]
    ds_read_b64_tr_b16 v[70:71], v25 offset:2048
    ds_read_b128 v[100:103], v48 offset:2048
    v_mfma_f32_16x16x32_bf16 a[80:83], v[72:75], v[136:139], a[80:83]
    buffer_load_dwordx4 v19, s[12:15], s67 offen offset:3072 lds
    v_mfma_f32_16x16x32_bf16 a[88:91], v[72:75], v[140:143], a[88:91]
    s_add_u32 m0, s64, 102400
    v_mfma_f32_16x16x32_bf16 a[144:147], v[72:75], v[144:147], a[144:147]
    buffer_load_dwordx4 v20, s[12:15], s67 offen offset:0 lds
    v_mfma_f32_16x16x32_bf16 a[152:155], v[72:75], v[148:151], a[152:155]
    v_mfma_f32_16x16x32_bf16 a[208:211], v[72:75], v[152:155], a[208:211]
    v_mfma_f32_16x16x32_bf16 a[216:219], v[72:75], v[156:159], a[216:219]
    ds_read_b128 v[104:107], v48 offset:4096
    v_mfma_f32_16x16x32_bf16 a[20:23], v[76:79], v[128:131], a[20:23]
    ds_read_b64_tr_b16 v[72:73], v26 offset:0
    v_mfma_f32_16x16x32_bf16 a[28:31], v[76:79], v[132:135], a[28:31]
    ds_read_b64_tr_b16 v[74:75], v26 offset:2048
    v_mfma_f32_16x16x32_bf16 a[84:87], v[76:79], v[136:139], a[84:87]
    buffer_load_dwordx4 v21, s[12:15], s67 offen offset:1024 lds
    v_mfma_f32_16x16x32_bf16 a[92:95], v[76:79], v[140:143], a[92:95]
    buffer_load_dwordx4 v22, s[12:15], s67 offen offset:2048 lds
    v_mfma_f32_16x16x32_bf16 a[148:151], v[76:79], v[144:147], a[148:151]
    buffer_load_dwordx4 v23, s[12:15], s67 offen offset:3072 lds
    v_mfma_f32_16x16x32_bf16 a[156:159], v[76:79], v[148:151], a[156:159]
    s_add_u32 s67, s67, 524288
    s_and_b32 s67, s67, 0x3fffff
    ds_read_b128 v[108:111], v48 offset:6144
    v_mfma_f32_16x16x32_bf16 a[212:215], v[76:79], v[152:155], a[212:215]
    v_mfma_f32_16x16x32_bf16 a[220:223], v[76:79], v[156:159], a[220:223]
    v_mfma_f32_16x16x32_bf16 a[32:35], v[80:83], v[128:131], a[32:35]
    ds_read_b64_tr_b16 v[76:77], v27 offset:0
    v_mfma_f32_16x16x32_bf16 a[40:43], v[80:83], v[132:135], a[40:43]
    s_add_u32 m0, s64, 32768
    ds_read_b64_tr_b16 v[78:79], v27 offset:2048
    v_mfma_f32_16x16x32_bf16 a[96:99], v[80:83], v[136:139], a[96:99]
    buffer_load_dwordx4 v8, s[8:11], s66 offen offset:0 lds
    v_mfma_f32_16x16x32_bf16 a[104:107], v[80:83], v[140:143], a[104:107]
    ds_read_b128 v[112:115], v48 offset:8192
    v_mfma_f32_16x16x32_bf16 a[160:163], v[80:83], v[144:147], a[160:163]
    buffer_load_dwordx4 v9, s[8:11], s66 offen offset:1024 lds
    v_mfma_f32_16x16x32_bf16 a[168:171], v[80:83], v[148:151], a[168:171]
    v_mfma_f32_16x16x32_bf16 a[224:227], v[80:83], v[152:155], a[224:227]
    v_mfma_f32_16x16x32_bf16 a[232:235], v[80:83], v[156:159], a[232:235]
    buffer_load_dwordx4 v10, s[8:11], s66 offen offset:2048 lds
    v_mfma_f32_16x16x32_bf16 a[36:39], v[84:87], v[128:131], a[36:39]
    ds_read_b64_tr_b16 v[80:81], v28 offset:0
    v_mfma_f32_16x16x32_bf16 a[44:47], v[84:87], v[132:135], a[44:47]
    ds_read_b64_tr_b16 v[82:83], v28 offset:2048
    ds_read_b128 v[116:119], v48 offset:10240
    v_mfma_f32_16x16x32_bf16 a[100:103], v[84:87], v[136:139], a[100:103]
    buffer_load_dwordx4 v11, s[8:11], s66 offen offset:3072 lds
    v_mfma_f32_16x16x32_bf16 a[108:111], v[84:87], v[140:143], a[108:111]
    v_mfma_f32_16x16x32_bf16 a[164:167], v[84:87], v[144:147], a[164:167]
    s_add_u32 m0, s64, 36864
    v_mfma_f32_16x16x32_bf16 a[172:175], v[84:87], v[148:151], a[172:175]
    buffer_load_dwordx4 v12, s[8:11], s66 offen offset:0 lds
    v_mfma_f32_16x16x32_bf16 a[228:231], v[84:87], v[152:155], a[228:231]
    v_mfma_f32_16x16x32_bf16 a[236:239], v[84:87], v[156:159], a[236:239]
    ds_read_b128 v[120:123], v48 offset:12288
    v_mfma_f32_16x16x32_bf16 a[48:51], v[88:91], v[128:131], a[48:51]
    ds_read_b64_tr_b16 v[84:85], v29 offset:0
    v_mfma_f32_16x16x32_bf16 a[56:59], v[88:91], v[132:135], a[56:59]
    ds_read_b64_tr_b16 v[86:87], v29 offset:2048
    v_mfma_f32_16x16x32_bf16 a[112:115], v[88:91], v[136:139], a[112:115]
    buffer_load_dwordx4 v13, s[8:11], s66 offen offset:1024 lds
    v_mfma_f32_16x16x32_bf16 a[120:123], v[88:91], v[140:143], a[120:123]
    buffer_load_dwordx4 v14, s[8:11], s66 offen offset:2048 lds
    v_mfma_f32_16x16x32_bf16 a[176:179], v[88:91], v[144:147], a[176:179]
    v_mfma_f32_16x16x32_bf16 a[184:187], v[88:91], v[148:151], a[184:187]
    ds_read_b128 v[124:127], v48 offset:14336
    v_mfma_f32_16x16x32_bf16 a[240:243], v[88:91], v[152:155], a[240:243]
    buffer_load_dwordx4 v15, s[8:11], s66 offen offset:3072 lds
    v_mfma_f32_16x16x32_bf16 a[248:251], v[88:91], v[156:159], a[248:251]
    s_add_u32 s66, s66, 128
    s_and_b32 s66, s66, 0x3ff
    v_mfma_f32_16x16x32_bf16 a[52:55], v[92:95], v[128:131], a[52:55]
    ds_read_b64_tr_b16 v[88:89], v30 offset:0
    v_mfma_f32_16x16x32_bf16 a[60:63], v[92:95], v[132:135], a[60:63]
    ds_read_b64_tr_b16 v[90:91], v30 offset:2048
    v_mfma_f32_16x16x32_bf16 a[116:119], v[92:95], v[136:139], a[116:119]
    buffer_store_byte v46, v42, s[28:31], 0 offen sc1
    v_mfma_f32_16x16x32_bf16 a[124:127], v[92:95], v[140:143], a[124:127]
    s_mov_b32 s5, 0
    v_mfma_f32_16x16x32_bf16 a[180:183], v[92:95], v[144:147], a[180:183]
    buffer_load_dword v36, v41, s[24:27], s5 offen
    v_mfma_f32_16x16x32_bf16 a[188:191], v[92:95], v[148:151], a[188:191]
    v_mfma_f32_16x16x32_bf16 a[244:247], v[92:95], v[152:155], a[244:247]
    s_waitcnt lgkmcnt(2)
    v_mfma_f32_16x16x32_bf16 a[252:255], v[92:95], v[156:159], a[252:255]
    ds_read_b64_tr_b16 v[92:93], v31 offset:0
    ds_read_b64_tr_b16 v[94:95], v31 offset:2048
    v_mfma_f32_16x16x32_bf16 a[0:3], v[64:67], v[96:99], a[0:3]
    v_mfma_f32_16x16x32_bf16 a[8:11], v[64:67], v[100:103], a[8:11]
    v_mfma_f32_16x16x32_bf16 a[64:67], v[64:67], v[104:107], a[64:67]
    v_mfma_f32_16x16x32_bf16 a[72:75], v[64:67], v[108:111], a[72:75]
    v_mfma_f32_16x16x32_bf16 a[128:131], v[64:67], v[112:115], a[128:131]
    v_mfma_f32_16x16x32_bf16 a[136:139], v[64:67], v[116:119], a[136:139]
    v_mfma_f32_16x16x32_bf16 a[192:195], v[64:67], v[120:123], a[192:195]
    v_mfma_f32_16x16x32_bf16 a[200:203], v[64:67], v[124:127], a[200:203]
    v_mfma_f32_16x16x32_bf16 a[4:7], v[68:71], v[96:99], a[4:7]
    ds_read_b64_tr_b16 v[64:65], v24 offset:16384
    v_mfma_f32_16x16x32_bf16 a[12:15], v[68:71], v[100:103], a[12:15]
    ds_read_b64_tr_b16 v[66:67], v24 offset:18432
    v_mfma_f32_16x16x32_bf16 a[68:71], v[68:71], v[104:107], a[68:71]
    v_mfma_f32_16x16x32_bf16 a[76:79], v[68:71], v[108:111], a[76:79]
    ds_read_b128 v[128:131], v49 offset:0
    v_mfma_f32_16x16x32_bf16 a[132:135], v[68:71], v[112:115], a[132:135]
    v_mfma_f32_16x16x32_bf16 a[140:143], v[68:71], v[116:119], a[140:143]
    v_mfma_f32_16x16x32_bf16 a[196:199], v[68:71], v[120:123], a[196:199]
    v_mfma_f32_16x16x32_bf16 a[204:207], v[68:71], v[124:127], a[204:207]
    v_mfma_f32_16x16x32_bf16 a[16:19], v[72:75], v[96:99], a[16:19]
    ds_read_b64_tr_b16 v[68:69], v25 offset:16384
    v_mfma_f32_16x16x32_bf16 a[24:27], v[72:75], v[100:103], a[24:27]
    ds_read_b64_tr_b16 v[70:71], v25 offset:18432
    ds_read_b128 v[132:135], v49 offset:2048
    v_mfma_f32_16x16x32_bf16 a[80:83], v[72:75], v[104:107], a[80:83]
    v_mfma_f32_16x16x32_bf16 a[88:91], v[72:75], v[108:111], a[88:91]
    v_mfma_f32_16x16x32_bf16 a[144:147], v[72:75], v[112:115], a[144:147]
    v_mfma_f32_16x16x32_bf16 a[152:155], v[72:75], v[116:119], a[152:155]
    v_mfma_f32_16x16x32_bf16 a[208:211], v[72:75], v[120:123], a[208:211]
    v_mfma_f32_16x16x32_bf16 a[216:219], v[72:75], v[124:127], a[216:219]
    ds_read_b128 v[136:139], v49 offset:4096
    v_mfma_f32_16x16x32_bf16 a[20:23], v[76:79], v[96:99], a[20:23]
    ds_read_b64_tr_b16 v[72:73], v26 offset:16384
    v_mfma_f32_16x16x32_bf16 a[28:31], v[76:79], v[100:103], a[28:31]
    ds_read_b64_tr_b16 v[74:75], v26 offset:18432
    v_mfma_f32_16x16x32_bf16 a[84:87], v[76:79], v[104:107], a[84:87]
    v_mfma_f32_16x16x32_bf16 a[92:95], v[76:79], v[108:111], a[92:95]
    v_mfma_f32_16x16x32_bf16 a[148:151], v[76:79], v[112:115], a[148:151]
    v_mfma_f32_16x16x32_bf16 a[156:159], v[76:79], v[116:119], a[156:159]
    ds_read_b128 v[140:143], v49 offset:6144
    v_mfma_f32_16x16x32_bf16 a[212:215], v[76:79], v[120:123], a[212:215]
    v_mfma_f32_16x16x32_bf16 a[220:223], v[76:79], v[124:127], a[220:223]
    v_mfma_f32_16x16x32_bf16 a[32:35], v[80:83], v[96:99], a[32:35]
    ds_read_b64_tr_b16 v[76:77], v27 offset:16384
    v_mfma_f32_16x16x32_bf16 a[40:43], v[80:83], v[100:103], a[40:43]
    ds_read_b64_tr_b16 v[78:79], v27 offset:18432
    v_mfma_f32_16x16x32_bf16 a[96:99], v[80:83], v[104:107], a[96:99]
    v_mfma_f32_16x16x32_bf16 a[104:107], v[80:83], v[108:111], a[104:107]
    ds_read_b128 v[144:147], v49 offset:8192
    v_mfma_f32_16x16x32_bf16 a[160:163], v[80:83], v[112:115], a[160:163]
    v_mfma_f32_16x16x32_bf16 a[168:171], v[80:83], v[116:119], a[168:171]
    v_mfma_f32_16x16x32_bf16 a[224:227], v[80:83], v[120:123], a[224:227]
    v_mfma_f32_16x16x32_bf16 a[232:235], v[80:83], v[124:127], a[232:235]
    v_mfma_f32_16x16x32_bf16 a[36:39], v[84:87], v[96:99], a[36:39]
    ds_read_b64_tr_b16 v[80:81], v28 offset:16384
    v_mfma_f32_16x16x32_bf16 a[44:47], v[84:87], v[100:103], a[44:47]
    ds_read_b64_tr_b16 v[82:83], v28 offset:18432
    ds_read_b128 v[148:151], v49 offset:10240
    v_mfma_f32_16x16x32_bf16 a[100:103], v[84:87], v[104:107], a[100:103]
    v_mfma_f32_16x16x32_bf16 a[108:111], v[84:87], v[108:111], a[108:111]
    v_mfma_f32_16x16x32_bf16 a[164:167], v[84:87], v[112:115], a[164:167]
    v_mfma_f32_16x16x32_bf16 a[172:175], v[84:87], v[116:119], a[172:175]
    v_mfma_f32_16x16x32_bf16 a[228:231], v[84:87], v[120:123], a[228:231]
    s_waitcnt lgkmcnt(15)
    v_mfma_f32_16x16x32_bf16 a[236:239], v[84:87], v[124:127], a[236:239]
    ds_read_b128 v[152:155], v49 offset:12288
    v_mfma_f32_16x16x32_bf16 a[48:51], v[88:91], v[96:99], a[48:51]
    ds_read_b64_tr_b16 v[84:85], v29 offset:16384
    v_mfma_f32_16x16x32_bf16 a[56:59], v[88:91], v[100:103], a[56:59]
    ds_read_b64_tr_b16 v[86:87], v29 offset:18432
    v_mfma_f32_16x16x32_bf16 a[112:115], v[88:91], v[104:107], a[112:115]
    v_mfma_f32_16x16x32_bf16 a[120:123], v[88:91], v[108:111], a[120:123]
    v_mfma_f32_16x16x32_bf16 a[176:179], v[88:91], v[112:115], a[176:179]
    v_mfma_f32_16x16x32_bf16 a[184:187], v[88:91], v[116:119], a[184:187]
    ds_read_b128 v[156:159], v49 offset:14336
    v_mfma_f32_16x16x32_bf16 a[240:243], v[88:91], v[120:123], a[240:243]
    v_mfma_f32_16x16x32_bf16 a[248:251], v[88:91], v[124:127], a[248:251]
    v_mfma_f32_16x16x32_bf16 a[52:55], v[92:95], v[96:99], a[52:55]
    ds_read_b64_tr_b16 v[88:89], v30 offset:16384
    v_mfma_f32_16x16x32_bf16 a[60:63], v[92:95], v[100:103], a[60:63]
    ds_read_b64_tr_b16 v[90:91], v30 offset:18432
    v_mfma_f32_16x16x32_bf16 a[116:119], v[92:95], v[104:107], a[116:119]
    v_mfma_f32_16x16x32_bf16 a[124:127], v[92:95], v[108:111], a[124:127]
    v_mfma_f32_16x16x32_bf16 a[180:183], v[92:95], v[112:115], a[180:183]
    v_mfma_f32_16x16x32_bf16 a[188:191], v[92:95], v[116:119], a[188:191]
    v_mfma_f32_16x16x32_bf16 a[244:247], v[92:95], v[120:123], a[244:247]
    s_waitcnt lgkmcnt(2)
    v_mfma_f32_16x16x32_bf16 a[252:255], v[92:95], v[124:127], a[252:255]
    ds_read_b64_tr_b16 v[92:93], v31 offset:16384
    ds_read_b64_tr_b16 v[94:95], v31 offset:18432
    v_mfma_f32_16x16x32_bf16 a[0:3], v[64:67], v[128:131], a[0:3]
    v_mfma_f32_16x16x32_bf16 a[8:11], v[64:67], v[132:135], a[8:11]
    v_mfma_f32_16x16x32_bf16 a[64:67], v[64:67], v[136:139], a[64:67]
    v_mfma_f32_16x16x32_bf16 a[72:75], v[64:67], v[140:143], a[72:75]
    v_mfma_f32_16x16x32_bf16 a[128:131], v[64:67], v[144:147], a[128:131]
    v_mfma_f32_16x16x32_bf16 a[136:139], v[64:67], v[148:151], a[136:139]
    v_mfma_f32_16x16x32_bf16 a[192:195], v[64:67], v[152:155], a[192:195]
    v_mfma_f32_16x16x32_bf16 a[200:203], v[64:67], v[156:159], a[200:203]
    s_waitcnt vmcnt(10) lgkmcnt(0)
    s_barrier
    v_mfma_f32_16x16x32_bf16 a[4:7], v[68:71], v[128:131], a[4:7]
    ds_read_b64_tr_b16 v[64:65], v24 offset:32768
    v_mfma_f32_16x16x32_bf16 a[12:15], v[68:71], v[132:135], a[12:15]
    s_add_u32 m0, s64, 65536
    ds_read_b64_tr_b16 v[66:67], v24 offset:34816
    v_mfma_f32_16x16x32_bf16 a[68:71], v[68:71], v[136:139], a[68:71]
    buffer_load_dwordx4 v16, s[12:15], s67 offen offset:0 lds
    v_mfma_f32_16x16x32_bf16 a[76:79], v[68:71], v[140:143], a[76:79]
    ds_read_b128 v[96:99], v50 offset:0
    v_mfma_f32_16x16x32_bf16 a[132:135], v[68:71], v[144:147], a[132:135]
    buffer_load_dwordx4 v17, s[12:15], s67 offen offset:1024 lds
    v_mfma_f32_16x16x32_bf16 a[140:143], v[68:71], v[148:151], a[140:143]
    v_mfma_f32_16x16x32_bf16 a[196:199], v[68:71], v[152:155], a[196:199]
    v_mfma_f32_16x16x32_bf16 a[204:207], v[68:71], v[156:159], a[204:207]
    buffer_load_dwordx4 v18, s[12:15], s67 offen offset:2048 lds
    v_mfma_f32_16x16x32_bf16 a[16:19], v[72:75], v[128:131], a[16:19]
    ds_read_b64_tr_b16 v[68:69], v25 offset:32768
    v_mfma_f32_16x16x32_bf16 a[24:27], v[72:75], v[132:135], a[24:27]
    ds_read_b64_tr_b16 v[70:71], v25 offset:34816
    ds_read_b128 v[100:103], v50 offset:2048
    v_mfma_f32_16x16x32_bf16 a[80:83], v[72:75], v[136:139], a[80:83]
    buffer_load_dwordx4 v19, s[12:15], s67 offen offset:3072 lds
    v_mfma_f32_16x16x32_bf16 a[88:91], v[72:75], v[140:143], a[88:91]
    s_add_u32 m0, s64, 69632
    v_mfma_f32_16x16x32_bf16 a[144:147], v[72:75], v[144:147], a[144:147]
    buffer_load_dwordx4 v20, s[12:15], s67 offen offset:0 lds
    v_mfma_f32_16x16x32_bf16 a[152:155], v[72:75], v[148:151], a[152:155]
    v_mfma_f32_16x16x32_bf16 a[208:211], v[72:75], v[152:155], a[208:211]
    v_mfma_f32_16x16x32_bf16 a[216:219], v[72:75], v[156:159], a[216:219]
    ds_read_b128 v[104:107], v50 offset:4096
    v_mfma_f32_16x16x32_bf16 a[20:23], v[76:79], v[128:131], a[20:23]
    ds_read_b64_tr_b16 v[72:73], v26 offset:32768
    v_mfma_f32_16x16x32_bf16 a[28:31], v[76:79], v[132:135], a[28:31]
    ds_read_b64_tr_b16 v[74:75], v26 offset:34816
    v_mfma_f32_16x16x32_bf16 a[84:87], v[76:79], v[136:139], a[84:87]
    buffer_load_dwordx4 v21, s[12:15], s67 offen offset:1024 lds
    v_mfma_f32_16x16x32_bf16 a[92:95], v[76:79], v[140:143], a[92:95]
    buffer_load_dwordx4 v22, s[12:15], s67 offen offset:2048 lds
    v_mfma_f32_16x16x32_bf16 a[148:151], v[76:79], v[144:147], a[148:151]
    buffer_load_dwordx4 v23, s[12:15], s67 offen offset:3072 lds
    v_mfma_f32_16x16x32_bf16 a[156:159], v[76:79], v[148:151], a[156:159]
    s_add_u32 s67, s67, 524288
    s_and_b32 s67, s67, 0x3fffff
    ds_read_b128 v[108:111], v50 offset:6144
    v_mfma_f32_16x16x32_bf16 a[212:215], v[76:79], v[152:155], a[212:215]
    v_mfma_f32_16x16x32_bf16 a[220:223], v[76:79], v[156:159], a[220:223]
    v_mfma_f32_16x16x32_bf16 a[32:35], v[80:83], v[128:131], a[32:35]
    ds_read_b64_tr_b16 v[76:77], v27 offset:32768
    v_mfma_f32_16x16x32_bf16 a[40:43], v[80:83], v[132:135], a[40:43]
    s_add_u32 m0, s64, 0
    ds_read_b64_tr_b16 v[78:79], v27 offset:34816
    v_mfma_f32_16x16x32_bf16 a[96:99], v[80:83], v[136:139], a[96:99]
    buffer_load_dwordx4 v8, s[8:11], s66 offen offset:0 lds
    v_mfma_f32_16x16x32_bf16 a[104:107], v[80:83], v[140:143], a[104:107]
    ds_read_b128 v[112:115], v50 offset:8192
    v_mfma_f32_16x16x32_bf16 a[160:163], v[80:83], v[144:147], a[160:163]
    v_mfma_f32_16x16x32_bf16 a[168:171], v[80:83], v[148:151], a[168:171]
    buffer_load_dwordx4 v9, s[8:11], s66 offen offset:1024 lds
    v_mfma_f32_16x16x32_bf16 a[224:227], v[80:83], v[152:155], a[224:227]
    v_mfma_f32_16x16x32_bf16 a[232:235], v[80:83], v[156:159], a[232:235]
    v_mfma_f32_16x16x32_bf16 a[36:39], v[84:87], v[128:131], a[36:39]
    ds_read_b64_tr_b16 v[80:81], v28 offset:32768
    v_mfma_f32_16x16x32_bf16 a[44:47], v[84:87], v[132:135], a[44:47]
    ds_read_b64_tr_b16 v[82:83], v28 offset:34816
    ds_read_b128 v[116:119], v50 offset:10240
    v_mfma_f32_16x16x32_bf16 a[100:103], v[84:87], v[136:139], a[100:103]
    buffer_load_dwordx4 v10, s[8:11], s66 offen offset:2048 lds
    v_mfma_f32_16x16x32_bf16 a[108:111], v[84:87], v[140:143], a[108:111]
    buffer_load_dwordx4 v11, s[8:11], s66 offen offset:3072 lds
    v_mfma_f32_16x16x32_bf16 a[164:167], v[84:87], v[144:147], a[164:167]
    v_mfma_f32_16x16x32_bf16 a[172:175], v[84:87], v[148:151], a[172:175]
    s_add_u32 m0, s64, 4096
    v_mfma_f32_16x16x32_bf16 a[228:231], v[84:87], v[152:155], a[228:231]
    buffer_load_dwordx4 v12, s[8:11], s66 offen offset:0 lds
    v_mfma_f32_16x16x32_bf16 a[236:239], v[84:87], v[156:159], a[236:239]
    ds_read_b128 v[120:123], v50 offset:12288
    v_mfma_f32_16x16x32_bf16 a[48:51], v[88:91], v[128:131], a[48:51]
    ds_read_b64_tr_b16 v[84:85], v29 offset:32768
    v_mfma_f32_16x16x32_bf16 a[56:59], v[88:91], v[132:135], a[56:59]
    ds_read_b64_tr_b16 v[86:87], v29 offset:34816
    v_mfma_f32_16x16x32_bf16 a[112:115], v[88:91], v[136:139], a[112:115]
    buffer_load_dwordx4 v13, s[8:11], s66 offen offset:1024 lds
    v_mfma_f32_16x16x32_bf16 a[120:123], v[88:91], v[140:143], a[120:123]
    v_mfma_f32_16x16x32_bf16 a[176:179], v[88:91], v[144:147], a[176:179]
    v_mfma_f32_16x16x32_bf16 a[184:187], v[88:91], v[148:151], a[184:187]
    ds_read_b128 v[124:127], v50 offset:14336
    v_mfma_f32_16x16x32_bf16 a[240:243], v[88:91], v[152:155], a[240:243]
    buffer_load_dwordx4 v14, s[8:11], s66 offen offset:2048 lds
    v_mfma_f32_16x16x32_bf16 a[248:251], v[88:91], v[156:159], a[248:251]
    v_mfma_f32_16x16x32_bf16 a[52:55], v[92:95], v[128:131], a[52:55]
    ds_read_b64_tr_b16 v[88:89], v30 offset:32768
    v_mfma_f32_16x16x32_bf16 a[60:63], v[92:95], v[132:135], a[60:63]
    ds_read_b64_tr_b16 v[90:91], v30 offset:34816
    v_mfma_f32_16x16x32_bf16 a[116:119], v[92:95], v[136:139], a[116:119]
    buffer_load_dwordx4 v15, s[8:11], s66 offen offset:3072 lds
    v_mfma_f32_16x16x32_bf16 a[124:127], v[92:95], v[140:143], a[124:127]
    s_add_u32 s66, s66, 128
    s_and_b32 s66, s66, 0x3ff
    s_mov_b32 s5, 32768
    buffer_load_dword v36, v41, s[24:27], s5 offen
    v_mfma_f32_16x16x32_bf16 a[180:183], v[92:95], v[144:147], a[180:183]
    v_mfma_f32_16x16x32_bf16 a[188:191], v[92:95], v[148:151], a[188:191]
    v_mfma_f32_16x16x32_bf16 a[244:247], v[92:95], v[152:155], a[244:247]
    s_waitcnt lgkmcnt(2)
    v_mfma_f32_16x16x32_bf16 a[252:255], v[92:95], v[156:159], a[252:255]
    ds_read_b64_tr_b16 v[92:93], v31 offset:32768
    ds_read_b64_tr_b16 v[94:95], v31 offset:34816
    v_mfma_f32_16x16x32_bf16 a[0:3], v[64:67], v[96:99], a[0:3]
    v_mfma_f32_16x16x32_bf16 a[8:11], v[64:67], v[100:103], a[8:11]
    v_mfma_f32_16x16x32_bf16 a[64:67], v[64:67], v[104:107], a[64:67]
    v_mfma_f32_16x16x32_bf16 a[72:75], v[64:67], v[108:111], a[72:75]
    v_mfma_f32_16x16x32_bf16 a[128:131], v[64:67], v[112:115], a[128:131]
    v_mfma_f32_16x16x32_bf16 a[136:139], v[64:67], v[116:119], a[136:139]
    v_mfma_f32_16x16x32_bf16 a[192:195], v[64:67], v[120:123], a[192:195]
    v_mfma_f32_16x16x32_bf16 a[200:203], v[64:67], v[124:127], a[200:203]
    v_mfma_f32_16x16x32_bf16 a[4:7], v[68:71], v[96:99], a[4:7]
    ds_read_b64_tr_b16 v[64:65], v24 offset:49152
    v_mfma_f32_16x16x32_bf16 a[12:15], v[68:71], v[100:103], a[12:15]
    ds_read_b64_tr_b16 v[66:67], v24 offset:51200
    v_mfma_f32_16x16x32_bf16 a[68:71], v[68:71], v[104:107], a[68:71]
    v_mfma_f32_16x16x32_bf16 a[76:79], v[68:71], v[108:111], a[76:79]
    ds_read_b128 v[128:131], v51 offset:0
    v_mfma_f32_16x16x32_bf16 a[132:135], v[68:71], v[112:115], a[132:135]
    v_mfma_f32_16x16x32_bf16 a[140:143], v[68:71], v[116:119], a[140:143]
    v_mfma_f32_16x16x32_bf16 a[196:199], v[68:71], v[120:123], a[196:199]
    v_mfma_f32_16x16x32_bf16 a[204:207], v[68:71], v[124:127], a[204:207]
    v_mfma_f32_16x16x32_bf16 a[16:19], v[72:75], v[96:99], a[16:19]
    ds_read_b64_tr_b16 v[68:69], v25 offset:49152
    v_mfma_f32_16x16x32_bf16 a[24:27], v[72:75], v[100:103], a[24:27]
    ds_read_b64_tr_b16 v[70:71], v25 offset:51200
    ds_read_b128 v[132:135], v51 offset:2048
    v_mfma_f32_16x16x32_bf16 a[80:83], v[72:75], v[104:107], a[80:83]
    v_mfma_f32_16x16x32_bf16 a[88:91], v[72:75], v[108:111], a[88:91]
    v_mfma_f32_16x16x32_bf16 a[144:147], v[72:75], v[112:115], a[144:147]
    v_mfma_f32_16x16x32_bf16 a[152:155], v[72:75], v[116:119], a[152:155]
    v_mfma_f32_16x16x32_bf16 a[208:211], v[72:75], v[120:123], a[208:211]
    v_mfma_f32_16x16x32_bf16 a[216:219], v[72:75], v[124:127], a[216:219]
    ds_read_b128 v[136:139], v51 offset:4096
    v_mfma_f32_16x16x32_bf16 a[20:23], v[76:79], v[96:99], a[20:23]
    ds_read_b64_tr_b16 v[72:73], v26 offset:49152
    v_mfma_f32_16x16x32_bf16 a[28:31], v[76:79], v[100:103], a[28:31]
    ds_read_b64_tr_b16 v[74:75], v26 offset:51200
    v_mfma_f32_16x16x32_bf16 a[84:87], v[76:79], v[104:107], a[84:87]
    v_mfma_f32_16x16x32_bf16 a[92:95], v[76:79], v[108:111], a[92:95]
    v_mfma_f32_16x16x32_bf16 a[148:151], v[76:79], v[112:115], a[148:151]
    v_mfma_f32_16x16x32_bf16 a[156:159], v[76:79], v[116:119], a[156:159]
    ds_read_b128 v[140:143], v51 offset:6144
    v_mfma_f32_16x16x32_bf16 a[212:215], v[76:79], v[120:123], a[212:215]
    v_mfma_f32_16x16x32_bf16 a[220:223], v[76:79], v[124:127], a[220:223]
    v_mfma_f32_16x16x32_bf16 a[32:35], v[80:83], v[96:99], a[32:35]
    ds_read_b64_tr_b16 v[76:77], v27 offset:49152
    v_mfma_f32_16x16x32_bf16 a[40:43], v[80:83], v[100:103], a[40:43]
    ds_read_b64_tr_b16 v[78:79], v27 offset:51200
    v_mfma_f32_16x16x32_bf16 a[96:99], v[80:83], v[104:107], a[96:99]
    s_getpc_b64 s[62:63]
ct_1:
    s_add_u32 s62, s62, fk_q-ct_1
    s_addc_u32 s63, s63, 0
    s_lshr_b32 s58, s2, 3
    s_lshl_b32 s58, s58, 10
    v_and_b32 v58, 7, v0
    v_lshl_add_u32 v58, v58, 7, s58
    v_min_u32 v58, fk_a0-fk_q-4, v58
    global_load_dword v58, v58, s[62:63]
    v_mfma_f32_16x16x32_bf16 a[104:107], v[80:83], v[108:111], a[104:107]
    ds_read_b128 v[144:147], v51 offset:8192
    v_mfma_f32_16x16x32_bf16 a[160:163], v[80:83], v[112:115], a[160:163]
    v_mfma_f32_16x16x32_bf16 a[168:171], v[80:83], v[116:119], a[168:171]
    v_mfma_f32_16x16x32_bf16 a[224:227], v[80:83], v[120:123], a[224:227]
    v_mfma_f32_16x16x32_bf16 a[232:235], v[80:83], v[124:127], a[232:235]
    v_mfma_f32_16x16x32_bf16 a[36:39], v[84:87], v[96:99], a[36:39]
    ds_read_b64_tr_b16 v[80:81], v28 offset:49152
    v_mfma_f32_16x16x32_bf16 a[44:47], v[84:87], v[100:103], a[44:47]
    ds_read_b64_tr_b16 v[82:83], v28 offset:51200
    ds_read_b128 v[148:151], v51 offset:10240
    v_mfma_f32_16x16x32_bf16 a[100:103], v[84:87], v[104:107], a[100:103]
    v_mfma_f32_16x16x32_bf16 a[108:111], v[84:87], v[108:111], a[108:111]
    v_mfma_f32_16x16x32_bf16 a[164:167], v[84:87], v[112:115], a[164:167]
    v_mfma_f32_16x16x32_bf16 a[172:175], v[84:87], v[116:119], a[172:175]
    v_mfma_f32_16x16x32_bf16 a[228:231], v[84:87], v[120:123], a[228:231]
    s_waitcnt lgkmcnt(15)
    v_mfma_f32_16x16x32_bf16 a[236:239], v[84:87], v[124:127], a[236:239]
    ds_read_b128 v[152:155], v51 offset:12288
    v_mfma_f32_16x16x32_bf16 a[48:51], v[88:91], v[96:99], a[48:51]
    ds_read_b64_tr_b16 v[84:85], v29 offset:49152
    v_mfma_f32_16x16x32_bf16 a[56:59], v[88:91], v[100:103], a[56:59]
    ds_read_b64_tr_b16 v[86:87], v29 offset:51200
    v_mfma_f32_16x16x32_bf16 a[112:115], v[88:91], v[104:107], a[112:115]
    v_mfma_f32_16x16x32_bf16 a[120:123], v[88:91], v[108:111], a[120:123]
    v_mfma_f32_16x16x32_bf16 a[176:179], v[88:91], v[112:115], a[176:179]
    v_mfma_f32_16x16x32_bf16 a[184:187], v[88:91], v[116:119], a[184:187]
    ds_read_b128 v[156:159], v51 offset:14336
    v_mfma_f32_16x16x32_bf16 a[240:243], v[88:91], v[120:123], a[240:243]
    v_mfma_f32_16x16x32_bf16 a[248:251], v[88:91], v[124:127], a[248:251]
    v_mfma_f32_16x16x32_bf16 a[52:55], v[92:95], v[96:99], a[52:55]
    ds_read_b64_tr_b16 v[88:89], v30 offset:49152
    v_mfma_f32_16x16x32_bf16 a[60:63], v[92:95], v[100:103], a[60:63]
    ds_read_b64_tr_b16 v[90:91], v30 offset:51200
    v_mfma_f32_16x16x32_bf16 a[116:119], v[92:95], v[104:107], a[116:119]
    v_mfma_f32_16x16x32_bf16 a[124:127], v[92:95], v[108:111], a[124:127]
    v_mfma_f32_16x16x32_bf16 a[180:183], v[92:95], v[112:115], a[180:183]
    v_mfma_f32_16x16x32_bf16 a[188:191], v[92:95], v[116:119], a[188:191]
    v_mfma_f32_16x16x32_bf16 a[244:247], v[92:95], v[120:123], a[244:247]
    s_waitcnt lgkmcnt(2)
    v_mfma_f32_16x16x32_bf16 a[252:255], v[92:95], v[124:127], a[252:255]
    ds_read_b64_tr_b16 v[92:93], v31 offset:49152
    ds_read_b64_tr_b16 v[94:95], v31 offset:51200
    v_mfma_f32_16x16x32_bf16 a[0:3], v[64:67], v[128:131], a[0:3]
    v_mfma_f32_16x16x32_bf16 a[8:11], v[64:67], v[132:135], a[8:11]
    v_mfma_f32_16x16x32_bf16 a[64:67], v[64:67], v[136:139], a[64:67]
    v_mfma_f32_16x16x32_bf16 a[72:75], v[64:67], v[140:143], a[72:75]
    v_mfma_f32_16x16x32_bf16 a[128:131], v[64:67], v[144:147], a[128:131]
    v_mfma_f32_16x16x32_bf16 a[136:139], v[64:67], v[148:151], a[136:139]
    v_mfma_f32_16x16x32_bf16 a[192:195], v[64:67], v[152:155], a[192:195]
    v_mfma_f32_16x16x32_bf16 a[200:203], v[64:67], v[156:159], a[200:203]
    s_waitcnt vmcnt(10) lgkmcnt(0)
    s_barrier
    v_mfma_f32_16x16x32_bf16 a[4:7], v[68:71], v[128:131], a[4:7]
    ds_read_b64_tr_b16 v[64:65], v24 offset:0
    v_mfma_f32_16x16x32_bf16 a[12:15], v[68:71], v[132:135], a[12:15]
    s_add_u32 m0, s64, 98304
    ds_read_b64_tr_b16 v[66:67], v24 offset:2048
    v_mfma_f32_16x16x32_bf16 a[68:71], v[68:71], v[136:139], a[68:71]
    buffer_load_dwordx4 v16, s[12:15], s67 offen offset:0 lds
    v_mfma_f32_16x16x32_bf16 a[76:79], v[68:71], v[140:143], a[76:79]
    ds_read_b128 v[96:99], v48 offset:32768
    v_mfma_f32_16x16x32_bf16 a[132:135], v[68:71], v[144:147], a[132:135]
    buffer_load_dwordx4 v17, s[12:15], s67 offen offset:1024 lds
    v_mfma_f32_16x16x32_bf16 a[140:143], v[68:71], v[148:151], a[140:143]
    v_mfma_f32_16x16x32_bf16 a[196:199], v[68:71], v[152:155], a[196:199]
    v_mfma_f32_16x16x32_bf16 a[204:207], v[68:71], v[156:159], a[204:207]
    buffer_load_dwordx4 v18, s[12:15], s67 offen offset:2048 lds
    v_mfma_f32_16x16x32_bf16 a[16:19], v[72:75], v[128:131], a[16:19]
    ds_read_b64_tr_b16 v[68:69], v25 offset:0
    v_mfma_f32_16x16x32_bf16 a[24:27], v[72:75], v[132:135], a[24:27]
    ds_read_b64_tr_b16 v[70:71], v25 offset:2048
    ds_read_b128 v[100:103], v48 offset:34816
    v_mfma_f32_16x16x32_bf16 a[80:83], v[72:75], v[136:139], a[80:83]
    buffer_load_dwordx4 v19, s[12:15], s67 offen offset:3072 lds
    v_mfma_f32_16x16x32_bf16 a[88:91], v[72:75], v[140:143], a[88:91]
    s_add_u32 m0, s64, 102400
    v_mfma_f32_16x16x32_bf16 a[144:147], v[72:75], v[144:147], a[144:147]
    buffer_load_dwordx4 v20, s[12:15], s67 offen offset:0 lds
    v_mfma_f32_16x16x32_bf16 a[152:155], v[72:75], v[148:151], a[152:155]
    v_mfma_f32_16x16x32_bf16 a[208:211], v[72:75], v[152:155], a[208:211]
    v_mfma_f32_16x16x32_bf16 a[216:219], v[72:75], v[156:159], a[216:219]
    ds_read_b128 v[104:107], v48 offset:36864
    v_mfma_f32_16x16x32_bf16 a[20:23], v[76:79], v[128:131], a[20:23]
    ds_read_b64_tr_b16 v[72:73], v26 offset:0
    v_mfma_f32_16x16x32_bf16 a[28:31], v[76:79], v[132:135], a[28:31]
    ds_read_b64_tr_b16 v[74:75], v26 offset:2048
    v_mfma_f32_16x16x32_bf16 a[84:87], v[76:79], v[136:139], a[84:87]
    buffer_load_dwordx4 v21, s[12:15], s67 offen offset:1024 lds
    v_mfma_f32_16x16x32_bf16 a[92:95], v[76:79], v[140:143], a[92:95]
    buffer_load_dwordx4 v22, s[12:15], s67 offen offset:2048 lds
    v_mfma_f32_16x16x32_bf16 a[148:151], v[76:79], v[144:147], a[148:151]
    buffer_load_dwordx4 v23, s[12:15], s67 offen offset:3072 lds
    v_mfma_f32_16x16x32_bf16 a[156:159], v[76:79], v[148:151], a[156:159]
    s_add_u32 s67, s67, 524288
    s_and_b32 s67, s67, 0x3fffff
    ds_read_b128 v[108:111], v48 offset:38912
    v_mfma_f32_16x16x32_bf16 a[212:215], v[76:79], v[152:155], a[212:215]
    v_mfma_f32_16x16x32_bf16 a[220:223], v[76:79], v[156:159], a[220:223]
    v_mfma_f32_16x16x32_bf16 a[32:35], v[80:83], v[128:131], a[32:35]
    ds_read_b64_tr_b16 v[76:77], v27 offset:0
    v_mfma_f32_16x16x32_bf16 a[40:43], v[80:83], v[132:135], a[40:43]
    ds_read_b64_tr_b16 v[78:79], v27 offset:2048
    v_mfma_f32_16x16x32_bf16 a[96:99], v[80:83], v[136:139], a[96:99]
    v_mfma_f32_16x16x32_bf16 a[104:107], v[80:83], v[140:143], a[104:107]
    ds_read_b128 v[112:115], v48 offset:40960
    v_mfma_f32_16x16x32_bf16 a[160:163], v[80:83], v[144:147], a[160:163]
    v_mfma_f32_16x16x32_bf16 a[168:171], v[80:83], v[148:151], a[168:171]
    v_mfma_f32_16x16x32_bf16 a[224:227], v[80:83], v[152:155], a[224:227]
    v_mfma_f32_16x16x32_bf16 a[232:235], v[80:83], v[156:159], a[232:235]
    v_mfma_f32_16x16x32_bf16 a[36:39], v[84:87], v[128:131], a[36:39]
    ds_read_b64_tr_b16 v[80:81], v28 offset:0
    v_mfma_f32_16x16x32_bf16 a[44:47], v[84:87], v[132:135], a[44:47]
    ds_read_b64_tr_b16 v[82:83], v28 offset:2048
    ds_read_b128 v[116:119], v48 offset:43008
    v_mfma_f32_16x16x32_bf16 a[100:103], v[84:87], v[136:139], a[100:103]
    v_mfma_f32_16x16x32_bf16 a[108:111], v[84:87], v[140:143], a[108:111]
    v_mfma_f32_16x16x32_bf16 a[164:167], v[84:87], v[144:147], a[164:167]
    v_mfma_f32_16x16x32_bf16 a[172:175], v[84:87], v[148:151], a[172:175]
    v_mfma_f32_16x16x32_bf16 a[228:231], v[84:87], v[152:155], a[228:231]
    v_mfma_f32_16x16x32_bf16 a[236:239], v[84:87], v[156:159], a[236:239]
    ds_read_b128 v[120:123], v48 offset:45056
    v_mfma_f32_16x16x32_bf16 a[48:51], v[88:91], v[128:131], a[48:51]
    ds_read_b64_tr_b16 v[84:85], v29 offset:0
    v_mfma_f32_16x16x32_bf16 a[56:59], v[88:91], v[132:135], a[56:59]
    ds_read_b64_tr_b16 v[86:87], v29 offset:2048
    v_mfma_f32_16x16x32_bf16 a[112:115], v[88:91], v[136:139], a[112:115]
    v_mfma_f32_16x16x32_bf16 a[120:123], v[88:91], v[140:143], a[120:123]
    v_mfma_f32_16x16x32_bf16 a[176:179], v[88:91], v[144:147], a[176:179]
    v_mfma_f32_16x16x32_bf16 a[184:187], v[88:91], v[148:151], a[184:187]
    ds_read_b128 v[124:127], v48 offset:47104
    v_mfma_f32_16x16x32_bf16 a[240:243], v[88:91], v[152:155], a[240:243]
    v_mfma_f32_16x16x32_bf16 a[248:251], v[88:91], v[156:159], a[248:251]
    v_mfma_f32_16x16x32_bf16 a[52:55], v[92:95], v[128:131], a[52:55]
    ds_read_b64_tr_b16 v[88:89], v30 offset:0
    v_mfma_f32_16x16x32_bf16 a[60:63], v[92:95], v[132:135], a[60:63]
    ds_read_b64_tr_b16 v[90:91], v30 offset:2048
    v_mfma_f32_16x16x32_bf16 a[116:119], v[92:95], v[136:139], a[116:119]
    v_mfma_f32_16x16x32_bf16 a[124:127], v[92:95], v[140:143], a[124:127]
    v_mfma_f32_16x16x32_bf16 a[180:183], v[92:95], v[144:147], a[180:183]
    v_mfma_f32_16x16x32_bf16 a[188:191], v[92:95], v[148:151], a[188:191]
    v_mfma_f32_16x16x32_bf16 a[244:247], v[92:95], v[152:155], a[244:247]
    s_waitcnt lgkmcnt(2)
    v_mfma_f32_16x16x32_bf16 a[252:255], v[92:95], v[156:159], a[252:255]
    ds_read_b64_tr_b16 v[92:93], v31 offset:0
    ds_read_b64_tr_b16 v[94:95], v31 offset:2048
    v_mfma_f32_16x16x32_bf16 a[0:3], v[64:67], v[96:99], a[0:3]
    v_lshlrev_b32 v8, 4, v1
    v_lshrrev_b32 v2, 4, v1
    v_mfma_f32_16x16x32_bf16 a[8:11], v[64:67], v[100:103], a[8:11]
    v_and_b32 v3, 15, v1
    v_lshlrev_b32 v4, 4, v3
    v_mfma_f32_16x16x32_bf16 a[64:67], v[64:67], v[104:107], a[64:67]
    buffer_load_dword v47, v44, s[28:31], 0 offen sc1
    v_mfma_f32_16x16x32_bf16 a[72:75], v[64:67], v[108:111], a[72:75]
    v_mfma_f32_16x16x32_bf16 a[128:131], v[64:67], v[112:115], a[128:131]
    v_lshl_add_u32 v4, v2, 9, v4
    s_mul_i32 s3, s36, 65536
    v_mfma_f32_16x16x32_bf16 a[136:139], v[64:67], v[116:119], a[136:139]
    s_add_u32 s3, s3, 0
    v_add_u32 v9, s3, v4
    v_mfma_f32_16x16x32_bf16 a[192:195], v[64:67], v[120:123], a[192:195]
    s_mul_i32 s3, s37, 65536
    s_add_u32 s3, s3, 0
    v_mfma_f32_16x16x32_bf16 a[200:203], v[64:67], v[124:127], a[200:203]
    v_add_u32 v10, s3, v4
    v_mfma_f32_16x16x32_bf16 a[4:7], v[68:71], v[96:99], a[4:7]
    ds_read_b64_tr_b16 v[64:65], v24 offset:16384
    v_lshlrev_b32 v4, 1, v2
    v_mfma_f32_16x16x32_bf16 a[12:15], v[68:71], v[100:103], a[12:15]
    ds_read_b64_tr_b16 v[66:67], v24 offset:18432
    v_xor_b32 v3, v3, v4
    v_mfma_f32_16x16x32_bf16 a[68:71], v[68:71], v[104:107], a[68:71]
    s_lshl_b32 s3, s32, 4
    v_add_u32 v2, s3, v2
    v_mfma_f32_16x16x32_bf16 a[76:79], v[68:71], v[108:111], a[76:79]
    ds_read_b128 v[128:131], v49 offset:32768
    v_lshlrev_b32 v2, 13, v2
    v_mfma_f32_16x16x32_bf16 a[132:135], v[68:71], v[112:115], a[132:135]
    s_lshl_b32 s3, s33, 8
    v_add_u32 v2, s3, v2
    v_mfma_f32_16x16x32_bf16 a[140:143], v[68:71], v[116:119], a[140:143]
    v_lshl_add_u32 v4, v3, 4, v2
    v_xor_b32 v3, 8, v3
    v_mfma_f32_16x16x32_bf16 a[196:199], v[68:71], v[120:123], a[196:199]
    v_lshl_add_u32 v2, v3, 4, v2
    v_add_u32 v12, 0, v4
    v_mfma_f32_16x16x32_bf16 a[204:207], v[68:71], v[124:127], a[204:207]
    v_add_u32 v13, 31744, v4
    v_add_u32 v14, 63488, v2
    v_mfma_f32_16x16x32_bf16 a[16:19], v[72:75], v[96:99], a[16:19]
    ds_read_b64_tr_b16 v[68:69], v25 offset:16384
    v_add_u32 v15, 95232, v2
    v_mfma_f32_16x16x32_bf16 a[24:27], v[72:75], v[100:103], a[24:27]
    ds_read_b64_tr_b16 v[70:71], v25 offset:18432
    ds_read_b128 v[132:135], v49 offset:34816
    v_mfma_f32_16x16x32_bf16 a[80:83], v[72:75], v[104:107], a[80:83]
    s_lshl_b32 s98, s32, 12
    v_mfma_f32_16x16x32_bf16 a[88:91], v[72:75], v[108:111], a[88:91]
    s_lshr_b32 s4, s34, 2
    s_add_u32 s4, s4, s33
    v_mfma_f32_16x16x32_bf16 a[144:147], v[72:75], v[112:115], a[144:147]
    s_mul_i32 s4, s4, 0
    s_add_u32 s3, s4, 0
    v_mfma_f32_16x16x32_bf16 a[152:155], v[72:75], v[116:119], a[152:155]
    s_and_b32 s3, s3, 3
    s_lshl_b32 s72, s3, 19
    v_mfma_f32_16x16x32_bf16 a[208:211], v[72:75], v[120:123], a[208:211]
    s_lshl_b32 s76, s3, 12
    s_add_u32 s3, s4, 1
    v_mfma_f32_16x16x32_bf16 a[216:219], v[72:75], v[124:127], a[216:219]
    ds_read_b128 v[136:139], v49 offset:36864
    s_and_b32 s3, s3, 3
    v_mfma_f32_16x16x32_bf16 a[20:23], v[76:79], v[96:99], a[20:23]
    ds_read_b64_tr_b16 v[72:73], v26 offset:16384
    s_lshl_b32 s73, s3, 19
    v_mfma_f32_16x16x32_bf16 a[28:31], v[76:79], v[100:103], a[28:31]
    ds_read_b64_tr_b16 v[74:75], v26 offset:18432
    s_lshl_b32 s77, s3, 12
    v_mfma_f32_16x16x32_bf16 a[84:87], v[76:79], v[104:107], a[84:87]
    s_add_u32 s3, s4, 2
    s_and_b32 s3, s3, 3
    v_mfma_f32_16x16x32_bf16 a[92:95], v[76:79], v[108:111], a[92:95]
    s_lshl_b32 s74, s3, 19
    v_mfma_f32_16x16x32_bf16 a[148:151], v[76:79], v[112:115], a[148:151]
    s_lshl_b32 s78, s3, 12
    s_add_u32 s3, s4, 3
    v_mfma_f32_16x16x32_bf16 a[156:159], v[76:79], v[116:119], a[156:159]
    ds_read_b128 v[140:143], v49 offset:38912
    s_and_b32 s3, s3, 3
    v_mfma_f32_16x16x32_bf16 a[212:215], v[76:79], v[120:123], a[212:215]
    s_lshl_b32 s75, s3, 19
    s_lshl_b32 s79, s3, 12
    v_mfma_f32_16x16x32_bf16 a[220:223], v[76:79], v[124:127], a[220:223]
    v_mov_b32 v11, v43
    v_mov_b32 v6, v45
    v_mfma_f32_16x16x32_bf16 a[32:35], v[80:83], v[96:99], a[32:35]
    ds_read_b64_tr_b16 v[76:77], v27 offset:16384
    v_mfma_f32_16x16x32_bf16 a[40:43], v[80:83], v[100:103], a[40:43]
    ds_read_b64_tr_b16 v[78:79], v27 offset:18432
    v_mfma_f32_16x16x32_bf16 a[96:99], v[80:83], v[104:107], a[96:99]
    v_mfma_f32_16x16x32_bf16 a[104:107], v[80:83], v[108:111], a[104:107]
    ds_read_b128 v[144:147], v49 offset:40960
    v_mfma_f32_16x16x32_bf16 a[160:163], v[80:83], v[112:115], a[160:163]
    v_mfma_f32_16x16x32_bf16 a[168:171], v[80:83], v[116:119], a[168:171]
    v_mfma_f32_16x16x32_bf16 a[224:227], v[80:83], v[120:123], a[224:227]
    v_mfma_f32_16x16x32_bf16 a[232:235], v[80:83], v[124:127], a[232:235]
    v_mfma_f32_16x16x32_bf16 a[36:39], v[84:87], v[96:99], a[36:39]
    ds_read_b64_tr_b16 v[80:81], v28 offset:16384
    v_mfma_f32_16x16x32_bf16 a[44:47], v[84:87], v[100:103], a[44:47]
    ds_read_b64_tr_b16 v[82:83], v28 offset:18432
    ds_read_b128 v[148:151], v49 offset:43008
    v_mfma_f32_16x16x32_bf16 a[100:103], v[84:87], v[104:107], a[100:103]
    v_mfma_f32_16x16x32_bf16 a[108:111], v[84:87], v[108:111], a[108:111]
    v_mfma_f32_16x16x32_bf16 a[164:167], v[84:87], v[112:115], a[164:167]
    v_mfma_f32_16x16x32_bf16 a[172:175], v[84:87], v[116:119], a[172:175]
    v_mfma_f32_16x16x32_bf16 a[228:231], v[84:87], v[120:123], a[228:231]
    s_waitcnt lgkmcnt(15)
    v_mfma_f32_16x16x32_bf16 a[236:239], v[84:87], v[124:127], a[236:239]
    ds_read_b128 v[152:155], v49 offset:45056
    v_mfma_f32_16x16x32_bf16 a[48:51], v[88:91], v[96:99], a[48:51]
    ds_read_b64_tr_b16 v[84:85], v29 offset:16384
    v_mfma_f32_16x16x32_bf16 a[56:59], v[88:91], v[100:103], a[56:59]
    ds_read_b64_tr_b16 v[86:87], v29 offset:18432
    v_mfma_f32_16x16x32_bf16 a[112:115], v[88:91], v[104:107], a[112:115]
    v_mfma_f32_16x16x32_bf16 a[120:123], v[88:91], v[108:111], a[120:123]
    v_mfma_f32_16x16x32_bf16 a[176:179], v[88:91], v[112:115], a[176:179]
    v_mfma_f32_16x16x32_bf16 a[184:187], v[88:91], v[116:119], a[184:187]
    ds_read_b128 v[156:159], v49 offset:47104
    v_mfma_f32_16x16x32_bf16 a[240:243], v[88:91], v[120:123], a[240:243]
    v_mfma_f32_16x16x32_bf16 a[248:251], v[88:91], v[124:127], a[248:251]
    v_mfma_f32_16x16x32_bf16 a[52:55], v[92:95], v[96:99], a[52:55]
    ds_read_b64_tr_b16 v[88:89], v30 offset:16384
    v_mfma_f32_16x16x32_bf16 a[60:63], v[92:95], v[100:103], a[60:63]
    ds_read_b64_tr_b16 v[90:91], v30 offset:18432
    v_mfma_f32_16x16x32_bf16 a[116:119], v[92:95], v[104:107], a[116:119]
    v_mfma_f32_16x16x32_bf16 a[124:127], v[92:95], v[108:111], a[124:127]
    v_mfma_f32_16x16x32_bf16 a[180:183], v[92:95], v[112:115], a[180:183]
    v_mfma_f32_16x16x32_bf16 a[188:191], v[92:95], v[116:119], a[188:191]
    v_mfma_f32_16x16x32_bf16 a[244:247], v[92:95], v[120:123], a[244:247]
    s_waitcnt lgkmcnt(2)
    v_mfma_f32_16x16x32_bf16 a[252:255], v[92:95], v[124:127], a[252:255]
    ds_read_b64_tr_b16 v[92:93], v31 offset:16384
    ds_read_b64_tr_b16 v[94:95], v31 offset:18432
    v_mfma_f32_16x16x32_bf16 a[0:3], v[64:67], v[128:131], a[0:3]
    v_mfma_f32_16x16x32_bf16 a[8:11], v[64:67], v[132:135], a[8:11]
    v_mfma_f32_16x16x32_bf16 a[64:67], v[64:67], v[136:139], a[64:67]
    v_mfma_f32_16x16x32_bf16 a[72:75], v[64:67], v[140:143], a[72:75]
    v_mfma_f32_16x16x32_bf16 a[128:131], v[64:67], v[144:147], a[128:131]
    v_mfma_f32_16x16x32_bf16 a[136:139], v[64:67], v[148:151], a[136:139]
    v_mfma_f32_16x16x32_bf16 a[192:195], v[64:67], v[152:155], a[192:195]
    v_mfma_f32_16x16x32_bf16 a[200:203], v[64:67], v[156:159], a[200:203]
    s_waitcnt vmcnt(1) lgkmcnt(0)
    s_barrier
    v_mfma_f32_16x16x32_bf16 a[4:7], v[68:71], v[128:131], a[4:7]
    ds_read_b64_tr_b16 v[64:65], v24 offset:32768
    v_mfma_f32_16x16x32_bf16 a[12:15], v[68:71], v[132:135], a[12:15]
    s_add_u32 m0, s98, 131072
    s_add_u32 s96, s72, 0
    ds_read_b64_tr_b16 v[66:67], v24 offset:34816
    v_mfma_f32_16x16x32_bf16 a[68:71], v[68:71], v[136:139], a[68:71]
    buffer_load_dwordx4 v12, s[24:27], s96 offen offset:0 lds
    v_mfma_f32_16x16x32_bf16 a[76:79], v[68:71], v[140:143], a[76:79]
    ds_read_b128 v[96:99], v48 offset:0
    v_mfma_f32_16x16x32_bf16 a[132:135], v[68:71], v[144:147], a[132:135]
    buffer_load_dwordx4 v13, s[24:27], s96 offen offset:1024 lds
    v_mfma_f32_16x16x32_bf16 a[140:143], v[68:71], v[148:151], a[140:143]
    v_mfma_f32_16x16x32_bf16 a[196:199], v[68:71], v[152:155], a[196:199]
    v_mfma_f32_16x16x32_bf16 a[204:207], v[68:71], v[156:159], a[204:207]
    buffer_load_dwordx4 v14, s[24:27], s96 offen offset:2048 lds
    v_mfma_f32_16x16x32_bf16 a[16:19], v[72:75], v[128:131], a[16:19]
    ds_read_b64_tr_b16 v[68:69], v25 offset:32768
    v_mfma_f32_16x16x32_bf16 a[24:27], v[72:75], v[132:135], a[24:27]
    ds_read_b64_tr_b16 v[70:71], v25 offset:34816
    ds_read_b128 v[100:103], v48 offset:2048
    v_mfma_f32_16x16x32_bf16 a[80:83], v[72:75], v[136:139], a[80:83]
    buffer_load_dwordx4 v15, s[24:27], s96 offen offset:3072 lds
    v_mfma_f32_16x16x32_bf16 a[88:91], v[72:75], v[140:143], a[88:91]
    s_add_u32 m0, s98, 147456
    s_add_u32 s96, s73, 0
    v_mfma_f32_16x16x32_bf16 a[144:147], v[72:75], v[144:147], a[144:147]
    buffer_load_dwordx4 v12, s[24:27], s96 offen offset:0 lds
    v_mfma_f32_16x16x32_bf16 a[152:155], v[72:75], v[148:151], a[152:155]
    v_mfma_f32_16x16x32_bf16 a[208:211], v[72:75], v[152:155], a[208:211]
    v_mfma_f32_16x16x32_bf16 a[216:219], v[72:75], v[156:159], a[216:219]
    ds_read_b128 v[104:107], v48 offset:4096
    v_mfma_f32_16x16x32_bf16 a[20:23], v[76:79], v[128:131], a[20:23]
    ds_read_b64_tr_b16 v[72:73], v26 offset:32768
    v_mfma_f32_16x16x32_bf16 a[28:31], v[76:79], v[132:135], a[28:31]
    ds_read_b64_tr_b16 v[74:75], v26 offset:34816
    v_mfma_f32_16x16x32_bf16 a[84:87], v[76:79], v[136:139], a[84:87]
    buffer_load_dwordx4 v13, s[24:27], s96 offen offset:1024 lds
    v_mfma_f32_16x16x32_bf16 a[92:95], v[76:79], v[140:143], a[92:95]
    buffer_load_dwordx4 v14, s[24:27], s96 offen offset:2048 lds
    v_mfma_f32_16x16x32_bf16 a[148:151], v[76:79], v[144:147], a[148:151]
    buffer_load_dwordx4 v15, s[24:27], s96 offen offset:3072 lds
    v_mfma_f32_16x16x32_bf16 a[156:159], v[76:79], v[148:151], a[156:159]
    ds_read_b128 v[108:111], v48 offset:6144
    v_mfma_f32_16x16x32_bf16 a[212:215], v[76:79], v[152:155], a[212:215]
    v_mfma_f32_16x16x32_bf16 a[220:223], v[76:79], v[156:159], a[220:223]
    v_mfma_f32_16x16x32_bf16 a[32:35], v[80:83], v[128:131], a[32:35]
    ds_read_b64_tr_b16 v[76:77], v27 offset:32768
    v_mfma_f32_16x16x32_bf16 a[40:43], v[80:83], v[132:135], a[40:43]
    ds_read_b64_tr_b16 v[78:79], v27 offset:34816
    v_mfma_f32_16x16x32_bf16 a[96:99], v[80:83], v[136:139], a[96:99]
    v_mfma_f32_16x16x32_bf16 a[104:107], v[80:83], v[140:143], a[104:107]
    ds_read_b128 v[112:115], v48 offset:8192
    v_mfma_f32_16x16x32_bf16 a[160:163], v[80:83], v[144:147], a[160:163]
    v_mfma_f32_16x16x32_bf16 a[168:171], v[80:83], v[148:151], a[168:171]
    v_mfma_f32_16x16x32_bf16 a[224:227], v[80:83], v[152:155], a[224:227]
    s_waitcnt vmcnt(8)
    v_cmp_ne_u32 vcc, 0x01010101, v47
    v_mfma_f32_16x16x32_bf16 a[232:235], v[80:83], v[156:159], a[232:235]
    v_mfma_f32_16x16x32_bf16 a[36:39], v[84:87], v[128:131], a[36:39]
    ds_read_b64_tr_b16 v[80:81], v28 offset:32768
    v_mfma_f32_16x16x32_bf16 a[44:47], v[84:87], v[132:135], a[44:47]
    ds_read_b64_tr_b16 v[82:83], v28 offset:34816
    ds_read_b128 v[116:119], v48 offset:10240
    v_mfma_f32_16x16x32_bf16 a[100:103], v[84:87], v[136:139], a[100:103]
    v_mfma_f32_16x16x32_bf16 a[108:111], v[84:87], v[140:143], a[108:111]
    v_mfma_f32_16x16x32_bf16 a[164:167], v[84:87], v[144:147], a[164:167]
    v_mfma_f32_16x16x32_bf16 a[172:175], v[84:87], v[148:151], a[172:175]
    v_mfma_f32_16x16x32_bf16 a[228:231], v[84:87], v[152:155], a[228:231]
    v_mfma_f32_16x16x32_bf16 a[236:239], v[84:87], v[156:159], a[236:239]
    ds_read_b128 v[120:123], v48 offset:12288
    v_mfma_f32_16x16x32_bf16 a[48:51], v[88:91], v[128:131], a[48:51]
    ds_read_b64_tr_b16 v[84:85], v29 offset:32768
    v_mfma_f32_16x16x32_bf16 a[56:59], v[88:91], v[132:135], a[56:59]
    ds_read_b64_tr_b16 v[86:87], v29 offset:34816
    v_mfma_f32_16x16x32_bf16 a[112:115], v[88:91], v[136:139], a[112:115]
    v_mfma_f32_16x16x32_bf16 a[120:123], v[88:91], v[140:143], a[120:123]
    v_mfma_f32_16x16x32_bf16 a[176:179], v[88:91], v[144:147], a[176:179]
    v_mfma_f32_16x16x32_bf16 a[184:187], v[88:91], v[148:151], a[184:187]
    ds_read_b128 v[124:127], v48 offset:14336
    v_mfma_f32_16x16x32_bf16 a[240:243], v[88:91], v[152:155], a[240:243]
    v_mfma_f32_16x16x32_bf16 a[248:251], v[88:91], v[156:159], a[248:251]
    v_mfma_f32_16x16x32_bf16 a[52:55], v[92:95], v[128:131], a[52:55]
    ds_read_b64_tr_b16 v[88:89], v30 offset:32768
    v_mfma_f32_16x16x32_bf16 a[60:63], v[92:95], v[132:135], a[60:63]
    ds_read_b64_tr_b16 v[90:91], v30 offset:34816
    v_mfma_f32_16x16x32_bf16 a[116:119], v[92:95], v[136:139], a[116:119]
    v_mfma_f32_16x16x32_bf16 a[124:127], v[92:95], v[140:143], a[124:127]
    v_mfma_f32_16x16x32_bf16 a[180:183], v[92:95], v[144:147], a[180:183]
    v_mfma_f32_16x16x32_bf16 a[188:191], v[92:95], v[148:151], a[188:191]
    v_mfma_f32_16x16x32_bf16 a[244:247], v[92:95], v[152:155], a[244:247]
    s_waitcnt lgkmcnt(2)
    s_cbranch_vccnz fk_lnw0
fk_lnw0_ret:
    v_mfma_f32_16x16x32_bf16 a[252:255], v[92:95], v[156:159], a[252:255]
    ds_read_b64_tr_b16 v[92:93], v31 offset:32768
    ds_read_b64_tr_b16 v[94:95], v31 offset:34816
    v_mfma_f32_16x16x32_bf16 a[0:3], v[64:67], v[96:99], a[0:3]
    v_mfma_f32_16x16x32_bf16 a[8:11], v[64:67], v[100:103], a[8:11]
    s_add_u32 s97, s76, 0
    v_mfma_f32_16x16x32_bf16 a[64:67], v[64:67], v[104:107], a[64:67]
    buffer_load_dwordx4 v[192:195], v9, s[16:19], s97 offen offset:0 sc1
    v_mfma_f32_16x16x32_bf16 a[72:75], v[64:67], v[108:111], a[72:75]
    v_mfma_f32_16x16x32_bf16 a[128:131], v[64:67], v[112:115], a[128:131]
    v_mfma_f32_16x16x32_bf16 a[136:139], v[64:67], v[116:119], a[136:139]
    buffer_load_dwordx4 v[196:199], v9, s[16:19], s97 offen offset:256 sc1
    v_mfma_f32_16x16x32_bf16 a[192:195], v[64:67], v[120:123], a[192:195]
    v_mfma_f32_16x16x32_bf16 a[200:203], v[64:67], v[124:127], a[200:203]
    v_mfma_f32_16x16x32_bf16 a[4:7], v[68:71], v[96:99], a[4:7]
    ds_read_b64_tr_b16 v[64:65], v24 offset:49152
    v_mfma_f32_16x16x32_bf16 a[12:15], v[68:71], v[100:103], a[12:15]
    ds_read_b64_tr_b16 v[66:67], v24 offset:51200
    v_mfma_f32_16x16x32_bf16 a[68:71], v[68:71], v[104:107], a[68:71]
    buffer_load_dwordx4 v[200:203], v10, s[16:19], s97 offen offset:0 sc1
    v_mfma_f32_16x16x32_bf16 a[76:79], v[68:71], v[108:111], a[76:79]
    ds_read_b128 v[128:131], v49 offset:0
    v_mfma_f32_16x16x32_bf16 a[132:135], v[68:71], v[112:115], a[132:135]
    buffer_load_dwordx4 v[204:207], v10, s[16:19], s97 offen offset:256 sc1
    v_mfma_f32_16x16x32_bf16 a[140:143], v[68:71], v[116:119], a[140:143]
    v_mfma_f32_16x16x32_bf16 a[196:199], v[68:71], v[120:123], a[196:199]
    v_mfma_f32_16x16x32_bf16 a[204:207], v[68:71], v[124:127], a[204:207]
    v_mfma_f32_16x16x32_bf16 a[16:19], v[72:75], v[96:99], a[16:19]
    ds_read_b64_tr_b16 v[68:69], v25 offset:49152
    v_mfma_f32_16x16x32_bf16 a[24:27], v[72:75], v[100:103], a[24:27]
    s_add_u32 s97, s76, 0
    ds_read_b64_tr_b16 v[70:71], v25 offset:51200
    ds_read_b128 v[132:135], v49 offset:2048
    v_mfma_f32_16x16x32_bf16 a[80:83], v[72:75], v[104:107], a[80:83]
    buffer_load_dwordx4 v[208:211], v9, s[16:19], s97 offen offset:2048 sc1
    v_mfma_f32_16x16x32_bf16 a[88:91], v[72:75], v[108:111], a[88:91]
    v_mfma_f32_16x16x32_bf16 a[144:147], v[72:75], v[112:115], a[144:147]
    buffer_load_dwordx4 v[212:215], v9, s[16:19], s97 offen offset:2304 sc1
    v_mfma_f32_16x16x32_bf16 a[152:155], v[72:75], v[116:119], a[152:155]
    v_mfma_f32_16x16x32_bf16 a[208:211], v[72:75], v[120:123], a[208:211]
    v_mfma_f32_16x16x32_bf16 a[216:219], v[72:75], v[124:127], a[216:219]
    ds_read_b128 v[136:139], v49 offset:4096
    v_mfma_f32_16x16x32_bf16 a[20:23], v[76:79], v[96:99], a[20:23]
    ds_read_b64_tr_b16 v[72:73], v26 offset:49152
    v_mfma_f32_16x16x32_bf16 a[28:31], v[76:79], v[100:103], a[28:31]
    ds_read_b64_tr_b16 v[74:75], v26 offset:51200
    v_mfma_f32_16x16x32_bf16 a[84:87], v[76:79], v[104:107], a[84:87]
    buffer_load_dwordx4 v[216:219], v10, s[16:19], s97 offen offset:2048 sc1
    v_mfma_f32_16x16x32_bf16 a[92:95], v[76:79], v[108:111], a[92:95]
    buffer_load_dwordx4 v[220:223], v10, s[16:19], s97 offen offset:2304 sc1
    v_mfma_f32_16x16x32_bf16 a[148:151], v[76:79], v[112:115], a[148:151]
    v_mfma_f32_16x16x32_bf16 a[156:159], v[76:79], v[116:119], a[156:159]
    ds_read_b128 v[140:143], v49 offset:6144
    v_mfma_f32_16x16x32_bf16 a[212:215], v[76:79], v[120:123], a[212:215]
    v_mfma_f32_16x16x32_bf16 a[220:223], v[76:79], v[124:127], a[220:223]
    v_mfma_f32_16x16x32_bf16 a[32:35], v[80:83], v[96:99], a[32:35]
    ds_read_b64_tr_b16 v[76:77], v27 offset:49152
    v_mfma_f32_16x16x32_bf16 a[40:43], v[80:83], v[100:103], a[40:43]
    s_add_u32 s97, s77, 0
    ds_read_b64_tr_b16 v[78:79], v27 offset:51200
    v_mfma_f32_16x16x32_bf16 a[96:99], v[80:83], v[104:107], a[96:99]
    buffer_load_dwordx4 v[224:227], v9, s[16:19], s97 offen offset:0 sc1
    v_mfma_f32_16x16x32_bf16 a[104:107], v[80:83], v[108:111], a[104:107]
    ds_read_b128 v[144:147], v49 offset:8192
    v_mfma_f32_16x16x32_bf16 a[160:163], v[80:83], v[112:115], a[160:163]
    v_mfma_f32_16x16x32_bf16 a[168:171], v[80:83], v[116:119], a[168:171]
    v_mfma_f32_16x16x32_bf16 a[224:227], v[80:83], v[120:123], a[224:227]
    v_mfma_f32_16x16x32_bf16 a[232:235], v[80:83], v[124:127], a[232:235]
    v_mfma_f32_16x16x32_bf16 a[36:39], v[84:87], v[96:99], a[36:39]
    ds_read_b64_tr_b16 v[80:81], v28 offset:49152
    v_mfma_f32_16x16x32_bf16 a[44:47], v[84:87], v[100:103], a[44:47]
    ds_read_b64_tr_b16 v[82:83], v28 offset:51200
    ds_read_b128 v[148:151], v49 offset:10240
    v_mfma_f32_16x16x32_bf16 a[100:103], v[84:87], v[104:107], a[100:103]
    buffer_load_dwordx4 v[228:231], v9, s[16:19], s97 offen offset:256 sc1
    v_mfma_f32_16x16x32_bf16 a[108:111], v[84:87], v[108:111], a[108:111]
    v_mfma_f32_16x16x32_bf16 a[164:167], v[84:87], v[112:115], a[164:167]
    v_mfma_f32_16x16x32_bf16 a[172:175], v[84:87], v[116:119], a[172:175]
    v_mfma_f32_16x16x32_bf16 a[228:231], v[84:87], v[120:123], a[228:231]
    s_waitcnt lgkmcnt(15)
    v_mfma_f32_16x16x32_bf16 a[236:239], v[84:87], v[124:127], a[236:239]
    ds_read_b128 v[152:155], v49 offset:12288
    v_mfma_f32_16x16x32_bf16 a[48:51], v[88:91], v[96:99], a[48:51]
    ds_read_b64_tr_b16 v[84:85], v29 offset:49152
    v_mfma_f32_16x16x32_bf16 a[56:59], v[88:91], v[100:103], a[56:59]
    ds_read_b64_tr_b16 v[86:87], v29 offset:51200
    v_mfma_f32_16x16x32_bf16 a[112:115], v[88:91], v[104:107], a[112:115]
    buffer_load_dwordx4 v[232:235], v10, s[16:19], s97 offen offset:0 sc1
    v_mfma_f32_16x16x32_bf16 a[120:123], v[88:91], v[108:111], a[120:123]
    v_mfma_f32_16x16x32_bf16 a[176:179], v[88:91], v[112:115], a[176:179]
    v_mfma_f32_16x16x32_bf16 a[184:187], v[88:91], v[116:119], a[184:187]
    ds_read_b128 v[156:159], v49 offset:14336
    v_mfma_f32_16x16x32_bf16 a[240:243], v[88:91], v[120:123], a[240:243]
    v_mfma_f32_16x16x32_bf16 a[248:251], v[88:91], v[124:127], a[248:251]
    buffer_load_dwordx4 v[236:239], v10, s[16:19], s97 offen offset:256 sc1
    v_mfma_f32_16x16x32_bf16 a[52:55], v[92:95], v[96:99], a[52:55]
    ds_read_b64_tr_b16 v[88:89], v30 offset:49152
    v_mfma_f32_16x16x32_bf16 a[60:63], v[92:95], v[100:103], a[60:63]
    ds_read_b64_tr_b16 v[90:91], v30 offset:51200
    v_mfma_f32_16x16x32_bf16 a[116:119], v[92:95], v[104:107], a[116:119]
    v_mfma_f32_16x16x32_bf16 a[124:127], v[92:95], v[108:111], a[124:127]
    v_mfma_f32_16x16x32_bf16 a[180:183], v[92:95], v[112:115], a[180:183]
    v_mfma_f32_16x16x32_bf16 a[188:191], v[92:95], v[116:119], a[188:191]
    v_mfma_f32_16x16x32_bf16 a[244:247], v[92:95], v[120:123], a[244:247]
    s_waitcnt lgkmcnt(2)
    v_mfma_f32_16x16x32_bf16 a[252:255], v[92:95], v[124:127], a[252:255]
    ds_read_b64_tr_b16 v[92:93], v31 offset:49152
    ds_read_b64_tr_b16 v[94:95], v31 offset:51200
    v_mfma_f32_16x16x32_bf16 a[0:3], v[64:67], v[128:131], a[0:3]
    v_mfma_f32_16x16x32_bf16 a[8:11], v[64:67], v[132:135], a[8:11]
    v_mfma_f32_16x16x32_bf16 a[64:67], v[64:67], v[136:139], a[64:67]
    v_mfma_f32_16x16x32_bf16 a[72:75], v[64:67], v[140:143], a[72:75]
    v_mfma_f32_16x16x32_bf16 a[128:131], v[64:67], v[144:147], a[128:131]
    v_mfma_f32_16x16x32_bf16 a[136:139], v[64:67], v[148:151], a[136:139]
    v_mfma_f32_16x16x32_bf16 a[192:195], v[64:67], v[152:155], a[192:195]
    v_mfma_f32_16x16x32_bf16 a[200:203], v[64:67], v[156:159], a[200:203]
    v_mfma_f32_16x16x32_bf16 a[4:7], v[68:71], v[128:131], a[4:7]
    v_mfma_f32_16x16x32_bf16 a[12:15], v[68:71], v[132:135], a[12:15]
    v_mfma_f32_16x16x32_bf16 a[68:71], v[68:71], v[136:139], a[68:71]
    v_mfma_f32_16x16x32_bf16 a[76:79], v[68:71], v[140:143], a[76:79]
    v_mfma_f32_16x16x32_bf16 a[132:135], v[68:71], v[144:147], a[132:135]
    v_mfma_f32_16x16x32_bf16 a[140:143], v[68:71], v[148:151], a[140:143]
    v_mfma_f32_16x16x32_bf16 a[196:199], v[68:71], v[152:155], a[196:199]
    v_mfma_f32_16x16x32_bf16 a[204:207], v[68:71], v[156:159], a[204:207]
    v_mfma_f32_16x16x32_bf16 a[16:19], v[72:75], v[128:131], a[16:19]
    v_mfma_f32_16x16x32_bf16 a[24:27], v[72:75], v[132:135], a[24:27]
    v_mfma_f32_16x16x32_bf16 a[80:83], v[72:75], v[136:139], a[80:83]
    v_mfma_f32_16x16x32_bf16 a[88:91], v[72:75], v[140:143], a[88:91]
    v_mfma_f32_16x16x32_bf16 a[144:147], v[72:75], v[144:147], a[144:147]
    v_mfma_f32_16x16x32_bf16 a[152:155], v[72:75], v[148:151], a[152:155]
    v_mfma_f32_16x16x32_bf16 a[208:211], v[72:75], v[152:155], a[208:211]
    v_mfma_f32_16x16x32_bf16 a[216:219], v[72:75], v[156:159], a[216:219]
    v_mfma_f32_16x16x32_bf16 a[20:23], v[76:79], v[128:131], a[20:23]
    v_mfma_f32_16x16x32_bf16 a[28:31], v[76:79], v[132:135], a[28:31]
    v_mfma_f32_16x16x32_bf16 a[84:87], v[76:79], v[136:139], a[84:87]
    v_mfma_f32_16x16x32_bf16 a[92:95], v[76:79], v[140:143], a[92:95]
    v_mfma_f32_16x16x32_bf16 a[148:151], v[76:79], v[144:147], a[148:151]
    v_mfma_f32_16x16x32_bf16 a[156:159], v[76:79], v[148:151], a[156:159]
    v_mfma_f32_16x16x32_bf16 a[212:215], v[76:79], v[152:155], a[212:215]
    v_mfma_f32_16x16x32_bf16 a[220:223], v[76:79], v[156:159], a[220:223]
    v_mfma_f32_16x16x32_bf16 a[32:35], v[80:83], v[128:131], a[32:35]
    v_bfe_u32 v2, v1, 2, 3
    v_mfma_f32_16x16x32_bf16 a[40:43], v[80:83], v[132:135], a[40:43]
    v_bfe_u32 v4, v1, 2, 2
    v_lshrrev_b32 v3, 4, v1
    v_mfma_f32_16x16x32_bf16 a[96:99], v[80:83], v[136:139], a[96:99]
    v_lshl_add_u32 v3, v3, 3, v4
    v_mfma_f32_16x16x32_bf16 a[104:107], v[80:83], v[140:143], a[104:107]
    v_lshlrev_b32 v3, 8, v3
    v_mfma_f32_16x16x32_bf16 a[160:163], v[80:83], v[144:147], a[160:163]
    v_and_b32 v4, 3, v1
    v_lshl_add_u32 v3, v4, 3, v3
    v_mfma_f32_16x16x32_bf16 a[168:171], v[80:83], v[148:151], a[168:171]
    v_add_u32 v3, 98304, v3
    v_mfma_f32_16x16x32_bf16 a[224:227], v[80:83], v[152:155], a[224:227]
    v_xor_b32 v5, 0, v2
    v_mfma_f32_16x16x32_bf16 a[232:235], v[80:83], v[156:159], a[232:235]
    v_lshl_add_u32 v24, v5, 5, v3
    v_xor_b32 v5, 1, v2
    v_mfma_f32_16x16x32_bf16 a[36:39], v[84:87], v[128:131], a[36:39]
    v_lshl_add_u32 v25, v5, 5, v3
    v_mfma_f32_16x16x32_bf16 a[44:47], v[84:87], v[132:135], a[44:47]
    v_xor_b32 v5, 2, v2
    v_mfma_f32_16x16x32_bf16 a[100:103], v[84:87], v[136:139], a[100:103]
    v_lshl_add_u32 v26, v5, 5, v3
    v_mfma_f32_16x16x32_bf16 a[108:111], v[84:87], v[140:143], a[108:111]
    v_xor_b32 v5, 3, v2
    v_lshl_add_u32 v27, v5, 5, v3
    v_mfma_f32_16x16x32_bf16 a[164:167], v[84:87], v[144:147], a[164:167]
    v_xor_b32 v5, 4, v2
    v_mfma_f32_16x16x32_bf16 a[172:175], v[84:87], v[148:151], a[172:175]
    v_lshl_add_u32 v28, v5, 5, v3
    v_mfma_f32_16x16x32_bf16 a[228:231], v[84:87], v[152:155], a[228:231]
    s_waitcnt lgkmcnt(2)
    v_xor_b32 v5, 5, v2
    v_lshl_add_u32 v29, v5, 5, v3
    v_mfma_f32_16x16x32_bf16 a[236:239], v[84:87], v[156:159], a[236:239]
    v_xor_b32 v5, 6, v2
    v_mfma_f32_16x16x32_bf16 a[48:51], v[88:91], v[128:131], a[48:51]
    v_lshl_add_u32 v30, v5, 5, v3
    v_mfma_f32_16x16x32_bf16 a[56:59], v[88:91], v[132:135], a[56:59]
    v_xor_b32 v5, 7, v2
    v_lshl_add_u32 v31, v5, 5, v3
    v_mfma_f32_16x16x32_bf16 a[112:115], v[88:91], v[136:139], a[112:115]
    v_bfe_u32 v4, v1, 4, 1
    v_mfma_f32_16x16x32_bf16 a[120:123], v[88:91], v[140:143], a[120:123]
    v_lshlrev_b32 v4, 10, v4
    v_mfma_f32_16x16x32_bf16 a[176:179], v[88:91], v[144:147], a[176:179]
    v_lshrrev_b32 v5, 5, v1
    v_lshl_add_u32 v4, v5, 9, v4
    v_mfma_f32_16x16x32_bf16 a[184:187], v[88:91], v[148:151], a[184:187]
    v_bfe_u32 v5, v1, 3, 1
    v_mfma_f32_16x16x32_bf16 a[240:243], v[88:91], v[152:155], a[240:243]
    s_waitcnt lgkmcnt(0)
    v_lshl_add_u32 v4, v5, 8, v4
    v_mfma_f32_16x16x32_bf16 a[248:251], v[88:91], v[156:159], a[248:251]
    v_and_b32 v5, 7, v1
    v_lshl_add_u32 v4, v5, 4, v4
    v_mfma_f32_16x16x32_bf16 a[52:55], v[92:95], v[128:131], a[52:55]
    v_lshrrev_b32 v5, 4, v1
    v_mfma_f32_16x16x32_bf16 a[60:63], v[92:95], v[132:135], a[60:63]
    v_lshlrev_b32 v5, 9, v5
    v_mfma_f32_16x16x32_bf16 a[116:119], v[92:95], v[136:139], a[116:119]
    v_and_b32 v3, 15, v1
    v_mfma_f32_16x16x32_bf16 a[124:127], v[92:95], v[140:143], a[124:127]
    v_lshl_add_u32 v5, v3, 4, v5
    s_cmp_eq_u32 s68, 0
    v_mfma_f32_16x16x32_bf16 a[180:183], v[92:95], v[144:147], a[180:183]
    s_cselect_b64 vcc, -1, 0
    v_mfma_f32_16x16x32_bf16 a[188:191], v[92:95], v[148:151], a[188:191]
    s_cselect_b32 s3, 2, 4
    v_mfma_f32_16x16x32_bf16 a[244:247], v[92:95], v[152:155], a[244:247]
    s_lshl_b32 s3, s3, 6
    v_cndmask_b32 v2, v5, v4, vcc
    v_mfma_f32_16x16x32_bf16 a[252:255], v[92:95], v[156:159], a[252:255]
    v_add_u32 v3, s3, v2
    s_branch fk_q
fk_v:
    s_waitcnt lgkmcnt(15)
    v_mfma_f32_16x16x32_bf16 a[0:3], v[96:99], v[64:67], 0
    v_mfma_f32_16x16x32_bf16 a[4:7], v[100:103], v[64:67], 0
    v_mfma_f32_16x16x32_bf16 a[64:67], v[104:107], v[64:67], 0
    v_mfma_f32_16x16x32_bf16 a[68:71], v[108:111], v[64:67], 0
    v_mfma_f32_16x16x32_bf16 a[128:131], v[112:115], v[64:67], 0
    v_mfma_f32_16x16x32_bf16 a[132:135], v[116:119], v[64:67], 0
    v_mfma_f32_16x16x32_bf16 a[192:195], v[120:123], v[64:67], 0
    s_waitcnt lgkmcnt(12)
    v_mfma_f32_16x16x32_bf16 a[196:199], v[124:127], v[64:67], 0
    v_mfma_f32_16x16x32_bf16 a[8:11], v[96:99], v[68:71], 0
    ds_read_b64_tr_b16 v[64:65], v24 offset:16384
    v_mfma_f32_16x16x32_bf16 a[12:15], v[100:103], v[68:71], 0
    ds_read_b64_tr_b16 v[66:67], v24 offset:18432
    v_mfma_f32_16x16x32_bf16 a[72:75], v[104:107], v[68:71], 0
    v_mfma_f32_16x16x32_bf16 a[76:79], v[108:111], v[68:71], 0
    ds_read_b128 v[128:131], v49 offset:32768
    v_mfma_f32_16x16x32_bf16 a[136:139], v[112:115], v[68:71], 0
    v_mfma_f32_16x16x32_bf16 a[140:143], v[116:119], v[68:71], 0
    v_mfma_f32_16x16x32_bf16 a[200:203], v[120:123], v[68:71], 0
    s_waitcnt lgkmcnt(13)
    v_mfma_f32_16x16x32_bf16 a[204:207], v[124:127], v[68:71], 0
    v_mfma_f32_16x16x32_bf16 a[16:19], v[96:99], v[72:75], 0
    ds_read_b64_tr_b16 v[68:69], v25 offset:16384
    v_mfma_f32_16x16x32_bf16 a[20:23], v[100:103], v[72:75], 0
    ds_read_b64_tr_b16 v[70:71], v25 offset:18432
    ds_read_b128 v[132:135], v49 offset:34816
    v_mfma_f32_16x16x32_bf16 a[80:83], v[104:107], v[72:75], 0
    v_mfma_f32_16x16x32_bf16 a[84:87], v[108:111], v[72:75], 0
    v_mfma_f32_16x16x32_bf16 a[144:147], v[112:115], v[72:75], 0
    v_mfma_f32_16x16x32_bf16 a[148:151], v[116:119], v[72:75], 0
    v_mfma_f32_16x16x32_bf16 a[208:211], v[120:123], v[72:75], 0
    s_waitcnt lgkmcnt(14)
    v_mfma_f32_16x16x32_bf16 a[212:215], v[124:127], v[72:75], 0
    ds_read_b128 v[136:139], v49 offset:36864
    v_mfma_f32_16x16x32_bf16 a[24:27], v[96:99], v[76:79], 0
    ds_read_b64_tr_b16 v[72:73], v26 offset:16384
    v_mfma_f32_16x16x32_bf16 a[28:31], v[100:103], v[76:79], 0
    ds_read_b64_tr_b16 v[74:75], v26 offset:18432
    v_mfma_f32_16x16x32_bf16 a[88:91], v[104:107], v[76:79], 0
    v_mfma_f32_16x16x32_bf16 a[92:95], v[108:111], v[76:79], 0
    v_mfma_f32_16x16x32_bf16 a[152:155], v[112:115], v[76:79], 0
    v_mfma_f32_16x16x32_bf16 a[156:159], v[116:119], v[76:79], 0
    ds_read_b128 v[140:143], v49 offset:38912
    v_mfma_f32_16x16x32_bf16 a[216:219], v[120:123], v[76:79], 0
    s_waitcnt lgkmcnt(15)
    v_mfma_f32_16x16x32_bf16 a[220:223], v[124:127], v[76:79], 0
    v_mfma_f32_16x16x32_bf16 a[32:35], v[96:99], v[80:83], 0
    ds_read_b64_tr_b16 v[76:77], v27 offset:16384
    v_mfma_f32_16x16x32_bf16 a[36:39], v[100:103], v[80:83], 0
    s_add_u32 m0, s64, 131072
    ds_read_b64_tr_b16 v[78:79], v27 offset:18432
    v_mfma_f32_16x16x32_bf16 a[96:99], v[104:107], v[80:83], 0
    buffer_load_dwordx4 v8, s[8:11], s66 offen offset:0 lds
    v_mfma_f32_16x16x32_bf16 a[100:103], v[108:111], v[80:83], 0
    ds_read_b128 v[144:147], v49 offset:40960
    v_mfma_f32_16x16x32_bf16 a[160:163], v[112:115], v[80:83], 0
    v_mfma_f32_16x16x32_bf16 a[164:167], v[116:119], v[80:83], 0
    buffer_load_dwordx4 v9, s[8:11], s66 offen offset:1024 lds
    v_mfma_f32_16x16x32_bf16 a[224:227], v[120:123], v[80:83], 0
    s_waitcnt lgkmcnt(15)
    v_mfma_f32_16x16x32_bf16 a[228:231], v[124:127], v[80:83], 0
    v_mfma_f32_16x16x32_bf16 a[40:43], v[96:99], v[84:87], 0
    ds_read_b64_tr_b16 v[80:81], v28 offset:16384
    v_mfma_f32_16x16x32_bf16 a[44:47], v[100:103], v[84:87], 0
    ds_read_b64_tr_b16 v[82:83], v28 offset:18432
    ds_read_b128 v[148:151], v49 offset:43008
    v_mfma_f32_16x16x32_bf16 a[104:107], v[104:107], v[84:87], 0
    buffer_load_dwordx4 v10, s[8:11], s66 offen offset:2048 lds
    v_mfma_f32_16x16x32_bf16 a[108:111], v[108:111], v[84:87], 0
    v_mfma_f32_16x16x32_bf16 a[168:171], v[112:115], v[84:87], 0
    buffer_load_dwordx4 v11, s[8:11], s66 offen offset:3072 lds
    v_mfma_f32_16x16x32_bf16 a[172:175], v[116:119], v[84:87], 0
    v_mfma_f32_16x16x32_bf16 a[232:235], v[120:123], v[84:87], 0
    v_mfma_f32_16x16x32_bf16 a[236:239], v[124:127], v[84:87], 0
    ds_read_b128 v[152:155], v49 offset:45056
    v_mfma_f32_16x16x32_bf16 a[48:51], v[96:99], v[88:91], 0
    ds_read_b64_tr_b16 v[84:85], v29 offset:16384
    v_mfma_f32_16x16x32_bf16 a[52:55], v[100:103], v[88:91], 0
    s_add_u32 m0, s64, 135168
    ds_read_b64_tr_b16 v[86:87], v29 offset:18432
    v_mfma_f32_16x16x32_bf16 a[112:115], v[104:107], v[88:91], 0
    buffer_load_dwordx4 v12, s[8:11], s66 offen offset:0 lds
    v_mfma_f32_16x16x32_bf16 a[116:119], v[108:111], v[88:91], 0
    v_mfma_f32_16x16x32_bf16 a[176:179], v[112:115], v[88:91], 0
    buffer_load_dwordx4 v13, s[8:11], s66 offen offset:1024 lds
    v_mfma_f32_16x16x32_bf16 a[180:183], v[116:119], v[88:91], 0
    ds_read_b128 v[156:159], v49 offset:47104
    v_mfma_f32_16x16x32_bf16 a[240:243], v[120:123], v[88:91], 0
    s_waitcnt lgkmcnt(15)
    v_mfma_f32_16x16x32_bf16 a[244:247], v[124:127], v[88:91], 0
    buffer_load_dwordx4 v14, s[8:11], s66 offen offset:2048 lds
    v_mfma_f32_16x16x32_bf16 a[56:59], v[96:99], v[92:95], 0
    ds_read_b64_tr_b16 v[88:89], v30 offset:16384
    v_mfma_f32_16x16x32_bf16 a[60:63], v[100:103], v[92:95], 0
    ds_read_b64_tr_b16 v[90:91], v30 offset:18432
    v_mfma_f32_16x16x32_bf16 a[120:123], v[104:107], v[92:95], 0
    v_mfma_f32_16x16x32_bf16 a[124:127], v[108:111], v[92:95], 0
    buffer_load_dwordx4 v15, s[8:11], s66 offen offset:3072 lds
    v_mfma_f32_16x16x32_bf16 a[184:187], v[112:115], v[92:95], 0
    s_add_u32 s66, s66, 128
    s_and_b32 s66, s66, 0x3ff
    v_mfma_f32_16x16x32_bf16 a[188:191], v[116:119], v[92:95], 0
    v_mfma_f32_16x16x32_bf16 a[248:251], v[120:123], v[92:95], 0
    s_waitcnt lgkmcnt(2)
    v_mfma_f32_16x16x32_bf16 a[252:255], v[124:127], v[92:95], 0
    ds_read_b64_tr_b16 v[92:93], v31 offset:16384
    ds_read_b64_tr_b16 v[94:95], v31 offset:18432
    v_mfma_f32_16x16x32_bf16 a[0:3], v[128:131], v[64:67], a[0:3]
    s_waitcnt vmcnt(11)
    v_lshlrev_b32 v184, 16, v160
    v_and_b32 v185, 0xffff0000, v160
    v_lshlrev_b32 v186, 16, v161
    v_mfma_f32_16x16x32_bf16 a[4:7], v[132:135], v[64:67], a[4:7]
    v_and_b32 v187, 0xffff0000, v161
    v_lshlrev_b32 v188, 16, v162
    v_mfma_f32_16x16x32_bf16 a[64:67], v[136:139], v[64:67], a[64:67]
    v_and_b32 v189, 0xffff0000, v162
    v_lshlrev_b32 v190, 16, v163
    v_and_b32 v191, 0xffff0000, v163
    v_mfma_f32_16x16x32_bf16 a[68:71], v[140:143], v[64:67], a[68:71]
    s_waitcnt vmcnt(10)
    v_lshlrev_b32 v192, 16, v164
    v_and_b32 v193, 0xffff0000, v164
    v_lshlrev_b32 v194, 16, v165
    v_mfma_f32_16x16x32_bf16 a[128:131], v[144:147], v[64:67], a[128:131]
    v_and_b32 v195, 0xffff0000, v165
    v_lshlrev_b32 v196, 16, v166
    v_mfma_f32_16x16x32_bf16 a[132:135], v[148:151], v[64:67], a[132:135]
    v_and_b32 v197, 0xffff0000, v166
    v_lshlrev_b32 v198, 16, v167
    v_and_b32 v199, 0xffff0000, v167
    v_mfma_f32_16x16x32_bf16 a[192:195], v[152:155], v[64:67], a[192:195]
    s_waitcnt vmcnt(9)
    v_lshlrev_b32 v200, 16, v168
    v_and_b32 v201, 0xffff0000, v168
    v_mfma_f32_16x16x32_bf16 a[196:199], v[156:159], v[64:67], a[196:199]
    v_lshlrev_b32 v202, 16, v169
    s_waitcnt lgkmcnt(0)
    s_barrier
    v_mfma_f32_16x16x32_bf16 a[8:11], v[128:131], v[68:71], a[8:11]
    ds_read_b64_tr_b16 v[64:65], v24 offset:32768
    v_and_b32 v203, 0xffff0000, v169
    v_lshlrev_b32 v204, 16, v170
    v_mfma_f32_16x16x32_bf16 a[12:15], v[132:135], v[68:71], a[12:15]
    s_add_u32 m0, s64, 65536
    ds_read_b64_tr_b16 v[66:67], v24 offset:34816
    v_and_b32 v205, 0xffff0000, v170
    v_mfma_f32_16x16x32_bf16 a[72:75], v[136:139], v[68:71], a[72:75]
    buffer_load_dwordx4 v16, s[12:15], s67 offen offset:0 lds
    v_mfma_f32_16x16x32_bf16 a[76:79], v[140:143], v[68:71], a[76:79]
    ds_read_b128 v[96:99], v48 offset:0
    v_lshlrev_b32 v206, 16, v171
    v_mfma_f32_16x16x32_bf16 a[136:139], v[144:147], v[68:71], a[136:139]
    buffer_load_dwordx4 v17, s[12:15], s67 offen offset:1024 lds
    v_mfma_f32_16x16x32_bf16 a[140:143], v[148:151], v[68:71], a[140:143]
    v_and_b32 v207, 0xffff0000, v171
    v_mfma_f32_16x16x32_bf16 a[200:203], v[152:155], v[68:71], a[200:203]
    s_waitcnt vmcnt(10)
    v_lshlrev_b32 v208, 16, v172
    v_and_b32 v209, 0xffff0000, v172
    v_lshlrev_b32 v210, 16, v173
    v_mfma_f32_16x16x32_bf16 a[204:207], v[156:159], v[68:71], a[204:207]
    buffer_load_dwordx4 v18, s[12:15], s67 offen offset:2048 lds
    v_mfma_f32_16x16x32_bf16 a[16:19], v[128:131], v[72:75], a[16:19]
    ds_read_b64_tr_b16 v[68:69], v25 offset:32768
    v_mfma_f32_16x16x32_bf16 a[20:23], v[132:135], v[72:75], a[20:23]
    ds_read_b64_tr_b16 v[70:71], v25 offset:34816
    ds_read_b128 v[100:103], v48 offset:2048
    v_and_b32 v211, 0xffff0000, v173
    v_mfma_f32_16x16x32_bf16 a[80:83], v[136:139], v[72:75], a[80:83]
    buffer_load_dwordx4 v19, s[12:15], s67 offen offset:3072 lds
    v_mfma_f32_16x16x32_bf16 a[84:87], v[140:143], v[72:75], a[84:87]
    s_add_u32 m0, s64, 69632
    v_lshlrev_b32 v212, 16, v174
    v_and_b32 v213, 0xffff0000, v174
    v_mfma_f32_16x16x32_bf16 a[144:147], v[144:147], v[72:75], a[144:147]
    buffer_load_dwordx4 v20, s[12:15], s67 offen offset:0 lds
    v_mfma_f32_16x16x32_bf16 a[148:151], v[148:151], v[72:75], a[148:151]
    v_lshlrev_b32 v214, 16, v175
    v_mfma_f32_16x16x32_bf16 a[208:211], v[152:155], v[72:75], a[208:211]
    v_and_b32 v215, 0xffff0000, v175
    v_add_f32 v216, v184, v185
    v_mul_f32 v217, v184, v184
    v_mfma_f32_16x16x32_bf16 a[212:215], v[156:159], v[72:75], a[212:215]
    ds_read_b128 v[104:107], v48 offset:4096
    v_fmac_f32 v217, v185, v185
    v_mfma_f32_16x16x32_bf16 a[24:27], v[128:131], v[76:79], a[24:27]
    ds_read_b64_tr_b16 v[72:73], v26 offset:32768
    v_add_f32 v216, v216, v186
    v_fmac_f32 v217, v186, v186
    v_mfma_f32_16x16x32_bf16 a[28:31], v[132:135], v[76:79], a[28:31]
    ds_read_b64_tr_b16 v[74:75], v26 offset:34816
    v_add_f32 v216, v216, v187
    v_fmac_f32 v217, v187, v187
    v_mfma_f32_16x16x32_bf16 a[88:91], v[136:139], v[76:79], a[88:91]
    buffer_load_dwordx4 v21, s[12:15], s67 offen offset:1024 lds
    v_mfma_f32_16x16x32_bf16 a[92:95], v[140:143], v[76:79], a[92:95]
    buffer_load_dwordx4 v22, s[12:15], s67 offen offset:2048 lds
    v_mfma_f32_16x16x32_bf16 a[152:155], v[144:147], v[76:79], a[152:155]
    buffer_load_dwordx4 v23, s[12:15], s67 offen offset:3072 lds
    v_mfma_f32_16x16x32_bf16 a[156:159], v[148:151], v[76:79], a[156:159]
    s_add_u32 s67, s67, 524288
    s_and_b32 s67, s67, 0x3fffff
    ds_read_b128 v[108:111], v48 offset:6144
    v_mfma_f32_16x16x32_bf16 a[216:219], v[152:155], v[76:79], a[216:219]
    v_mfma_f32_16x16x32_bf16 a[220:223], v[156:159], v[76:79], a[220:223]
    v_add_f32 v216, v216, v188
    v_fmac_f32 v217, v188, v188
    v_mfma_f32_16x16x32_bf16 a[32:35], v[128:131], v[80:83], a[32:35]
    ds_read_b64_tr_b16 v[76:77], v27 offset:32768
    v_add_f32 v216, v216, v189
    v_fmac_f32 v217, v189, v189
    v_mfma_f32_16x16x32_bf16 a[36:39], v[132:135], v[80:83], a[36:39]
    ds_read_b64_tr_b16 v[78:79], v27 offset:34816
    v_add_f32 v216, v216, v190
    v_fmac_f32 v217, v190, v190
    v_mfma_f32_16x16x32_bf16 a[96:99], v[136:139], v[80:83], a[96:99]
    buffer_load_dword v37, v39, s[8:11], s78 offen
    v_mfma_f32_16x16x32_bf16 a[100:103], v[140:143], v[80:83], a[100:103]
    ds_read_b128 v[112:115], v48 offset:8192
    v_mfma_f32_16x16x32_bf16 a[160:163], v[144:147], v[80:83], a[160:163]
    s_add_u32 m0, s64, 32768
    v_add_f32 v216, v216, v191
    v_fmac_f32 v217, v191, v191
    v_add_f32 v216, v216, v192
    v_mfma_f32_16x16x32_bf16 a[164:167], v[148:151], v[80:83], a[164:167]
    buffer_load_dwordx4 v8, s[8:11], s66 offen offset:0 lds
    v_mfma_f32_16x16x32_bf16 a[224:227], v[152:155], v[80:83], a[224:227]
    v_fmac_f32 v217, v192, v192
    v_add_f32 v216, v216, v193
    v_mfma_f32_16x16x32_bf16 a[228:231], v[156:159], v[80:83], a[228:231]
    v_fmac_f32 v217, v193, v193
    v_add_f32 v216, v216, v194
    v_fmac_f32 v217, v194, v194
    v_mfma_f32_16x16x32_bf16 a[40:43], v[128:131], v[84:87], a[40:43]
    ds_read_b64_tr_b16 v[80:81], v28 offset:32768
    v_add_f32 v216, v216, v195
    v_fmac_f32 v217, v195, v195
    v_mfma_f32_16x16x32_bf16 a[44:47], v[132:135], v[84:87], a[44:47]
    ds_read_b64_tr_b16 v[82:83], v28 offset:34816
    ds_read_b128 v[116:119], v48 offset:10240
    v_add_f32 v216, v216, v196
    v_mfma_f32_16x16x32_bf16 a[104:107], v[136:139], v[84:87], a[104:107]
    buffer_load_dwordx4 v9, s[8:11], s66 offen offset:1024 lds
    v_mfma_f32_16x16x32_bf16 a[108:111], v[140:143], v[84:87], a[108:111]
    buffer_load_dwordx4 v10, s[8:11], s66 offen offset:2048 lds
    v_mfma_f32_16x16x32_bf16 a[168:171], v[144:147], v[84:87], a[168:171]
    v_mfma_f32_16x16x32_bf16 a[172:175], v[148:151], v[84:87], a[172:175]
    v_fmac_f32 v217, v196, v196
    v_add_f32 v216, v216, v197
    v_fmac_f32 v217, v197, v197
    v_mfma_f32_16x16x32_bf16 a[232:235], v[152:155], v[84:87], a[232:235]
    buffer_load_dwordx4 v11, s[8:11], s66 offen offset:3072 lds
    v_mfma_f32_16x16x32_bf16 a[236:239], v[156:159], v[84:87], a[236:239]
    ds_read_b128 v[120:123], v48 offset:12288
    v_add_f32 v216, v216, v198
    v_mfma_f32_16x16x32_bf16 a[48:51], v[128:131], v[88:91], a[48:51]
    ds_read_b64_tr_b16 v[84:85], v29 offset:32768
    v_fmac_f32 v217, v198, v198
    v_add_f32 v216, v216, v199
    v_mfma_f32_16x16x32_bf16 a[52:55], v[132:135], v[88:91], a[52:55]
    s_add_u32 m0, s64, 36864
    ds_read_b64_tr_b16 v[86:87], v29 offset:34816
    v_fmac_f32 v217, v199, v199
    v_add_f32 v216, v216, v200
    v_mfma_f32_16x16x32_bf16 a[112:115], v[136:139], v[88:91], a[112:115]
    buffer_load_dwordx4 v12, s[8:11], s66 offen offset:0 lds
    v_mfma_f32_16x16x32_bf16 a[116:119], v[140:143], v[88:91], a[116:119]
    v_fmac_f32 v217, v200, v200
    v_add_f32 v216, v216, v201
    v_mfma_f32_16x16x32_bf16 a[176:179], v[144:147], v[88:91], a[176:179]
    v_fmac_f32 v217, v201, v201
    v_add_f32 v216, v216, v202
    v_mfma_f32_16x16x32_bf16 a[180:183], v[148:151], v[88:91], a[180:183]
    ds_read_b128 v[124:127], v48 offset:14336
    v_fmac_f32 v217, v202, v202
    v_add_f32 v216, v216, v203
    v_mfma_f32_16x16x32_bf16 a[240:243], v[152:155], v[88:91], a[240:243]
    buffer_load_dwordx4 v13, s[8:11], s66 offen offset:1024 lds
    v_mfma_f32_16x16x32_bf16 a[244:247], v[156:159], v[88:91], a[244:247]
    v_fmac_f32 v217, v203, v203
    v_add_f32 v216, v216, v204
    v_mfma_f32_16x16x32_bf16 a[56:59], v[128:131], v[92:95], a[56:59]
    ds_read_b64_tr_b16 v[88:89], v30 offset:32768
    v_fmac_f32 v217, v204, v204
    v_add_f32 v216, v216, v205
    v_mfma_f32_16x16x32_bf16 a[60:63], v[132:135], v[92:95], a[60:63]
    ds_read_b64_tr_b16 v[90:91], v30 offset:34816
    v_fmac_f32 v217, v205, v205
    v_add_f32 v216, v216, v206
    v_mfma_f32_16x16x32_bf16 a[120:123], v[136:139], v[92:95], a[120:123]
    buffer_load_dwordx4 v14, s[8:11], s66 offen offset:2048 lds
    v_mfma_f32_16x16x32_bf16 a[124:127], v[140:143], v[92:95], a[124:127]
    buffer_load_dwordx4 v15, s[8:11], s66 offen offset:3072 lds
    v_mfma_f32_16x16x32_bf16 a[184:187], v[144:147], v[92:95], a[184:187]
    s_add_u32 s66, s66, 128
    s_and_b32 s66, s66, 0x3ff
    v_mfma_f32_16x16x32_bf16 a[188:191], v[148:151], v[92:95], a[188:191]
    v_fmac_f32 v217, v206, v206
    v_add_f32 v216, v216, v207
    v_mfma_f32_16x16x32_bf16 a[248:251], v[152:155], v[92:95], a[248:251]
    s_waitcnt lgkmcnt(2)
    v_fmac_f32 v217, v207, v207
    v_add_f32 v216, v216, v208
    v_fmac_f32 v217, v208, v208
    v_mfma_f32_16x16x32_bf16 a[252:255], v[156:159], v[92:95], a[252:255]
    ds_read_b64_tr_b16 v[92:93], v31 offset:32768
    ds_read_b64_tr_b16 v[94:95], v31 offset:34816
    v_add_f32 v216, v216, v209
    v_mfma_f32_16x16x32_bf16 a[0:3], v[96:99], v[64:67], a[0:3]
    v_fmac_f32 v217, v209, v209
    v_add_f32 v216, v216, v210
    v_mfma_f32_16x16x32_bf16 a[4:7], v[100:103], v[64:67], a[4:7]
    v_fmac_f32 v217, v210, v210
    v_add_f32 v216, v216, v211
    v_mfma_f32_16x16x32_bf16 a[64:67], v[104:107], v[64:67], a[64:67]
    v_fmac_f32 v217, v211, v211
    v_mfma_f32_16x16x32_bf16 a[68:71], v[108:111], v[64:67], a[68:71]
    v_add_f32 v216, v216, v212
    v_fmac_f32 v217, v212, v212
    v_mfma_f32_16x16x32_bf16 a[128:131], v[112:115], v[64:67], a[128:131]
    v_add_f32 v216, v216, v213
    v_fmac_f32 v217, v213, v213
    v_mfma_f32_16x16x32_bf16 a[132:135], v[116:119], v[64:67], a[132:135]
    v_add_f32 v216, v216, v214
    v_fmac_f32 v217, v214, v214
    v_mfma_f32_16x16x32_bf16 a[192:195], v[120:123], v[64:67], a[192:195]
    v_add_f32 v216, v216, v215
    v_fmac_f32 v217, v215, v215
    v_mfma_f32_16x16x32_bf16 a[196:199], v[124:127], v[64:67], a[196:199]
    s_nop 1
    v_mfma_f32_16x16x32_bf16 a[8:11], v[96:99], v[68:71], a[8:11]
    ds_read_b64_tr_b16 v[64:65], v24 offset:49152
    v_mfma_f32_16x16x32_bf16 a[12:15], v[100:103], v[68:71], a[12:15]
    ds_read_b64_tr_b16 v[66:67], v24 offset:51200
    v_add_f32_dpp v216, v216, v216 row_ror:8 row_mask:0xf bank_mask:0xf
    v_mfma_f32_16x16x32_bf16 a[72:75], v[104:107], v[68:71], a[72:75]
    v_add_f32_dpp v217, v217, v217 row_ror:8 row_mask:0xf bank_mask:0xf
    v_mov_b32 v218, v216
    v_mfma_f32_16x16x32_bf16 a[76:79], v[108:111], v[68:71], a[76:79]
    ds_read_b128 v[128:131], v49 offset:0
    v_mov_b32 v219, v217
    v_mfma_f32_16x16x32_bf16 a[136:139], v[112:115], v[68:71], a[136:139]
    s_nop 0
    v_mfma_f32_16x16x32_bf16 a[140:143], v[116:119], v[68:71], a[140:143]
    v_permlane16_swap_b32 v216, v218
    s_nop 0
    v_mfma_f32_16x16x32_bf16 a[200:203], v[120:123], v[68:71], a[200:203]
    v_permlane16_swap_b32 v217, v219
    v_add_f32 v216, v216, v218
    v_mfma_f32_16x16x32_bf16 a[204:207], v[124:127], v[68:71], a[204:207]
    v_add_f32 v217, v217, v219
    v_mov_b32 v218, v216
    v_mfma_f32_16x16x32_bf16 a[16:19], v[96:99], v[72:75], a[16:19]
    ds_read_b64_tr_b16 v[68:69], v25 offset:49152
    v_mov_b32 v219, v217
    v_mfma_f32_16x16x32_bf16 a[20:23], v[100:103], v[72:75], a[20:23]
    ds_read_b64_tr_b16 v[70:71], v25 offset:51200
    ds_read_b128 v[132:135], v49 offset:2048
    v_mfma_f32_16x16x32_bf16 a[80:83], v[104:107], v[72:75], a[80:83]
    s_nop 0
    v_mfma_f32_16x16x32_bf16 a[84:87], v[108:111], v[72:75], a[84:87]
    v_permlane32_swap_b32 v216, v218
    s_nop 0
    v_mfma_f32_16x16x32_bf16 a[144:147], v[112:115], v[72:75], a[144:147]
    v_permlane32_swap_b32 v217, v219
    v_add_f32 v216, v216, v218
    v_mfma_f32_16x16x32_bf16 a[148:151], v[116:119], v[72:75], a[148:151]
    v_add_f32 v217, v217, v219
    s_lshl_b32 s5, s2, 7
    v_mfma_f32_16x16x32_bf16 a[208:211], v[120:123], v[72:75], a[208:211]
    s_add_u32 s5, s5, 74186752
    v_mfma_f32_16x16x32_bf16 a[212:215], v[124:127], v[72:75], a[212:215]
    ds_read_b128 v[136:139], v49 offset:4096
    v_lshrrev_b32 v59, 2, v0
    v_mfma_f32_16x16x32_bf16 a[24:27], v[96:99], v[76:79], a[24:27]
    ds_read_b64_tr_b16 v[72:73], v26 offset:49152
    v_min_u32 v59, 1, v59
    v_mfma_f32_16x16x32_bf16 a[28:31], v[100:103], v[76:79], a[28:31]
    ds_read_b64_tr_b16 v[74:75], v26 offset:51200
    v_lshlrev_b32 v59, 30, v59
    v_mfma_f32_16x16x32_bf16 a[88:91], v[104:107], v[76:79], a[88:91]
    v_lshl_add_u32 v58, v0, 15, v59
    v_mov_b32 v59, 0
    v_mfma_f32_16x16x32_bf16 a[92:95], v[108:111], v[76:79], a[92:95]
    v_mfma_f32_16x16x32_bf16 a[152:155], v[112:115], v[76:79], a[152:155]
    buffer_store_dword v59, v58, s[16:19], s5 offen sc1
    v_mfma_f32_16x16x32_bf16 a[156:159], v[116:119], v[76:79], a[156:159]
    ds_read_b128 v[140:143], v49 offset:6144
    v_mfma_f32_16x16x32_bf16 a[216:219], v[120:123], v[76:79], a[216:219]
    buffer_store_dwordx2 v[216:217], v55, s[16:19], 0 offen
    v_mfma_f32_16x16x32_bf16 a[220:223], v[124:127], v[76:79], a[220:223]
    v_mfma_f32_16x16x32_bf16 a[32:35], v[96:99], v[80:83], a[32:35]
    ds_read_b64_tr_b16 v[76:77], v27 offset:49152
    v_mfma_f32_16x16x32_bf16 a[36:39], v[100:103], v[80:83], a[36:39]
    ds_read_b64_tr_b16 v[78:79], v27 offset:51200
    v_mfma_f32_16x16x32_bf16 a[96:99], v[104:107], v[80:83], a[96:99]
    v_mfma_f32_16x16x32_bf16 a[100:103], v[108:111], v[80:83], a[100:103]
    ds_read_b128 v[144:147], v49 offset:8192
    v_mfma_f32_16x16x32_bf16 a[160:163], v[112:115], v[80:83], a[160:163]
    v_mfma_f32_16x16x32_bf16 a[164:167], v[116:119], v[80:83], a[164:167]
    v_mfma_f32_16x16x32_bf16 a[224:227], v[120:123], v[80:83], a[224:227]
    v_mfma_f32_16x16x32_bf16 a[228:231], v[124:127], v[80:83], a[228:231]
    v_mfma_f32_16x16x32_bf16 a[40:43], v[96:99], v[84:87], a[40:43]
    ds_read_b64_tr_b16 v[80:81], v28 offset:49152
    v_mfma_f32_16x16x32_bf16 a[44:47], v[100:103], v[84:87], a[44:47]
    ds_read_b64_tr_b16 v[82:83], v28 offset:51200
    ds_read_b128 v[148:151], v49 offset:10240
    v_mfma_f32_16x16x32_bf16 a[104:107], v[104:107], v[84:87], a[104:107]
    v_mfma_f32_16x16x32_bf16 a[108:111], v[108:111], v[84:87], a[108:111]
    v_mfma_f32_16x16x32_bf16 a[168:171], v[112:115], v[84:87], a[168:171]
    v_mfma_f32_16x16x32_bf16 a[172:175], v[116:119], v[84:87], a[172:175]
    v_mfma_f32_16x16x32_bf16 a[232:235], v[120:123], v[84:87], a[232:235]
    s_waitcnt lgkmcnt(15)
    v_mfma_f32_16x16x32_bf16 a[236:239], v[124:127], v[84:87], a[236:239]
    ds_read_b128 v[152:155], v49 offset:12288
    v_mfma_f32_16x16x32_bf16 a[48:51], v[96:99], v[88:91], a[48:51]
    ds_read_b64_tr_b16 v[84:85], v29 offset:49152
    v_mfma_f32_16x16x32_bf16 a[52:55], v[100:103], v[88:91], a[52:55]
    ds_read_b64_tr_b16 v[86:87], v29 offset:51200
    v_mfma_f32_16x16x32_bf16 a[112:115], v[104:107], v[88:91], a[112:115]
    v_mfma_f32_16x16x32_bf16 a[116:119], v[108:111], v[88:91], a[116:119]
    v_mfma_f32_16x16x32_bf16 a[176:179], v[112:115], v[88:91], a[176:179]
    v_mfma_f32_16x16x32_bf16 a[180:183], v[116:119], v[88:91], a[180:183]
    ds_read_b128 v[156:159], v49 offset:14336
    v_mfma_f32_16x16x32_bf16 a[240:243], v[120:123], v[88:91], a[240:243]
    v_mfma_f32_16x16x32_bf16 a[244:247], v[124:127], v[88:91], a[244:247]
    v_mfma_f32_16x16x32_bf16 a[56:59], v[96:99], v[92:95], a[56:59]
    ds_read_b64_tr_b16 v[88:89], v30 offset:49152
    v_mfma_f32_16x16x32_bf16 a[60:63], v[100:103], v[92:95], a[60:63]
    ds_read_b64_tr_b16 v[90:91], v30 offset:51200
    v_mfma_f32_16x16x32_bf16 a[120:123], v[104:107], v[92:95], a[120:123]
    v_mfma_f32_16x16x32_bf16 a[124:127], v[108:111], v[92:95], a[124:127]
    v_mfma_f32_16x16x32_bf16 a[184:187], v[112:115], v[92:95], a[184:187]
    v_mfma_f32_16x16x32_bf16 a[188:191], v[116:119], v[92:95], a[188:191]
    v_mfma_f32_16x16x32_bf16 a[248:251], v[120:123], v[92:95], a[248:251]
    s_waitcnt lgkmcnt(2)
    v_mfma_f32_16x16x32_bf16 a[252:255], v[124:127], v[92:95], a[252:255]
    ds_read_b64_tr_b16 v[92:93], v31 offset:49152
    ds_read_b64_tr_b16 v[94:95], v31 offset:51200
    v_mfma_f32_16x16x32_bf16 a[0:3], v[128:131], v[64:67], a[0:3]
    v_mfma_f32_16x16x32_bf16 a[4:7], v[132:135], v[64:67], a[4:7]
    v_mfma_f32_16x16x32_bf16 a[64:67], v[136:139], v[64:67], a[64:67]
    v_mfma_f32_16x16x32_bf16 a[68:71], v[140:143], v[64:67], a[68:71]
    v_mfma_f32_16x16x32_bf16 a[128:131], v[144:147], v[64:67], a[128:131]
    v_mfma_f32_16x16x32_bf16 a[132:135], v[148:151], v[64:67], a[132:135]
    v_mfma_f32_16x16x32_bf16 a[192:195], v[152:155], v[64:67], a[192:195]
    v_mfma_f32_16x16x32_bf16 a[196:199], v[156:159], v[64:67], a[196:199]
    s_waitcnt vmcnt(0) lgkmcnt(0)
    s_barrier
    v_mfma_f32_16x16x32_bf16 a[8:11], v[128:131], v[68:71], a[8:11]
    ds_read_b64_tr_b16 v[64:65], v24 offset:0
    v_mfma_f32_16x16x32_bf16 a[12:15], v[132:135], v[68:71], a[12:15]
    s_add_u32 m0, s64, 98304
    ds_read_b64_tr_b16 v[66:67], v24 offset:2048
    v_mfma_f32_16x16x32_bf16 a[72:75], v[136:139], v[68:71], a[72:75]
    buffer_load_dwordx4 v16, s[12:15], s67 offen offset:0 lds
    v_mfma_f32_16x16x32_bf16 a[76:79], v[140:143], v[68:71], a[76:79]
    ds_read_b128 v[96:99], v50 offset:0
    v_mfma_f32_16x16x32_bf16 a[136:139], v[144:147], v[68:71], a[136:139]
    buffer_load_dwordx4 v17, s[12:15], s67 offen offset:1024 lds
    v_mfma_f32_16x16x32_bf16 a[140:143], v[148:151], v[68:71], a[140:143]
    v_mfma_f32_16x16x32_bf16 a[200:203], v[152:155], v[68:71], a[200:203]
    v_mfma_f32_16x16x32_bf16 a[204:207], v[156:159], v[68:71], a[204:207]
    buffer_load_dwordx4 v18, s[12:15], s67 offen offset:2048 lds
    v_mfma_f32_16x16x32_bf16 a[16:19], v[128:131], v[72:75], a[16:19]
    ds_read_b64_tr_b16 v[68:69], v25 offset:0
    v_mfma_f32_16x16x32_bf16 a[20:23], v[132:135], v[72:75], a[20:23]
    ds_read_b64_tr_b16 v[70:71], v25 offset:2048
    ds_read_b128 v[100:103], v50 offset:2048
    v_mfma_f32_16x16x32_bf16 a[80:83], v[136:139], v[72:75], a[80:83]
    buffer_load_dwordx4 v19, s[12:15], s67 offen offset:3072 lds
    v_mfma_f32_16x16x32_bf16 a[84:87], v[140:143], v[72:75], a[84:87]
    s_add_u32 m0, s64, 102400
    v_mfma_f32_16x16x32_bf16 a[144:147], v[144:147], v[72:75], a[144:147]
    buffer_load_dwordx4 v20, s[12:15], s67 offen offset:0 lds
    v_mfma_f32_16x16x32_bf16 a[148:151], v[148:151], v[72:75], a[148:151]
    v_mfma_f32_16x16x32_bf16 a[208:211], v[152:155], v[72:75], a[208:211]
    v_mfma_f32_16x16x32_bf16 a[212:215], v[156:159], v[72:75], a[212:215]
    ds_read_b128 v[104:107], v50 offset:4096
    v_mfma_f32_16x16x32_bf16 a[24:27], v[128:131], v[76:79], a[24:27]
    ds_read_b64_tr_b16 v[72:73], v26 offset:0
    v_mfma_f32_16x16x32_bf16 a[28:31], v[132:135], v[76:79], a[28:31]
    ds_read_b64_tr_b16 v[74:75], v26 offset:2048
    v_mfma_f32_16x16x32_bf16 a[88:91], v[136:139], v[76:79], a[88:91]
    buffer_load_dwordx4 v21, s[12:15], s67 offen offset:1024 lds
    v_mfma_f32_16x16x32_bf16 a[92:95], v[140:143], v[76:79], a[92:95]
    buffer_load_dwordx4 v22, s[12:15], s67 offen offset:2048 lds
    v_mfma_f32_16x16x32_bf16 a[152:155], v[144:147], v[76:79], a[152:155]
    buffer_load_dwordx4 v23, s[12:15], s67 offen offset:3072 lds
    v_mfma_f32_16x16x32_bf16 a[156:159], v[148:151], v[76:79], a[156:159]
    s_add_u32 s67, s67, 524288
    s_and_b32 s67, s67, 0x3fffff
    ds_read_b128 v[108:111], v50 offset:6144
    v_mfma_f32_16x16x32_bf16 a[216:219], v[152:155], v[76:79], a[216:219]
    v_mfma_f32_16x16x32_bf16 a[220:223], v[156:159], v[76:79], a[220:223]
    v_mfma_f32_16x16x32_bf16 a[32:35], v[128:131], v[80:83], a[32:35]
    ds_read_b64_tr_b16 v[76:77], v27 offset:0
    v_mfma_f32_16x16x32_bf16 a[36:39], v[132:135], v[80:83], a[36:39]
    ds_read_b64_tr_b16 v[78:79], v27 offset:2048
    v_mfma_f32_16x16x32_bf16 a[96:99], v[136:139], v[80:83], a[96:99]
    buffer_load_dwordx4 v[176:179], v54, s[16:19], 0 offen offset:0 sc1
    v_mfma_f32_16x16x32_bf16 a[100:103], v[140:143], v[80:83], a[100:103]
    ds_read_b128 v[112:115], v50 offset:8192
    v_mfma_f32_16x16x32_bf16 a[160:163], v[144:147], v[80:83], a[160:163]
    buffer_load_dwordx4 v[180:183], v54, s[16:19], 0 offen offset:16 sc1
    v_mfma_f32_16x16x32_bf16 a[164:167], v[148:151], v[80:83], a[164:167]
    v_mfma_f32_16x16x32_bf16 a[224:227], v[152:155], v[80:83], a[224:227]
    s_add_u32 m0, s64, 0
    v_mfma_f32_16x16x32_bf16 a[228:231], v[156:159], v[80:83], a[228:231]
    buffer_load_dwordx4 v8, s[8:11], s66 offen offset:0 lds
    v_mfma_f32_16x16x32_bf16 a[40:43], v[128:131], v[84:87], a[40:43]
    ds_read_b64_tr_b16 v[80:81], v28 offset:0
    v_mfma_f32_16x16x32_bf16 a[44:47], v[132:135], v[84:87], a[44:47]
    ds_read_b64_tr_b16 v[82:83], v28 offset:2048
    ds_read_b128 v[116:119], v50 offset:10240
    v_mfma_f32_16x16x32_bf16 a[104:107], v[136:139], v[84:87], a[104:107]
    buffer_load_dwordx4 v9, s[8:11], s66 offen offset:1024 lds
    v_mfma_f32_16x16x32_bf16 a[108:111], v[140:143], v[84:87], a[108:111]
    v_mfma_f32_16x16x32_bf16 a[168:171], v[144:147], v[84:87], a[168:171]
    buffer_load_dwordx4 v10, s[8:11], s66 offen offset:2048 lds
    v_mfma_f32_16x16x32_bf16 a[172:175], v[148:151], v[84:87], a[172:175]
    v_mfma_f32_16x16x32_bf16 a[232:235], v[152:155], v[84:87], a[232:235]
    v_mfma_f32_16x16x32_bf16 a[236:239], v[156:159], v[84:87], a[236:239]
    ds_read_b128 v[120:123], v50 offset:12288
    v_mfma_f32_16x16x32_bf16 a[48:51], v[128:131], v[88:91], a[48:51]
    ds_read_b64_tr_b16 v[84:85], v29 offset:0
    v_mfma_f32_16x16x32_bf16 a[52:55], v[132:135], v[88:91], a[52:55]
    ds_read_b64_tr_b16 v[86:87], v29 offset:2048
    v_mfma_f32_16x16x32_bf16 a[112:115], v[136:139], v[88:91], a[112:115]
    buffer_load_dwordx4 v11, s[8:11], s66 offen offset:3072 lds
    v_mfma_f32_16x16x32_bf16 a[116:119], v[140:143], v[88:91], a[116:119]
    s_add_u32 m0, s64, 4096
    s_nop 0
    buffer_load_dwordx4 v12, s[8:11], s66 offen offset:0 lds
    v_mfma_f32_16x16x32_bf16 a[176:179], v[144:147], v[88:91], a[176:179]
    buffer_load_dwordx4 v13, s[8:11], s66 offen offset:1024 lds
    v_mfma_f32_16x16x32_bf16 a[180:183], v[148:151], v[88:91], a[180:183]
    ds_read_b128 v[124:127], v50 offset:14336
    v_mfma_f32_16x16x32_bf16 a[240:243], v[152:155], v[88:91], a[240:243]
    v_mfma_f32_16x16x32_bf16 a[244:247], v[156:159], v[88:91], a[244:247]
    buffer_load_dwordx4 v14, s[8:11], s66 offen offset:2048 lds
    v_mfma_f32_16x16x32_bf16 a[56:59], v[128:131], v[92:95], a[56:59]
    ds_read_b64_tr_b16 v[88:89], v30 offset:0
    v_mfma_f32_16x16x32_bf16 a[60:63], v[132:135], v[92:95], a[60:63]
    ds_read_b64_tr_b16 v[90:91], v30 offset:2048
    v_mfma_f32_16x16x32_bf16 a[120:123], v[136:139], v[92:95], a[120:123]
    buffer_load_dwordx4 v15, s[8:11], s66 offen offset:3072 lds
    v_mfma_f32_16x16x32_bf16 a[124:127], v[140:143], v[92:95], a[124:127]
    s_add_u32 s66, s66, 128
    s_and_b32 s66, s66, 0x3ff
    v_mfma_f32_16x16x32_bf16 a[184:187], v[144:147], v[92:95], a[184:187]
    s_cmp_lt_u32 s32, 2
    s_cbranch_scc1 fk_tc1
    buffer_load_dword v36, v40, s[72:75], 0 offen
    s_branch fk_uc1
fk_tc1:
    buffer_load_dword v36, v39, s[8:11], s79 offen
fk_uc1:
    v_mfma_f32_16x16x32_bf16 a[188:191], v[148:151], v[92:95], a[188:191]
    v_mfma_f32_16x16x32_bf16 a[248:251], v[152:155], v[92:95], a[248:251]
    s_waitcnt lgkmcnt(2)
    v_mfma_f32_16x16x32_bf16 a[252:255], v[156:159], v[92:95], a[252:255]
    ds_read_b64_tr_b16 v[92:93], v31 offset:0
    ds_read_b64_tr_b16 v[94:95], v31 offset:2048
    v_mfma_f32_16x16x32_bf16 a[0:3], v[96:99], v[64:67], a[0:3]
    v_mfma_f32_16x16x32_bf16 a[4:7], v[100:103], v[64:67], a[4:7]
    v_mfma_f32_16x16x32_bf16 a[64:67], v[104:107], v[64:67], a[64:67]
    v_mfma_f32_16x16x32_bf16 a[68:71], v[108:111], v[64:67], a[68:71]
    v_mfma_f32_16x16x32_bf16 a[128:131], v[112:115], v[64:67], a[128:131]
    v_mfma_f32_16x16x32_bf16 a[132:135], v[116:119], v[64:67], a[132:135]
    v_mfma_f32_16x16x32_bf16 a[192:195], v[120:123], v[64:67], a[192:195]
    v_mfma_f32_16x16x32_bf16 a[196:199], v[124:127], v[64:67], a[196:199]
    v_mfma_f32_16x16x32_bf16 a[8:11], v[96:99], v[68:71], a[8:11]
    ds_read_b64_tr_b16 v[64:65], v24 offset:16384
    v_mfma_f32_16x16x32_bf16 a[12:15], v[100:103], v[68:71], a[12:15]
    ds_read_b64_tr_b16 v[66:67], v24 offset:18432
    v_mfma_f32_16x16x32_bf16 a[72:75], v[104:107], v[68:71], a[72:75]
    v_mfma_f32_16x16x32_bf16 a[76:79], v[108:111], v[68:71], a[76:79]
    ds_read_b128 v[128:131], v51 offset:0
    v_mfma_f32_16x16x32_bf16 a[136:139], v[112:115], v[68:71], a[136:139]
    v_mfma_f32_16x16x32_bf16 a[140:143], v[116:119], v[68:71], a[140:143]
    v_mfma_f32_16x16x32_bf16 a[200:203], v[120:123], v[68:71], a[200:203]
    v_mfma_f32_16x16x32_bf16 a[204:207], v[124:127], v[68:71], a[204:207]
    v_mfma_f32_16x16x32_bf16 a[16:19], v[96:99], v[72:75], a[16:19]
    ds_read_b64_tr_b16 v[68:69], v25 offset:16384
    v_mfma_f32_16x16x32_bf16 a[20:23], v[100:103], v[72:75], a[20:23]
    ds_read_b64_tr_b16 v[70:71], v25 offset:18432
    ds_read_b128 v[132:135], v51 offset:2048
    v_mfma_f32_16x16x32_bf16 a[80:83], v[104:107], v[72:75], a[80:83]
    v_mfma_f32_16x16x32_bf16 a[84:87], v[108:111], v[72:75], a[84:87]
    v_mfma_f32_16x16x32_bf16 a[144:147], v[112:115], v[72:75], a[144:147]
    v_mfma_f32_16x16x32_bf16 a[148:151], v[116:119], v[72:75], a[148:151]
    v_mfma_f32_16x16x32_bf16 a[208:211], v[120:123], v[72:75], a[208:211]
    v_mfma_f32_16x16x32_bf16 a[212:215], v[124:127], v[72:75], a[212:215]
    ds_read_b128 v[136:139], v51 offset:4096
    v_mfma_f32_16x16x32_bf16 a[24:27], v[96:99], v[76:79], a[24:27]
    ds_read_b64_tr_b16 v[72:73], v26 offset:16384
    v_mfma_f32_16x16x32_bf16 a[28:31], v[100:103], v[76:79], a[28:31]
    ds_read_b64_tr_b16 v[74:75], v26 offset:18432
    v_mfma_f32_16x16x32_bf16 a[88:91], v[104:107], v[76:79], a[88:91]
    v_mfma_f32_16x16x32_bf16 a[92:95], v[108:111], v[76:79], a[92:95]
    v_mfma_f32_16x16x32_bf16 a[152:155], v[112:115], v[76:79], a[152:155]
    v_mfma_f32_16x16x32_bf16 a[156:159], v[116:119], v[76:79], a[156:159]
    ds_read_b128 v[140:143], v51 offset:6144
    v_mfma_f32_16x16x32_bf16 a[216:219], v[120:123], v[76:79], a[216:219]
    v_mfma_f32_16x16x32_bf16 a[220:223], v[124:127], v[76:79], a[220:223]
    v_mfma_f32_16x16x32_bf16 a[32:35], v[96:99], v[80:83], a[32:35]
    ds_read_b64_tr_b16 v[76:77], v27 offset:16384
    v_mfma_f32_16x16x32_bf16 a[36:39], v[100:103], v[80:83], a[36:39]
    ds_read_b64_tr_b16 v[78:79], v27 offset:18432
    v_mfma_f32_16x16x32_bf16 a[96:99], v[104:107], v[80:83], a[96:99]
    s_waitcnt vmcnt(10)
    v_add_f32 v216, v176, v178
    s_waitcnt vmcnt(9)
    v_add_f32 v218, v180, v182
    v_mfma_f32_16x16x32_bf16 a[100:103], v[108:111], v[80:83], a[100:103]
    ds_read_b128 v[144:147], v51 offset:8192
    v_mfma_f32_16x16x32_bf16 a[160:163], v[112:115], v[80:83], a[160:163]
    v_add_f32 v217, v177, v179
    v_mfma_f32_16x16x32_bf16 a[164:167], v[116:119], v[80:83], a[164:167]
    v_add_f32 v219, v181, v183
    v_mfma_f32_16x16x32_bf16 a[224:227], v[120:123], v[80:83], a[224:227]
    v_add_f32 v216, v216, v218
    v_add_f32 v217, v217, v219
    v_mfma_f32_16x16x32_bf16 a[228:231], v[124:127], v[80:83], a[228:231]
    v_mul_f32 v216, 0x3a800000, v216
    v_mfma_f32_16x16x32_bf16 a[40:43], v[96:99], v[84:87], a[40:43]
    ds_read_b64_tr_b16 v[80:81], v28 offset:16384
    v_mfma_f32_16x16x32_bf16 a[44:47], v[100:103], v[84:87], a[44:47]
    ds_read_b64_tr_b16 v[82:83], v28 offset:18432
    ds_read_b128 v[148:151], v51 offset:10240
    v_mfma_f32_16x16x32_bf16 a[104:107], v[104:107], v[84:87], a[104:107]
    v_mfma_f32_16x16x32_bf16 a[108:111], v[108:111], v[84:87], a[108:111]
    v_mul_f32 v217, 0x3a800000, v217
    v_fma_f32 v217, -v216, v216, v217
    v_mfma_f32_16x16x32_bf16 a[168:171], v[112:115], v[84:87], a[168:171]
    v_max_f32 v217, 0, v217
    v_mfma_f32_16x16x32_bf16 a[172:175], v[116:119], v[84:87], a[172:175]
    v_add_f32 v217, 0x3727c5ac, v217
    v_mfma_f32_16x16x32_bf16 a[232:235], v[120:123], v[84:87], a[232:235]
    s_waitcnt lgkmcnt(15)
    v_rsq_f32 v217, v217
    v_mfma_f32_16x16x32_bf16 a[236:239], v[124:127], v[84:87], a[236:239]
    ds_read_b128 v[152:155], v51 offset:12288
    v_mfma_f32_16x16x32_bf16 a[48:51], v[96:99], v[88:91], a[48:51]
    ds_read_b64_tr_b16 v[84:85], v29 offset:16384
    v_mfma_f32_16x16x32_bf16 a[52:55], v[100:103], v[88:91], a[52:55]
    ds_read_b64_tr_b16 v[86:87], v29 offset:18432
    v_mfma_f32_16x16x32_bf16 a[112:115], v[104:107], v[88:91], a[112:115]
    s_nop 0
    v_mfma_f32_16x16x32_bf16 a[116:119], v[108:111], v[88:91], a[116:119]
    v_mul_f32 v217, 0x3e0293ee, v217
    v_mfma_f32_16x16x32_bf16 a[176:179], v[112:115], v[88:91], a[176:179]
    v_mul_f32 v216, v216, v217
    v_fma_f32 v184, v184, v217, -v216
    v_mfma_f32_16x16x32_bf16 a[180:183], v[116:119], v[88:91], a[180:183]
    ds_read_b128 v[156:159], v51 offset:14336
    v_mfma_f32_16x16x32_bf16 a[240:243], v[120:123], v[88:91], a[240:243]
    v_fma_f32 v185, v185, v217, -v216
    v_mfma_f32_16x16x32_bf16 a[244:247], v[124:127], v[88:91], a[244:247]
    v_cvt_pk_bf16_f32 v160, v184, v185
    v_mfma_f32_16x16x32_bf16 a[56:59], v[96:99], v[92:95], a[56:59]
    ds_read_b64_tr_b16 v[88:89], v30 offset:16384
    v_mfma_f32_16x16x32_bf16 a[60:63], v[100:103], v[92:95], a[60:63]
    ds_read_b64_tr_b16 v[90:91], v30 offset:18432
    v_fma_f32 v186, v186, v217, -v216
    v_mfma_f32_16x16x32_bf16 a[120:123], v[104:107], v[92:95], a[120:123]
    v_fma_f32 v187, v187, v217, -v216
    v_mfma_f32_16x16x32_bf16 a[124:127], v[108:111], v[92:95], a[124:127]
    v_cvt_pk_bf16_f32 v161, v186, v187
    v_mfma_f32_16x16x32_bf16 a[184:187], v[112:115], v[92:95], a[184:187]
    v_fma_f32 v188, v188, v217, -v216
    v_mfma_f32_16x16x32_bf16 a[188:191], v[116:119], v[92:95], a[188:191]
    v_fma_f32 v189, v189, v217, -v216
    v_cvt_pk_bf16_f32 v162, v188, v189
    v_mfma_f32_16x16x32_bf16 a[248:251], v[120:123], v[92:95], a[248:251]
    s_waitcnt lgkmcnt(2)
    v_mfma_f32_16x16x32_bf16 a[252:255], v[124:127], v[92:95], a[252:255]
    ds_read_b64_tr_b16 v[92:93], v31 offset:16384
    ds_read_b64_tr_b16 v[94:95], v31 offset:18432
    v_mfma_f32_16x16x32_bf16 a[0:3], v[128:131], v[64:67], a[0:3]
    v_fma_f32 v190, v190, v217, -v216
    v_fma_f32 v191, v191, v217, -v216
    v_mfma_f32_16x16x32_bf16 a[4:7], v[132:135], v[64:67], a[4:7]
    v_cvt_pk_bf16_f32 v163, v190, v191
    s_mov_b32 s5, 0
    v_mfma_f32_16x16x32_bf16 a[64:67], v[136:139], v[64:67], a[64:67]
    buffer_store_dwordx4 v[160:163], v56, s[16:19], s5 offen sc1
    v_mfma_f32_16x16x32_bf16 a[68:71], v[140:143], v[64:67], a[68:71]
    v_fma_f32 v192, v192, v217, -v216
    v_mfma_f32_16x16x32_bf16 a[128:131], v[144:147], v[64:67], a[128:131]
    v_fma_f32 v193, v193, v217, -v216
    v_cvt_pk_bf16_f32 v164, v192, v193
    v_fma_f32 v194, v194, v217, -v216
    v_mfma_f32_16x16x32_bf16 a[132:135], v[148:151], v[64:67], a[132:135]
    v_fma_f32 v195, v195, v217, -v216
    v_cvt_pk_bf16_f32 v165, v194, v195
    v_mfma_f32_16x16x32_bf16 a[192:195], v[152:155], v[64:67], a[192:195]
    v_fma_f32 v196, v196, v217, -v216
    v_fma_f32 v197, v197, v217, -v216
    v_mfma_f32_16x16x32_bf16 a[196:199], v[156:159], v[64:67], a[196:199]
    s_waitcnt lgkmcnt(0)
    s_barrier
    v_mfma_f32_16x16x32_bf16 a[8:11], v[128:131], v[68:71], a[8:11]
    ds_read_b64_tr_b16 v[64:65], v24 offset:32768
    v_cvt_pk_bf16_f32 v166, v196, v197
    v_fma_f32 v198, v198, v217, -v216
    v_mfma_f32_16x16x32_bf16 a[12:15], v[132:135], v[68:71], a[12:15]
    s_add_u32 m0, s64, 65536
    ds_read_b64_tr_b16 v[66:67], v24 offset:34816
    v_fma_f32 v199, v199, v217, -v216
    v_mfma_f32_16x16x32_bf16 a[72:75], v[136:139], v[68:71], a[72:75]
    buffer_load_dwordx4 v16, s[12:15], s67 offen offset:0 lds
    v_mfma_f32_16x16x32_bf16 a[76:79], v[140:143], v[68:71], a[76:79]
    ds_read_b128 v[96:99], v48 offset:32768
    v_mfma_f32_16x16x32_bf16 a[136:139], v[144:147], v[68:71], a[136:139]
    buffer_load_dwordx4 v17, s[12:15], s67 offen offset:1024 lds
    v_mfma_f32_16x16x32_bf16 a[140:143], v[148:151], v[68:71], a[140:143]
    v_mfma_f32_16x16x32_bf16 a[200:203], v[152:155], v[68:71], a[200:203]
    v_cvt_pk_bf16_f32 v167, v198, v199
    s_mov_b32 s5, 4096
    v_mfma_f32_16x16x32_bf16 a[204:207], v[156:159], v[68:71], a[204:207]
    buffer_load_dwordx4 v18, s[12:15], s67 offen offset:2048 lds
    v_mfma_f32_16x16x32_bf16 a[16:19], v[128:131], v[72:75], a[16:19]
    ds_read_b64_tr_b16 v[68:69], v25 offset:32768
    v_mfma_f32_16x16x32_bf16 a[20:23], v[132:135], v[72:75], a[20:23]
    ds_read_b64_tr_b16 v[70:71], v25 offset:34816
    ds_read_b128 v[100:103], v48 offset:34816
    v_mfma_f32_16x16x32_bf16 a[80:83], v[136:139], v[72:75], a[80:83]
    buffer_load_dwordx4 v19, s[12:15], s67 offen offset:3072 lds
    v_mfma_f32_16x16x32_bf16 a[84:87], v[140:143], v[72:75], a[84:87]
    s_add_u32 m0, s64, 69632
    v_mfma_f32_16x16x32_bf16 a[144:147], v[144:147], v[72:75], a[144:147]
    buffer_load_dwordx4 v20, s[12:15], s67 offen offset:0 lds
    v_mfma_f32_16x16x32_bf16 a[148:151], v[148:151], v[72:75], a[148:151]
    buffer_store_dwordx4 v[164:167], v56, s[16:19], s5 offen sc1
    v_mfma_f32_16x16x32_bf16 a[208:211], v[152:155], v[72:75], a[208:211]
    v_fma_f32 v200, v200, v217, -v216
    v_mfma_f32_16x16x32_bf16 a[212:215], v[156:159], v[72:75], a[212:215]
    ds_read_b128 v[104:107], v48 offset:36864
    v_fma_f32 v201, v201, v217, -v216
    v_mfma_f32_16x16x32_bf16 a[24:27], v[128:131], v[76:79], a[24:27]
    ds_read_b64_tr_b16 v[72:73], v26 offset:32768
    v_cvt_pk_bf16_f32 v168, v200, v201
    v_mfma_f32_16x16x32_bf16 a[28:31], v[132:135], v[76:79], a[28:31]
    ds_read_b64_tr_b16 v[74:75], v26 offset:34816
    v_fma_f32 v202, v202, v217, -v216
    v_fma_f32 v203, v203, v217, -v216
    v_mfma_f32_16x16x32_bf16 a[88:91], v[136:139], v[76:79], a[88:91]
    buffer_load_dwordx4 v21, s[12:15], s67 offen offset:1024 lds
    v_mfma_f32_16x16x32_bf16 a[92:95], v[140:143], v[76:79], a[92:95]
    buffer_load_dwordx4 v22, s[12:15], s67 offen offset:2048 lds
    v_mfma_f32_16x16x32_bf16 a[152:155], v[144:147], v[76:79], a[152:155]
    buffer_load_dwordx4 v23, s[12:15], s67 offen offset:3072 lds
    v_mfma_f32_16x16x32_bf16 a[156:159], v[148:151], v[76:79], a[156:159]
    s_add_u32 s67, s67, 524288
    s_and_b32 s67, s67, 0x3fffff
    ds_read_b128 v[108:111], v48 offset:38912
    v_mfma_f32_16x16x32_bf16 a[216:219], v[152:155], v[76:79], a[216:219]
    v_mfma_f32_16x16x32_bf16 a[220:223], v[156:159], v[76:79], a[220:223]
    v_mfma_f32_16x16x32_bf16 a[32:35], v[128:131], v[80:83], a[32:35]
    ds_read_b64_tr_b16 v[76:77], v27 offset:32768
    v_cvt_pk_bf16_f32 v169, v202, v203
    v_mfma_f32_16x16x32_bf16 a[36:39], v[132:135], v[80:83], a[36:39]
    s_add_u32 m0, s64, 131072
    ds_read_b64_tr_b16 v[78:79], v27 offset:34816
    v_fma_f32 v204, v204, v217, -v216
    v_fma_f32 v205, v205, v217, -v216
    v_mfma_f32_16x16x32_bf16 a[96:99], v[136:139], v[80:83], a[96:99]
    buffer_load_dwordx4 v8, s[8:11], s66 offen offset:0 lds
    v_mfma_f32_16x16x32_bf16 a[100:103], v[140:143], v[80:83], a[100:103]
    ds_read_b128 v[112:115], v48 offset:40960
    v_mfma_f32_16x16x32_bf16 a[160:163], v[144:147], v[80:83], a[160:163]
    v_cvt_pk_bf16_f32 v170, v204, v205
    v_fma_f32 v206, v206, v217, -v216
    v_mfma_f32_16x16x32_bf16 a[164:167], v[148:151], v[80:83], a[164:167]
    buffer_load_dwordx4 v9, s[8:11], s66 offen offset:1024 lds
    v_mfma_f32_16x16x32_bf16 a[224:227], v[152:155], v[80:83], a[224:227]
    v_fma_f32 v207, v207, v217, -v216
    v_mfma_f32_16x16x32_bf16 a[228:231], v[156:159], v[80:83], a[228:231]
    v_cvt_pk_bf16_f32 v171, v206, v207
    s_mov_b32 s5, 8192
    v_mfma_f32_16x16x32_bf16 a[40:43], v[128:131], v[84:87], a[40:43]
    ds_read_b64_tr_b16 v[80:81], v28 offset:32768
    v_mfma_f32_16x16x32_bf16 a[44:47], v[132:135], v[84:87], a[44:47]
    ds_read_b64_tr_b16 v[82:83], v28 offset:34816
    ds_read_b128 v[116:119], v48 offset:43008
    v_mfma_f32_16x16x32_bf16 a[104:107], v[136:139], v[84:87], a[104:107]
    buffer_load_dwordx4 v10, s[8:11], s66 offen offset:2048 lds
    v_mfma_f32_16x16x32_bf16 a[108:111], v[140:143], v[84:87], a[108:111]
    buffer_store_dwordx4 v[168:171], v56, s[16:19], s5 offen sc1
    v_mfma_f32_16x16x32_bf16 a[168:171], v[144:147], v[84:87], a[168:171]
    buffer_load_dwordx4 v11, s[8:11], s66 offen offset:3072 lds
    v_mfma_f32_16x16x32_bf16 a[172:175], v[148:151], v[84:87], a[172:175]
    v_mfma_f32_16x16x32_bf16 a[232:235], v[152:155], v[84:87], a[232:235]
    v_fma_f32 v208, v208, v217, -v216
    v_fma_f32 v209, v209, v217, -v216
    v_mfma_f32_16x16x32_bf16 a[236:239], v[156:159], v[84:87], a[236:239]
    ds_read_b128 v[120:123], v48 offset:45056
    v_cvt_pk_bf16_f32 v172, v208, v209
    v_mfma_f32_16x16x32_bf16 a[48:51], v[128:131], v[88:91], a[48:51]
    ds_read_b64_tr_b16 v[84:85], v29 offset:32768
    v_fma_f32 v210, v210, v217, -v216
    v_mfma_f32_16x16x32_bf16 a[52:55], v[132:135], v[88:91], a[52:55]
    s_add_u32 m0, s64, 135168
    ds_read_b64_tr_b16 v[86:87], v29 offset:34816
    v_fma_f32 v211, v211, v217, -v216
    v_cvt_pk_bf16_f32 v173, v210, v211
    v_mfma_f32_16x16x32_bf16 a[112:115], v[136:139], v[88:91], a[112:115]
    buffer_load_dwordx4 v12, s[8:11], s66 offen offset:0 lds
    v_mfma_f32_16x16x32_bf16 a[116:119], v[140:143], v[88:91], a[116:119]
    v_mfma_f32_16x16x32_bf16 a[176:179], v[144:147], v[88:91], a[176:179]
    buffer_load_dwordx4 v13, s[8:11], s66 offen offset:1024 lds
    v_mfma_f32_16x16x32_bf16 a[180:183], v[148:151], v[88:91], a[180:183]
    ds_read_b128 v[124:127], v48 offset:47104
    v_mfma_f32_16x16x32_bf16 a[240:243], v[152:155], v[88:91], a[240:243]
    v_fma_f32 v212, v212, v217, -v216
    v_fma_f32 v213, v213, v217, -v216
    v_cvt_pk_bf16_f32 v174, v212, v213
    v_mfma_f32_16x16x32_bf16 a[244:247], v[156:159], v[88:91], a[244:247]
    buffer_load_dwordx4 v14, s[8:11], s66 offen offset:2048 lds
    v_mfma_f32_16x16x32_bf16 a[56:59], v[128:131], v[92:95], a[56:59]
    ds_read_b64_tr_b16 v[88:89], v30 offset:32768
    v_mfma_f32_16x16x32_bf16 a[60:63], v[132:135], v[92:95], a[60:63]
    ds_read_b64_tr_b16 v[90:91], v30 offset:34816
    v_fma_f32 v214, v214, v217, -v216
    v_mfma_f32_16x16x32_bf16 a[120:123], v[136:139], v[92:95], a[120:123]
    v_fma_f32 v215, v215, v217, -v216
    v_cvt_pk_bf16_f32 v175, v214, v215
    v_mfma_f32_16x16x32_bf16 a[124:127], v[140:143], v[92:95], a[124:127]
    buffer_load_dwordx4 v15, s[8:11], s66 offen offset:3072 lds
    v_mfma_f32_16x16x32_bf16 a[184:187], v[144:147], v[92:95], a[184:187]
    s_add_u32 s66, s66, 128
    s_and_b32 s66, s66, 0x3ff
    v_mfma_f32_16x16x32_bf16 a[188:191], v[148:151], v[92:95], a[188:191]
    s_mov_b32 s5, 12288
    v_mfma_f32_16x16x32_bf16 a[248:251], v[152:155], v[92:95], a[248:251]
    s_waitcnt lgkmcnt(2)
    buffer_store_dwordx4 v[172:175], v56, s[16:19], s5 offen sc1
    v_mfma_f32_16x16x32_bf16 a[252:255], v[156:159], v[92:95], a[252:255]
    ds_read_b64_tr_b16 v[92:93], v31 offset:32768
    ds_read_b64_tr_b16 v[94:95], v31 offset:34816
    v_mfma_f32_16x16x32_bf16 a[0:3], v[96:99], v[64:67], a[0:3]
    v_mfma_f32_16x16x32_bf16 a[4:7], v[100:103], v[64:67], a[4:7]
    v_mfma_f32_16x16x32_bf16 a[64:67], v[104:107], v[64:67], a[64:67]
    v_mfma_f32_16x16x32_bf16 a[68:71], v[108:111], v[64:67], a[68:71]
    v_mfma_f32_16x16x32_bf16 a[128:131], v[112:115], v[64:67], a[128:131]
    v_mfma_f32_16x16x32_bf16 a[132:135], v[116:119], v[64:67], a[132:135]
    v_mfma_f32_16x16x32_bf16 a[192:195], v[120:123], v[64:67], a[192:195]
    v_mfma_f32_16x16x32_bf16 a[196:199], v[124:127], v[64:67], a[196:199]
    v_mfma_f32_16x16x32_bf16 a[8:11], v[96:99], v[68:71], a[8:11]
    ds_read_b64_tr_b16 v[64:65], v24 offset:49152
    v_mfma_f32_16x16x32_bf16 a[12:15], v[100:103], v[68:71], a[12:15]
    ds_read_b64_tr_b16 v[66:67], v24 offset:51200
    v_mfma_f32_16x16x32_bf16 a[72:75], v[104:107], v[68:71], a[72:75]
    v_mfma_f32_16x16x32_bf16 a[76:79], v[108:111], v[68:71], a[76:79]
    ds_read_b128 v[128:131], v49 offset:32768
    v_mfma_f32_16x16x32_bf16 a[136:139], v[112:115], v[68:71], a[136:139]
    v_mfma_f32_16x16x32_bf16 a[140:143], v[116:119], v[68:71], a[140:143]
    v_mfma_f32_16x16x32_bf16 a[200:203], v[120:123], v[68:71], a[200:203]
    v_mfma_f32_16x16x32_bf16 a[204:207], v[124:127], v[68:71], a[204:207]
    v_mfma_f32_16x16x32_bf16 a[16:19], v[96:99], v[72:75], a[16:19]
    ds_read_b64_tr_b16 v[68:69], v25 offset:49152
    v_mfma_f32_16x16x32_bf16 a[20:23], v[100:103], v[72:75], a[20:23]
    ds_read_b64_tr_b16 v[70:71], v25 offset:51200
    ds_read_b128 v[132:135], v49 offset:34816
    v_mfma_f32_16x16x32_bf16 a[80:83], v[104:107], v[72:75], a[80:83]
    v_mfma_f32_16x16x32_bf16 a[84:87], v[108:111], v[72:75], a[84:87]
    v_mfma_f32_16x16x32_bf16 a[144:147], v[112:115], v[72:75], a[144:147]
    v_mfma_f32_16x16x32_bf16 a[148:151], v[116:119], v[72:75], a[148:151]
    v_mfma_f32_16x16x32_bf16 a[208:211], v[120:123], v[72:75], a[208:211]
    v_mfma_f32_16x16x32_bf16 a[212:215], v[124:127], v[72:75], a[212:215]
    ds_read_b128 v[136:139], v49 offset:36864
    v_mfma_f32_16x16x32_bf16 a[24:27], v[96:99], v[76:79], a[24:27]
    ds_read_b64_tr_b16 v[72:73], v26 offset:49152
    v_mfma_f32_16x16x32_bf16 a[28:31], v[100:103], v[76:79], a[28:31]
    ds_read_b64_tr_b16 v[74:75], v26 offset:51200
    v_mfma_f32_16x16x32_bf16 a[88:91], v[104:107], v[76:79], a[88:91]
    v_mfma_f32_16x16x32_bf16 a[92:95], v[108:111], v[76:79], a[92:95]
    v_mfma_f32_16x16x32_bf16 a[152:155], v[112:115], v[76:79], a[152:155]
    v_mfma_f32_16x16x32_bf16 a[156:159], v[116:119], v[76:79], a[156:159]
    ds_read_b128 v[140:143], v49 offset:38912
    v_mfma_f32_16x16x32_bf16 a[216:219], v[120:123], v[76:79], a[216:219]
    v_mfma_f32_16x16x32_bf16 a[220:223], v[124:127], v[76:79], a[220:223]
    v_mfma_f32_16x16x32_bf16 a[32:35], v[96:99], v[80:83], a[32:35]
    ds_read_b64_tr_b16 v[76:77], v27 offset:49152
    v_mfma_f32_16x16x32_bf16 a[36:39], v[100:103], v[80:83], a[36:39]
    ds_read_b64_tr_b16 v[78:79], v27 offset:51200
    v_mfma_f32_16x16x32_bf16 a[96:99], v[104:107], v[80:83], a[96:99]
    v_mfma_f32_16x16x32_bf16 a[100:103], v[108:111], v[80:83], a[100:103]
    ds_read_b128 v[144:147], v49 offset:40960
    v_mfma_f32_16x16x32_bf16 a[160:163], v[112:115], v[80:83], a[160:163]
    v_mfma_f32_16x16x32_bf16 a[164:167], v[116:119], v[80:83], a[164:167]
    v_mfma_f32_16x16x32_bf16 a[224:227], v[120:123], v[80:83], a[224:227]
    v_mfma_f32_16x16x32_bf16 a[228:231], v[124:127], v[80:83], a[228:231]
    v_mfma_f32_16x16x32_bf16 a[40:43], v[96:99], v[84:87], a[40:43]
    ds_read_b64_tr_b16 v[80:81], v28 offset:49152
    v_mfma_f32_16x16x32_bf16 a[44:47], v[100:103], v[84:87], a[44:47]
    ds_read_b64_tr_b16 v[82:83], v28 offset:51200
    ds_read_b128 v[148:151], v49 offset:43008
    v_mfma_f32_16x16x32_bf16 a[104:107], v[104:107], v[84:87], a[104:107]
    v_mfma_f32_16x16x32_bf16 a[108:111], v[108:111], v[84:87], a[108:111]
    v_mfma_f32_16x16x32_bf16 a[168:171], v[112:115], v[84:87], a[168:171]
    v_mfma_f32_16x16x32_bf16 a[172:175], v[116:119], v[84:87], a[172:175]
    v_mfma_f32_16x16x32_bf16 a[232:235], v[120:123], v[84:87], a[232:235]
    s_waitcnt lgkmcnt(15)
    v_mfma_f32_16x16x32_bf16 a[236:239], v[124:127], v[84:87], a[236:239]
    ds_read_b128 v[152:155], v49 offset:45056
    v_mfma_f32_16x16x32_bf16 a[48:51], v[96:99], v[88:91], a[48:51]
    ds_read_b64_tr_b16 v[84:85], v29 offset:49152
    v_mfma_f32_16x16x32_bf16 a[52:55], v[100:103], v[88:91], a[52:55]
    ds_read_b64_tr_b16 v[86:87], v29 offset:51200
    v_mfma_f32_16x16x32_bf16 a[112:115], v[104:107], v[88:91], a[112:115]
    v_mfma_f32_16x16x32_bf16 a[116:119], v[108:111], v[88:91], a[116:119]
    v_mfma_f32_16x16x32_bf16 a[176:179], v[112:115], v[88:91], a[176:179]
    v_mfma_f32_16x16x32_bf16 a[180:183], v[116:119], v[88:91], a[180:183]
    ds_read_b128 v[156:159], v49 offset:47104
    v_mfma_f32_16x16x32_bf16 a[240:243], v[120:123], v[88:91], a[240:243]
    v_mfma_f32_16x16x32_bf16 a[244:247], v[124:127], v[88:91], a[244:247]
    v_mfma_f32_16x16x32_bf16 a[56:59], v[96:99], v[92:95], a[56:59]
    ds_read_b64_tr_b16 v[88:89], v30 offset:49152
    v_mfma_f32_16x16x32_bf16 a[60:63], v[100:103], v[92:95], a[60:63]
    ds_read_b64_tr_b16 v[90:91], v30 offset:51200
    v_mfma_f32_16x16x32_bf16 a[120:123], v[104:107], v[92:95], a[120:123]
    v_mfma_f32_16x16x32_bf16 a[124:127], v[108:111], v[92:95], a[124:127]
    v_mfma_f32_16x16x32_bf16 a[184:187], v[112:115], v[92:95], a[184:187]
    v_mfma_f32_16x16x32_bf16 a[188:191], v[116:119], v[92:95], a[188:191]
    v_mfma_f32_16x16x32_bf16 a[248:251], v[120:123], v[92:95], a[248:251]
    s_waitcnt lgkmcnt(2)
    v_mfma_f32_16x16x32_bf16 a[252:255], v[124:127], v[92:95], a[252:255]
    ds_read_b64_tr_b16 v[92:93], v31 offset:49152
    ds_read_b64_tr_b16 v[94:95], v31 offset:51200
    v_mfma_f32_16x16x32_bf16 a[0:3], v[128:131], v[64:67], a[0:3]
    v_mfma_f32_16x16x32_bf16 a[4:7], v[132:135], v[64:67], a[4:7]
    v_mfma_f32_16x16x32_bf16 a[64:67], v[136:139], v[64:67], a[64:67]
    v_mfma_f32_16x16x32_bf16 a[68:71], v[140:143], v[64:67], a[68:71]
    v_mfma_f32_16x16x32_bf16 a[128:131], v[144:147], v[64:67], a[128:131]
    v_mfma_f32_16x16x32_bf16 a[132:135], v[148:151], v[64:67], a[132:135]
    v_mfma_f32_16x16x32_bf16 a[192:195], v[152:155], v[64:67], a[192:195]
    v_mfma_f32_16x16x32_bf16 a[196:199], v[156:159], v[64:67], a[196:199]
    s_waitcnt vmcnt(0) lgkmcnt(0)
    s_barrier
    v_mfma_f32_16x16x32_bf16 a[8:11], v[128:131], v[68:71], a[8:11]
    ds_read_b64_tr_b16 v[64:65], v24 offset:0
    v_mfma_f32_16x16x32_bf16 a[12:15], v[132:135], v[68:71], a[12:15]
    s_add_u32 m0, s64, 98304
    ds_read_b64_tr_b16 v[66:67], v24 offset:2048
    v_mfma_f32_16x16x32_bf16 a[72:75], v[136:139], v[68:71], a[72:75]
    buffer_load_dwordx4 v16, s[12:15], s67 offen offset:0 lds
    v_mfma_f32_16x16x32_bf16 a[76:79], v[140:143], v[68:71], a[76:79]
    ds_read_b128 v[96:99], v48 offset:0
    v_mfma_f32_16x16x32_bf16 a[136:139], v[144:147], v[68:71], a[136:139]
    buffer_load_dwordx4 v17, s[12:15], s67 offen offset:1024 lds
    v_mfma_f32_16x16x32_bf16 a[140:143], v[148:151], v[68:71], a[140:143]
    v_mfma_f32_16x16x32_bf16 a[200:203], v[152:155], v[68:71], a[200:203]
    v_mfma_f32_16x16x32_bf16 a[204:207], v[156:159], v[68:71], a[204:207]
    buffer_load_dwordx4 v18, s[12:15], s67 offen offset:2048 lds
    v_mfma_f32_16x16x32_bf16 a[16:19], v[128:131], v[72:75], a[16:19]
    ds_read_b64_tr_b16 v[68:69], v25 offset:0
    v_mfma_f32_16x16x32_bf16 a[20:23], v[132:135], v[72:75], a[20:23]
    ds_read_b64_tr_b16 v[70:71], v25 offset:2048
    ds_read_b128 v[100:103], v48 offset:2048
    v_mfma_f32_16x16x32_bf16 a[80:83], v[136:139], v[72:75], a[80:83]
    buffer_load_dwordx4 v19, s[12:15], s67 offen offset:3072 lds
    v_mfma_f32_16x16x32_bf16 a[84:87], v[140:143], v[72:75], a[84:87]
    s_add_u32 m0, s64, 102400
    v_mfma_f32_16x16x32_bf16 a[144:147], v[144:147], v[72:75], a[144:147]
    buffer_load_dwordx4 v20, s[12:15], s67 offen offset:0 lds
    v_mfma_f32_16x16x32_bf16 a[148:151], v[148:151], v[72:75], a[148:151]
    v_mfma_f32_16x16x32_bf16 a[208:211], v[152:155], v[72:75], a[208:211]
    v_mfma_f32_16x16x32_bf16 a[212:215], v[156:159], v[72:75], a[212:215]
    ds_read_b128 v[104:107], v48 offset:4096
    v_mfma_f32_16x16x32_bf16 a[24:27], v[128:131], v[76:79], a[24:27]
    ds_read_b64_tr_b16 v[72:73], v26 offset:0
    v_mfma_f32_16x16x32_bf16 a[28:31], v[132:135], v[76:79], a[28:31]
    ds_read_b64_tr_b16 v[74:75], v26 offset:2048
    v_mfma_f32_16x16x32_bf16 a[88:91], v[136:139], v[76:79], a[88:91]
    buffer_load_dwordx4 v21, s[12:15], s67 offen offset:1024 lds
    v_mfma_f32_16x16x32_bf16 a[92:95], v[140:143], v[76:79], a[92:95]
    buffer_load_dwordx4 v22, s[12:15], s67 offen offset:2048 lds
    v_mfma_f32_16x16x32_bf16 a[152:155], v[144:147], v[76:79], a[152:155]
    buffer_load_dwordx4 v23, s[12:15], s67 offen offset:3072 lds
    v_mfma_f32_16x16x32_bf16 a[156:159], v[148:151], v[76:79], a[156:159]
    s_add_u32 s67, s67, 524288
    s_and_b32 s67, s67, 0x3fffff
    ds_read_b128 v[108:111], v48 offset:6144
    v_mfma_f32_16x16x32_bf16 a[216:219], v[152:155], v[76:79], a[216:219]
    v_mfma_f32_16x16x32_bf16 a[220:223], v[156:159], v[76:79], a[220:223]
    v_mfma_f32_16x16x32_bf16 a[32:35], v[128:131], v[80:83], a[32:35]
    ds_read_b64_tr_b16 v[76:77], v27 offset:0
    v_mfma_f32_16x16x32_bf16 a[36:39], v[132:135], v[80:83], a[36:39]
    s_add_u32 m0, s64, 32768
    ds_read_b64_tr_b16 v[78:79], v27 offset:2048
    v_mfma_f32_16x16x32_bf16 a[96:99], v[136:139], v[80:83], a[96:99]
    buffer_load_dwordx4 v8, s[8:11], s66 offen offset:0 lds
    v_mfma_f32_16x16x32_bf16 a[100:103], v[140:143], v[80:83], a[100:103]
    ds_read_b128 v[112:115], v48 offset:8192
    v_mfma_f32_16x16x32_bf16 a[160:163], v[144:147], v[80:83], a[160:163]
    buffer_load_dwordx4 v9, s[8:11], s66 offen offset:1024 lds
    v_mfma_f32_16x16x32_bf16 a[164:167], v[148:151], v[80:83], a[164:167]
    v_mfma_f32_16x16x32_bf16 a[224:227], v[152:155], v[80:83], a[224:227]
    v_mfma_f32_16x16x32_bf16 a[228:231], v[156:159], v[80:83], a[228:231]
    buffer_load_dwordx4 v10, s[8:11], s66 offen offset:2048 lds
    v_mfma_f32_16x16x32_bf16 a[40:43], v[128:131], v[84:87], a[40:43]
    ds_read_b64_tr_b16 v[80:81], v28 offset:0
    v_mfma_f32_16x16x32_bf16 a[44:47], v[132:135], v[84:87], a[44:47]
    ds_read_b64_tr_b16 v[82:83], v28 offset:2048
    ds_read_b128 v[116:119], v48 offset:10240
    v_mfma_f32_16x16x32_bf16 a[104:107], v[136:139], v[84:87], a[104:107]
    buffer_load_dwordx4 v11, s[8:11], s66 offen offset:3072 lds
    v_mfma_f32_16x16x32_bf16 a[108:111], v[140:143], v[84:87], a[108:111]
    v_mfma_f32_16x16x32_bf16 a[168:171], v[144:147], v[84:87], a[168:171]
    s_add_u32 m0, s64, 36864
    v_mfma_f32_16x16x32_bf16 a[172:175], v[148:151], v[84:87], a[172:175]
    buffer_load_dwordx4 v12, s[8:11], s66 offen offset:0 lds
    v_mfma_f32_16x16x32_bf16 a[232:235], v[152:155], v[84:87], a[232:235]
    v_mfma_f32_16x16x32_bf16 a[236:239], v[156:159], v[84:87], a[236:239]
    ds_read_b128 v[120:123], v48 offset:12288
    v_mfma_f32_16x16x32_bf16 a[48:51], v[128:131], v[88:91], a[48:51]
    ds_read_b64_tr_b16 v[84:85], v29 offset:0
    v_mfma_f32_16x16x32_bf16 a[52:55], v[132:135], v[88:91], a[52:55]
    ds_read_b64_tr_b16 v[86:87], v29 offset:2048
    v_mfma_f32_16x16x32_bf16 a[112:115], v[136:139], v[88:91], a[112:115]
    buffer_load_dwordx4 v13, s[8:11], s66 offen offset:1024 lds
    v_mfma_f32_16x16x32_bf16 a[116:119], v[140:143], v[88:91], a[116:119]
    buffer_load_dwordx4 v14, s[8:11], s66 offen offset:2048 lds
    v_mfma_f32_16x16x32_bf16 a[176:179], v[144:147], v[88:91], a[176:179]
    v_mfma_f32_16x16x32_bf16 a[180:183], v[148:151], v[88:91], a[180:183]
    ds_read_b128 v[124:127], v48 offset:14336
    v_mfma_f32_16x16x32_bf16 a[240:243], v[152:155], v[88:91], a[240:243]
    buffer_load_dwordx4 v15, s[8:11], s66 offen offset:3072 lds
    v_mfma_f32_16x16x32_bf16 a[244:247], v[156:159], v[88:91], a[244:247]
    s_add_u32 s66, s66, 128
    s_and_b32 s66, s66, 0x3ff
    v_mfma_f32_16x16x32_bf16 a[56:59], v[128:131], v[92:95], a[56:59]
    ds_read_b64_tr_b16 v[88:89], v30 offset:0
    v_mfma_f32_16x16x32_bf16 a[60:63], v[132:135], v[92:95], a[60:63]
    ds_read_b64_tr_b16 v[90:91], v30 offset:2048
    v_mfma_f32_16x16x32_bf16 a[120:123], v[136:139], v[92:95], a[120:123]
    buffer_store_byte v46, v42, s[28:31], 0 offen sc1
    v_mfma_f32_16x16x32_bf16 a[124:127], v[140:143], v[92:95], a[124:127]
    s_mov_b32 s5, 0
    v_mfma_f32_16x16x32_bf16 a[184:187], v[144:147], v[92:95], a[184:187]
    buffer_load_dword v36, v41, s[24:27], s5 offen
    v_mfma_f32_16x16x32_bf16 a[188:191], v[148:151], v[92:95], a[188:191]
    v_mfma_f32_16x16x32_bf16 a[248:251], v[152:155], v[92:95], a[248:251]
    s_waitcnt lgkmcnt(2)
    v_mfma_f32_16x16x32_bf16 a[252:255], v[156:159], v[92:95], a[252:255]
    ds_read_b64_tr_b16 v[92:93], v31 offset:0
    ds_read_b64_tr_b16 v[94:95], v31 offset:2048
    v_mfma_f32_16x16x32_bf16 a[0:3], v[96:99], v[64:67], a[0:3]
    v_mfma_f32_16x16x32_bf16 a[4:7], v[100:103], v[64:67], a[4:7]
    v_mfma_f32_16x16x32_bf16 a[64:67], v[104:107], v[64:67], a[64:67]
    v_mfma_f32_16x16x32_bf16 a[68:71], v[108:111], v[64:67], a[68:71]
    v_mfma_f32_16x16x32_bf16 a[128:131], v[112:115], v[64:67], a[128:131]
    v_mfma_f32_16x16x32_bf16 a[132:135], v[116:119], v[64:67], a[132:135]
    v_mfma_f32_16x16x32_bf16 a[192:195], v[120:123], v[64:67], a[192:195]
    v_mfma_f32_16x16x32_bf16 a[196:199], v[124:127], v[64:67], a[196:199]
    v_mfma_f32_16x16x32_bf16 a[8:11], v[96:99], v[68:71], a[8:11]
    ds_read_b64_tr_b16 v[64:65], v24 offset:16384
    v_mfma_f32_16x16x32_bf16 a[12:15], v[100:103], v[68:71], a[12:15]
    ds_read_b64_tr_b16 v[66:67], v24 offset:18432
    v_mfma_f32_16x16x32_bf16 a[72:75], v[104:107], v[68:71], a[72:75]
    v_mfma_f32_16x16x32_bf16 a[76:79], v[108:111], v[68:71], a[76:79]
    ds_read_b128 v[128:131], v49 offset:0
    v_mfma_f32_16x16x32_bf16 a[136:139], v[112:115], v[68:71], a[136:139]
    v_mfma_f32_16x16x32_bf16 a[140:143], v[116:119], v[68:71], a[140:143]
    v_mfma_f32_16x16x32_bf16 a[200:203], v[120:123], v[68:71], a[200:203]
    v_mfma_f32_16x16x32_bf16 a[204:207], v[124:127], v[68:71], a[204:207]
    v_mfma_f32_16x16x32_bf16 a[16:19], v[96:99], v[72:75], a[16:19]
    ds_read_b64_tr_b16 v[68:69], v25 offset:16384
    v_mfma_f32_16x16x32_bf16 a[20:23], v[100:103], v[72:75], a[20:23]
    ds_read_b64_tr_b16 v[70:71], v25 offset:18432
    ds_read_b128 v[132:135], v49 offset:2048
    v_mfma_f32_16x16x32_bf16 a[80:83], v[104:107], v[72:75], a[80:83]
    v_mfma_f32_16x16x32_bf16 a[84:87], v[108:111], v[72:75], a[84:87]
    v_mfma_f32_16x16x32_bf16 a[144:147], v[112:115], v[72:75], a[144:147]
    v_mfma_f32_16x16x32_bf16 a[148:151], v[116:119], v[72:75], a[148:151]
    v_mfma_f32_16x16x32_bf16 a[208:211], v[120:123], v[72:75], a[208:211]
    v_mfma_f32_16x16x32_bf16 a[212:215], v[124:127], v[72:75], a[212:215]
    ds_read_b128 v[136:139], v49 offset:4096
    v_mfma_f32_16x16x32_bf16 a[24:27], v[96:99], v[76:79], a[24:27]
    ds_read_b64_tr_b16 v[72:73], v26 offset:16384
    v_mfma_f32_16x16x32_bf16 a[28:31], v[100:103], v[76:79], a[28:31]
    ds_read_b64_tr_b16 v[74:75], v26 offset:18432
    v_mfma_f32_16x16x32_bf16 a[88:91], v[104:107], v[76:79], a[88:91]
    v_mfma_f32_16x16x32_bf16 a[92:95], v[108:111], v[76:79], a[92:95]
    v_mfma_f32_16x16x32_bf16 a[152:155], v[112:115], v[76:79], a[152:155]
    v_mfma_f32_16x16x32_bf16 a[156:159], v[116:119], v[76:79], a[156:159]
    ds_read_b128 v[140:143], v49 offset:6144
    v_mfma_f32_16x16x32_bf16 a[216:219], v[120:123], v[76:79], a[216:219]
    v_mfma_f32_16x16x32_bf16 a[220:223], v[124:127], v[76:79], a[220:223]
    v_mfma_f32_16x16x32_bf16 a[32:35], v[96:99], v[80:83], a[32:35]
    ds_read_b64_tr_b16 v[76:77], v27 offset:16384
    v_mfma_f32_16x16x32_bf16 a[36:39], v[100:103], v[80:83], a[36:39]
    ds_read_b64_tr_b16 v[78:79], v27 offset:18432
    v_mfma_f32_16x16x32_bf16 a[96:99], v[104:107], v[80:83], a[96:99]
    v_mfma_f32_16x16x32_bf16 a[100:103], v[108:111], v[80:83], a[100:103]
    ds_read_b128 v[144:147], v49 offset:8192
    v_mfma_f32_16x16x32_bf16 a[160:163], v[112:115], v[80:83], a[160:163]
    v_mfma_f32_16x16x32_bf16 a[164:167], v[116:119], v[80:83], a[164:167]
    v_mfma_f32_16x16x32_bf16 a[224:227], v[120:123], v[80:83], a[224:227]
    v_mfma_f32_16x16x32_bf16 a[228:231], v[124:127], v[80:83], a[228:231]
    v_mfma_f32_16x16x32_bf16 a[40:43], v[96:99], v[84:87], a[40:43]
    ds_read_b64_tr_b16 v[80:81], v28 offset:16384
    v_mfma_f32_16x16x32_bf16 a[44:47], v[100:103], v[84:87], a[44:47]
    ds_read_b64_tr_b16 v[82:83], v28 offset:18432
    ds_read_b128 v[148:151], v49 offset:10240
    v_mfma_f32_16x16x32_bf16 a[104:107], v[104:107], v[84:87], a[104:107]
    v_mfma_f32_16x16x32_bf16 a[108:111], v[108:111], v[84:87], a[108:111]
    v_mfma_f32_16x16x32_bf16 a[168:171], v[112:115], v[84:87], a[168:171]
    v_mfma_f32_16x16x32_bf16 a[172:175], v[116:119], v[84:87], a[172:175]
    v_mfma_f32_16x16x32_bf16 a[232:235], v[120:123], v[84:87], a[232:235]
    s_waitcnt lgkmcnt(15)
    v_mfma_f32_16x16x32_bf16 a[236:239], v[124:127], v[84:87], a[236:239]
    ds_read_b128 v[152:155], v49 offset:12288
    v_mfma_f32_16x16x32_bf16 a[48:51], v[96:99], v[88:91], a[48:51]
    ds_read_b64_tr_b16 v[84:85], v29 offset:16384
    v_mfma_f32_16x16x32_bf16 a[52:55], v[100:103], v[88:91], a[52:55]
    ds_read_b64_tr_b16 v[86:87], v29 offset:18432
    v_mfma_f32_16x16x32_bf16 a[112:115], v[104:107], v[88:91], a[112:115]
    v_mfma_f32_16x16x32_bf16 a[116:119], v[108:111], v[88:91], a[116:119]
    v_mfma_f32_16x16x32_bf16 a[176:179], v[112:115], v[88:91], a[176:179]
    v_mfma_f32_16x16x32_bf16 a[180:183], v[116:119], v[88:91], a[180:183]
    ds_read_b128 v[156:159], v49 offset:14336
    v_mfma_f32_16x16x32_bf16 a[240:243], v[120:123], v[88:91], a[240:243]
    v_mfma_f32_16x16x32_bf16 a[244:247], v[124:127], v[88:91], a[244:247]
    v_mfma_f32_16x16x32_bf16 a[56:59], v[96:99], v[92:95], a[56:59]
    ds_read_b64_tr_b16 v[88:89], v30 offset:16384
    v_mfma_f32_16x16x32_bf16 a[60:63], v[100:103], v[92:95], a[60:63]
    ds_read_b64_tr_b16 v[90:91], v30 offset:18432
    v_mfma_f32_16x16x32_bf16 a[120:123], v[104:107], v[92:95], a[120:123]
    v_mfma_f32_16x16x32_bf16 a[124:127], v[108:111], v[92:95], a[124:127]
    v_mfma_f32_16x16x32_bf16 a[184:187], v[112:115], v[92:95], a[184:187]
    v_mfma_f32_16x16x32_bf16 a[188:191], v[116:119], v[92:95], a[188:191]
    v_mfma_f32_16x16x32_bf16 a[248:251], v[120:123], v[92:95], a[248:251]
    s_waitcnt lgkmcnt(2)
    v_mfma_f32_16x16x32_bf16 a[252:255], v[124:127], v[92:95], a[252:255]
    ds_read_b64_tr_b16 v[92:93], v31 offset:16384
    ds_read_b64_tr_b16 v[94:95], v31 offset:18432
    v_mfma_f32_16x16x32_bf16 a[0:3], v[128:131], v[64:67], a[0:3]
    v_mfma_f32_16x16x32_bf16 a[4:7], v[132:135], v[64:67], a[4:7]
    v_mfma_f32_16x16x32_bf16 a[64:67], v[136:139], v[64:67], a[64:67]
    v_mfma_f32_16x16x32_bf16 a[68:71], v[140:143], v[64:67], a[68:71]
    v_mfma_f32_16x16x32_bf16 a[128:131], v[144:147], v[64:67], a[128:131]
    v_mfma_f32_16x16x32_bf16 a[132:135], v[148:151], v[64:67], a[132:135]
    v_mfma_f32_16x16x32_bf16 a[192:195], v[152:155], v[64:67], a[192:195]
    v_mfma_f32_16x16x32_bf16 a[196:199], v[156:159], v[64:67], a[196:199]
    s_waitcnt vmcnt(10) lgkmcnt(0)
    s_barrier
    v_mfma_f32_16x16x32_bf16 a[8:11], v[128:131], v[68:71], a[8:11]
    ds_read_b64_tr_b16 v[64:65], v24 offset:32768
    v_mfma_f32_16x16x32_bf16 a[12:15], v[132:135], v[68:71], a[12:15]
    s_add_u32 m0, s64, 65536
    ds_read_b64_tr_b16 v[66:67], v24 offset:34816
    v_mfma_f32_16x16x32_bf16 a[72:75], v[136:139], v[68:71], a[72:75]
    buffer_load_dwordx4 v16, s[12:15], s67 offen offset:0 lds
    v_mfma_f32_16x16x32_bf16 a[76:79], v[140:143], v[68:71], a[76:79]
    ds_read_b128 v[96:99], v50 offset:0
    v_mfma_f32_16x16x32_bf16 a[136:139], v[144:147], v[68:71], a[136:139]
    buffer_load_dwordx4 v17, s[12:15], s67 offen offset:1024 lds
    v_mfma_f32_16x16x32_bf16 a[140:143], v[148:151], v[68:71], a[140:143]
    v_mfma_f32_16x16x32_bf16 a[200:203], v[152:155], v[68:71], a[200:203]
    v_mfma_f32_16x16x32_bf16 a[204:207], v[156:159], v[68:71], a[204:207]
    buffer_load_dwordx4 v18, s[12:15], s67 offen offset:2048 lds
    v_mfma_f32_16x16x32_bf16 a[16:19], v[128:131], v[72:75], a[16:19]
    ds_read_b64_tr_b16 v[68:69], v25 offset:32768
    v_mfma_f32_16x16x32_bf16 a[20:23], v[132:135], v[72:75], a[20:23]
    ds_read_b64_tr_b16 v[70:71], v25 offset:34816
    ds_read_b128 v[100:103], v50 offset:2048
    v_mfma_f32_16x16x32_bf16 a[80:83], v[136:139], v[72:75], a[80:83]
    buffer_load_dwordx4 v19, s[12:15], s67 offen offset:3072 lds
    v_mfma_f32_16x16x32_bf16 a[84:87], v[140:143], v[72:75], a[84:87]
    s_add_u32 m0, s64, 69632
    v_mfma_f32_16x16x32_bf16 a[144:147], v[144:147], v[72:75], a[144:147]
    buffer_load_dwordx4 v20, s[12:15], s67 offen offset:0 lds
    v_mfma_f32_16x16x32_bf16 a[148:151], v[148:151], v[72:75], a[148:151]
    v_mfma_f32_16x16x32_bf16 a[208:211], v[152:155], v[72:75], a[208:211]
    v_mfma_f32_16x16x32_bf16 a[212:215], v[156:159], v[72:75], a[212:215]
    ds_read_b128 v[104:107], v50 offset:4096
    v_mfma_f32_16x16x32_bf16 a[24:27], v[128:131], v[76:79], a[24:27]
    ds_read_b64_tr_b16 v[72:73], v26 offset:32768
    v_mfma_f32_16x16x32_bf16 a[28:31], v[132:135], v[76:79], a[28:31]
    ds_read_b64_tr_b16 v[74:75], v26 offset:34816
    v_mfma_f32_16x16x32_bf16 a[88:91], v[136:139], v[76:79], a[88:91]
    buffer_load_dwordx4 v21, s[12:15], s67 offen offset:1024 lds
    v_mfma_f32_16x16x32_bf16 a[92:95], v[140:143], v[76:79], a[92:95]
    buffer_load_dwordx4 v22, s[12:15], s67 offen offset:2048 lds
    v_mfma_f32_16x16x32_bf16 a[152:155], v[144:147], v[76:79], a[152:155]
    buffer_load_dwordx4 v23, s[12:15], s67 offen offset:3072 lds
    v_mfma_f32_16x16x32_bf16 a[156:159], v[148:151], v[76:79], a[156:159]
    s_add_u32 s67, s67, 524288
    s_and_b32 s67, s67, 0x3fffff
    ds_read_b128 v[108:111], v50 offset:6144
    v_mfma_f32_16x16x32_bf16 a[216:219], v[152:155], v[76:79], a[216:219]
    v_mfma_f32_16x16x32_bf16 a[220:223], v[156:159], v[76:79], a[220:223]
    v_mfma_f32_16x16x32_bf16 a[32:35], v[128:131], v[80:83], a[32:35]
    ds_read_b64_tr_b16 v[76:77], v27 offset:32768
    v_mfma_f32_16x16x32_bf16 a[36:39], v[132:135], v[80:83], a[36:39]
    s_add_u32 m0, s64, 0
    ds_read_b64_tr_b16 v[78:79], v27 offset:34816
    v_mfma_f32_16x16x32_bf16 a[96:99], v[136:139], v[80:83], a[96:99]
    buffer_load_dwordx4 v8, s[8:11], s66 offen offset:0 lds
    v_mfma_f32_16x16x32_bf16 a[100:103], v[140:143], v[80:83], a[100:103]
    ds_read_b128 v[112:115], v50 offset:8192
    v_mfma_f32_16x16x32_bf16 a[160:163], v[144:147], v[80:83], a[160:163]
    v_mfma_f32_16x16x32_bf16 a[164:167], v[148:151], v[80:83], a[164:167]
    buffer_load_dwordx4 v9, s[8:11], s66 offen offset:1024 lds
    v_mfma_f32_16x16x32_bf16 a[224:227], v[152:155], v[80:83], a[224:227]
    v_mfma_f32_16x16x32_bf16 a[228:231], v[156:159], v[80:83], a[228:231]
    v_mfma_f32_16x16x32_bf16 a[40:43], v[128:131], v[84:87], a[40:43]
    ds_read_b64_tr_b16 v[80:81], v28 offset:32768
    v_mfma_f32_16x16x32_bf16 a[44:47], v[132:135], v[84:87], a[44:47]
    ds_read_b64_tr_b16 v[82:83], v28 offset:34816
    ds_read_b128 v[116:119], v50 offset:10240
    v_mfma_f32_16x16x32_bf16 a[104:107], v[136:139], v[84:87], a[104:107]
    buffer_load_dwordx4 v10, s[8:11], s66 offen offset:2048 lds
    v_mfma_f32_16x16x32_bf16 a[108:111], v[140:143], v[84:87], a[108:111]
    buffer_load_dwordx4 v11, s[8:11], s66 offen offset:3072 lds
    v_mfma_f32_16x16x32_bf16 a[168:171], v[144:147], v[84:87], a[168:171]
    v_mfma_f32_16x16x32_bf16 a[172:175], v[148:151], v[84:87], a[172:175]
    s_add_u32 m0, s64, 4096
    v_mfma_f32_16x16x32_bf16 a[232:235], v[152:155], v[84:87], a[232:235]
    buffer_load_dwordx4 v12, s[8:11], s66 offen offset:0 lds
    v_mfma_f32_16x16x32_bf16 a[236:239], v[156:159], v[84:87], a[236:239]
    ds_read_b128 v[120:123], v50 offset:12288
    v_mfma_f32_16x16x32_bf16 a[48:51], v[128:131], v[88:91], a[48:51]
    ds_read_b64_tr_b16 v[84:85], v29 offset:32768
    v_mfma_f32_16x16x32_bf16 a[52:55], v[132:135], v[88:91], a[52:55]
    ds_read_b64_tr_b16 v[86:87], v29 offset:34816
    v_mfma_f32_16x16x32_bf16 a[112:115], v[136:139], v[88:91], a[112:115]
    buffer_load_dwordx4 v13, s[8:11], s66 offen offset:1024 lds
    v_mfma_f32_16x16x32_bf16 a[116:119], v[140:143], v[88:91], a[116:119]
    v_mfma_f32_16x16x32_bf16 a[176:179], v[144:147], v[88:91], a[176:179]
    v_mfma_f32_16x16x32_bf16 a[180:183], v[148:151], v[88:91], a[180:183]
    ds_read_b128 v[124:127], v50 offset:14336
    v_mfma_f32_16x16x32_bf16 a[240:243], v[152:155], v[88:91], a[240:243]
    buffer_load_dwordx4 v14, s[8:11], s66 offen offset:2048 lds
    v_mfma_f32_16x16x32_bf16 a[244:247], v[156:159], v[88:91], a[244:247]
    v_mfma_f32_16x16x32_bf16 a[56:59], v[128:131], v[92:95], a[56:59]
    ds_read_b64_tr_b16 v[88:89], v30 offset:32768
    v_mfma_f32_16x16x32_bf16 a[60:63], v[132:135], v[92:95], a[60:63]
    ds_read_b64_tr_b16 v[90:91], v30 offset:34816
    v_mfma_f32_16x16x32_bf16 a[120:123], v[136:139], v[92:95], a[120:123]
    buffer_load_dwordx4 v15, s[8:11], s66 offen offset:3072 lds
    v_mfma_f32_16x16x32_bf16 a[124:127], v[140:143], v[92:95], a[124:127]
    s_add_u32 s66, s66, 128
    s_and_b32 s66, s66, 0x3ff
    s_mov_b32 s5, 32768
    buffer_load_dword v36, v41, s[24:27], s5 offen
    v_mfma_f32_16x16x32_bf16 a[184:187], v[144:147], v[92:95], a[184:187]
    v_mfma_f32_16x16x32_bf16 a[188:191], v[148:151], v[92:95], a[188:191]
    v_mfma_f32_16x16x32_bf16 a[248:251], v[152:155], v[92:95], a[248:251]
    s_waitcnt lgkmcnt(2)
    v_mfma_f32_16x16x32_bf16 a[252:255], v[156:159], v[92:95], a[252:255]
    ds_read_b64_tr_b16 v[92:93], v31 offset:32768
    ds_read_b64_tr_b16 v[94:95], v31 offset:34816
    v_mfma_f32_16x16x32_bf16 a[0:3], v[96:99], v[64:67], a[0:3]
    v_mfma_f32_16x16x32_bf16 a[4:7], v[100:103], v[64:67], a[4:7]
    v_mfma_f32_16x16x32_bf16 a[64:67], v[104:107], v[64:67], a[64:67]
    v_mfma_f32_16x16x32_bf16 a[68:71], v[108:111], v[64:67], a[68:71]
    v_mfma_f32_16x16x32_bf16 a[128:131], v[112:115], v[64:67], a[128:131]
    v_mfma_f32_16x16x32_bf16 a[132:135], v[116:119], v[64:67], a[132:135]
    v_mfma_f32_16x16x32_bf16 a[192:195], v[120:123], v[64:67], a[192:195]
    v_mfma_f32_16x16x32_bf16 a[196:199], v[124:127], v[64:67], a[196:199]
    v_mfma_f32_16x16x32_bf16 a[8:11], v[96:99], v[68:71], a[8:11]
    ds_read_b64_tr_b16 v[64:65], v24 offset:49152
    v_mfma_f32_16x16x32_bf16 a[12:15], v[100:103], v[68:71], a[12:15]
    ds_read_b64_tr_b16 v[66:67], v24 offset:51200
    v_mfma_f32_16x16x32_bf16 a[72:75], v[104:107], v[68:71], a[72:75]
    v_mfma_f32_16x16x32_bf16 a[76:79], v[108:111], v[68:71], a[76:79]
    ds_read_b128 v[128:131], v51 offset:0
    v_mfma_f32_16x16x32_bf16 a[136:139], v[112:115], v[68:71], a[136:139]
    v_mfma_f32_16x16x32_bf16 a[140:143], v[116:119], v[68:71], a[140:143]
    v_mfma_f32_16x16x32_bf16 a[200:203], v[120:123], v[68:71], a[200:203]
    v_mfma_f32_16x16x32_bf16 a[204:207], v[124:127], v[68:71], a[204:207]
    v_mfma_f32_16x16x32_bf16 a[16:19], v[96:99], v[72:75], a[16:19]
    ds_read_b64_tr_b16 v[68:69], v25 offset:49152
    v_mfma_f32_16x16x32_bf16 a[20:23], v[100:103], v[72:75], a[20:23]
    ds_read_b64_tr_b16 v[70:71], v25 offset:51200
    ds_read_b128 v[132:135], v51 offset:2048
    v_mfma_f32_16x16x32_bf16 a[80:83], v[104:107], v[72:75], a[80:83]
    v_mfma_f32_16x16x32_bf16 a[84:87], v[108:111], v[72:75], a[84:87]
    v_mfma_f32_16x16x32_bf16 a[144:147], v[112:115], v[72:75], a[144:147]
    v_mfma_f32_16x16x32_bf16 a[148:151], v[116:119], v[72:75], a[148:151]
    v_mfma_f32_16x16x32_bf16 a[208:211], v[120:123], v[72:75], a[208:211]
    v_mfma_f32_16x16x32_bf16 a[212:215], v[124:127], v[72:75], a[212:215]
    ds_read_b128 v[136:139], v51 offset:4096
    v_mfma_f32_16x16x32_bf16 a[24:27], v[96:99], v[76:79], a[24:27]
    ds_read_b64_tr_b16 v[72:73], v26 offset:49152
    v_mfma_f32_16x16x32_bf16 a[28:31], v[100:103], v[76:79], a[28:31]
    ds_read_b64_tr_b16 v[74:75], v26 offset:51200
    v_mfma_f32_16x16x32_bf16 a[88:91], v[104:107], v[76:79], a[88:91]
    v_mfma_f32_16x16x32_bf16 a[92:95], v[108:111], v[76:79], a[92:95]
    v_mfma_f32_16x16x32_bf16 a[152:155], v[112:115], v[76:79], a[152:155]
    v_mfma_f32_16x16x32_bf16 a[156:159], v[116:119], v[76:79], a[156:159]
    ds_read_b128 v[140:143], v51 offset:6144
    v_mfma_f32_16x16x32_bf16 a[216:219], v[120:123], v[76:79], a[216:219]
    v_mfma_f32_16x16x32_bf16 a[220:223], v[124:127], v[76:79], a[220:223]
    v_mfma_f32_16x16x32_bf16 a[32:35], v[96:99], v[80:83], a[32:35]
    ds_read_b64_tr_b16 v[76:77], v27 offset:49152
    v_mfma_f32_16x16x32_bf16 a[36:39], v[100:103], v[80:83], a[36:39]
    ds_read_b64_tr_b16 v[78:79], v27 offset:51200
    v_mfma_f32_16x16x32_bf16 a[96:99], v[104:107], v[80:83], a[96:99]
    s_getpc_b64 s[62:63]
ct_2:
    s_add_u32 s62, s62, fk_q-ct_2
    s_addc_u32 s63, s63, 0
    s_lshr_b32 s58, s2, 3
    s_lshl_b32 s58, s58, 10
    v_and_b32 v58, 7, v0
    v_lshl_add_u32 v58, v58, 7, s58
    v_min_u32 v58, fk_a0-fk_q-4, v58
    global_load_dword v58, v58, s[62:63]
    v_mfma_f32_16x16x32_bf16 a[100:103], v[108:111], v[80:83], a[100:103]
    ds_read_b128 v[144:147], v51 offset:8192
    v_mfma_f32_16x16x32_bf16 a[160:163], v[112:115], v[80:83], a[160:163]
    v_mfma_f32_16x16x32_bf16 a[164:167], v[116:119], v[80:83], a[164:167]
    v_mfma_f32_16x16x32_bf16 a[224:227], v[120:123], v[80:83], a[224:227]
    v_mfma_f32_16x16x32_bf16 a[228:231], v[124:127], v[80:83], a[228:231]
    v_mfma_f32_16x16x32_bf16 a[40:43], v[96:99], v[84:87], a[40:43]
    ds_read_b64_tr_b16 v[80:81], v28 offset:49152
    v_mfma_f32_16x16x32_bf16 a[44:47], v[100:103], v[84:87], a[44:47]
    ds_read_b64_tr_b16 v[82:83], v28 offset:51200
    ds_read_b128 v[148:151], v51 offset:10240
    v_mfma_f32_16x16x32_bf16 a[104:107], v[104:107], v[84:87], a[104:107]
    v_mfma_f32_16x16x32_bf16 a[108:111], v[108:111], v[84:87], a[108:111]
    v_mfma_f32_16x16x32_bf16 a[168:171], v[112:115], v[84:87], a[168:171]
    v_mfma_f32_16x16x32_bf16 a[172:175], v[116:119], v[84:87], a[172:175]
    v_mfma_f32_16x16x32_bf16 a[232:235], v[120:123], v[84:87], a[232:235]
    s_waitcnt lgkmcnt(15)
    v_mfma_f32_16x16x32_bf16 a[236:239], v[124:127], v[84:87], a[236:239]
    ds_read_b128 v[152:155], v51 offset:12288
    v_mfma_f32_16x16x32_bf16 a[48:51], v[96:99], v[88:91], a[48:51]
    ds_read_b64_tr_b16 v[84:85], v29 offset:49152
    v_mfma_f32_16x16x32_bf16 a[52:55], v[100:103], v[88:91], a[52:55]
    ds_read_b64_tr_b16 v[86:87], v29 offset:51200
    v_mfma_f32_16x16x32_bf16 a[112:115], v[104:107], v[88:91], a[112:115]
    v_mfma_f32_16x16x32_bf16 a[116:119], v[108:111], v[88:91], a[116:119]
    v_mfma_f32_16x16x32_bf16 a[176:179], v[112:115], v[88:91], a[176:179]
    v_mfma_f32_16x16x32_bf16 a[180:183], v[116:119], v[88:91], a[180:183]
    ds_read_b128 v[156:159], v51 offset:14336
    v_mfma_f32_16x16x32_bf16 a[240:243], v[120:123], v[88:91], a[240:243]
    v_mfma_f32_16x16x32_bf16 a[244:247], v[124:127], v[88:91], a[244:247]
    v_mfma_f32_16x16x32_bf16 a[56:59], v[96:99], v[92:95], a[56:59]
    ds_read_b64_tr_b16 v[88:89], v30 offset:49152
    v_mfma_f32_16x16x32_bf16 a[60:63], v[100:103], v[92:95], a[60:63]
    ds_read_b64_tr_b16 v[90:91], v30 offset:51200
    v_mfma_f32_16x16x32_bf16 a[120:123], v[104:107], v[92:95], a[120:123]
    v_mfma_f32_16x16x32_bf16 a[124:127], v[108:111], v[92:95], a[124:127]
    v_mfma_f32_16x16x32_bf16 a[184:187], v[112:115], v[92:95], a[184:187]
    v_mfma_f32_16x16x32_bf16 a[188:191], v[116:119], v[92:95], a[188:191]
    v_mfma_f32_16x16x32_bf16 a[248:251], v[120:123], v[92:95], a[248:251]
    s_waitcnt lgkmcnt(2)
    v_mfma_f32_16x16x32_bf16 a[252:255], v[124:127], v[92:95], a[252:255]
    ds_read_b64_tr_b16 v[92:93], v31 offset:49152
    ds_read_b64_tr_b16 v[94:95], v31 offset:51200
    v_mfma_f32_16x16x32_bf16 a[0:3], v[128:131], v[64:67], a[0:3]
    v_mfma_f32_16x16x32_bf16 a[4:7], v[132:135], v[64:67], a[4:7]
    v_mfma_f32_16x16x32_bf16 a[64:67], v[136:139], v[64:67], a[64:67]
    v_mfma_f32_16x16x32_bf16 a[68:71], v[140:143], v[64:67], a[68:71]
    v_mfma_f32_16x16x32_bf16 a[128:131], v[144:147], v[64:67], a[128:131]
    v_mfma_f32_16x16x32_bf16 a[132:135], v[148:151], v[64:67], a[132:135]
    v_mfma_f32_16x16x32_bf16 a[192:195], v[152:155], v[64:67], a[192:195]
    v_mfma_f32_16x16x32_bf16 a[196:199], v[156:159], v[64:67], a[196:199]
    s_waitcnt vmcnt(10) lgkmcnt(0)
    s_barrier
    v_mfma_f32_16x16x32_bf16 a[8:11], v[128:131], v[68:71], a[8:11]
    ds_read_b64_tr_b16 v[64:65], v24 offset:0
    v_mfma_f32_16x16x32_bf16 a[12:15], v[132:135], v[68:71], a[12:15]
    s_add_u32 m0, s64, 98304
    ds_read_b64_tr_b16 v[66:67], v24 offset:2048
    v_mfma_f32_16x16x32_bf16 a[72:75], v[136:139], v[68:71], a[72:75]
    buffer_load_dwordx4 v16, s[12:15], s67 offen offset:0 lds
    v_mfma_f32_16x16x32_bf16 a[76:79], v[140:143], v[68:71], a[76:79]
    ds_read_b128 v[96:99], v48 offset:32768
    v_mfma_f32_16x16x32_bf16 a[136:139], v[144:147], v[68:71], a[136:139]
    buffer_load_dwordx4 v17, s[12:15], s67 offen offset:1024 lds
    v_mfma_f32_16x16x32_bf16 a[140:143], v[148:151], v[68:71], a[140:143]
    v_mfma_f32_16x16x32_bf16 a[200:203], v[152:155], v[68:71], a[200:203]
    v_mfma_f32_16x16x32_bf16 a[204:207], v[156:159], v[68:71], a[204:207]
    buffer_load_dwordx4 v18, s[12:15], s67 offen offset:2048 lds
    v_mfma_f32_16x16x32_bf16 a[16:19], v[128:131], v[72:75], a[16:19]
    ds_read_b64_tr_b16 v[68:69], v25 offset:0
    v_mfma_f32_16x16x32_bf16 a[20:23], v[132:135], v[72:75], a[20:23]
    ds_read_b64_tr_b16 v[70:71], v25 offset:2048
    ds_read_b128 v[100:103], v48 offset:34816
    v_mfma_f32_16x16x32_bf16 a[80:83], v[136:139], v[72:75], a[80:83]
    buffer_load_dwordx4 v19, s[12:15], s67 offen offset:3072 lds
    v_mfma_f32_16x16x32_bf16 a[84:87], v[140:143], v[72:75], a[84:87]
    s_add_u32 m0, s64, 102400
    v_mfma_f32_16x16x32_bf16 a[144:147], v[144:147], v[72:75], a[144:147]
    buffer_load_dwordx4 v20, s[12:15], s67 offen offset:0 lds
    v_mfma_f32_16x16x32_bf16 a[148:151], v[148:151], v[72:75], a[148:151]
    v_mfma_f32_16x16x32_bf16 a[208:211], v[152:155], v[72:75], a[208:211]
    v_mfma_f32_16x16x32_bf16 a[212:215], v[156:159], v[72:75], a[212:215]
    ds_read_b128 v[104:107], v48 offset:36864
    v_mfma_f32_16x16x32_bf16 a[24:27], v[128:131], v[76:79], a[24:27]
    ds_read_b64_tr_b16 v[72:73], v26 offset:0
    v_mfma_f32_16x16x32_bf16 a[28:31], v[132:135], v[76:79], a[28:31]
    ds_read_b64_tr_b16 v[74:75], v26 offset:2048
    v_mfma_f32_16x16x32_bf16 a[88:91], v[136:139], v[76:79], a[88:91]
    buffer_load_dwordx4 v21, s[12:15], s67 offen offset:1024 lds
    v_mfma_f32_16x16x32_bf16 a[92:95], v[140:143], v[76:79], a[92:95]
    buffer_load_dwordx4 v22, s[12:15], s67 offen offset:2048 lds
    v_mfma_f32_16x16x32_bf16 a[152:155], v[144:147], v[76:79], a[152:155]
    buffer_load_dwordx4 v23, s[12:15], s67 offen offset:3072 lds
    v_mfma_f32_16x16x32_bf16 a[156:159], v[148:151], v[76:79], a[156:159]
    s_add_u32 s67, s67, 524288
    s_and_b32 s67, s67, 0x3fffff
    ds_read_b128 v[108:111], v48 offset:38912
    v_mfma_f32_16x16x32_bf16 a[216:219], v[152:155], v[76:79], a[216:219]
    v_mfma_f32_16x16x32_bf16 a[220:223], v[156:159], v[76:79], a[220:223]
    v_mfma_f32_16x16x32_bf16 a[32:35], v[128:131], v[80:83], a[32:35]
    ds_read_b64_tr_b16 v[76:77], v27 offset:0
    v_mfma_f32_16x16x32_bf16 a[36:39], v[132:135], v[80:83], a[36:39]
    ds_read_b64_tr_b16 v[78:79], v27 offset:2048
    v_mfma_f32_16x16x32_bf16 a[96:99], v[136:139], v[80:83], a[96:99]
    v_mfma_f32_16x16x32_bf16 a[100:103], v[140:143], v[80:83], a[100:103]
    ds_read_b128 v[112:115], v48 offset:40960
    v_mfma_f32_16x16x32_bf16 a[160:163], v[144:147], v[80:83], a[160:163]
    v_mfma_f32_16x16x32_bf16 a[164:167], v[148:151], v[80:83], a[164:167]
    v_mfma_f32_16x16x32_bf16 a[224:227], v[152:155], v[80:83], a[224:227]
    v_mfma_f32_16x16x32_bf16 a[228:231], v[156:159], v[80:83], a[228:231]
    v_mfma_f32_16x16x32_bf16 a[40:43], v[128:131], v[84:87], a[40:43]
    ds_read_b64_tr_b16 v[80:81], v28 offset:0
    v_mfma_f32_16x16x32_bf16 a[44:47], v[132:135], v[84:87], a[44:47]
    ds_read_b64_tr_b16 v[82:83], v28 offset:2048
    ds_read_b128 v[116:119], v48 offset:43008
    v_mfma_f32_16x16x32_bf16 a[104:107], v[136:139], v[84:87], a[104:107]
    v_mfma_f32_16x16x32_bf16 a[108:111], v[140:143], v[84:87], a[108:111]
    v_mfma_f32_16x16x32_bf16 a[168:171], v[144:147], v[84:87], a[168:171]
    v_mfma_f32_16x16x32_bf16 a[172:175], v[148:151], v[84:87], a[172:175]
    v_mfma_f32_16x16x32_bf16 a[232:235], v[152:155], v[84:87], a[232:235]
    v_mfma_f32_16x16x32_bf16 a[236:239], v[156:159], v[84:87], a[236:239]
    ds_read_b128 v[120:123], v48 offset:45056
    v_mfma_f32_16x16x32_bf16 a[48:51], v[128:131], v[88:91], a[48:51]
    ds_read_b64_tr_b16 v[84:85], v29 offset:0
    v_mfma_f32_16x16x32_bf16 a[52:55], v[132:135], v[88:91], a[52:55]
    ds_read_b64_tr_b16 v[86:87], v29 offset:2048
    v_mfma_f32_16x16x32_bf16 a[112:115], v[136:139], v[88:91], a[112:115]
    v_mfma_f32_16x16x32_bf16 a[116:119], v[140:143], v[88:91], a[116:119]
    v_mfma_f32_16x16x32_bf16 a[176:179], v[144:147], v[88:91], a[176:179]
    v_mfma_f32_16x16x32_bf16 a[180:183], v[148:151], v[88:91], a[180:183]
    ds_read_b128 v[124:127], v48 offset:47104
    v_mfma_f32_16x16x32_bf16 a[240:243], v[152:155], v[88:91], a[240:243]
    v_mfma_f32_16x16x32_bf16 a[244:247], v[156:159], v[88:91], a[244:247]
    v_mfma_f32_16x16x32_bf16 a[56:59], v[128:131], v[92:95], a[56:59]
    ds_read_b64_tr_b16 v[88:89], v30 offset:0
    v_mfma_f32_16x16x32_bf16 a[60:63], v[132:135], v[92:95], a[60:63]
    ds_read_b64_tr_b16 v[90:91], v30 offset:2048
    v_mfma_f32_16x16x32_bf16 a[120:123], v[136:139], v[92:95], a[120:123]
    v_mfma_f32_16x16x32_bf16 a[124:127], v[140:143], v[92:95], a[124:127]
    v_mfma_f32_16x16x32_bf16 a[184:187], v[144:147], v[92:95], a[184:187]
    v_mfma_f32_16x16x32_bf16 a[188:191], v[148:151], v[92:95], a[188:191]
    v_mfma_f32_16x16x32_bf16 a[248:251], v[152:155], v[92:95], a[248:251]
    s_waitcnt lgkmcnt(2)
    v_mfma_f32_16x16x32_bf16 a[252:255], v[156:159], v[92:95], a[252:255]
    ds_read_b64_tr_b16 v[92:93], v31 offset:0
    ds_read_b64_tr_b16 v[94:95], v31 offset:2048
    v_mfma_f32_16x16x32_bf16 a[0:3], v[96:99], v[64:67], a[0:3]
    v_lshlrev_b32 v8, 4, v1
    v_lshrrev_b32 v2, 4, v1
    v_mfma_f32_16x16x32_bf16 a[4:7], v[100:103], v[64:67], a[4:7]
    v_and_b32 v3, 15, v1
    v_lshlrev_b32 v4, 4, v3
    v_mfma_f32_16x16x32_bf16 a[64:67], v[104:107], v[64:67], a[64:67]
    buffer_load_dword v47, v44, s[28:31], 0 offen sc1
    v_mfma_f32_16x16x32_bf16 a[68:71], v[108:111], v[64:67], a[68:71]
    v_mfma_f32_16x16x32_bf16 a[128:131], v[112:115], v[64:67], a[128:131]
    v_lshl_add_u32 v4, v2, 9, v4
    s_mul_i32 s3, s36, 65536
    v_mfma_f32_16x16x32_bf16 a[132:135], v[116:119], v[64:67], a[132:135]
    s_add_u32 s3, s3, 0
    v_add_u32 v9, s3, v4
    v_mfma_f32_16x16x32_bf16 a[192:195], v[120:123], v[64:67], a[192:195]
    s_mul_i32 s3, s37, 65536
    s_add_u32 s3, s3, 0
    v_mfma_f32_16x16x32_bf16 a[196:199], v[124:127], v[64:67], a[196:199]
    v_add_u32 v10, s3, v4
    v_mfma_f32_16x16x32_bf16 a[8:11], v[96:99], v[68:71], a[8:11]
    ds_read_b64_tr_b16 v[64:65], v24 offset:16384
    v_lshlrev_b32 v4, 1, v2
    v_mfma_f32_16x16x32_bf16 a[12:15], v[100:103], v[68:71], a[12:15]
    ds_read_b64_tr_b16 v[66:67], v24 offset:18432
    v_xor_b32 v3, v3, v4
    v_mfma_f32_16x16x32_bf16 a[72:75], v[104:107], v[68:71], a[72:75]
    s_lshl_b32 s3, s32, 4
    v_add_u32 v2, s3, v2
    v_mfma_f32_16x16x32_bf16 a[76:79], v[108:111], v[68:71], a[76:79]
    ds_read_b128 v[128:131], v49 offset:32768
    v_lshlrev_b32 v2, 13, v2
    v_mfma_f32_16x16x32_bf16 a[136:139], v[112:115], v[68:71], a[136:139]
    s_lshl_b32 s3, s33, 8
    v_add_u32 v2, s3, v2
    v_mfma_f32_16x16x32_bf16 a[140:143], v[116:119], v[68:71], a[140:143]
    v_lshl_add_u32 v4, v3, 4, v2
    v_xor_b32 v3, 8, v3
    v_mfma_f32_16x16x32_bf16 a[200:203], v[120:123], v[68:71], a[200:203]
    v_lshl_add_u32 v2, v3, 4, v2
    v_add_u32 v12, 0, v4
    v_mfma_f32_16x16x32_bf16 a[204:207], v[124:127], v[68:71], a[204:207]
    v_add_u32 v13, 31744, v4
    v_add_u32 v14, 63488, v2
    v_mfma_f32_16x16x32_bf16 a[16:19], v[96:99], v[72:75], a[16:19]
    ds_read_b64_tr_b16 v[68:69], v25 offset:16384
    v_add_u32 v15, 95232, v2
    v_mfma_f32_16x16x32_bf16 a[20:23], v[100:103], v[72:75], a[20:23]
    ds_read_b64_tr_b16 v[70:71], v25 offset:18432
    ds_read_b128 v[132:135], v49 offset:34816
    v_mfma_f32_16x16x32_bf16 a[80:83], v[104:107], v[72:75], a[80:83]
    s_lshl_b32 s98, s32, 12
    v_mfma_f32_16x16x32_bf16 a[84:87], v[108:111], v[72:75], a[84:87]
    s_lshr_b32 s4, s34, 2
    s_add_u32 s4, s4, s33
    v_mfma_f32_16x16x32_bf16 a[144:147], v[112:115], v[72:75], a[144:147]
    s_mul_i32 s4, s4, 0
    s_add_u32 s3, s4, 0
    v_mfma_f32_16x16x32_bf16 a[148:151], v[116:119], v[72:75], a[148:151]
    s_and_b32 s3, s3, 3
    s_lshl_b32 s72, s3, 19
    v_mfma_f32_16x16x32_bf16 a[208:211], v[120:123], v[72:75], a[208:211]
    s_lshl_b32 s76, s3, 12
    s_add_u32 s3, s4, 1
    v_mfma_f32_16x16x32_bf16 a[212:215], v[124:127], v[72:75], a[212:215]
    ds_read_b128 v[136:139], v49 offset:36864
    s_and_b32 s3, s3, 3
    v_mfma_f32_16x16x32_bf16 a[24:27], v[96:99], v[76:79], a[24:27]
    ds_read_b64_tr_b16 v[72:73], v26 offset:16384
    s_lshl_b32 s73, s3, 19
    v_mfma_f32_16x16x32_bf16 a[28:31], v[100:103], v[76:79], a[28:31]
    ds_read_b64_tr_b16 v[74:75], v26 offset:18432
    s_lshl_b32 s77, s3, 12
    v_mfma_f32_16x16x32_bf16 a[88:91], v[104:107], v[76:79], a[88:91]
    s_add_u32 s3, s4, 2
    s_and_b32 s3, s3, 3
    v_mfma_f32_16x16x32_bf16 a[92:95], v[108:111], v[76:79], a[92:95]
    s_lshl_b32 s74, s3, 19
    v_mfma_f32_16x16x32_bf16 a[152:155], v[112:115], v[76:79], a[152:155]
    s_lshl_b32 s78, s3, 12
    s_add_u32 s3, s4, 3
    v_mfma_f32_16x16x32_bf16 a[156:159], v[116:119], v[76:79], a[156:159]
    ds_read_b128 v[140:143], v49 offset:38912
    s_and_b32 s3, s3, 3
    v_mfma_f32_16x16x32_bf16 a[216:219], v[120:123], v[76:79], a[216:219]
    s_lshl_b32 s75, s3, 19
    s_lshl_b32 s79, s3, 12
    v_mfma_f32_16x16x32_bf16 a[220:223], v[124:127], v[76:79], a[220:223]
    v_mov_b32 v11, v43
    v_mov_b32 v6, v45
    v_mfma_f32_16x16x32_bf16 a[32:35], v[96:99], v[80:83], a[32:35]
    ds_read_b64_tr_b16 v[76:77], v27 offset:16384
    v_mfma_f32_16x16x32_bf16 a[36:39], v[100:103], v[80:83], a[36:39]
    ds_read_b64_tr_b16 v[78:79], v27 offset:18432
    v_mfma_f32_16x16x32_bf16 a[96:99], v[104:107], v[80:83], a[96:99]
    v_mfma_f32_16x16x32_bf16 a[100:103], v[108:111], v[80:83], a[100:103]
    ds_read_b128 v[144:147], v49 offset:40960
    v_mfma_f32_16x16x32_bf16 a[160:163], v[112:115], v[80:83], a[160:163]
    v_mfma_f32_16x16x32_bf16 a[164:167], v[116:119], v[80:83], a[164:167]
    v_mfma_f32_16x16x32_bf16 a[224:227], v[120:123], v[80:83], a[224:227]
    v_mfma_f32_16x16x32_bf16 a[228:231], v[124:127], v[80:83], a[228:231]
    v_mfma_f32_16x16x32_bf16 a[40:43], v[96:99], v[84:87], a[40:43]
    ds_read_b64_tr_b16 v[80:81], v28 offset:16384
    v_mfma_f32_16x16x32_bf16 a[44:47], v[100:103], v[84:87], a[44:47]
    ds_read_b64_tr_b16 v[82:83], v28 offset:18432
    ds_read_b128 v[148:151], v49 offset:43008
    v_mfma_f32_16x16x32_bf16 a[104:107], v[104:107], v[84:87], a[104:107]
    v_mfma_f32_16x16x32_bf16 a[108:111], v[108:111], v[84:87], a[108:111]
    v_mfma_f32_16x16x32_bf16 a[168:171], v[112:115], v[84:87], a[168:171]
    v_mfma_f32_16x16x32_bf16 a[172:175], v[116:119], v[84:87], a[172:175]
    v_mfma_f32_16x16x32_bf16 a[232:235], v[120:123], v[84:87], a[232:235]
    s_waitcnt lgkmcnt(15)
    v_mfma_f32_16x16x32_bf16 a[236:239], v[124:127], v[84:87], a[236:239]
    ds_read_b128 v[152:155], v49 offset:45056
    v_mfma_f32_16x16x32_bf16 a[48:51], v[96:99], v[88:91], a[48:51]
    ds_read_b64_tr_b16 v[84:85], v29 offset:16384
    v_mfma_f32_16x16x32_bf16 a[52:55], v[100:103], v[88:91], a[52:55]
    ds_read_b64_tr_b16 v[86:87], v29 offset:18432
    v_mfma_f32_16x16x32_bf16 a[112:115], v[104:107], v[88:91], a[112:115]
    v_mfma_f32_16x16x32_bf16 a[116:119], v[108:111], v[88:91], a[116:119]
    v_mfma_f32_16x16x32_bf16 a[176:179], v[112:115], v[88:91], a[176:179]
    v_mfma_f32_16x16x32_bf16 a[180:183], v[116:119], v[88:91], a[180:183]
    ds_read_b128 v[156:159], v49 offset:47104
    v_mfma_f32_16x16x32_bf16 a[240:243], v[120:123], v[88:91], a[240:243]
    v_mfma_f32_16x16x32_bf16 a[244:247], v[124:127], v[88:91], a[244:247]
    v_mfma_f32_16x16x32_bf16 a[56:59], v[96:99], v[92:95], a[56:59]
    ds_read_b64_tr_b16 v[88:89], v30 offset:16384
    v_mfma_f32_16x16x32_bf16 a[60:63], v[100:103], v[92:95], a[60:63]
    ds_read_b64_tr_b16 v[90:91], v30 offset:18432
    v_mfma_f32_16x16x32_bf16 a[120:123], v[104:107], v[92:95], a[120:123]
    v_mfma_f32_16x16x32_bf16 a[124:127], v[108:111], v[92:95], a[124:127]
    v_mfma_f32_16x16x32_bf16 a[184:187], v[112:115], v[92:95], a[184:187]
    v_mfma_f32_16x16x32_bf16 a[188:191], v[116:119], v[92:95], a[188:191]
    v_mfma_f32_16x16x32_bf16 a[248:251], v[120:123], v[92:95], a[248:251]
    s_waitcnt lgkmcnt(2)
    v_mfma_f32_16x16x32_bf16 a[252:255], v[124:127], v[92:95], a[252:255]
    ds_read_b64_tr_b16 v[92:93], v31 offset:16384
    ds_read_b64_tr_b16 v[94:95], v31 offset:18432
    v_mfma_f32_16x16x32_bf16 a[0:3], v[128:131], v[64:67], a[0:3]
    v_mfma_f32_16x16x32_bf16 a[4:7], v[132:135], v[64:67], a[4:7]
    v_mfma_f32_16x16x32_bf16 a[64:67], v[136:139], v[64:67], a[64:67]
    v_mfma_f32_16x16x32_bf16 a[68:71], v[140:143], v[64:67], a[68:71]
    v_mfma_f32_16x16x32_bf16 a[128:131], v[144:147], v[64:67], a[128:131]
    v_mfma_f32_16x16x32_bf16 a[132:135], v[148:151], v[64:67], a[132:135]
    v_mfma_f32_16x16x32_bf16 a[192:195], v[152:155], v[64:67], a[192:195]
    v_mfma_f32_16x16x32_bf16 a[196:199], v[156:159], v[64:67], a[196:199]
    s_waitcnt vmcnt(1) lgkmcnt(0)
    s_barrier
    v_mfma_f32_16x16x32_bf16 a[8:11], v[128:131], v[68:71], a[8:11]
    ds_read_b64_tr_b16 v[64:65], v24 offset:32768
    v_mfma_f32_16x16x32_bf16 a[12:15], v[132:135], v[68:71], a[12:15]
    s_add_u32 m0, s98, 131072
    s_add_u32 s96, s72, 0
    ds_read_b64_tr_b16 v[66:67], v24 offset:34816
    v_mfma_f32_16x16x32_bf16 a[72:75], v[136:139], v[68:71], a[72:75]
    buffer_load_dwordx4 v12, s[24:27], s96 offen offset:0 lds
    v_mfma_f32_16x16x32_bf16 a[76:79], v[140:143], v[68:71], a[76:79]
    ds_read_b128 v[96:99], v48 offset:0
    v_mfma_f32_16x16x32_bf16 a[136:139], v[144:147], v[68:71], a[136:139]
    buffer_load_dwordx4 v13, s[24:27], s96 offen offset:1024 lds
    v_mfma_f32_16x16x32_bf16 a[140:143], v[148:151], v[68:71], a[140:143]
    v_mfma_f32_16x16x32_bf16 a[200:203], v[152:155], v[68:71], a[200:203]
    v_mfma_f32_16x16x32_bf16 a[204:207], v[156:159], v[68:71], a[204:207]
    buffer_load_dwordx4 v14, s[24:27], s96 offen offset:2048 lds
    v_mfma_f32_16x16x32_bf16 a[16:19], v[128:131], v[72:75], a[16:19]
    ds_read_b64_tr_b16 v[68:69], v25 offset:32768
    v_mfma_f32_16x16x32_bf16 a[20:23], v[132:135], v[72:75], a[20:23]
    ds_read_b64_tr_b16 v[70:71], v25 offset:34816
    ds_read_b128 v[100:103], v48 offset:2048
    v_mfma_f32_16x16x32_bf16 a[80:83], v[136:139], v[72:75], a[80:83]
    buffer_load_dwordx4 v15, s[24:27], s96 offen offset:3072 lds
    v_mfma_f32_16x16x32_bf16 a[84:87], v[140:143], v[72:75], a[84:87]
    s_add_u32 m0, s98, 147456
    s_add_u32 s96, s73, 0
    v_mfma_f32_16x16x32_bf16 a[144:147], v[144:147], v[72:75], a[144:147]
    buffer_load_dwordx4 v12, s[24:27], s96 offen offset:0 lds
    v_mfma_f32_16x16x32_bf16 a[148:151], v[148:151], v[72:75], a[148:151]
    v_mfma_f32_16x16x32_bf16 a[208:211], v[152:155], v[72:75], a[208:211]
    v_mfma_f32_16x16x32_bf16 a[212:215], v[156:159], v[72:75], a[212:215]
    ds_read_b128 v[104:107], v48 offset:4096
    v_mfma_f32_16x16x32_bf16 a[24:27], v[128:131], v[76:79], a[24:27]
    ds_read_b64_tr_b16 v[72:73], v26 offset:32768
    v_mfma_f32_16x16x32_bf16 a[28:31], v[132:135], v[76:79], a[28:31]
    ds_read_b64_tr_b16 v[74:75], v26 offset:34816
    v_mfma_f32_16x16x32_bf16 a[88:91], v[136:139], v[76:79], a[88:91]
    buffer_load_dwordx4 v13, s[24:27], s96 offen offset:1024 lds
    v_mfma_f32_16x16x32_bf16 a[92:95], v[140:143], v[76:79], a[92:95]
    buffer_load_dwordx4 v14, s[24:27], s96 offen offset:2048 lds
    v_mfma_f32_16x16x32_bf16 a[152:155], v[144:147], v[76:79], a[152:155]
    buffer_load_dwordx4 v15, s[24:27], s96 offen offset:3072 lds
    v_mfma_f32_16x16x32_bf16 a[156:159], v[148:151], v[76:79], a[156:159]
    ds_read_b128 v[108:111], v48 offset:6144
    v_mfma_f32_16x16x32_bf16 a[216:219], v[152:155], v[76:79], a[216:219]
    v_mfma_f32_16x16x32_bf16 a[220:223], v[156:159], v[76:79], a[220:223]
    v_mfma_f32_16x16x32_bf16 a[32:35], v[128:131], v[80:83], a[32:35]
    ds_read_b64_tr_b16 v[76:77], v27 offset:32768
    v_mfma_f32_16x16x32_bf16 a[36:39], v[132:135], v[80:83], a[36:39]
    ds_read_b64_tr_b16 v[78:79], v27 offset:34816
    v_mfma_f32_16x16x32_bf16 a[96:99], v[136:139], v[80:83], a[96:99]
    v_mfma_f32_16x16x32_bf16 a[100:103], v[140:143], v[80:83], a[100:103]
    ds_read_b128 v[112:115], v48 offset:8192
    v_mfma_f32_16x16x32_bf16 a[160:163], v[144:147], v[80:83], a[160:163]
    v_mfma_f32_16x16x32_bf16 a[164:167], v[148:151], v[80:83], a[164:167]
    v_mfma_f32_16x16x32_bf16 a[224:227], v[152:155], v[80:83], a[224:227]
    s_waitcnt vmcnt(8)
    v_cmp_ne_u32 vcc, 0x01010101, v47
    v_mfma_f32_16x16x32_bf16 a[228:231], v[156:159], v[80:83], a[228:231]
    v_mfma_f32_16x16x32_bf16 a[40:43], v[128:131], v[84:87], a[40:43]
    ds_read_b64_tr_b16 v[80:81], v28 offset:32768
    v_mfma_f32_16x16x32_bf16 a[44:47], v[132:135], v[84:87], a[44:47]
    ds_read_b64_tr_b16 v[82:83], v28 offset:34816
    ds_read_b128 v[116:119], v48 offset:10240
    v_mfma_f32_16x16x32_bf16 a[104:107], v[136:139], v[84:87], a[104:107]
    v_mfma_f32_16x16x32_bf16 a[108:111], v[140:143], v[84:87], a[108:111]
    v_mfma_f32_16x16x32_bf16 a[168:171], v[144:147], v[84:87], a[168:171]
    v_mfma_f32_16x16x32_bf16 a[172:175], v[148:151], v[84:87], a[172:175]
    v_mfma_f32_16x16x32_bf16 a[232:235], v[152:155], v[84:87], a[232:235]
    v_mfma_f32_16x16x32_bf16 a[236:239], v[156:159], v[84:87], a[236:239]
    ds_read_b128 v[120:123], v48 offset:12288
    v_mfma_f32_16x16x32_bf16 a[48:51], v[128:131], v[88:91], a[48:51]
    ds_read_b64_tr_b16 v[84:85], v29 offset:32768
    v_mfma_f32_16x16x32_bf16 a[52:55], v[132:135], v[88:91], a[52:55]
    ds_read_b64_tr_b16 v[86:87], v29 offset:34816
    v_mfma_f32_16x16x32_bf16 a[112:115], v[136:139], v[88:91], a[112:115]
    v_mfma_f32_16x16x32_bf16 a[116:119], v[140:143], v[88:91], a[116:119]
    v_mfma_f32_16x16x32_bf16 a[176:179], v[144:147], v[88:91], a[176:179]
    v_mfma_f32_16x16x32_bf16 a[180:183], v[148:151], v[88:91], a[180:183]
    ds_read_b128 v[124:127], v48 offset:14336
    v_mfma_f32_16x16x32_bf16 a[240:243], v[152:155], v[88:91], a[240:243]
    v_mfma_f32_16x16x32_bf16 a[244:247], v[156:159], v[88:91], a[244:247]
    v_mfma_f32_16x16x32_bf16 a[56:59], v[128:131], v[92:95], a[56:59]
    ds_read_b64_tr_b16 v[88:89], v30 offset:32768
    v_mfma_f32_16x16x32_bf16 a[60:63], v[132:135], v[92:95], a[60:63]
    ds_read_b64_tr_b16 v[90:91], v30 offset:34816
    v_mfma_f32_16x16x32_bf16 a[120:123], v[136:139], v[92:95], a[120:123]
    v_mfma_f32_16x16x32_bf16 a[124:127], v[140:143], v[92:95], a[124:127]
    v_mfma_f32_16x16x32_bf16 a[184:187], v[144:147], v[92:95], a[184:187]
    v_mfma_f32_16x16x32_bf16 a[188:191], v[148:151], v[92:95], a[188:191]
    v_mfma_f32_16x16x32_bf16 a[248:251], v[152:155], v[92:95], a[248:251]
    s_waitcnt lgkmcnt(2)
    s_cbranch_vccnz fk_lnw1
fk_lnw1_ret:
    v_mfma_f32_16x16x32_bf16 a[252:255], v[156:159], v[92:95], a[252:255]
    ds_read_b64_tr_b16 v[92:93], v31 offset:32768
    ds_read_b64_tr_b16 v[94:95], v31 offset:34816
    v_mfma_f32_16x16x32_bf16 a[0:3], v[96:99], v[64:67], a[0:3]
    v_mfma_f32_16x16x32_bf16 a[4:7], v[100:103], v[64:67], a[4:7]
    s_add_u32 s97, s76, 0
    v_mfma_f32_16x16x32_bf16 a[64:67], v[104:107], v[64:67], a[64:67]
    buffer_load_dwordx4 v[192:195], v9, s[16:19], s97 offen offset:0 sc1
    v_mfma_f32_16x16x32_bf16 a[68:71], v[108:111], v[64:67], a[68:71]
    v_mfma_f32_16x16x32_bf16 a[128:131], v[112:115], v[64:67], a[128:131]
    v_mfma_f32_16x16x32_bf16 a[132:135], v[116:119], v[64:67], a[132:135]
    buffer_load_dwordx4 v[196:199], v9, s[16:19], s97 offen offset:256 sc1
    v_mfma_f32_16x16x32_bf16 a[192:195], v[120:123], v[64:67], a[192:195]
    v_mfma_f32_16x16x32_bf16 a[196:199], v[124:127], v[64:67], a[196:199]
    v_mfma_f32_16x16x32_bf16 a[8:11], v[96:99], v[68:71], a[8:11]
    ds_read_b64_tr_b16 v[64:65], v24 offset:49152
    v_mfma_f32_16x16x32_bf16 a[12:15], v[100:103], v[68:71], a[12:15]
    ds_read_b64_tr_b16 v[66:67], v24 offset:51200
    v_mfma_f32_16x16x32_bf16 a[72:75], v[104:107], v[68:71], a[72:75]
    buffer_load_dwordx4 v[200:203], v10, s[16:19], s97 offen offset:0 sc1
    v_mfma_f32_16x16x32_bf16 a[76:79], v[108:111], v[68:71], a[76:79]
    ds_read_b128 v[128:131], v49 offset:0
    v_mfma_f32_16x16x32_bf16 a[136:139], v[112:115], v[68:71], a[136:139]
    buffer_load_dwordx4 v[204:207], v10, s[16:19], s97 offen offset:256 sc1
    v_mfma_f32_16x16x32_bf16 a[140:143], v[116:119], v[68:71], a[140:143]
    v_mfma_f32_16x16x32_bf16 a[200:203], v[120:123], v[68:71], a[200:203]
    v_mfma_f32_16x16x32_bf16 a[204:207], v[124:127], v[68:71], a[204:207]
    v_mfma_f32_16x16x32_bf16 a[16:19], v[96:99], v[72:75], a[16:19]
    ds_read_b64_tr_b16 v[68:69], v25 offset:49152
    v_mfma_f32_16x16x32_bf16 a[20:23], v[100:103], v[72:75], a[20:23]
    s_add_u32 s97, s76, 0
    ds_read_b64_tr_b16 v[70:71], v25 offset:51200
    ds_read_b128 v[132:135], v49 offset:2048
    v_mfma_f32_16x16x32_bf16 a[80:83], v[104:107], v[72:75], a[80:83]
    buffer_load_dwordx4 v[208:211], v9, s[16:19], s97 offen offset:2048 sc1
    v_mfma_f32_16x16x32_bf16 a[84:87], v[108:111], v[72:75], a[84:87]
    v_mfma_f32_16x16x32_bf16 a[144:147], v[112:115], v[72:75], a[144:147]
    buffer_load_dwordx4 v[212:215], v9, s[16:19], s97 offen offset:2304 sc1
    v_mfma_f32_16x16x32_bf16 a[148:151], v[116:119], v[72:75], a[148:151]
    v_mfma_f32_16x16x32_bf16 a[208:211], v[120:123], v[72:75], a[208:211]
    v_mfma_f32_16x16x32_bf16 a[212:215], v[124:127], v[72:75], a[212:215]
    ds_read_b128 v[136:139], v49 offset:4096
    v_mfma_f32_16x16x32_bf16 a[24:27], v[96:99], v[76:79], a[24:27]
    ds_read_b64_tr_b16 v[72:73], v26 offset:49152
    v_mfma_f32_16x16x32_bf16 a[28:31], v[100:103], v[76:79], a[28:31]
    ds_read_b64_tr_b16 v[74:75], v26 offset:51200
    v_mfma_f32_16x16x32_bf16 a[88:91], v[104:107], v[76:79], a[88:91]
    buffer_load_dwordx4 v[216:219], v10, s[16:19], s97 offen offset:2048 sc1
    v_mfma_f32_16x16x32_bf16 a[92:95], v[108:111], v[76:79], a[92:95]
    buffer_load_dwordx4 v[220:223], v10, s[16:19], s97 offen offset:2304 sc1
    v_mfma_f32_16x16x32_bf16 a[152:155], v[112:115], v[76:79], a[152:155]
    v_mfma_f32_16x16x32_bf16 a[156:159], v[116:119], v[76:79], a[156:159]
    ds_read_b128 v[140:143], v49 offset:6144
    v_mfma_f32_16x16x32_bf16 a[216:219], v[120:123], v[76:79], a[216:219]
    v_mfma_f32_16x16x32_bf16 a[220:223], v[124:127], v[76:79], a[220:223]
    v_mfma_f32_16x16x32_bf16 a[32:35], v[96:99], v[80:83], a[32:35]
    ds_read_b64_tr_b16 v[76:77], v27 offset:49152
    v_mfma_f32_16x16x32_bf16 a[36:39], v[100:103], v[80:83], a[36:39]
    s_add_u32 s97, s77, 0
    ds_read_b64_tr_b16 v[78:79], v27 offset:51200
    v_mfma_f32_16x16x32_bf16 a[96:99], v[104:107], v[80:83], a[96:99]
    buffer_load_dwordx4 v[224:227], v9, s[16:19], s97 offen offset:0 sc1
    v_mfma_f32_16x16x32_bf16 a[100:103], v[108:111], v[80:83], a[100:103]
    ds_read_b128 v[144:147], v49 offset:8192
    v_mfma_f32_16x16x32_bf16 a[160:163], v[112:115], v[80:83], a[160:163]
    v_mfma_f32_16x16x32_bf16 a[164:167], v[116:119], v[80:83], a[164:167]
    v_mfma_f32_16x16x32_bf16 a[224:227], v[120:123], v[80:83], a[224:227]
    v_mfma_f32_16x16x32_bf16 a[228:231], v[124:127], v[80:83], a[228:231]
    v_mfma_f32_16x16x32_bf16 a[40:43], v[96:99], v[84:87], a[40:43]
    ds_read_b64_tr_b16 v[80:81], v28 offset:49152
    v_mfma_f32_16x16x32_bf16 a[44:47], v[100:103], v[84:87], a[44:47]
    ds_read_b64_tr_b16 v[82:83], v28 offset:51200
    ds_read_b128 v[148:151], v49 offset:10240
    v_mfma_f32_16x16x32_bf16 a[104:107], v[104:107], v[84:87], a[104:107]
    buffer_load_dwordx4 v[228:231], v9, s[16:19], s97 offen offset:256 sc1
    v_mfma_f32_16x16x32_bf16 a[108:111], v[108:111], v[84:87], a[108:111]
    v_mfma_f32_16x16x32_bf16 a[168:171], v[112:115], v[84:87], a[168:171]
    v_mfma_f32_16x16x32_bf16 a[172:175], v[116:119], v[84:87], a[172:175]
    v_mfma_f32_16x16x32_bf16 a[232:235], v[120:123], v[84:87], a[232:235]
    s_waitcnt lgkmcnt(15)
    v_mfma_f32_16x16x32_bf16 a[236:239], v[124:127], v[84:87], a[236:239]
    ds_read_b128 v[152:155], v49 offset:12288
    v_mfma_f32_16x16x32_bf16 a[48:51], v[96:99], v[88:91], a[48:51]
    ds_read_b64_tr_b16 v[84:85], v29 offset:49152
    v_mfma_f32_16x16x32_bf16 a[52:55], v[100:103], v[88:91], a[52:55]
    ds_read_b64_tr_b16 v[86:87], v29 offset:51200
    v_mfma_f32_16x16x32_bf16 a[112:115], v[104:107], v[88:91], a[112:115]
    buffer_load_dwordx4 v[232:235], v10, s[16:19], s97 offen offset:0 sc1
    v_mfma_f32_16x16x32_bf16 a[116:119], v[108:111], v[88:91], a[116:119]
    v_mfma_f32_16x16x32_bf16 a[176:179], v[112:115], v[88:91], a[176:179]
    v_mfma_f32_16x16x32_bf16 a[180:183], v[116:119], v[88:91], a[180:183]
    ds_read_b128 v[156:159], v49 offset:14336
    v_mfma_f32_16x16x32_bf16 a[240:243], v[120:123], v[88:91], a[240:243]
    v_mfma_f32_16x16x32_bf16 a[244:247], v[124:127], v[88:91], a[244:247]
    buffer_load_dwordx4 v[236:239], v10, s[16:19], s97 offen offset:256 sc1
    v_mfma_f32_16x16x32_bf16 a[56:59], v[96:99], v[92:95], a[56:59]
    ds_read_b64_tr_b16 v[88:89], v30 offset:49152
    v_mfma_f32_16x16x32_bf16 a[60:63], v[100:103], v[92:95], a[60:63]
    ds_read_b64_tr_b16 v[90:91], v30 offset:51200
    v_mfma_f32_16x16x32_bf16 a[120:123], v[104:107], v[92:95], a[120:123]
    v_mfma_f32_16x16x32_bf16 a[124:127], v[108:111], v[92:95], a[124:127]
    v_mfma_f32_16x16x32_bf16 a[184:187], v[112:115], v[92:95], a[184:187]
    v_mfma_f32_16x16x32_bf16 a[188:191], v[116:119], v[92:95], a[188:191]
    v_mfma_f32_16x16x32_bf16 a[248:251], v[120:123], v[92:95], a[248:251]
    s_waitcnt lgkmcnt(2)
    v_mfma_f32_16x16x32_bf16 a[252:255], v[124:127], v[92:95], a[252:255]
    ds_read_b64_tr_b16 v[92:93], v31 offset:49152
    ds_read_b64_tr_b16 v[94:95], v31 offset:51200
    v_mfma_f32_16x16x32_bf16 a[0:3], v[128:131], v[64:67], a[0:3]
    v_mfma_f32_16x16x32_bf16 a[4:7], v[132:135], v[64:67], a[4:7]
    v_mfma_f32_16x16x32_bf16 a[64:67], v[136:139], v[64:67], a[64:67]
    v_mfma_f32_16x16x32_bf16 a[68:71], v[140:143], v[64:67], a[68:71]
    v_mfma_f32_16x16x32_bf16 a[128:131], v[144:147], v[64:67], a[128:131]
    v_mfma_f32_16x16x32_bf16 a[132:135], v[148:151], v[64:67], a[132:135]
    v_mfma_f32_16x16x32_bf16 a[192:195], v[152:155], v[64:67], a[192:195]
    v_mfma_f32_16x16x32_bf16 a[196:199], v[156:159], v[64:67], a[196:199]
    v_mfma_f32_16x16x32_bf16 a[8:11], v[128:131], v[68:71], a[8:11]
    v_mfma_f32_16x16x32_bf16 a[12:15], v[132:135], v[68:71], a[12:15]
    v_mfma_f32_16x16x32_bf16 a[72:75], v[136:139], v[68:71], a[72:75]
    v_mfma_f32_16x16x32_bf16 a[76:79], v[140:143], v[68:71], a[76:79]
    v_mfma_f32_16x16x32_bf16 a[136:139], v[144:147], v[68:71], a[136:139]
    v_mfma_f32_16x16x32_bf16 a[140:143], v[148:151], v[68:71], a[140:143]
    v_mfma_f32_16x16x32_bf16 a[200:203], v[152:155], v[68:71], a[200:203]
    v_mfma_f32_16x16x32_bf16 a[204:207], v[156:159], v[68:71], a[204:207]
    v_mfma_f32_16x16x32_bf16 a[16:19], v[128:131], v[72:75], a[16:19]
    v_mfma_f32_16x16x32_bf16 a[20:23], v[132:135], v[72:75], a[20:23]
    v_mfma_f32_16x16x32_bf16 a[80:83], v[136:139], v[72:75], a[80:83]
    v_mfma_f32_16x16x32_bf16 a[84:87], v[140:143], v[72:75], a[84:87]
    v_mfma_f32_16x16x32_bf16 a[144:147], v[144:147], v[72:75], a[144:147]
    v_mfma_f32_16x16x32_bf16 a[148:151], v[148:151], v[72:75], a[148:151]
    v_mfma_f32_16x16x32_bf16 a[208:211], v[152:155], v[72:75], a[208:211]
    v_mfma_f32_16x16x32_bf16 a[212:215], v[156:159], v[72:75], a[212:215]
    v_mfma_f32_16x16x32_bf16 a[24:27], v[128:131], v[76:79], a[24:27]
    v_mfma_f32_16x16x32_bf16 a[28:31], v[132:135], v[76:79], a[28:31]
    v_mfma_f32_16x16x32_bf16 a[88:91], v[136:139], v[76:79], a[88:91]
    v_mfma_f32_16x16x32_bf16 a[92:95], v[140:143], v[76:79], a[92:95]
    v_mfma_f32_16x16x32_bf16 a[152:155], v[144:147], v[76:79], a[152:155]
    v_mfma_f32_16x16x32_bf16 a[156:159], v[148:151], v[76:79], a[156:159]
    v_mfma_f32_16x16x32_bf16 a[216:219], v[152:155], v[76:79], a[216:219]
    v_mfma_f32_16x16x32_bf16 a[220:223], v[156:159], v[76:79], a[220:223]
    v_mfma_f32_16x16x32_bf16 a[32:35], v[128:131], v[80:83], a[32:35]
    v_bfe_u32 v2, v1, 2, 3
    v_mfma_f32_16x16x32_bf16 a[36:39], v[132:135], v[80:83], a[36:39]
    v_bfe_u32 v4, v1, 2, 2
    v_lshrrev_b32 v3, 4, v1
    v_mfma_f32_16x16x32_bf16 a[96:99], v[136:139], v[80:83], a[96:99]
    v_lshl_add_u32 v3, v3, 3, v4
    v_mfma_f32_16x16x32_bf16 a[100:103], v[140:143], v[80:83], a[100:103]
    v_lshlrev_b32 v3, 8, v3
    v_mfma_f32_16x16x32_bf16 a[160:163], v[144:147], v[80:83], a[160:163]
    v_and_b32 v4, 3, v1
    v_lshl_add_u32 v3, v4, 3, v3
    v_mfma_f32_16x16x32_bf16 a[164:167], v[148:151], v[80:83], a[164:167]
    v_add_u32 v3, 98304, v3
    v_mfma_f32_16x16x32_bf16 a[224:227], v[152:155], v[80:83], a[224:227]
    v_xor_b32 v5, 0, v2
    v_mfma_f32_16x16x32_bf16 a[228:231], v[156:159], v[80:83], a[228:231]
    v_lshl_add_u32 v24, v5, 5, v3
    v_xor_b32 v5, 1, v2
    v_mfma_f32_16x16x32_bf16 a[40:43], v[128:131], v[84:87], a[40:43]
    v_lshl_add_u32 v25, v5, 5, v3
    v_mfma_f32_16x16x32_bf16 a[44:47], v[132:135], v[84:87], a[44:47]
    v_xor_b32 v5, 2, v2
    v_mfma_f32_16x16x32_bf16 a[104:107], v[136:139], v[84:87], a[104:107]
    v_lshl_add_u32 v26, v5, 5, v3
    v_mfma_f32_16x16x32_bf16 a[108:111], v[140:143], v[84:87], a[108:111]
    v_xor_b32 v5, 3, v2
    v_lshl_add_u32 v27, v5, 5, v3
    v_mfma_f32_16x16x32_bf16 a[168:171], v[144:147], v[84:87], a[168:171]
    v_xor_b32 v5, 4, v2
    v_mfma_f32_16x16x32_bf16 a[172:175], v[148:151], v[84:87], a[172:175]
    v_lshl_add_u32 v28, v5, 5, v3
    v_mfma_f32_16x16x32_bf16 a[232:235], v[152:155], v[84:87], a[232:235]
    s_waitcnt lgkmcnt(2)
    v_xor_b32 v5, 5, v2
    v_lshl_add_u32 v29, v5, 5, v3
    v_mfma_f32_16x16x32_bf16 a[236:239], v[156:159], v[84:87], a[236:239]
    v_xor_b32 v5, 6, v2
    v_mfma_f32_16x16x32_bf16 a[48:51], v[128:131], v[88:91], a[48:51]
    v_lshl_add_u32 v30, v5, 5, v3
    v_mfma_f32_16x16x32_bf16 a[52:55], v[132:135], v[88:91], a[52:55]
    v_xor_b32 v5, 7, v2
    v_lshl_add_u32 v31, v5, 5, v3
    v_mfma_f32_16x16x32_bf16 a[112:115], v[136:139], v[88:91], a[112:115]
    v_bfe_u32 v4, v1, 4, 1
    v_mfma_f32_16x16x32_bf16 a[116:119], v[140:143], v[88:91], a[116:119]
    v_lshlrev_b32 v4, 10, v4
    v_mfma_f32_16x16x32_bf16 a[176:179], v[144:147], v[88:91], a[176:179]
    v_lshrrev_b32 v5, 5, v1
    v_lshl_add_u32 v4, v5, 9, v4
    v_mfma_f32_16x16x32_bf16 a[180:183], v[148:151], v[88:91], a[180:183]
    v_bfe_u32 v5, v1, 3, 1
    v_mfma_f32_16x16x32_bf16 a[240:243], v[152:155], v[88:91], a[240:243]
    s_waitcnt lgkmcnt(0)
    v_lshl_add_u32 v4, v5, 8, v4
    v_mfma_f32_16x16x32_bf16 a[244:247], v[156:159], v[88:91], a[244:247]
    v_and_b32 v5, 7, v1
    v_lshl_add_u32 v4, v5, 4, v4
    v_mfma_f32_16x16x32_bf16 a[56:59], v[128:131], v[92:95], a[56:59]
    v_lshrrev_b32 v5, 4, v1
    v_mfma_f32_16x16x32_bf16 a[60:63], v[132:135], v[92:95], a[60:63]
    v_lshlrev_b32 v5, 9, v5
    v_mfma_f32_16x16x32_bf16 a[120:123], v[136:139], v[92:95], a[120:123]
    v_and_b32 v3, 15, v1
    v_mfma_f32_16x16x32_bf16 a[124:127], v[140:143], v[92:95], a[124:127]
    v_lshl_add_u32 v5, v3, 4, v5
    s_cmp_eq_u32 s68, 0
    v_mfma_f32_16x16x32_bf16 a[184:187], v[144:147], v[92:95], a[184:187]
    s_cselect_b64 vcc, -1, 0
    v_mfma_f32_16x16x32_bf16 a[188:191], v[148:151], v[92:95], a[188:191]
    s_cselect_b32 s3, 2, 4
    v_mfma_f32_16x16x32_bf16 a[248:251], v[152:155], v[92:95], a[248:251]
    s_lshl_b32 s3, s3, 6
    v_cndmask_b32 v2, v5, v4, vcc
    v_mfma_f32_16x16x32_bf16 a[252:255], v[156:159], v[92:95], a[252:255]
    v_add_u32 v3, s3, v2
fk_q:
    s_waitcnt vmcnt(16)
    s_barrier
    ds_read_b64_tr_b16 v[160:161], v24 offset:32768
    ds_read_b64_tr_b16 v[162:163], v24 offset:33792
    ds_read_b64_tr_b16 v[164:165], v25 offset:32768
    ds_read_b64_tr_b16 v[166:167], v25 offset:33792
    ds_read_b64_tr_b16 v[168:169], v26 offset:32768
    ds_read_b64_tr_b16 v[170:171], v26 offset:33792
    ds_read_b64_tr_b16 v[172:173], v27 offset:32768
    ds_read_b64_tr_b16 v[174:175], v27 offset:33792
    ds_read_b64_tr_b16 v[176:177], v28 offset:32768
    ds_read_b64_tr_b16 v[178:179], v28 offset:33792
    ds_read_b64_tr_b16 v[180:181], v29 offset:32768
    ds_read_b64_tr_b16 v[182:183], v29 offset:33792
    ds_read_b64_tr_b16 v[184:185], v30 offset:32768
    ds_read_b64_tr_b16 v[186:187], v30 offset:33792
    ds_read_b64_tr_b16 v[188:189], v31 offset:32768
    ds_read_b64_tr_b16 v[190:191], v31 offset:33792
    s_add_u32 m0, s98, 98304
    s_add_u32 s96, s74, 0
    buffer_load_dwordx4 v12, s[24:27], s96 offen offset:0 lds
    buffer_load_dwordx4 v13, s[24:27], s96 offen offset:1024 lds
    buffer_load_dwordx4 v14, s[24:27], s96 offen offset:2048 lds
    buffer_load_dwordx4 v15, s[24:27], s96 offen offset:3072 lds
    s_waitcnt vmcnt(12) lgkmcnt(14)
    v_mfma_f32_16x16x32_bf16 v[32:35], v[160:163], v[192:195], 0
    s_add_u32 s97, s77, 0
    s_nop 0
    s_add_u32 s4, s99, 0
    v_mfma_f32_16x16x32_bf16 v[40:43], v[160:163], v[196:199], 0
    buffer_load_dwordx4 v[240:243], v9, s[16:19], s97 offen offset:2048 sc1
    v_mfma_f32_16x16x32_bf16 v[96:99], v[160:163], v[200:203], 0
    v_mfma_f32_16x16x32_bf16 v[104:107], v[160:163], v[204:207], 0
    v_accvgpr_read_b32 v16, a0
    v_accvgpr_read_b32 v17, a1
    v_accvgpr_read_b32 v18, a2
    s_waitcnt lgkmcnt(12)
    v_mfma_f32_16x16x32_bf16 v[36:39], v[164:167], v[192:195], 0
    ds_read_b64_tr_b16 v[160:161], v24 offset:40960
    v_accvgpr_read_b32 v19, a3
    v_mfma_f32_16x16x32_bf16 v[44:47], v[164:167], v[196:199], 0
    ds_read_b64_tr_b16 v[162:163], v24 offset:41984
    v_accvgpr_read_b32 v20, a4
    v_mfma_f32_16x16x32_bf16 v[100:103], v[164:167], v[200:203], 0
    s_waitcnt lgkmcnt(10)
    v_accvgpr_read_b32 v21, a5
    v_accvgpr_read_b32 v22, a6
    v_mfma_f32_16x16x32_bf16 v[108:111], v[164:167], v[204:207], 0
    v_accvgpr_read_b32 v23, a7
    v_cvt_pk_bf16_f32 v16, v16, v17
    v_mfma_f32_16x16x32_bf16 v[48:51], v[168:171], v[192:195], 0
    ds_read_b64_tr_b16 v[164:165], v25 offset:40960
    v_cvt_pk_bf16_f32 v17, v18, v19
    v_mfma_f32_16x16x32_bf16 v[56:59], v[168:171], v[196:199], 0
    ds_read_b64_tr_b16 v[166:167], v25 offset:41984
    v_cvt_pk_bf16_f32 v18, v20, v21
    v_mfma_f32_16x16x32_bf16 v[112:115], v[168:171], v[200:203], 0
    buffer_load_dwordx4 v[244:247], v9, s[16:19], s97 offen offset:2304 sc1
    v_mfma_f32_16x16x32_bf16 v[120:123], v[168:171], v[204:207], 0
    v_mfma_f32_16x16x32_bf16 v[52:55], v[172:175], v[192:195], 0
    ds_read_b64_tr_b16 v[168:169], v26 offset:40960
    v_cvt_pk_bf16_f32 v19, v22, v23
    v_mfma_f32_16x16x32_bf16 v[60:63], v[172:175], v[196:199], 0
    ds_read_b64_tr_b16 v[170:171], v26 offset:41984
    v_mfma_f32_16x16x32_bf16 v[116:119], v[172:175], v[200:203], 0
    s_waitcnt lgkmcnt(10)
    buffer_store_dwordx4 v[16:19], v2, s[16:19], s4 offen offset:0 sc1
    v_mfma_f32_16x16x32_bf16 v[124:127], v[172:175], v[204:207], 0
    s_nop 0
    s_add_u32 s4, s99, 0
    v_mfma_f32_16x16x32_bf16 v[64:67], v[176:179], v[192:195], 0
    ds_read_b64_tr_b16 v[172:173], v27 offset:40960
    v_accvgpr_read_b32 v16, a8
    v_mfma_f32_16x16x32_bf16 v[72:75], v[176:179], v[196:199], 0
    ds_read_b64_tr_b16 v[174:175], v27 offset:41984
    v_accvgpr_read_b32 v17, a9
    v_mfma_f32_16x16x32_bf16 v[128:131], v[176:179], v[200:203], 0
    buffer_load_dwordx4 v[248:251], v10, s[16:19], s97 offen offset:2048 sc1
    v_mfma_f32_16x16x32_bf16 v[136:139], v[176:179], v[204:207], 0
    v_accvgpr_read_b32 v18, a10
    v_mfma_f32_16x16x32_bf16 v[68:71], v[180:183], v[192:195], 0
    ds_read_b64_tr_b16 v[176:177], v28 offset:40960
    v_accvgpr_read_b32 v19, a11
    v_mfma_f32_16x16x32_bf16 v[76:79], v[180:183], v[196:199], 0
    ds_read_b64_tr_b16 v[178:179], v28 offset:41984
    v_accvgpr_read_b32 v20, a12
    v_mfma_f32_16x16x32_bf16 v[132:135], v[180:183], v[200:203], 0
    s_waitcnt lgkmcnt(10)
    v_accvgpr_read_b32 v21, a13
    v_accvgpr_read_b32 v22, a14
    v_mfma_f32_16x16x32_bf16 v[140:143], v[180:183], v[204:207], 0
    buffer_load_dwordx4 v[252:255], v10, s[16:19], s97 offen offset:2304 sc1
    v_mfma_f32_16x16x32_bf16 v[80:83], v[184:187], v[192:195], 0
    ds_read_b64_tr_b16 v[180:181], v29 offset:40960
    v_mfma_f32_16x16x32_bf16 v[88:91], v[184:187], v[196:199], 0
    ds_read_b64_tr_b16 v[182:183], v29 offset:41984
    v_mfma_f32_16x16x32_bf16 v[144:147], v[184:187], v[200:203], 0
    v_accvgpr_read_b32 v23, a15
    v_cvt_pk_bf16_f32 v16, v16, v17
    v_mfma_f32_16x16x32_bf16 v[152:155], v[184:187], v[204:207], 0
    v_cvt_pk_bf16_f32 v17, v18, v19
    v_cvt_pk_bf16_f32 v18, v20, v21
    v_mfma_f32_16x16x32_bf16 v[84:87], v[188:191], v[192:195], 0
    ds_read_b64_tr_b16 v[184:185], v30 offset:40960
    v_cvt_pk_bf16_f32 v19, v22, v23
    v_mfma_f32_16x16x32_bf16 v[92:95], v[188:191], v[196:199], 0
    ds_read_b64_tr_b16 v[186:187], v30 offset:41984
    v_mfma_f32_16x16x32_bf16 v[148:151], v[188:191], v[200:203], 0
    s_waitcnt vmcnt(13) lgkmcnt(10)
    buffer_store_dwordx4 v[16:19], v3, s[16:19], s4 offen offset:0 sc1
    v_mfma_f32_16x16x32_bf16 v[156:159], v[188:191], v[204:207], 0
    ds_read_b64_tr_b16 v[188:189], v31 offset:40960
    ds_read_b64_tr_b16 v[190:191], v31 offset:41984
    v_mfma_f32_16x16x32_bf16 v[32:35], v[160:163], v[208:211], v[32:35]
    s_nop 0
    s_add_u32 s4, s99, 0
    v_accvgpr_read_b32 v16, a16
    v_mfma_f32_16x16x32_bf16 v[40:43], v[160:163], v[212:215], v[40:43]
    v_accvgpr_read_b32 v17, a17
    v_accvgpr_read_b32 v18, a18
    v_mfma_f32_16x16x32_bf16 v[96:99], v[160:163], v[216:219], v[96:99]
    v_accvgpr_read_b32 v19, a19
    v_accvgpr_read_b32 v20, a20
    v_accvgpr_read_b32 v21, a21
    v_mfma_f32_16x16x32_bf16 v[104:107], v[160:163], v[220:223], v[104:107]
    v_accvgpr_read_b32 v22, a22
    s_barrier
    v_mfma_f32_16x16x32_bf16 v[36:39], v[164:167], v[208:211], v[36:39]
    ds_read_b64_tr_b16 v[160:161], v24 offset:49152
    v_accvgpr_read_b32 v23, a23
    v_mfma_f32_16x16x32_bf16 v[44:47], v[164:167], v[212:215], v[44:47]
    s_add_u32 s97, s78, 0
    ds_read_b64_tr_b16 v[162:163], v24 offset:50176
    v_cvt_pk_bf16_f32 v16, v16, v17
    v_cvt_pk_bf16_f32 v17, v18, v19
    v_mfma_f32_16x16x32_bf16 v[100:103], v[164:167], v[216:219], v[100:103]
    s_waitcnt lgkmcnt(10)
    buffer_load_dwordx4 v[192:195], v9, s[16:19], s97 offen offset:0 sc1
    v_mfma_f32_16x16x32_bf16 v[108:111], v[164:167], v[220:223], v[108:111]
    v_cvt_pk_bf16_f32 v18, v20, v21
    v_mfma_f32_16x16x32_bf16 v[48:51], v[168:171], v[208:211], v[48:51]
    ds_read_b64_tr_b16 v[164:165], v25 offset:49152
    v_cvt_pk_bf16_f32 v19, v22, v23
    v_mfma_f32_16x16x32_bf16 v[56:59], v[168:171], v[212:215], v[56:59]
    ds_read_b64_tr_b16 v[166:167], v25 offset:50176
    buffer_store_dwordx4 v[16:19], v2, s[16:19], s4 offen offset:2048 sc1
    v_mfma_f32_16x16x32_bf16 v[112:115], v[168:171], v[216:219], v[112:115]
    buffer_load_dwordx4 v[196:199], v9, s[16:19], s97 offen offset:256 sc1
    v_mfma_f32_16x16x32_bf16 v[120:123], v[168:171], v[220:223], v[120:123]
    v_mfma_f32_16x16x32_bf16 v[52:55], v[172:175], v[208:211], v[52:55]
    ds_read_b64_tr_b16 v[168:169], v26 offset:49152
    s_nop 0
    s_add_u32 s4, s99, 0
    v_mfma_f32_16x16x32_bf16 v[60:63], v[172:175], v[212:215], v[60:63]
    s_add_u32 m0, s98, 114688
    s_add_u32 s96, s75, 0
    ds_read_b64_tr_b16 v[170:171], v26 offset:50176
    v_accvgpr_read_b32 v16, a24
    v_mfma_f32_16x16x32_bf16 v[116:119], v[172:175], v[216:219], v[116:119]
    s_waitcnt lgkmcnt(10)
    buffer_load_dwordx4 v12, s[24:27], s96 offen offset:0 lds
    v_mfma_f32_16x16x32_bf16 v[124:127], v[172:175], v[220:223], v[124:127]
    buffer_load_dwordx4 v13, s[24:27], s96 offen offset:1024 lds
    v_mfma_f32_16x16x32_bf16 v[64:67], v[176:179], v[208:211], v[64:67]
    ds_read_b64_tr_b16 v[172:173], v27 offset:49152
    v_mfma_f32_16x16x32_bf16 v[72:75], v[176:179], v[212:215], v[72:75]
    ds_read_b64_tr_b16 v[174:175], v27 offset:50176
    v_accvgpr_read_b32 v17, a25
    v_mfma_f32_16x16x32_bf16 v[128:131], v[176:179], v[216:219], v[128:131]
    buffer_load_dwordx4 v14, s[24:27], s96 offen offset:2048 lds
    v_mfma_f32_16x16x32_bf16 v[136:139], v[176:179], v[220:223], v[136:139]
    v_accvgpr_read_b32 v18, a26
    v_mfma_f32_16x16x32_bf16 v[68:71], v[180:183], v[208:211], v[68:71]
    ds_read_b64_tr_b16 v[176:177], v28 offset:49152
    v_accvgpr_read_b32 v19, a27
    v_accvgpr_read_b32 v20, a28
    v_mfma_f32_16x16x32_bf16 v[76:79], v[180:183], v[212:215], v[76:79]
    ds_read_b64_tr_b16 v[178:179], v28 offset:50176
    v_accvgpr_read_b32 v21, a29
    v_accvgpr_read_b32 v22, a30
    v_mfma_f32_16x16x32_bf16 v[132:135], v[180:183], v[216:219], v[132:135]
    s_waitcnt lgkmcnt(10)
    buffer_load_dwordx4 v15, s[24:27], s96 offen offset:3072 lds
    v_mfma_f32_16x16x32_bf16 v[140:143], v[180:183], v[220:223], v[140:143]
    v_accvgpr_read_b32 v23, a31
    v_mfma_f32_16x16x32_bf16 v[80:83], v[184:187], v[208:211], v[80:83]
    ds_read_b64_tr_b16 v[180:181], v29 offset:49152
    v_cvt_pk_bf16_f32 v16, v16, v17
    v_cvt_pk_bf16_f32 v17, v18, v19
    v_mfma_f32_16x16x32_bf16 v[88:91], v[184:187], v[212:215], v[88:91]
    ds_read_b64_tr_b16 v[182:183], v29 offset:50176
    v_cvt_pk_bf16_f32 v18, v20, v21
    v_mfma_f32_16x16x32_bf16 v[144:147], v[184:187], v[216:219], v[144:147]
    buffer_load_dwordx4 v[200:203], v10, s[16:19], s97 offen offset:0 sc1
    v_mfma_f32_16x16x32_bf16 v[152:155], v[184:187], v[220:223], v[152:155]
    buffer_load_dwordx4 v[204:207], v10, s[16:19], s97 offen offset:256 sc1
    v_mfma_f32_16x16x32_bf16 v[84:87], v[188:191], v[208:211], v[84:87]
    ds_read_b64_tr_b16 v[184:185], v30 offset:49152
    v_mfma_f32_16x16x32_bf16 v[92:95], v[188:191], v[212:215], v[92:95]
    ds_read_b64_tr_b16 v[186:187], v30 offset:50176
    v_cvt_pk_bf16_f32 v19, v22, v23
    v_mfma_f32_16x16x32_bf16 v[148:151], v[188:191], v[216:219], v[148:151]
    s_waitcnt vmcnt(19) lgkmcnt(10)
    buffer_store_dwordx4 v[16:19], v3, s[16:19], s4 offen offset:2048 sc1
    v_mfma_f32_16x16x32_bf16 v[156:159], v[188:191], v[220:223], v[156:159]
    ds_read_b64_tr_b16 v[188:189], v31 offset:49152
    ds_read_b64_tr_b16 v[190:191], v31 offset:50176
    v_mfma_f32_16x16x32_bf16 v[32:35], v[160:163], v[224:227], v[32:35]
    s_add_u32 s97, s78, 0
    s_nop 0
    s_add_u32 s4, s99, 4096
    v_mfma_f32_16x16x32_bf16 v[40:43], v[160:163], v[228:231], v[40:43]
    buffer_load_dwordx4 v[208:211], v9, s[16:19], s97 offen offset:2048 sc1
    v_mfma_f32_16x16x32_bf16 v[96:99], v[160:163], v[232:235], v[96:99]
    v_mfma_f32_16x16x32_bf16 v[104:107], v[160:163], v[236:239], v[104:107]
    v_accvgpr_read_b32 v16, a32
    v_accvgpr_read_b32 v17, a33
    v_accvgpr_read_b32 v18, a34
    v_mfma_f32_16x16x32_bf16 v[36:39], v[164:167], v[224:227], v[36:39]
    ds_read_b64_tr_b16 v[160:161], v24 offset:57344
    v_accvgpr_read_b32 v19, a35
    v_mfma_f32_16x16x32_bf16 v[44:47], v[164:167], v[228:231], v[44:47]
    ds_read_b64_tr_b16 v[162:163], v24 offset:58368
    v_accvgpr_read_b32 v20, a36
    v_mfma_f32_16x16x32_bf16 v[100:103], v[164:167], v[232:235], v[100:103]
    s_waitcnt lgkmcnt(10)
    v_accvgpr_read_b32 v21, a37
    v_accvgpr_read_b32 v22, a38
    v_mfma_f32_16x16x32_bf16 v[108:111], v[164:167], v[236:239], v[108:111]
    v_accvgpr_read_b32 v23, a39
    v_cvt_pk_bf16_f32 v16, v16, v17
    v_mfma_f32_16x16x32_bf16 v[48:51], v[168:171], v[224:227], v[48:51]
    ds_read_b64_tr_b16 v[164:165], v25 offset:57344
    v_cvt_pk_bf16_f32 v17, v18, v19
    v_mfma_f32_16x16x32_bf16 v[56:59], v[168:171], v[228:231], v[56:59]
    ds_read_b64_tr_b16 v[166:167], v25 offset:58368
    v_cvt_pk_bf16_f32 v18, v20, v21
    v_mfma_f32_16x16x32_bf16 v[112:115], v[168:171], v[232:235], v[112:115]
    buffer_load_dwordx4 v[212:215], v9, s[16:19], s97 offen offset:2304 sc1
    v_mfma_f32_16x16x32_bf16 v[120:123], v[168:171], v[236:239], v[120:123]
    v_mfma_f32_16x16x32_bf16 v[52:55], v[172:175], v[224:227], v[52:55]
    ds_read_b64_tr_b16 v[168:169], v26 offset:57344
    v_cvt_pk_bf16_f32 v19, v22, v23
    v_mfma_f32_16x16x32_bf16 v[60:63], v[172:175], v[228:231], v[60:63]
    ds_read_b64_tr_b16 v[170:171], v26 offset:58368
    v_mfma_f32_16x16x32_bf16 v[116:119], v[172:175], v[232:235], v[116:119]
    s_waitcnt lgkmcnt(10)
    buffer_store_dwordx4 v[16:19], v2, s[16:19], s4 offen offset:0 sc1
    v_mfma_f32_16x16x32_bf16 v[124:127], v[172:175], v[236:239], v[124:127]
    s_nop 0
    s_add_u32 s4, s99, 4096
    v_mfma_f32_16x16x32_bf16 v[64:67], v[176:179], v[224:227], v[64:67]
    ds_read_b64_tr_b16 v[172:173], v27 offset:57344
    v_accvgpr_read_b32 v16, a40
    v_mfma_f32_16x16x32_bf16 v[72:75], v[176:179], v[228:231], v[72:75]
    ds_read_b64_tr_b16 v[174:175], v27 offset:58368
    v_accvgpr_read_b32 v17, a41
    v_mfma_f32_16x16x32_bf16 v[128:131], v[176:179], v[232:235], v[128:131]
    buffer_load_dwordx4 v[216:219], v10, s[16:19], s97 offen offset:2048 sc1
    v_mfma_f32_16x16x32_bf16 v[136:139], v[176:179], v[236:239], v[136:139]
    v_accvgpr_read_b32 v18, a42
    v_mfma_f32_16x16x32_bf16 v[68:71], v[180:183], v[224:227], v[68:71]
    ds_read_b64_tr_b16 v[176:177], v28 offset:57344
    v_accvgpr_read_b32 v19, a43
    v_mfma_f32_16x16x32_bf16 v[76:79], v[180:183], v[228:231], v[76:79]
    ds_read_b64_tr_b16 v[178:179], v28 offset:58368
    v_accvgpr_read_b32 v20, a44
    v_mfma_f32_16x16x32_bf16 v[132:135], v[180:183], v[232:235], v[132:135]
    s_waitcnt lgkmcnt(10)
    v_accvgpr_read_b32 v21, a45
    v_accvgpr_read_b32 v22, a46
    v_mfma_f32_16x16x32_bf16 v[140:143], v[180:183], v[236:239], v[140:143]
    buffer_load_dwordx4 v[220:223], v10, s[16:19], s97 offen offset:2304 sc1
    v_mfma_f32_16x16x32_bf16 v[80:83], v[184:187], v[224:227], v[80:83]
    ds_read_b64_tr_b16 v[180:181], v29 offset:57344
    v_mfma_f32_16x16x32_bf16 v[88:91], v[184:187], v[228:231], v[88:91]
    ds_read_b64_tr_b16 v[182:183], v29 offset:58368
    v_mfma_f32_16x16x32_bf16 v[144:147], v[184:187], v[232:235], v[144:147]
    v_accvgpr_read_b32 v23, a47
    v_cvt_pk_bf16_f32 v16, v16, v17
    v_mfma_f32_16x16x32_bf16 v[152:155], v[184:187], v[236:239], v[152:155]
    v_cvt_pk_bf16_f32 v17, v18, v19
    v_cvt_pk_bf16_f32 v18, v20, v21
    v_mfma_f32_16x16x32_bf16 v[84:87], v[188:191], v[224:227], v[84:87]
    ds_read_b64_tr_b16 v[184:185], v30 offset:57344
    v_cvt_pk_bf16_f32 v19, v22, v23
    v_mfma_f32_16x16x32_bf16 v[92:95], v[188:191], v[228:231], v[92:95]
    ds_read_b64_tr_b16 v[186:187], v30 offset:58368
    v_mfma_f32_16x16x32_bf16 v[148:151], v[188:191], v[232:235], v[148:151]
    s_waitcnt vmcnt(16) lgkmcnt(10)
    buffer_store_dwordx4 v[16:19], v3, s[16:19], s4 offen offset:0 sc1
    v_mfma_f32_16x16x32_bf16 v[156:159], v[188:191], v[236:239], v[156:159]
    ds_read_b64_tr_b16 v[188:189], v31 offset:57344
    ds_read_b64_tr_b16 v[190:191], v31 offset:58368
    v_mfma_f32_16x16x32_bf16 v[32:35], v[160:163], v[240:243], v[32:35]
    s_nop 0
    s_add_u32 s4, s99, 4096
    v_accvgpr_read_b32 v16, a48
    v_mfma_f32_16x16x32_bf16 v[40:43], v[160:163], v[244:247], v[40:43]
    v_accvgpr_read_b32 v17, a49
    v_accvgpr_read_b32 v18, a50
    v_mfma_f32_16x16x32_bf16 v[96:99], v[160:163], v[248:251], v[96:99]
    v_accvgpr_read_b32 v19, a51
    v_accvgpr_read_b32 v20, a52
    v_accvgpr_read_b32 v21, a53
    v_mfma_f32_16x16x32_bf16 v[104:107], v[160:163], v[252:255], v[104:107]
    v_accvgpr_read_b32 v22, a54
    s_barrier
    v_mfma_f32_16x16x32_bf16 v[36:39], v[164:167], v[240:243], v[36:39]
    ds_read_b64_tr_b16 v[160:161], v24 offset:0
    v_accvgpr_read_b32 v23, a55
    v_mfma_f32_16x16x32_bf16 v[44:47], v[164:167], v[244:247], v[44:47]
    s_add_u32 s97, s79, 0
    ds_read_b64_tr_b16 v[162:163], v24 offset:1024
    v_cvt_pk_bf16_f32 v16, v16, v17
    v_cvt_pk_bf16_f32 v17, v18, v19
    v_mfma_f32_16x16x32_bf16 v[100:103], v[164:167], v[248:251], v[100:103]
    s_waitcnt lgkmcnt(10)
    buffer_load_dwordx4 v[224:227], v9, s[16:19], s97 offen offset:0 sc1
    v_mfma_f32_16x16x32_bf16 v[108:111], v[164:167], v[252:255], v[108:111]
    v_cvt_pk_bf16_f32 v18, v20, v21
    v_mfma_f32_16x16x32_bf16 v[48:51], v[168:171], v[240:243], v[48:51]
    ds_read_b64_tr_b16 v[164:165], v25 offset:0
    v_cvt_pk_bf16_f32 v19, v22, v23
    v_mfma_f32_16x16x32_bf16 v[56:59], v[168:171], v[244:247], v[56:59]
    ds_read_b64_tr_b16 v[166:167], v25 offset:1024
    buffer_store_dwordx4 v[16:19], v2, s[16:19], s4 offen offset:2048 sc1
    v_mfma_f32_16x16x32_bf16 v[112:115], v[168:171], v[248:251], v[112:115]
    buffer_load_dwordx4 v[228:231], v9, s[16:19], s97 offen offset:256 sc1
    v_mfma_f32_16x16x32_bf16 v[120:123], v[168:171], v[252:255], v[120:123]
    v_mfma_f32_16x16x32_bf16 v[52:55], v[172:175], v[240:243], v[52:55]
    ds_read_b64_tr_b16 v[168:169], v26 offset:0
    s_nop 0
    s_add_u32 s4, s99, 4096
    v_mfma_f32_16x16x32_bf16 v[60:63], v[172:175], v[244:247], v[60:63]
    s_add_u32 m0, s98, 131072
    s_add_u32 s96, s72, 2097152
    ds_read_b64_tr_b16 v[170:171], v26 offset:1024
    v_accvgpr_read_b32 v16, a56
    v_mfma_f32_16x16x32_bf16 v[116:119], v[172:175], v[248:251], v[116:119]
    s_waitcnt lgkmcnt(10)
    buffer_load_dwordx4 v12, s[24:27], s96 offen offset:0 lds
    v_mfma_f32_16x16x32_bf16 v[124:127], v[172:175], v[252:255], v[124:127]
    buffer_load_dwordx4 v13, s[24:27], s96 offen offset:1024 lds
    v_mfma_f32_16x16x32_bf16 v[64:67], v[176:179], v[240:243], v[64:67]
    ds_read_b64_tr_b16 v[172:173], v27 offset:0
    v_mfma_f32_16x16x32_bf16 v[72:75], v[176:179], v[244:247], v[72:75]
    ds_read_b64_tr_b16 v[174:175], v27 offset:1024
    v_accvgpr_read_b32 v17, a57
    v_mfma_f32_16x16x32_bf16 v[128:131], v[176:179], v[248:251], v[128:131]
    buffer_load_dwordx4 v14, s[24:27], s96 offen offset:2048 lds
    v_mfma_f32_16x16x32_bf16 v[136:139], v[176:179], v[252:255], v[136:139]
    v_accvgpr_read_b32 v18, a58
    v_mfma_f32_16x16x32_bf16 v[68:71], v[180:183], v[240:243], v[68:71]
    ds_read_b64_tr_b16 v[176:177], v28 offset:0
    v_accvgpr_read_b32 v19, a59
    v_accvgpr_read_b32 v20, a60
    v_mfma_f32_16x16x32_bf16 v[76:79], v[180:183], v[244:247], v[76:79]
    ds_read_b64_tr_b16 v[178:179], v28 offset:1024
    v_accvgpr_read_b32 v21, a61
    v_accvgpr_read_b32 v22, a62
    v_mfma_f32_16x16x32_bf16 v[132:135], v[180:183], v[248:251], v[132:135]
    s_waitcnt lgkmcnt(10)
    buffer_load_dwordx4 v15, s[24:27], s96 offen offset:3072 lds
    v_mfma_f32_16x16x32_bf16 v[140:143], v[180:183], v[252:255], v[140:143]
    v_accvgpr_read_b32 v23, a63
    v_mfma_f32_16x16x32_bf16 v[80:83], v[184:187], v[240:243], v[80:83]
    ds_read_b64_tr_b16 v[180:181], v29 offset:0
    v_cvt_pk_bf16_f32 v16, v16, v17
    v_cvt_pk_bf16_f32 v17, v18, v19
    v_mfma_f32_16x16x32_bf16 v[88:91], v[184:187], v[244:247], v[88:91]
    ds_read_b64_tr_b16 v[182:183], v29 offset:1024
    v_cvt_pk_bf16_f32 v18, v20, v21
    v_mfma_f32_16x16x32_bf16 v[144:147], v[184:187], v[248:251], v[144:147]
    buffer_load_dwordx4 v[232:235], v10, s[16:19], s97 offen offset:0 sc1
    v_mfma_f32_16x16x32_bf16 v[152:155], v[184:187], v[252:255], v[152:155]
    buffer_load_dwordx4 v[236:239], v10, s[16:19], s97 offen offset:256 sc1
    v_mfma_f32_16x16x32_bf16 v[84:87], v[188:191], v[240:243], v[84:87]
    ds_read_b64_tr_b16 v[184:185], v30 offset:0
    v_mfma_f32_16x16x32_bf16 v[92:95], v[188:191], v[244:247], v[92:95]
    ds_read_b64_tr_b16 v[186:187], v30 offset:1024
    v_cvt_pk_bf16_f32 v19, v22, v23
    v_mfma_f32_16x16x32_bf16 v[148:151], v[188:191], v[248:251], v[148:151]
    s_waitcnt vmcnt(16) lgkmcnt(10)
    buffer_store_dwordx4 v[16:19], v3, s[16:19], s4 offen offset:2048 sc1
    v_mfma_f32_16x16x32_bf16 v[156:159], v[188:191], v[252:255], v[156:159]
    ds_read_b64_tr_b16 v[188:189], v31 offset:0
    ds_read_b64_tr_b16 v[190:191], v31 offset:1024
    v_mfma_f32_16x16x32_bf16 v[32:35], v[160:163], v[192:195], v[32:35]
    s_add_u32 s97, s79, 0
    s_nop 0
    s_add_u32 s4, s99, 131072
    v_mfma_f32_16x16x32_bf16 v[40:43], v[160:163], v[196:199], v[40:43]
    buffer_load_dwordx4 v[240:243], v9, s[16:19], s97 offen offset:2048 sc1
    v_mfma_f32_16x16x32_bf16 v[96:99], v[160:163], v[200:203], v[96:99]
    v_mfma_f32_16x16x32_bf16 v[104:107], v[160:163], v[204:207], v[104:107]
    v_mfma_f32_16x16x32_bf16 v[36:39], v[164:167], v[192:195], v[36:39]
    ds_read_b64_tr_b16 v[160:161], v24 offset:8192
    v_accvgpr_read_b32 v16, a64
    v_mfma_f32_16x16x32_bf16 v[44:47], v[164:167], v[196:199], v[44:47]
    ds_read_b64_tr_b16 v[162:163], v24 offset:9216
    v_mfma_f32_16x16x32_bf16 v[100:103], v[164:167], v[200:203], v[100:103]
    s_waitcnt lgkmcnt(10)
    v_accvgpr_read_b32 v17, a65
    v_accvgpr_read_b32 v18, a66
    v_mfma_f32_16x16x32_bf16 v[108:111], v[164:167], v[204:207], v[108:111]
    v_accvgpr_read_b32 v19, a67
    v_mfma_f32_16x16x32_bf16 v[48:51], v[168:171], v[192:195], v[48:51]
    ds_read_b64_tr_b16 v[164:165], v25 offset:8192
    v_accvgpr_read_b32 v20, a68
    v_mfma_f32_16x16x32_bf16 v[56:59], v[168:171], v[196:199], v[56:59]
    ds_read_b64_tr_b16 v[166:167], v25 offset:9216
    v_mfma_f32_16x16x32_bf16 v[112:115], v[168:171], v[200:203], v[112:115]
    buffer_load_dwordx4 v[244:247], v9, s[16:19], s97 offen offset:2304 sc1
    v_mfma_f32_16x16x32_bf16 v[120:123], v[168:171], v[204:207], v[120:123]
    v_mfma_f32_16x16x32_bf16 v[52:55], v[172:175], v[192:195], v[52:55]
    ds_read_b64_tr_b16 v[168:169], v26 offset:8192
    v_mfma_f32_16x16x32_bf16 v[60:63], v[172:175], v[196:199], v[60:63]
    ds_read_b64_tr_b16 v[170:171], v26 offset:9216
    v_accvgpr_read_b32 v21, a69
    v_mfma_f32_16x16x32_bf16 v[116:119], v[172:175], v[200:203], v[116:119]
    s_waitcnt lgkmcnt(10)
    v_accvgpr_read_b32 v22, a70
    v_mfma_f32_16x16x32_bf16 v[124:127], v[172:175], v[204:207], v[124:127]
    v_accvgpr_read_b32 v23, a71
    v_cvt_pk_bf16_f32 v16, v16, v17
    v_mfma_f32_16x16x32_bf16 v[64:67], v[176:179], v[192:195], v[64:67]
    ds_read_b64_tr_b16 v[172:173], v27 offset:8192
    v_mfma_f32_16x16x32_bf16 v[72:75], v[176:179], v[196:199], v[72:75]
    ds_read_b64_tr_b16 v[174:175], v27 offset:9216
    v_cvt_pk_bf16_f32 v17, v18, v19
    v_mfma_f32_16x16x32_bf16 v[128:131], v[176:179], v[200:203], v[128:131]
    buffer_load_dwordx4 v[248:251], v10, s[16:19], s97 offen offset:2048 sc1
    v_mfma_f32_16x16x32_bf16 v[136:139], v[176:179], v[204:207], v[136:139]
    v_mfma_f32_16x16x32_bf16 v[68:71], v[180:183], v[192:195], v[68:71]
    ds_read_b64_tr_b16 v[176:177], v28 offset:8192
    v_mfma_f32_16x16x32_bf16 v[76:79], v[180:183], v[196:199], v[76:79]
    ds_read_b64_tr_b16 v[178:179], v28 offset:9216
    v_mfma_f32_16x16x32_bf16 v[132:135], v[180:183], v[200:203], v[132:135]
    s_waitcnt lgkmcnt(10)
    v_cvt_pk_bf16_f32 v18, v20, v21
    v_cvt_pk_bf16_f32 v19, v22, v23
    v_mfma_f32_16x16x32_bf16 v[140:143], v[180:183], v[204:207], v[140:143]
    buffer_load_dwordx4 v[252:255], v10, s[16:19], s97 offen offset:2304 sc1
    v_mfma_f32_16x16x32_bf16 v[80:83], v[184:187], v[192:195], v[80:83]
    ds_read_b64_tr_b16 v[180:181], v29 offset:8192
    v_mfma_f32_16x16x32_bf16 v[88:91], v[184:187], v[196:199], v[88:91]
    ds_read_b64_tr_b16 v[182:183], v29 offset:9216
    v_mfma_f32_16x16x32_bf16 v[144:147], v[184:187], v[200:203], v[144:147]
    v_mfma_f32_16x16x32_bf16 v[152:155], v[184:187], v[204:207], v[152:155]
    v_mfma_f32_16x16x32_bf16 v[84:87], v[188:191], v[192:195], v[84:87]
    ds_read_b64_tr_b16 v[184:185], v30 offset:8192
    buffer_store_dwordx4 v[16:19], v2, s[16:19], s4 offen offset:0 sc1
    v_mfma_f32_16x16x32_bf16 v[92:95], v[188:191], v[196:199], v[92:95]
    ds_read_b64_tr_b16 v[186:187], v30 offset:9216
    v_mfma_f32_16x16x32_bf16 v[148:151], v[188:191], v[200:203], v[148:151]
    s_waitcnt vmcnt(16) lgkmcnt(10)
    v_mfma_f32_16x16x32_bf16 v[156:159], v[188:191], v[204:207], v[156:159]
    ds_read_b64_tr_b16 v[188:189], v31 offset:8192
    ds_read_b64_tr_b16 v[190:191], v31 offset:9216
    v_mfma_f32_16x16x32_bf16 v[32:35], v[160:163], v[208:211], v[32:35]
    s_nop 0
    s_add_u32 s4, s99, 131072
    v_accvgpr_read_b32 v16, a72
    v_mfma_f32_16x16x32_bf16 v[40:43], v[160:163], v[212:215], v[40:43]
    v_accvgpr_read_b32 v17, a73
    v_accvgpr_read_b32 v18, a74
    v_mfma_f32_16x16x32_bf16 v[96:99], v[160:163], v[216:219], v[96:99]
    v_accvgpr_read_b32 v19, a75
    v_accvgpr_read_b32 v20, a76
    v_accvgpr_read_b32 v21, a77
    v_mfma_f32_16x16x32_bf16 v[104:107], v[160:163], v[220:223], v[104:107]
    v_accvgpr_read_b32 v22, a78
    s_barrier
    v_mfma_f32_16x16x32_bf16 v[36:39], v[164:167], v[208:211], v[36:39]
    ds_read_b64_tr_b16 v[160:161], v24 offset:16384
    v_accvgpr_read_b32 v23, a79
    v_mfma_f32_16x16x32_bf16 v[44:47], v[164:167], v[212:215], v[44:47]
    s_add_u32 s97, s76, 16384
    ds_read_b64_tr_b16 v[162:163], v24 offset:17408
    v_cvt_pk_bf16_f32 v16, v16, v17
    v_cvt_pk_bf16_f32 v17, v18, v19
    v_mfma_f32_16x16x32_bf16 v[100:103], v[164:167], v[216:219], v[100:103]
    s_waitcnt lgkmcnt(10)
    buffer_load_dwordx4 v[192:195], v9, s[16:19], s97 offen offset:0 sc1
    v_mfma_f32_16x16x32_bf16 v[108:111], v[164:167], v[220:223], v[108:111]
    v_cvt_pk_bf16_f32 v18, v20, v21
    v_mfma_f32_16x16x32_bf16 v[48:51], v[168:171], v[208:211], v[48:51]
    ds_read_b64_tr_b16 v[164:165], v25 offset:16384
    v_cvt_pk_bf16_f32 v19, v22, v23
    v_mfma_f32_16x16x32_bf16 v[56:59], v[168:171], v[212:215], v[56:59]
    ds_read_b64_tr_b16 v[166:167], v25 offset:17408
    buffer_store_dwordx4 v[16:19], v3, s[16:19], s4 offen offset:0 sc1
    v_mfma_f32_16x16x32_bf16 v[112:115], v[168:171], v[216:219], v[112:115]
    buffer_load_dwordx4 v[196:199], v9, s[16:19], s97 offen offset:256 sc1
    v_mfma_f32_16x16x32_bf16 v[120:123], v[168:171], v[220:223], v[120:123]
    v_mfma_f32_16x16x32_bf16 v[52:55], v[172:175], v[208:211], v[52:55]
    ds_read_b64_tr_b16 v[168:169], v26 offset:16384
    s_nop 0
    s_add_u32 s4, s99, 131072
    v_mfma_f32_16x16x32_bf16 v[60:63], v[172:175], v[212:215], v[60:63]
    s_add_u32 m0, s98, 147456
    s_add_u32 s96, s73, 2097152
    ds_read_b64_tr_b16 v[170:171], v26 offset:17408
    v_accvgpr_read_b32 v16, a80
    v_mfma_f32_16x16x32_bf16 v[116:119], v[172:175], v[216:219], v[116:119]
    s_waitcnt lgkmcnt(10)
    buffer_load_dwordx4 v12, s[24:27], s96 offen offset:0 lds
    v_mfma_f32_16x16x32_bf16 v[124:127], v[172:175], v[220:223], v[124:127]
    buffer_load_dwordx4 v13, s[24:27], s96 offen offset:1024 lds
    v_mfma_f32_16x16x32_bf16 v[64:67], v[176:179], v[208:211], v[64:67]
    ds_read_b64_tr_b16 v[172:173], v27 offset:16384
    v_mfma_f32_16x16x32_bf16 v[72:75], v[176:179], v[212:215], v[72:75]
    ds_read_b64_tr_b16 v[174:175], v27 offset:17408
    v_accvgpr_read_b32 v17, a81
    v_mfma_f32_16x16x32_bf16 v[128:131], v[176:179], v[216:219], v[128:131]
    buffer_load_dwordx4 v14, s[24:27], s96 offen offset:2048 lds
    v_mfma_f32_16x16x32_bf16 v[136:139], v[176:179], v[220:223], v[136:139]
    v_accvgpr_read_b32 v18, a82
    v_mfma_f32_16x16x32_bf16 v[68:71], v[180:183], v[208:211], v[68:71]
    ds_read_b64_tr_b16 v[176:177], v28 offset:16384
    v_accvgpr_read_b32 v19, a83
    v_accvgpr_read_b32 v20, a84
    v_mfma_f32_16x16x32_bf16 v[76:79], v[180:183], v[212:215], v[76:79]
    ds_read_b64_tr_b16 v[178:179], v28 offset:17408
    v_accvgpr_read_b32 v21, a85
    v_accvgpr_read_b32 v22, a86
    v_mfma_f32_16x16x32_bf16 v[132:135], v[180:183], v[216:219], v[132:135]
    s_waitcnt lgkmcnt(10)
    buffer_load_dwordx4 v15, s[24:27], s96 offen offset:3072 lds
    v_mfma_f32_16x16x32_bf16 v[140:143], v[180:183], v[220:223], v[140:143]
    v_accvgpr_read_b32 v23, a87
    v_mfma_f32_16x16x32_bf16 v[80:83], v[184:187], v[208:211], v[80:83]
    ds_read_b64_tr_b16 v[180:181], v29 offset:16384
    v_cvt_pk_bf16_f32 v16, v16, v17
    v_cvt_pk_bf16_f32 v17, v18, v19
    v_mfma_f32_16x16x32_bf16 v[88:91], v[184:187], v[212:215], v[88:91]
    ds_read_b64_tr_b16 v[182:183], v29 offset:17408
    v_cvt_pk_bf16_f32 v18, v20, v21
    v_mfma_f32_16x16x32_bf16 v[144:147], v[184:187], v[216:219], v[144:147]
    buffer_load_dwordx4 v[200:203], v10, s[16:19], s97 offen offset:0 sc1
    v_mfma_f32_16x16x32_bf16 v[152:155], v[184:187], v[220:223], v[152:155]
    buffer_load_dwordx4 v[204:207], v10, s[16:19], s97 offen offset:256 sc1
    v_mfma_f32_16x16x32_bf16 v[84:87], v[188:191], v[208:211], v[84:87]
    ds_read_b64_tr_b16 v[184:185], v30 offset:16384
    v_mfma_f32_16x16x32_bf16 v[92:95], v[188:191], v[212:215], v[92:95]
    ds_read_b64_tr_b16 v[186:187], v30 offset:17408
    v_cvt_pk_bf16_f32 v19, v22, v23
    v_mfma_f32_16x16x32_bf16 v[148:151], v[188:191], v[216:219], v[148:151]
    s_waitcnt vmcnt(15) lgkmcnt(10)
    buffer_store_dwordx4 v[16:19], v2, s[16:19], s4 offen offset:2048 sc1
    v_mfma_f32_16x16x32_bf16 v[156:159], v[188:191], v[220:223], v[156:159]
    ds_read_b64_tr_b16 v[188:189], v31 offset:16384
    ds_read_b64_tr_b16 v[190:191], v31 offset:17408
    v_mfma_f32_16x16x32_bf16 v[32:35], v[160:163], v[224:227], v[32:35]
    s_add_u32 s97, s76, 16384
    s_nop 0
    s_add_u32 s4, s99, 131072
    v_mfma_f32_16x16x32_bf16 v[40:43], v[160:163], v[228:231], v[40:43]
    buffer_load_dwordx4 v[208:211], v9, s[16:19], s97 offen offset:2048 sc1
    v_mfma_f32_16x16x32_bf16 v[96:99], v[160:163], v[232:235], v[96:99]
    v_mfma_f32_16x16x32_bf16 v[104:107], v[160:163], v[236:239], v[104:107]
    v_accvgpr_read_b32 v16, a88
    v_accvgpr_read_b32 v17, a89
    v_accvgpr_read_b32 v18, a90
    v_mfma_f32_16x16x32_bf16 v[36:39], v[164:167], v[224:227], v[36:39]
    ds_read_b64_tr_b16 v[160:161], v24 offset:24576
    v_accvgpr_read_b32 v19, a91
    v_mfma_f32_16x16x32_bf16 v[44:47], v[164:167], v[228:231], v[44:47]
    ds_read_b64_tr_b16 v[162:163], v24 offset:25600
    v_accvgpr_read_b32 v20, a92
    v_mfma_f32_16x16x32_bf16 v[100:103], v[164:167], v[232:235], v[100:103]
    s_waitcnt lgkmcnt(10)
    v_accvgpr_read_b32 v21, a93
    v_accvgpr_read_b32 v22, a94
    v_mfma_f32_16x16x32_bf16 v[108:111], v[164:167], v[236:239], v[108:111]
    v_accvgpr_read_b32 v23, a95
    v_cvt_pk_bf16_f32 v16, v16, v17
    v_mfma_f32_16x16x32_bf16 v[48:51], v[168:171], v[224:227], v[48:51]
    ds_read_b64_tr_b16 v[164:165], v25 offset:24576
    v_cvt_pk_bf16_f32 v17, v18, v19
    v_mfma_f32_16x16x32_bf16 v[56:59], v[168:171], v[228:231], v[56:59]
    ds_read_b64_tr_b16 v[166:167], v25 offset:25600
    v_cvt_pk_bf16_f32 v18, v20, v21
    v_mfma_f32_16x16x32_bf16 v[112:115], v[168:171], v[232:235], v[112:115]
    buffer_load_dwordx4 v[212:215], v9, s[16:19], s97 offen offset:2304 sc1
    v_mfma_f32_16x16x32_bf16 v[120:123], v[168:171], v[236:239], v[120:123]
    v_mfma_f32_16x16x32_bf16 v[52:55], v[172:175], v[224:227], v[52:55]
    ds_read_b64_tr_b16 v[168:169], v26 offset:24576
    v_cvt_pk_bf16_f32 v19, v22, v23
    v_mfma_f32_16x16x32_bf16 v[60:63], v[172:175], v[228:231], v[60:63]
    ds_read_b64_tr_b16 v[170:171], v26 offset:25600
    v_mfma_f32_16x16x32_bf16 v[116:119], v[172:175], v[232:235], v[116:119]
    s_waitcnt lgkmcnt(10)
    buffer_store_dwordx4 v[16:19], v3, s[16:19], s4 offen offset:2048 sc1
    v_mfma_f32_16x16x32_bf16 v[124:127], v[172:175], v[236:239], v[124:127]
    s_nop 0
    s_add_u32 s4, s99, 135168
    v_mfma_f32_16x16x32_bf16 v[64:67], v[176:179], v[224:227], v[64:67]
    ds_read_b64_tr_b16 v[172:173], v27 offset:24576
    v_accvgpr_read_b32 v16, a96
    v_mfma_f32_16x16x32_bf16 v[72:75], v[176:179], v[228:231], v[72:75]
    ds_read_b64_tr_b16 v[174:175], v27 offset:25600
    v_accvgpr_read_b32 v17, a97
    v_mfma_f32_16x16x32_bf16 v[128:131], v[176:179], v[232:235], v[128:131]
    buffer_load_dwordx4 v[216:219], v10, s[16:19], s97 offen offset:2048 sc1
    v_mfma_f32_16x16x32_bf16 v[136:139], v[176:179], v[236:239], v[136:139]
    v_accvgpr_read_b32 v18, a98
    v_mfma_f32_16x16x32_bf16 v[68:71], v[180:183], v[224:227], v[68:71]
    ds_read_b64_tr_b16 v[176:177], v28 offset:24576
    v_accvgpr_read_b32 v19, a99
    v_mfma_f32_16x16x32_bf16 v[76:79], v[180:183], v[228:231], v[76:79]
    ds_read_b64_tr_b16 v[178:179], v28 offset:25600
    v_accvgpr_read_b32 v20, a100
    v_mfma_f32_16x16x32_bf16 v[132:135], v[180:183], v[232:235], v[132:135]
    s_waitcnt lgkmcnt(10)
    v_accvgpr_read_b32 v21, a101
    v_accvgpr_read_b32 v22, a102
    v_mfma_f32_16x16x32_bf16 v[140:143], v[180:183], v[236:239], v[140:143]
    buffer_load_dwordx4 v[220:223], v10, s[16:19], s97 offen offset:2304 sc1
    v_mfma_f32_16x16x32_bf16 v[80:83], v[184:187], v[224:227], v[80:83]
    ds_read_b64_tr_b16 v[180:181], v29 offset:24576
    v_mfma_f32_16x16x32_bf16 v[88:91], v[184:187], v[228:231], v[88:91]
    ds_read_b64_tr_b16 v[182:183], v29 offset:25600
    v_mfma_f32_16x16x32_bf16 v[144:147], v[184:187], v[232:235], v[144:147]
    v_accvgpr_read_b32 v23, a103
    v_cvt_pk_bf16_f32 v16, v16, v17
    v_mfma_f32_16x16x32_bf16 v[152:155], v[184:187], v[236:239], v[152:155]
    v_cvt_pk_bf16_f32 v17, v18, v19
    v_cvt_pk_bf16_f32 v18, v20, v21
    v_mfma_f32_16x16x32_bf16 v[84:87], v[188:191], v[224:227], v[84:87]
    ds_read_b64_tr_b16 v[184:185], v30 offset:24576
    v_cvt_pk_bf16_f32 v19, v22, v23
    v_mfma_f32_16x16x32_bf16 v[92:95], v[188:191], v[228:231], v[92:95]
    ds_read_b64_tr_b16 v[186:187], v30 offset:25600
    v_mfma_f32_16x16x32_bf16 v[148:151], v[188:191], v[232:235], v[148:151]
    s_waitcnt vmcnt(16) lgkmcnt(10)
    buffer_store_dwordx4 v[16:19], v2, s[16:19], s4 offen offset:0 sc1
    v_mfma_f32_16x16x32_bf16 v[156:159], v[188:191], v[236:239], v[156:159]
    ds_read_b64_tr_b16 v[188:189], v31 offset:24576
    ds_read_b64_tr_b16 v[190:191], v31 offset:25600
    v_mfma_f32_16x16x32_bf16 v[32:35], v[160:163], v[240:243], v[32:35]
    s_nop 0
    s_add_u32 s4, s99, 135168
    v_accvgpr_read_b32 v16, a104
    v_mfma_f32_16x16x32_bf16 v[40:43], v[160:163], v[244:247], v[40:43]
    v_accvgpr_read_b32 v17, a105
    v_accvgpr_read_b32 v18, a106
    v_mfma_f32_16x16x32_bf16 v[96:99], v[160:163], v[248:251], v[96:99]
    v_accvgpr_read_b32 v19, a107
    v_accvgpr_read_b32 v20, a108
    v_accvgpr_read_b32 v21, a109
    v_mfma_f32_16x16x32_bf16 v[104:107], v[160:163], v[252:255], v[104:107]
    v_accvgpr_read_b32 v22, a110
    s_barrier
    v_mfma_f32_16x16x32_bf16 v[36:39], v[164:167], v[240:243], v[36:39]
    ds_read_b64_tr_b16 v[160:161], v24 offset:32768
    v_accvgpr_read_b32 v23, a111
    v_mfma_f32_16x16x32_bf16 v[44:47], v[164:167], v[244:247], v[44:47]
    s_add_u32 s97, s77, 16384
    ds_read_b64_tr_b16 v[162:163], v24 offset:33792
    v_cvt_pk_bf16_f32 v16, v16, v17
    v_cvt_pk_bf16_f32 v17, v18, v19
    v_mfma_f32_16x16x32_bf16 v[100:103], v[164:167], v[248:251], v[100:103]
    s_waitcnt lgkmcnt(10)
    buffer_load_dwordx4 v[224:227], v9, s[16:19], s97 offen offset:0 sc1
    v_mfma_f32_16x16x32_bf16 v[108:111], v[164:167], v[252:255], v[108:111]
    v_cvt_pk_bf16_f32 v18, v20, v21
    v_mfma_f32_16x16x32_bf16 v[48:51], v[168:171], v[240:243], v[48:51]
    ds_read_b64_tr_b16 v[164:165], v25 offset:32768
    v_cvt_pk_bf16_f32 v19, v22, v23
    v_mfma_f32_16x16x32_bf16 v[56:59], v[168:171], v[244:247], v[56:59]
    ds_read_b64_tr_b16 v[166:167], v25 offset:33792
    buffer_store_dwordx4 v[16:19], v3, s[16:19], s4 offen offset:0 sc1
    v_mfma_f32_16x16x32_bf16 v[112:115], v[168:171], v[248:251], v[112:115]
    buffer_load_dwordx4 v[228:231], v9, s[16:19], s97 offen offset:256 sc1
    v_mfma_f32_16x16x32_bf16 v[120:123], v[168:171], v[252:255], v[120:123]
    v_mfma_f32_16x16x32_bf16 v[52:55], v[172:175], v[240:243], v[52:55]
    ds_read_b64_tr_b16 v[168:169], v26 offset:32768
    s_nop 0
    s_add_u32 s4, s99, 135168
    v_mfma_f32_16x16x32_bf16 v[60:63], v[172:175], v[244:247], v[60:63]
    s_add_u32 m0, s98, 98304
    s_add_u32 s96, s74, 2097152
    ds_read_b64_tr_b16 v[170:171], v26 offset:33792
    v_accvgpr_read_b32 v16, a112
    v_mfma_f32_16x16x32_bf16 v[116:119], v[172:175], v[248:251], v[116:119]
    s_waitcnt lgkmcnt(10)
    buffer_load_dwordx4 v12, s[24:27], s96 offen offset:0 lds
    v_mfma_f32_16x16x32_bf16 v[124:127], v[172:175], v[252:255], v[124:127]
    buffer_load_dwordx4 v13, s[24:27], s96 offen offset:1024 lds
    v_mfma_f32_16x16x32_bf16 v[64:67], v[176:179], v[240:243], v[64:67]
    ds_read_b64_tr_b16 v[172:173], v27 offset:32768
    v_mfma_f32_16x16x32_bf16 v[72:75], v[176:179], v[244:247], v[72:75]
    ds_read_b64_tr_b16 v[174:175], v27 offset:33792
    v_accvgpr_read_b32 v17, a113
    v_mfma_f32_16x16x32_bf16 v[128:131], v[176:179], v[248:251], v[128:131]
    buffer_load_dwordx4 v14, s[24:27], s96 offen offset:2048 lds
    v_mfma_f32_16x16x32_bf16 v[136:139], v[176:179], v[252:255], v[136:139]
    v_accvgpr_read_b32 v18, a114
    v_mfma_f32_16x16x32_bf16 v[68:71], v[180:183], v[240:243], v[68:71]
    ds_read_b64_tr_b16 v[176:177], v28 offset:32768
    v_accvgpr_read_b32 v19, a115
    v_accvgpr_read_b32 v20, a116
    v_mfma_f32_16x16x32_bf16 v[76:79], v[180:183], v[244:247], v[76:79]
    ds_read_b64_tr_b16 v[178:179], v28 offset:33792
    v_accvgpr_read_b32 v21, a117
    v_accvgpr_read_b32 v22, a118
    v_mfma_f32_16x16x32_bf16 v[132:135], v[180:183], v[248:251], v[132:135]
    s_waitcnt lgkmcnt(10)
    buffer_load_dwordx4 v15, s[24:27], s96 offen offset:3072 lds
    v_mfma_f32_16x16x32_bf16 v[140:143], v[180:183], v[252:255], v[140:143]
    v_accvgpr_read_b32 v23, a119
    v_mfma_f32_16x16x32_bf16 v[80:83], v[184:187], v[240:243], v[80:83]
    ds_read_b64_tr_b16 v[180:181], v29 offset:32768
    v_cvt_pk_bf16_f32 v16, v16, v17
    v_cvt_pk_bf16_f32 v17, v18, v19
    v_mfma_f32_16x16x32_bf16 v[88:91], v[184:187], v[244:247], v[88:91]
    ds_read_b64_tr_b16 v[182:183], v29 offset:33792
    v_cvt_pk_bf16_f32 v18, v20, v21
    v_mfma_f32_16x16x32_bf16 v[144:147], v[184:187], v[248:251], v[144:147]
    buffer_load_dwordx4 v[232:235], v10, s[16:19], s97 offen offset:0 sc1
    v_mfma_f32_16x16x32_bf16 v[152:155], v[184:187], v[252:255], v[152:155]
    buffer_load_dwordx4 v[236:239], v10, s[16:19], s97 offen offset:256 sc1
    v_mfma_f32_16x16x32_bf16 v[84:87], v[188:191], v[240:243], v[84:87]
    ds_read_b64_tr_b16 v[184:185], v30 offset:32768
    v_mfma_f32_16x16x32_bf16 v[92:95], v[188:191], v[244:247], v[92:95]
    ds_read_b64_tr_b16 v[186:187], v30 offset:33792
    v_cvt_pk_bf16_f32 v19, v22, v23
    v_mfma_f32_16x16x32_bf16 v[148:151], v[188:191], v[248:251], v[148:151]
    s_waitcnt vmcnt(16) lgkmcnt(10)
    buffer_store_dwordx4 v[16:19], v2, s[16:19], s4 offen offset:2048 sc1
    v_mfma_f32_16x16x32_bf16 v[156:159], v[188:191], v[252:255], v[156:159]
    ds_read_b64_tr_b16 v[188:189], v31 offset:32768
    ds_read_b64_tr_b16 v[190:191], v31 offset:33792
    v_mfma_f32_16x16x32_bf16 v[32:35], v[160:163], v[192:195], v[32:35]
    s_add_u32 s97, s77, 16384
    s_nop 0
    s_add_u32 s4, s99, 135168
    v_mfma_f32_16x16x32_bf16 v[40:43], v[160:163], v[196:199], v[40:43]
    buffer_load_dwordx4 v[240:243], v9, s[16:19], s97 offen offset:2048 sc1
    v_mfma_f32_16x16x32_bf16 v[96:99], v[160:163], v[200:203], v[96:99]
    v_mfma_f32_16x16x32_bf16 v[104:107], v[160:163], v[204:207], v[104:107]
    v_mfma_f32_16x16x32_bf16 v[36:39], v[164:167], v[192:195], v[36:39]
    ds_read_b64_tr_b16 v[160:161], v24 offset:40960
    v_accvgpr_read_b32 v16, a120
    v_mfma_f32_16x16x32_bf16 v[44:47], v[164:167], v[196:199], v[44:47]
    ds_read_b64_tr_b16 v[162:163], v24 offset:41984
    v_mfma_f32_16x16x32_bf16 v[100:103], v[164:167], v[200:203], v[100:103]
    s_waitcnt lgkmcnt(10)
    v_accvgpr_read_b32 v17, a121
    v_accvgpr_read_b32 v18, a122
    v_mfma_f32_16x16x32_bf16 v[108:111], v[164:167], v[204:207], v[108:111]
    v_accvgpr_read_b32 v19, a123
    v_mfma_f32_16x16x32_bf16 v[48:51], v[168:171], v[192:195], v[48:51]
    ds_read_b64_tr_b16 v[164:165], v25 offset:40960
    v_accvgpr_read_b32 v20, a124
    v_mfma_f32_16x16x32_bf16 v[56:59], v[168:171], v[196:199], v[56:59]
    ds_read_b64_tr_b16 v[166:167], v25 offset:41984
    v_mfma_f32_16x16x32_bf16 v[112:115], v[168:171], v[200:203], v[112:115]
    buffer_load_dwordx4 v[244:247], v9, s[16:19], s97 offen offset:2304 sc1
    v_mfma_f32_16x16x32_bf16 v[120:123], v[168:171], v[204:207], v[120:123]
    v_mfma_f32_16x16x32_bf16 v[52:55], v[172:175], v[192:195], v[52:55]
    ds_read_b64_tr_b16 v[168:169], v26 offset:40960
    v_mfma_f32_16x16x32_bf16 v[60:63], v[172:175], v[196:199], v[60:63]
    ds_read_b64_tr_b16 v[170:171], v26 offset:41984
    v_accvgpr_read_b32 v21, a125
    v_mfma_f32_16x16x32_bf16 v[116:119], v[172:175], v[200:203], v[116:119]
    s_waitcnt lgkmcnt(10)
    v_accvgpr_read_b32 v22, a126
    v_mfma_f32_16x16x32_bf16 v[124:127], v[172:175], v[204:207], v[124:127]
    v_accvgpr_read_b32 v23, a127
    v_cvt_pk_bf16_f32 v16, v16, v17
    v_mfma_f32_16x16x32_bf16 v[64:67], v[176:179], v[192:195], v[64:67]
    ds_read_b64_tr_b16 v[172:173], v27 offset:40960
    v_mfma_f32_16x16x32_bf16 v[72:75], v[176:179], v[196:199], v[72:75]
    ds_read_b64_tr_b16 v[174:175], v27 offset:41984
    v_cvt_pk_bf16_f32 v17, v18, v19
    v_mfma_f32_16x16x32_bf16 v[128:131], v[176:179], v[200:203], v[128:131]
    buffer_load_dwordx4 v[248:251], v10, s[16:19], s97 offen offset:2048 sc1
    v_mfma_f32_16x16x32_bf16 v[136:139], v[176:179], v[204:207], v[136:139]
    v_mfma_f32_16x16x32_bf16 v[68:71], v[180:183], v[192:195], v[68:71]
    ds_read_b64_tr_b16 v[176:177], v28 offset:40960
    v_mfma_f32_16x16x32_bf16 v[76:79], v[180:183], v[196:199], v[76:79]
    ds_read_b64_tr_b16 v[178:179], v28 offset:41984
    v_mfma_f32_16x16x32_bf16 v[132:135], v[180:183], v[200:203], v[132:135]
    s_waitcnt lgkmcnt(10)
    v_cvt_pk_bf16_f32 v18, v20, v21
    v_cvt_pk_bf16_f32 v19, v22, v23
    v_mfma_f32_16x16x32_bf16 v[140:143], v[180:183], v[204:207], v[140:143]
    buffer_load_dwordx4 v[252:255], v10, s[16:19], s97 offen offset:2304 sc1
    v_mfma_f32_16x16x32_bf16 v[80:83], v[184:187], v[192:195], v[80:83]
    ds_read_b64_tr_b16 v[180:181], v29 offset:40960
    v_mfma_f32_16x16x32_bf16 v[88:91], v[184:187], v[196:199], v[88:91]
    ds_read_b64_tr_b16 v[182:183], v29 offset:41984
    v_mfma_f32_16x16x32_bf16 v[144:147], v[184:187], v[200:203], v[144:147]
    v_mfma_f32_16x16x32_bf16 v[152:155], v[184:187], v[204:207], v[152:155]
    v_mfma_f32_16x16x32_bf16 v[84:87], v[188:191], v[192:195], v[84:87]
    ds_read_b64_tr_b16 v[184:185], v30 offset:40960
    buffer_store_dwordx4 v[16:19], v3, s[16:19], s4 offen offset:2048 sc1
    v_mfma_f32_16x16x32_bf16 v[92:95], v[188:191], v[196:199], v[92:95]
    ds_read_b64_tr_b16 v[186:187], v30 offset:41984
    v_mfma_f32_16x16x32_bf16 v[148:151], v[188:191], v[200:203], v[148:151]
    s_waitcnt vmcnt(16) lgkmcnt(10)
    v_mfma_f32_16x16x32_bf16 v[156:159], v[188:191], v[204:207], v[156:159]
    ds_read_b64_tr_b16 v[188:189], v31 offset:40960
    ds_read_b64_tr_b16 v[190:191], v31 offset:41984
    v_mfma_f32_16x16x32_bf16 v[32:35], v[160:163], v[208:211], v[32:35]
    s_nop 0
    s_add_u32 s4, s99, 262144
    v_accvgpr_read_b32 v16, a128
    v_mfma_f32_16x16x32_bf16 v[40:43], v[160:163], v[212:215], v[40:43]
    v_accvgpr_read_b32 v17, a129
    v_accvgpr_read_b32 v18, a130
    v_mfma_f32_16x16x32_bf16 v[96:99], v[160:163], v[216:219], v[96:99]
    v_accvgpr_read_b32 v19, a131
    v_accvgpr_read_b32 v20, a132
    v_accvgpr_read_b32 v21, a133
    v_mfma_f32_16x16x32_bf16 v[104:107], v[160:163], v[220:223], v[104:107]
    v_accvgpr_read_b32 v22, a134
    s_barrier
    v_mfma_f32_16x16x32_bf16 v[36:39], v[164:167], v[208:211], v[36:39]
    ds_read_b64_tr_b16 v[160:161], v24 offset:49152
    v_accvgpr_read_b32 v23, a135
    v_mfma_f32_16x16x32_bf16 v[44:47], v[164:167], v[212:215], v[44:47]
    s_add_u32 s97, s78, 16384
    ds_read_b64_tr_b16 v[162:163], v24 offset:50176
    v_cvt_pk_bf16_f32 v16, v16, v17
    v_cvt_pk_bf16_f32 v17, v18, v19
    v_mfma_f32_16x16x32_bf16 v[100:103], v[164:167], v[216:219], v[100:103]
    s_waitcnt lgkmcnt(10)
    buffer_load_dwordx4 v[192:195], v9, s[16:19], s97 offen offset:0 sc1
    v_mfma_f32_16x16x32_bf16 v[108:111], v[164:167], v[220:223], v[108:111]
    v_cvt_pk_bf16_f32 v18, v20, v21
    v_mfma_f32_16x16x32_bf16 v[48:51], v[168:171], v[208:211], v[48:51]
    ds_read_b64_tr_b16 v[164:165], v25 offset:49152
    v_cvt_pk_bf16_f32 v19, v22, v23
    v_mfma_f32_16x16x32_bf16 v[56:59], v[168:171], v[212:215], v[56:59]
    ds_read_b64_tr_b16 v[166:167], v25 offset:50176
    buffer_store_dwordx4 v[16:19], v2, s[16:19], s4 offen offset:0 sc1
    v_mfma_f32_16x16x32_bf16 v[112:115], v[168:171], v[216:219], v[112:115]
    buffer_load_dwordx4 v[196:199], v9, s[16:19], s97 offen offset:256 sc1
    v_mfma_f32_16x16x32_bf16 v[120:123], v[168:171], v[220:223], v[120:123]
    v_mfma_f32_16x16x32_bf16 v[52:55], v[172:175], v[208:211], v[52:55]
    ds_read_b64_tr_b16 v[168:169], v26 offset:49152
    s_nop 0
    s_add_u32 s4, s99, 262144
    v_mfma_f32_16x16x32_bf16 v[60:63], v[172:175], v[212:215], v[60:63]
    s_add_u32 m0, s98, 114688
    s_add_u32 s96, s75, 2097152
    ds_read_b64_tr_b16 v[170:171], v26 offset:50176
    v_accvgpr_read_b32 v16, a136
    v_mfma_f32_16x16x32_bf16 v[116:119], v[172:175], v[216:219], v[116:119]
    s_waitcnt lgkmcnt(10)
    buffer_load_dwordx4 v12, s[24:27], s96 offen offset:0 lds
    v_mfma_f32_16x16x32_bf16 v[124:127], v[172:175], v[220:223], v[124:127]
    buffer_load_dwordx4 v13, s[24:27], s96 offen offset:1024 lds
    v_mfma_f32_16x16x32_bf16 v[64:67], v[176:179], v[208:211], v[64:67]
    ds_read_b64_tr_b16 v[172:173], v27 offset:49152
    v_mfma_f32_16x16x32_bf16 v[72:75], v[176:179], v[212:215], v[72:75]
    ds_read_b64_tr_b16 v[174:175], v27 offset:50176
    v_accvgpr_read_b32 v17, a137
    v_mfma_f32_16x16x32_bf16 v[128:131], v[176:179], v[216:219], v[128:131]
    buffer_load_dwordx4 v14, s[24:27], s96 offen offset:2048 lds
    v_mfma_f32_16x16x32_bf16 v[136:139], v[176:179], v[220:223], v[136:139]
    v_accvgpr_read_b32 v18, a138
    v_mfma_f32_16x16x32_bf16 v[68:71], v[180:183], v[208:211], v[68:71]
    ds_read_b64_tr_b16 v[176:177], v28 offset:49152
    v_accvgpr_read_b32 v19, a139
    v_accvgpr_read_b32 v20, a140
    v_mfma_f32_16x16x32_bf16 v[76:79], v[180:183], v[212:215], v[76:79]
    ds_read_b64_tr_b16 v[178:179], v28 offset:50176
    v_accvgpr_read_b32 v21, a141
    v_accvgpr_read_b32 v22, a142
    v_mfma_f32_16x16x32_bf16 v[132:135], v[180:183], v[216:219], v[132:135]
    s_waitcnt lgkmcnt(10)
    buffer_load_dwordx4 v15, s[24:27], s96 offen offset:3072 lds
    v_mfma_f32_16x16x32_bf16 v[140:143], v[180:183], v[220:223], v[140:143]
    v_accvgpr_read_b32 v23, a143
    v_mfma_f32_16x16x32_bf16 v[80:83], v[184:187], v[208:211], v[80:83]
    ds_read_b64_tr_b16 v[180:181], v29 offset:49152
    v_cvt_pk_bf16_f32 v16, v16, v17
    v_cvt_pk_bf16_f32 v17, v18, v19
    v_mfma_f32_16x16x32_bf16 v[88:91], v[184:187], v[212:215], v[88:91]
    ds_read_b64_tr_b16 v[182:183], v29 offset:50176
    v_cvt_pk_bf16_f32 v18, v20, v21
    v_mfma_f32_16x16x32_bf16 v[144:147], v[184:187], v[216:219], v[144:147]
    buffer_load_dwordx4 v[200:203], v10, s[16:19], s97 offen offset:0 sc1
    v_mfma_f32_16x16x32_bf16 v[152:155], v[184:187], v[220:223], v[152:155]
    buffer_load_dwordx4 v[204:207], v10, s[16:19], s97 offen offset:256 sc1
    v_mfma_f32_16x16x32_bf16 v[84:87], v[188:191], v[208:211], v[84:87]
    ds_read_b64_tr_b16 v[184:185], v30 offset:49152
    v_mfma_f32_16x16x32_bf16 v[92:95], v[188:191], v[212:215], v[92:95]
    ds_read_b64_tr_b16 v[186:187], v30 offset:50176
    v_cvt_pk_bf16_f32 v19, v22, v23
    v_mfma_f32_16x16x32_bf16 v[148:151], v[188:191], v[216:219], v[148:151]
    s_waitcnt vmcnt(15) lgkmcnt(10)
    buffer_store_dwordx4 v[16:19], v3, s[16:19], s4 offen offset:0 sc1
    v_mfma_f32_16x16x32_bf16 v[156:159], v[188:191], v[220:223], v[156:159]
    ds_read_b64_tr_b16 v[188:189], v31 offset:49152
    ds_read_b64_tr_b16 v[190:191], v31 offset:50176
    v_mfma_f32_16x16x32_bf16 v[32:35], v[160:163], v[224:227], v[32:35]
    s_add_u32 s97, s78, 16384
    s_nop 0
    s_add_u32 s4, s99, 262144
    v_mfma_f32_16x16x32_bf16 v[40:43], v[160:163], v[228:231], v[40:43]
    buffer_load_dwordx4 v[208:211], v9, s[16:19], s97 offen offset:2048 sc1
    v_mfma_f32_16x16x32_bf16 v[96:99], v[160:163], v[232:235], v[96:99]
    v_mfma_f32_16x16x32_bf16 v[104:107], v[160:163], v[236:239], v[104:107]
    v_accvgpr_read_b32 v16, a144
    v_accvgpr_read_b32 v17, a145
    v_accvgpr_read_b32 v18, a146
    v_mfma_f32_16x16x32_bf16 v[36:39], v[164:167], v[224:227], v[36:39]
    ds_read_b64_tr_b16 v[160:161], v24 offset:57344
    v_accvgpr_read_b32 v19, a147
    v_mfma_f32_16x16x32_bf16 v[44:47], v[164:167], v[228:231], v[44:47]
    ds_read_b64_tr_b16 v[162:163], v24 offset:58368
    v_accvgpr_read_b32 v20, a148
    v_mfma_f32_16x16x32_bf16 v[100:103], v[164:167], v[232:235], v[100:103]
    s_waitcnt lgkmcnt(10)
    v_accvgpr_read_b32 v21, a149
    v_accvgpr_read_b32 v22, a150
    v_mfma_f32_16x16x32_bf16 v[108:111], v[164:167], v[236:239], v[108:111]
    v_accvgpr_read_b32 v23, a151
    v_cvt_pk_bf16_f32 v16, v16, v17
    v_mfma_f32_16x16x32_bf16 v[48:51], v[168:171], v[224:227], v[48:51]
    ds_read_b64_tr_b16 v[164:165], v25 offset:57344
    v_cvt_pk_bf16_f32 v17, v18, v19
    v_mfma_f32_16x16x32_bf16 v[56:59], v[168:171], v[228:231], v[56:59]
    ds_read_b64_tr_b16 v[166:167], v25 offset:58368
    v_cvt_pk_bf16_f32 v18, v20, v21
    v_mfma_f32_16x16x32_bf16 v[112:115], v[168:171], v[232:235], v[112:115]
    buffer_load_dwordx4 v[212:215], v9, s[16:19], s97 offen offset:2304 sc1
    v_mfma_f32_16x16x32_bf16 v[120:123], v[168:171], v[236:239], v[120:123]
    v_mfma_f32_16x16x32_bf16 v[52:55], v[172:175], v[224:227], v[52:55]
    ds_read_b64_tr_b16 v[168:169], v26 offset:57344
    v_cvt_pk_bf16_f32 v19, v22, v23
    v_mfma_f32_16x16x32_bf16 v[60:63], v[172:175], v[228:231], v[60:63]
    ds_read_b64_tr_b16 v[170:171], v26 offset:58368
    v_mfma_f32_16x16x32_bf16 v[116:119], v[172:175], v[232:235], v[116:119]
    s_waitcnt lgkmcnt(10)
    buffer_store_dwordx4 v[16:19], v2, s[16:19], s4 offen offset:2048 sc1
    v_mfma_f32_16x16x32_bf16 v[124:127], v[172:175], v[236:239], v[124:127]
    s_nop 0
    s_add_u32 s4, s99, 262144
    v_mfma_f32_16x16x32_bf16 v[64:67], v[176:179], v[224:227], v[64:67]
    ds_read_b64_tr_b16 v[172:173], v27 offset:57344
    v_accvgpr_read_b32 v16, a152
    v_mfma_f32_16x16x32_bf16 v[72:75], v[176:179], v[228:231], v[72:75]
    ds_read_b64_tr_b16 v[174:175], v27 offset:58368
    v_accvgpr_read_b32 v17, a153
    v_mfma_f32_16x16x32_bf16 v[128:131], v[176:179], v[232:235], v[128:131]
    buffer_load_dwordx4 v[216:219], v10, s[16:19], s97 offen offset:2048 sc1
    v_mfma_f32_16x16x32_bf16 v[136:139], v[176:179], v[236:239], v[136:139]
    v_accvgpr_read_b32 v18, a154
    v_mfma_f32_16x16x32_bf16 v[68:71], v[180:183], v[224:227], v[68:71]
    ds_read_b64_tr_b16 v[176:177], v28 offset:57344
    v_accvgpr_read_b32 v19, a155
    v_mfma_f32_16x16x32_bf16 v[76:79], v[180:183], v[228:231], v[76:79]
    ds_read_b64_tr_b16 v[178:179], v28 offset:58368
    v_accvgpr_read_b32 v20, a156
    v_mfma_f32_16x16x32_bf16 v[132:135], v[180:183], v[232:235], v[132:135]
    s_waitcnt lgkmcnt(10)
    v_accvgpr_read_b32 v21, a157
    v_accvgpr_read_b32 v22, a158
    v_mfma_f32_16x16x32_bf16 v[140:143], v[180:183], v[236:239], v[140:143]
    buffer_load_dwordx4 v[220:223], v10, s[16:19], s97 offen offset:2304 sc1
    v_mfma_f32_16x16x32_bf16 v[80:83], v[184:187], v[224:227], v[80:83]
    ds_read_b64_tr_b16 v[180:181], v29 offset:57344
    v_mfma_f32_16x16x32_bf16 v[88:91], v[184:187], v[228:231], v[88:91]
    ds_read_b64_tr_b16 v[182:183], v29 offset:58368
    v_mfma_f32_16x16x32_bf16 v[144:147], v[184:187], v[232:235], v[144:147]
    v_accvgpr_read_b32 v23, a159
    v_cvt_pk_bf16_f32 v16, v16, v17
    v_mfma_f32_16x16x32_bf16 v[152:155], v[184:187], v[236:239], v[152:155]
    v_cvt_pk_bf16_f32 v17, v18, v19
    v_cvt_pk_bf16_f32 v18, v20, v21
    v_mfma_f32_16x16x32_bf16 v[84:87], v[188:191], v[224:227], v[84:87]
    ds_read_b64_tr_b16 v[184:185], v30 offset:57344
    v_cvt_pk_bf16_f32 v19, v22, v23
    v_mfma_f32_16x16x32_bf16 v[92:95], v[188:191], v[228:231], v[92:95]
    ds_read_b64_tr_b16 v[186:187], v30 offset:58368
    v_mfma_f32_16x16x32_bf16 v[148:151], v[188:191], v[232:235], v[148:151]
    s_waitcnt vmcnt(16) lgkmcnt(10)
    buffer_store_dwordx4 v[16:19], v3, s[16:19], s4 offen offset:2048 sc1
    v_mfma_f32_16x16x32_bf16 v[156:159], v[188:191], v[236:239], v[156:159]
    ds_read_b64_tr_b16 v[188:189], v31 offset:57344
    ds_read_b64_tr_b16 v[190:191], v31 offset:58368
    v_mfma_f32_16x16x32_bf16 v[32:35], v[160:163], v[240:243], v[32:35]
    s_nop 0
    s_add_u32 s4, s99, 266240
    v_accvgpr_read_b32 v16, a160
    v_mfma_f32_16x16x32_bf16 v[40:43], v[160:163], v[244:247], v[40:43]
    v_accvgpr_read_b32 v17, a161
    v_accvgpr_read_b32 v18, a162
    v_mfma_f32_16x16x32_bf16 v[96:99], v[160:163], v[248:251], v[96:99]
    v_accvgpr_read_b32 v19, a163
    v_accvgpr_read_b32 v20, a164
    v_accvgpr_read_b32 v21, a165
    v_mfma_f32_16x16x32_bf16 v[104:107], v[160:163], v[252:255], v[104:107]
    v_accvgpr_read_b32 v22, a166
    s_barrier
    v_mfma_f32_16x16x32_bf16 v[36:39], v[164:167], v[240:243], v[36:39]
    ds_read_b64_tr_b16 v[160:161], v24 offset:0
    v_accvgpr_read_b32 v23, a167
    v_mfma_f32_16x16x32_bf16 v[44:47], v[164:167], v[244:247], v[44:47]
    s_add_u32 s97, s79, 16384
    ds_read_b64_tr_b16 v[162:163], v24 offset:1024
    v_cvt_pk_bf16_f32 v16, v16, v17
    v_cvt_pk_bf16_f32 v17, v18, v19
    v_mfma_f32_16x16x32_bf16 v[100:103], v[164:167], v[248:251], v[100:103]
    s_waitcnt lgkmcnt(10)
    buffer_load_dwordx4 v[224:227], v9, s[16:19], s97 offen offset:0 sc1
    v_mfma_f32_16x16x32_bf16 v[108:111], v[164:167], v[252:255], v[108:111]
    v_cvt_pk_bf16_f32 v18, v20, v21
    v_mfma_f32_16x16x32_bf16 v[48:51], v[168:171], v[240:243], v[48:51]
    ds_read_b64_tr_b16 v[164:165], v25 offset:0
    v_cvt_pk_bf16_f32 v19, v22, v23
    v_mfma_f32_16x16x32_bf16 v[56:59], v[168:171], v[244:247], v[56:59]
    ds_read_b64_tr_b16 v[166:167], v25 offset:1024
    buffer_store_dwordx4 v[16:19], v2, s[16:19], s4 offen offset:0 sc1
    v_mfma_f32_16x16x32_bf16 v[112:115], v[168:171], v[248:251], v[112:115]
    buffer_load_dwordx4 v[228:231], v9, s[16:19], s97 offen offset:256 sc1
    v_mfma_f32_16x16x32_bf16 v[120:123], v[168:171], v[252:255], v[120:123]
    v_mfma_f32_16x16x32_bf16 v[52:55], v[172:175], v[240:243], v[52:55]
    ds_read_b64_tr_b16 v[168:169], v26 offset:0
    s_nop 0
    s_add_u32 s4, s99, 266240
    v_mfma_f32_16x16x32_bf16 v[60:63], v[172:175], v[244:247], v[60:63]
    s_add_u32 m0, s98, 131072
    s_add_u32 s96, s72, 4194304
    ds_read_b64_tr_b16 v[170:171], v26 offset:1024
    v_accvgpr_read_b32 v16, a168
    v_mfma_f32_16x16x32_bf16 v[116:119], v[172:175], v[248:251], v[116:119]
    s_waitcnt lgkmcnt(10)
    buffer_load_dwordx4 v12, s[24:27], s96 offen offset:0 lds
    v_mfma_f32_16x16x32_bf16 v[124:127], v[172:175], v[252:255], v[124:127]
    buffer_load_dwordx4 v13, s[24:27], s96 offen offset:1024 lds
    v_mfma_f32_16x16x32_bf16 v[64:67], v[176:179], v[240:243], v[64:67]
    ds_read_b64_tr_b16 v[172:173], v27 offset:0
    v_mfma_f32_16x16x32_bf16 v[72:75], v[176:179], v[244:247], v[72:75]
    ds_read_b64_tr_b16 v[174:175], v27 offset:1024
    v_accvgpr_read_b32 v17, a169
    v_mfma_f32_16x16x32_bf16 v[128:131], v[176:179], v[248:251], v[128:131]
    buffer_load_dwordx4 v14, s[24:27], s96 offen offset:2048 lds
    v_mfma_f32_16x16x32_bf16 v[136:139], v[176:179], v[252:255], v[136:139]
    v_accvgpr_read_b32 v18, a170
    v_mfma_f32_16x16x32_bf16 v[68:71], v[180:183], v[240:243], v[68:71]
    ds_read_b64_tr_b16 v[176:177], v28 offset:0
    v_accvgpr_read_b32 v19, a171
    v_accvgpr_read_b32 v20, a172
    v_mfma_f32_16x16x32_bf16 v[76:79], v[180:183], v[244:247], v[76:79]
    ds_read_b64_tr_b16 v[178:179], v28 offset:1024
    v_accvgpr_read_b32 v21, a173
    v_accvgpr_read_b32 v22, a174
    v_mfma_f32_16x16x32_bf16 v[132:135], v[180:183], v[248:251], v[132:135]
    s_waitcnt lgkmcnt(10)
    buffer_load_dwordx4 v15, s[24:27], s96 offen offset:3072 lds
    v_mfma_f32_16x16x32_bf16 v[140:143], v[180:183], v[252:255], v[140:143]
    v_accvgpr_read_b32 v23, a175
    v_mfma_f32_16x16x32_bf16 v[80:83], v[184:187], v[240:243], v[80:83]
    ds_read_b64_tr_b16 v[180:181], v29 offset:0
    v_cvt_pk_bf16_f32 v16, v16, v17
    v_cvt_pk_bf16_f32 v17, v18, v19
    v_mfma_f32_16x16x32_bf16 v[88:91], v[184:187], v[244:247], v[88:91]
    ds_read_b64_tr_b16 v[182:183], v29 offset:1024
    v_cvt_pk_bf16_f32 v18, v20, v21
    v_mfma_f32_16x16x32_bf16 v[144:147], v[184:187], v[248:251], v[144:147]
    buffer_load_dwordx4 v[232:235], v10, s[16:19], s97 offen offset:0 sc1
    v_mfma_f32_16x16x32_bf16 v[152:155], v[184:187], v[252:255], v[152:155]
    buffer_load_dwordx4 v[236:239], v10, s[16:19], s97 offen offset:256 sc1
    v_mfma_f32_16x16x32_bf16 v[84:87], v[188:191], v[240:243], v[84:87]
    ds_read_b64_tr_b16 v[184:185], v30 offset:0
    v_mfma_f32_16x16x32_bf16 v[92:95], v[188:191], v[244:247], v[92:95]
    ds_read_b64_tr_b16 v[186:187], v30 offset:1024
    v_cvt_pk_bf16_f32 v19, v22, v23
    v_mfma_f32_16x16x32_bf16 v[148:151], v[188:191], v[248:251], v[148:151]
    s_waitcnt vmcnt(16) lgkmcnt(10)
    buffer_store_dwordx4 v[16:19], v3, s[16:19], s4 offen offset:0 sc1
    v_mfma_f32_16x16x32_bf16 v[156:159], v[188:191], v[252:255], v[156:159]
    ds_read_b64_tr_b16 v[188:189], v31 offset:0
    ds_read_b64_tr_b16 v[190:191], v31 offset:1024
    v_mfma_f32_16x16x32_bf16 v[32:35], v[160:163], v[192:195], v[32:35]
    s_add_u32 s97, s79, 16384
    s_nop 0
    s_add_u32 s4, s99, 266240
    v_mfma_f32_16x16x32_bf16 v[40:43], v[160:163], v[196:199], v[40:43]
    buffer_load_dwordx4 v[240:243], v9, s[16:19], s97 offen offset:2048 sc1
    v_mfma_f32_16x16x32_bf16 v[96:99], v[160:163], v[200:203], v[96:99]
    v_accvgpr_read_b32 v16, a176
    v_mfma_f32_16x16x32_bf16 v[104:107], v[160:163], v[204:207], v[104:107]
    v_accvgpr_read_b32 v17, a177
    v_accvgpr_read_b32 v18, a178
    v_mfma_f32_16x16x32_bf16 v[36:39], v[164:167], v[192:195], v[36:39]
    ds_read_b64_tr_b16 v[160:161], v24 offset:8192
    v_accvgpr_read_b32 v19, a179
    v_mfma_f32_16x16x32_bf16 v[44:47], v[164:167], v[196:199], v[44:47]
    ds_read_b64_tr_b16 v[162:163], v24 offset:9216
    v_accvgpr_read_b32 v20, a180
    v_mfma_f32_16x16x32_bf16 v[100:103], v[164:167], v[200:203], v[100:103]
    s_waitcnt lgkmcnt(10)
    v_accvgpr_read_b32 v21, a181
    v_accvgpr_read_b32 v22, a182
    v_mfma_f32_16x16x32_bf16 v[108:111], v[164:167], v[204:207], v[108:111]
    v_accvgpr_read_b32 v23, a183
    v_cvt_pk_bf16_f32 v16, v16, v17
    v_mfma_f32_16x16x32_bf16 v[48:51], v[168:171], v[192:195], v[48:51]
    ds_read_b64_tr_b16 v[164:165], v25 offset:8192
    v_cvt_pk_bf16_f32 v17, v18, v19
    v_mfma_f32_16x16x32_bf16 v[56:59], v[168:171], v[196:199], v[56:59]
    ds_read_b64_tr_b16 v[166:167], v25 offset:9216
    v_cvt_pk_bf16_f32 v18, v20, v21
    v_mfma_f32_16x16x32_bf16 v[112:115], v[168:171], v[200:203], v[112:115]
    buffer_load_dwordx4 v[244:247], v9, s[16:19], s97 offen offset:2304 sc1
    v_mfma_f32_16x16x32_bf16 v[120:123], v[168:171], v[204:207], v[120:123]
    v_cvt_pk_bf16_f32 v19, v22, v23
    v_mfma_f32_16x16x32_bf16 v[52:55], v[172:175], v[192:195], v[52:55]
    ds_read_b64_tr_b16 v[168:169], v26 offset:8192
    v_mfma_f32_16x16x32_bf16 v[60:63], v[172:175], v[196:199], v[60:63]
    ds_read_b64_tr_b16 v[170:171], v26 offset:9216
    buffer_store_dwordx4 v[16:19], v2, s[16:19], s4 offen offset:2048 sc1
    v_mfma_f32_16x16x32_bf16 v[116:119], v[172:175], v[200:203], v[116:119]
    s_waitcnt lgkmcnt(10)
    v_mfma_f32_16x16x32_bf16 v[124:127], v[172:175], v[204:207], v[124:127]
    s_nop 0
    s_add_u32 s4, s99, 266240
    v_accvgpr_read_b32 v16, a184
    v_mfma_f32_16x16x32_bf16 v[64:67], v[176:179], v[192:195], v[64:67]
    ds_read_b64_tr_b16 v[172:173], v27 offset:8192
    v_accvgpr_read_b32 v17, a185
    v_mfma_f32_16x16x32_bf16 v[72:75], v[176:179], v[196:199], v[72:75]
    ds_read_b64_tr_b16 v[174:175], v27 offset:9216
    v_accvgpr_read_b32 v18, a186
    v_mfma_f32_16x16x32_bf16 v[128:131], v[176:179], v[200:203], v[128:131]
    buffer_load_dwordx4 v[248:251], v10, s[16:19], s97 offen offset:2048 sc1
    v_mfma_f32_16x16x32_bf16 v[136:139], v[176:179], v[204:207], v[136:139]
    v_mfma_f32_16x16x32_bf16 v[68:71], v[180:183], v[192:195], v[68:71]
    ds_read_b64_tr_b16 v[176:177], v28 offset:8192
    v_accvgpr_read_b32 v19, a187
    v_mfma_f32_16x16x32_bf16 v[76:79], v[180:183], v[196:199], v[76:79]
    ds_read_b64_tr_b16 v[178:179], v28 offset:9216
    v_accvgpr_read_b32 v20, a188
    v_mfma_f32_16x16x32_bf16 v[132:135], v[180:183], v[200:203], v[132:135]
    s_waitcnt lgkmcnt(10)
    v_accvgpr_read_b32 v21, a189
    v_accvgpr_read_b32 v22, a190
    v_accvgpr_read_b32 v23, a191
    v_mfma_f32_16x16x32_bf16 v[140:143], v[180:183], v[204:207], v[140:143]
    buffer_load_dwordx4 v[252:255], v10, s[16:19], s97 offen offset:2304 sc1
    v_mfma_f32_16x16x32_bf16 v[80:83], v[184:187], v[192:195], v[80:83]
    ds_read_b64_tr_b16 v[180:181], v29 offset:8192
    v_mfma_f32_16x16x32_bf16 v[88:91], v[184:187], v[196:199], v[88:91]
    ds_read_b64_tr_b16 v[182:183], v29 offset:9216
    v_mfma_f32_16x16x32_bf16 v[144:147], v[184:187], v[200:203], v[144:147]
    v_cvt_pk_bf16_f32 v16, v16, v17
    v_cvt_pk_bf16_f32 v17, v18, v19
    v_mfma_f32_16x16x32_bf16 v[152:155], v[184:187], v[204:207], v[152:155]
    v_cvt_pk_bf16_f32 v18, v20, v21
    v_cvt_pk_bf16_f32 v19, v22, v23
    v_mfma_f32_16x16x32_bf16 v[84:87], v[188:191], v[192:195], v[84:87]
    ds_read_b64_tr_b16 v[184:185], v30 offset:8192
    v_mfma_f32_16x16x32_bf16 v[92:95], v[188:191], v[196:199], v[92:95]
    ds_read_b64_tr_b16 v[186:187], v30 offset:9216
    buffer_store_dwordx4 v[16:19], v3, s[16:19], s4 offen offset:2048 sc1
    v_mfma_f32_16x16x32_bf16 v[148:151], v[188:191], v[200:203], v[148:151]
    s_waitcnt vmcnt(17) lgkmcnt(10)
    v_mov_b32 v5, 1
    v_mfma_f32_16x16x32_bf16 v[156:159], v[188:191], v[204:207], v[156:159]
    ds_read_b64_tr_b16 v[188:189], v31 offset:8192
    ds_read_b64_tr_b16 v[190:191], v31 offset:9216
    v_mfma_f32_16x16x32_bf16 v[32:35], v[160:163], v[208:211], v[32:35]
    s_nop 0
    s_add_u32 s4, s99, 393216
    v_mfma_f32_16x16x32_bf16 v[40:43], v[160:163], v[212:215], v[40:43]
    v_accvgpr_read_b32 v16, a192
    v_accvgpr_read_b32 v17, a193
    v_mfma_f32_16x16x32_bf16 v[96:99], v[160:163], v[216:219], v[96:99]
    v_accvgpr_read_b32 v18, a194
    v_accvgpr_read_b32 v19, a195
    v_accvgpr_read_b32 v20, a196
    v_mfma_f32_16x16x32_bf16 v[104:107], v[160:163], v[220:223], v[104:107]
    s_barrier
    v_mfma_f32_16x16x32_bf16 v[36:39], v[164:167], v[208:211], v[36:39]
    ds_read_b64_tr_b16 v[160:161], v24 offset:16384
    v_accvgpr_read_b32 v21, a197
    v_mfma_f32_16x16x32_bf16 v[44:47], v[164:167], v[212:215], v[44:47]
    s_add_u32 s97, s76, 32768
    ds_read_b64_tr_b16 v[162:163], v24 offset:17408
    v_accvgpr_read_b32 v22, a198
    v_mfma_f32_16x16x32_bf16 v[100:103], v[164:167], v[216:219], v[100:103]
    s_waitcnt lgkmcnt(10)
    buffer_load_dwordx4 v[192:195], v9, s[16:19], s97 offen offset:0 sc1
    v_mfma_f32_16x16x32_bf16 v[108:111], v[164:167], v[220:223], v[108:111]
    v_accvgpr_read_b32 v23, a199
    v_mfma_f32_16x16x32_bf16 v[48:51], v[168:171], v[208:211], v[48:51]
    ds_read_b64_tr_b16 v[164:165], v25 offset:16384
    v_cvt_pk_bf16_f32 v16, v16, v17
    v_mfma_f32_16x16x32_bf16 v[56:59], v[168:171], v[212:215], v[56:59]
    ds_read_b64_tr_b16 v[166:167], v25 offset:17408
    v_cvt_pk_bf16_f32 v17, v18, v19
    v_mfma_f32_16x16x32_bf16 v[112:115], v[168:171], v[216:219], v[112:115]
    buffer_load_dwordx4 v[196:199], v9, s[16:19], s97 offen offset:256 sc1
    v_mfma_f32_16x16x32_bf16 v[120:123], v[168:171], v[220:223], v[120:123]
    s_add_u32 m0, s98, 147456
    s_add_u32 s96, s73, 4194304
    buffer_load_dwordx4 v12, s[24:27], s96 offen offset:0 lds
    v_mfma_f32_16x16x32_bf16 v[52:55], v[172:175], v[208:211], v[52:55]
    ds_read_b64_tr_b16 v[168:169], v26 offset:16384
    v_mfma_f32_16x16x32_bf16 v[60:63], v[172:175], v[212:215], v[60:63]
    ds_read_b64_tr_b16 v[170:171], v26 offset:17408
    v_mfma_f32_16x16x32_bf16 v[116:119], v[172:175], v[216:219], v[116:119]
    s_waitcnt lgkmcnt(10)
    buffer_load_dwordx4 v13, s[24:27], s96 offen offset:1024 lds
    v_mfma_f32_16x16x32_bf16 v[124:127], v[172:175], v[220:223], v[124:127]
    v_mfma_f32_16x16x32_bf16 v[64:67], v[176:179], v[208:211], v[64:67]
    ds_read_b64_tr_b16 v[172:173], v27 offset:16384
    v_mfma_f32_16x16x32_bf16 v[72:75], v[176:179], v[212:215], v[72:75]
    ds_read_b64_tr_b16 v[174:175], v27 offset:17408
    v_cvt_pk_bf16_f32 v18, v20, v21
    v_cvt_pk_bf16_f32 v19, v22, v23
    v_mfma_f32_16x16x32_bf16 v[128:131], v[176:179], v[216:219], v[128:131]
    buffer_load_dwordx4 v14, s[24:27], s96 offen offset:2048 lds
    v_mfma_f32_16x16x32_bf16 v[136:139], v[176:179], v[220:223], v[136:139]
    buffer_load_dwordx4 v15, s[24:27], s96 offen offset:3072 lds
    v_mfma_f32_16x16x32_bf16 v[68:71], v[180:183], v[208:211], v[68:71]
    ds_read_b64_tr_b16 v[176:177], v28 offset:16384
    v_mfma_f32_16x16x32_bf16 v[76:79], v[180:183], v[212:215], v[76:79]
    ds_read_b64_tr_b16 v[178:179], v28 offset:17408
    v_mfma_f32_16x16x32_bf16 v[132:135], v[180:183], v[216:219], v[132:135]
    s_waitcnt lgkmcnt(10)
    buffer_load_dwordx4 v[200:203], v10, s[16:19], s97 offen offset:0 sc1
    v_mfma_f32_16x16x32_bf16 v[140:143], v[180:183], v[220:223], v[140:143]
    v_mfma_f32_16x16x32_bf16 v[80:83], v[184:187], v[208:211], v[80:83]
    ds_read_b64_tr_b16 v[180:181], v29 offset:16384
    v_mfma_f32_16x16x32_bf16 v[88:91], v[184:187], v[212:215], v[88:91]
    ds_read_b64_tr_b16 v[182:183], v29 offset:17408
    buffer_store_dwordx4 v[16:19], v2, s[16:19], s4 offen offset:0 sc1
    v_mfma_f32_16x16x32_bf16 v[144:147], v[184:187], v[216:219], v[144:147]
    buffer_load_dwordx4 v[204:207], v10, s[16:19], s97 offen offset:256 sc1
    v_mfma_f32_16x16x32_bf16 v[152:155], v[184:187], v[220:223], v[152:155]
    v_mfma_f32_16x16x32_bf16 v[84:87], v[188:191], v[208:211], v[84:87]
    ds_read_b64_tr_b16 v[184:185], v30 offset:16384
    v_mfma_f32_16x16x32_bf16 v[92:95], v[188:191], v[212:215], v[92:95]
    ds_read_b64_tr_b16 v[186:187], v30 offset:17408
    v_mfma_f32_16x16x32_bf16 v[148:151], v[188:191], v[216:219], v[148:151]
    s_waitcnt vmcnt(16) lgkmcnt(10)
    buffer_store_dword v5, v11, s[16:19], 0 offen sc1
    v_mfma_f32_16x16x32_bf16 v[156:159], v[188:191], v[220:223], v[156:159]
    ds_read_b64_tr_b16 v[188:189], v31 offset:16384
    ds_read_b64_tr_b16 v[190:191], v31 offset:17408
    v_mfma_f32_16x16x32_bf16 v[32:35], v[160:163], v[224:227], v[32:35]
    s_add_u32 s97, s76, 32768
    s_nop 0
    s_add_u32 s4, s99, 393216
    v_mfma_f32_16x16x32_bf16 v[40:43], v[160:163], v[228:231], v[40:43]
    buffer_load_dwordx4 v[208:211], v9, s[16:19], s97 offen offset:2048 sc1
    v_mfma_f32_16x16x32_bf16 v[96:99], v[160:163], v[232:235], v[96:99]
    v_mfma_f32_16x16x32_bf16 v[104:107], v[160:163], v[236:239], v[104:107]
    v_accvgpr_read_b32 v16, a200
    v_accvgpr_read_b32 v17, a201
    v_accvgpr_read_b32 v18, a202
    v_mfma_f32_16x16x32_bf16 v[36:39], v[164:167], v[224:227], v[36:39]
    ds_read_b64_tr_b16 v[160:161], v24 offset:24576
    v_accvgpr_read_b32 v19, a203
    v_mfma_f32_16x16x32_bf16 v[44:47], v[164:167], v[228:231], v[44:47]
    ds_read_b64_tr_b16 v[162:163], v24 offset:25600
    v_accvgpr_read_b32 v20, a204
    v_mfma_f32_16x16x32_bf16 v[100:103], v[164:167], v[232:235], v[100:103]
    s_waitcnt lgkmcnt(10)
    v_accvgpr_read_b32 v21, a205
    v_accvgpr_read_b32 v22, a206
    v_mfma_f32_16x16x32_bf16 v[108:111], v[164:167], v[236:239], v[108:111]
    v_accvgpr_read_b32 v23, a207
    v_cvt_pk_bf16_f32 v16, v16, v17
    v_mfma_f32_16x16x32_bf16 v[48:51], v[168:171], v[224:227], v[48:51]
    ds_read_b64_tr_b16 v[164:165], v25 offset:24576
    v_cvt_pk_bf16_f32 v17, v18, v19
    v_mfma_f32_16x16x32_bf16 v[56:59], v[168:171], v[228:231], v[56:59]
    ds_read_b64_tr_b16 v[166:167], v25 offset:25600
    v_cvt_pk_bf16_f32 v18, v20, v21
    v_mfma_f32_16x16x32_bf16 v[112:115], v[168:171], v[232:235], v[112:115]
    buffer_load_dwordx4 v[212:215], v9, s[16:19], s97 offen offset:2304 sc1
    v_mfma_f32_16x16x32_bf16 v[120:123], v[168:171], v[236:239], v[120:123]
    v_mfma_f32_16x16x32_bf16 v[52:55], v[172:175], v[224:227], v[52:55]
    ds_read_b64_tr_b16 v[168:169], v26 offset:24576
    v_cvt_pk_bf16_f32 v19, v22, v23
    v_mfma_f32_16x16x32_bf16 v[60:63], v[172:175], v[228:231], v[60:63]
    ds_read_b64_tr_b16 v[170:171], v26 offset:25600
    v_mfma_f32_16x16x32_bf16 v[116:119], v[172:175], v[232:235], v[116:119]
    s_waitcnt lgkmcnt(10)
    buffer_store_dwordx4 v[16:19], v3, s[16:19], s4 offen offset:0 sc1
    v_mfma_f32_16x16x32_bf16 v[124:127], v[172:175], v[236:239], v[124:127]
    s_nop 0
    s_add_u32 s4, s99, 393216
    v_mfma_f32_16x16x32_bf16 v[64:67], v[176:179], v[224:227], v[64:67]
    ds_read_b64_tr_b16 v[172:173], v27 offset:24576
    v_accvgpr_read_b32 v16, a208
    v_mfma_f32_16x16x32_bf16 v[72:75], v[176:179], v[228:231], v[72:75]
    ds_read_b64_tr_b16 v[174:175], v27 offset:25600
    v_accvgpr_read_b32 v17, a209
    v_mfma_f32_16x16x32_bf16 v[128:131], v[176:179], v[232:235], v[128:131]
    buffer_load_dwordx4 v[216:219], v10, s[16:19], s97 offen offset:2048 sc1
    v_mfma_f32_16x16x32_bf16 v[136:139], v[176:179], v[236:239], v[136:139]
    v_accvgpr_read_b32 v18, a210
    v_mfma_f32_16x16x32_bf16 v[68:71], v[180:183], v[224:227], v[68:71]
    ds_read_b64_tr_b16 v[176:177], v28 offset:24576
    v_accvgpr_read_b32 v19, a211
    v_mfma_f32_16x16x32_bf16 v[76:79], v[180:183], v[228:231], v[76:79]
    ds_read_b64_tr_b16 v[178:179], v28 offset:25600
    v_accvgpr_read_b32 v20, a212
    v_mfma_f32_16x16x32_bf16 v[132:135], v[180:183], v[232:235], v[132:135]
    s_waitcnt lgkmcnt(10)
    v_accvgpr_read_b32 v21, a213
    v_accvgpr_read_b32 v22, a214
    v_mfma_f32_16x16x32_bf16 v[140:143], v[180:183], v[236:239], v[140:143]
    buffer_load_dwordx4 v[220:223], v10, s[16:19], s97 offen offset:2304 sc1
    v_mfma_f32_16x16x32_bf16 v[80:83], v[184:187], v[224:227], v[80:83]
    ds_read_b64_tr_b16 v[180:181], v29 offset:24576
    v_mfma_f32_16x16x32_bf16 v[88:91], v[184:187], v[228:231], v[88:91]
    ds_read_b64_tr_b16 v[182:183], v29 offset:25600
    v_mfma_f32_16x16x32_bf16 v[144:147], v[184:187], v[232:235], v[144:147]
    v_accvgpr_read_b32 v23, a215
    v_cvt_pk_bf16_f32 v16, v16, v17
    v_mfma_f32_16x16x32_bf16 v[152:155], v[184:187], v[236:239], v[152:155]
    v_cvt_pk_bf16_f32 v17, v18, v19
    v_cvt_pk_bf16_f32 v18, v20, v21
    v_mfma_f32_16x16x32_bf16 v[84:87], v[188:191], v[224:227], v[84:87]
    ds_read_b64_tr_b16 v[184:185], v30 offset:24576
    v_cvt_pk_bf16_f32 v19, v22, v23
    v_mfma_f32_16x16x32_bf16 v[92:95], v[188:191], v[228:231], v[92:95]
    ds_read_b64_tr_b16 v[186:187], v30 offset:25600
    v_mfma_f32_16x16x32_bf16 v[148:151], v[188:191], v[232:235], v[148:151]
    s_waitcnt vmcnt(16) lgkmcnt(10)
    buffer_store_dwordx4 v[16:19], v2, s[16:19], s4 offen offset:2048 sc1
    v_mfma_f32_16x16x32_bf16 v[156:159], v[188:191], v[236:239], v[156:159]
    ds_read_b64_tr_b16 v[188:189], v31 offset:24576
    ds_read_b64_tr_b16 v[190:191], v31 offset:25600
    v_mfma_f32_16x16x32_bf16 v[32:35], v[160:163], v[240:243], v[32:35]
    s_nop 0
    s_add_u32 s4, s99, 393216
    v_accvgpr_read_b32 v16, a216
    v_mfma_f32_16x16x32_bf16 v[40:43], v[160:163], v[244:247], v[40:43]
    v_accvgpr_read_b32 v17, a217
    v_accvgpr_read_b32 v18, a218
    v_mfma_f32_16x16x32_bf16 v[96:99], v[160:163], v[248:251], v[96:99]
    v_accvgpr_read_b32 v19, a219
    v_accvgpr_read_b32 v20, a220
    v_accvgpr_read_b32 v21, a221
    v_mfma_f32_16x16x32_bf16 v[104:107], v[160:163], v[252:255], v[104:107]
    v_accvgpr_read_b32 v22, a222
    s_barrier
    v_mfma_f32_16x16x32_bf16 v[36:39], v[164:167], v[240:243], v[36:39]
    ds_read_b64_tr_b16 v[160:161], v24 offset:32768
    v_accvgpr_read_b32 v23, a223
    v_mfma_f32_16x16x32_bf16 v[44:47], v[164:167], v[244:247], v[44:47]
    s_add_u32 s97, s77, 32768
    ds_read_b64_tr_b16 v[162:163], v24 offset:33792
    v_cvt_pk_bf16_f32 v16, v16, v17
    v_cvt_pk_bf16_f32 v17, v18, v19
    v_mfma_f32_16x16x32_bf16 v[100:103], v[164:167], v[248:251], v[100:103]
    s_waitcnt lgkmcnt(10)
    buffer_load_dwordx4 v[224:227], v9, s[16:19], s97 offen offset:0 sc1
    v_mfma_f32_16x16x32_bf16 v[108:111], v[164:167], v[252:255], v[108:111]
    v_cvt_pk_bf16_f32 v18, v20, v21
    v_mfma_f32_16x16x32_bf16 v[48:51], v[168:171], v[240:243], v[48:51]
    ds_read_b64_tr_b16 v[164:165], v25 offset:32768
    v_cvt_pk_bf16_f32 v19, v22, v23
    v_mfma_f32_16x16x32_bf16 v[56:59], v[168:171], v[244:247], v[56:59]
    ds_read_b64_tr_b16 v[166:167], v25 offset:33792
    buffer_store_dwordx4 v[16:19], v3, s[16:19], s4 offen offset:2048 sc1
    v_mfma_f32_16x16x32_bf16 v[112:115], v[168:171], v[248:251], v[112:115]
    buffer_load_dwordx4 v[228:231], v9, s[16:19], s97 offen offset:256 sc1
    v_mfma_f32_16x16x32_bf16 v[120:123], v[168:171], v[252:255], v[120:123]
    v_mfma_f32_16x16x32_bf16 v[52:55], v[172:175], v[240:243], v[52:55]
    ds_read_b64_tr_b16 v[168:169], v26 offset:32768
    s_nop 0
    s_add_u32 s4, s99, 397312
    v_mfma_f32_16x16x32_bf16 v[60:63], v[172:175], v[244:247], v[60:63]
    s_add_u32 m0, s98, 98304
    s_add_u32 s96, s74, 4194304
    ds_read_b64_tr_b16 v[170:171], v26 offset:33792
    v_accvgpr_read_b32 v16, a224
    v_mfma_f32_16x16x32_bf16 v[116:119], v[172:175], v[248:251], v[116:119]
    s_waitcnt lgkmcnt(10)
    buffer_load_dwordx4 v12, s[24:27], s96 offen offset:0 lds
    v_mfma_f32_16x16x32_bf16 v[124:127], v[172:175], v[252:255], v[124:127]
    buffer_load_dwordx4 v13, s[24:27], s96 offen offset:1024 lds
    v_mfma_f32_16x16x32_bf16 v[64:67], v[176:179], v[240:243], v[64:67]
    ds_read_b64_tr_b16 v[172:173], v27 offset:32768
    v_mfma_f32_16x16x32_bf16 v[72:75], v[176:179], v[244:247], v[72:75]
    ds_read_b64_tr_b16 v[174:175], v27 offset:33792
    v_accvgpr_read_b32 v17, a225
    v_mfma_f32_16x16x32_bf16 v[128:131], v[176:179], v[248:251], v[128:131]
    buffer_load_dwordx4 v14, s[24:27], s96 offen offset:2048 lds
    v_mfma_f32_16x16x32_bf16 v[136:139], v[176:179], v[252:255], v[136:139]
    v_accvgpr_read_b32 v18, a226
    v_mfma_f32_16x16x32_bf16 v[68:71], v[180:183], v[240:243], v[68:71]
    ds_read_b64_tr_b16 v[176:177], v28 offset:32768
    v_accvgpr_read_b32 v19, a227
    v_accvgpr_read_b32 v20, a228
    v_mfma_f32_16x16x32_bf16 v[76:79], v[180:183], v[244:247], v[76:79]
    ds_read_b64_tr_b16 v[178:179], v28 offset:33792
    v_accvgpr_read_b32 v21, a229
    v_accvgpr_read_b32 v22, a230
    v_mfma_f32_16x16x32_bf16 v[132:135], v[180:183], v[248:251], v[132:135]
    s_waitcnt lgkmcnt(10)
    buffer_load_dwordx4 v15, s[24:27], s96 offen offset:3072 lds
    v_mfma_f32_16x16x32_bf16 v[140:143], v[180:183], v[252:255], v[140:143]
    v_accvgpr_read_b32 v23, a231
    v_mfma_f32_16x16x32_bf16 v[80:83], v[184:187], v[240:243], v[80:83]
    ds_read_b64_tr_b16 v[180:181], v29 offset:32768
    v_cvt_pk_bf16_f32 v16, v16, v17
    v_cvt_pk_bf16_f32 v17, v18, v19
    v_mfma_f32_16x16x32_bf16 v[88:91], v[184:187], v[244:247], v[88:91]
    ds_read_b64_tr_b16 v[182:183], v29 offset:33792
    v_cvt_pk_bf16_f32 v18, v20, v21
    v_mfma_f32_16x16x32_bf16 v[144:147], v[184:187], v[248:251], v[144:147]
    buffer_load_dwordx4 v[232:235], v10, s[16:19], s97 offen offset:0 sc1
    v_mfma_f32_16x16x32_bf16 v[152:155], v[184:187], v[252:255], v[152:155]
    buffer_load_dwordx4 v[236:239], v10, s[16:19], s97 offen offset:256 sc1
    v_mfma_f32_16x16x32_bf16 v[84:87], v[188:191], v[240:243], v[84:87]
    ds_read_b64_tr_b16 v[184:185], v30 offset:32768
    v_mfma_f32_16x16x32_bf16 v[92:95], v[188:191], v[244:247], v[92:95]
    ds_read_b64_tr_b16 v[186:187], v30 offset:33792
    v_cvt_pk_bf16_f32 v19, v22, v23
    v_mfma_f32_16x16x32_bf16 v[148:151], v[188:191], v[248:251], v[148:151]
    s_waitcnt vmcnt(16) lgkmcnt(10)
    buffer_store_dwordx4 v[16:19], v2, s[16:19], s4 offen offset:0 sc1
    v_mfma_f32_16x16x32_bf16 v[156:159], v[188:191], v[252:255], v[156:159]
    ds_read_b64_tr_b16 v[188:189], v31 offset:32768
    ds_read_b64_tr_b16 v[190:191], v31 offset:33792
    v_mfma_f32_16x16x32_bf16 v[32:35], v[160:163], v[192:195], v[32:35]
    s_add_u32 s97, s77, 32768
    s_nop 0
    s_add_u32 s4, s99, 397312
    v_accvgpr_read_b32 v16, a232
    v_mfma_f32_16x16x32_bf16 v[40:43], v[160:163], v[196:199], v[40:43]
    buffer_load_dwordx4 v[240:243], v9, s[16:19], s97 offen offset:2048 sc1
    v_mfma_f32_16x16x32_bf16 v[96:99], v[160:163], v[200:203], v[96:99]
    v_accvgpr_read_b32 v17, a233
    v_mfma_f32_16x16x32_bf16 v[104:107], v[160:163], v[204:207], v[104:107]
    v_accvgpr_read_b32 v18, a234
    v_accvgpr_read_b32 v19, a235
    v_accvgpr_read_b32 v20, a236
    v_mfma_f32_16x16x32_bf16 v[36:39], v[164:167], v[192:195], v[36:39]
    ds_read_b64_tr_b16 v[160:161], v24 offset:40960
    v_accvgpr_read_b32 v21, a237
    v_mfma_f32_16x16x32_bf16 v[44:47], v[164:167], v[196:199], v[44:47]
    ds_read_b64_tr_b16 v[162:163], v24 offset:41984
    v_accvgpr_read_b32 v22, a238
    v_accvgpr_read_b32 v23, a239
    v_mfma_f32_16x16x32_bf16 v[100:103], v[164:167], v[200:203], v[100:103]
    s_waitcnt lgkmcnt(10)
    v_cvt_pk_bf16_f32 v16, v16, v17
    v_cvt_pk_bf16_f32 v17, v18, v19
    v_mfma_f32_16x16x32_bf16 v[108:111], v[164:167], v[204:207], v[108:111]
    v_cvt_pk_bf16_f32 v18, v20, v21
    v_cvt_pk_bf16_f32 v19, v22, v23
    v_mfma_f32_16x16x32_bf16 v[48:51], v[168:171], v[192:195], v[48:51]
    ds_read_b64_tr_b16 v[164:165], v25 offset:40960
    buffer_store_dwordx4 v[16:19], v3, s[16:19], s4 offen offset:0 sc1
    v_mfma_f32_16x16x32_bf16 v[56:59], v[168:171], v[196:199], v[56:59]
    ds_read_b64_tr_b16 v[166:167], v25 offset:41984
    v_mfma_f32_16x16x32_bf16 v[112:115], v[168:171], v[200:203], v[112:115]
    buffer_load_dwordx4 v[244:247], v9, s[16:19], s97 offen offset:2304 sc1
    v_mfma_f32_16x16x32_bf16 v[120:123], v[168:171], v[204:207], v[120:123]
    s_nop 0
    s_add_u32 s4, s99, 397312
    v_mfma_f32_16x16x32_bf16 v[52:55], v[172:175], v[192:195], v[52:55]
    ds_read_b64_tr_b16 v[168:169], v26 offset:40960
    v_accvgpr_read_b32 v16, a240
    v_mfma_f32_16x16x32_bf16 v[60:63], v[172:175], v[196:199], v[60:63]
    ds_read_b64_tr_b16 v[170:171], v26 offset:41984
    v_accvgpr_read_b32 v17, a241
    v_accvgpr_read_b32 v18, a242
    v_mfma_f32_16x16x32_bf16 v[116:119], v[172:175], v[200:203], v[116:119]
    s_waitcnt lgkmcnt(10)
    v_accvgpr_read_b32 v19, a243
    v_accvgpr_read_b32 v20, a244
    v_mfma_f32_16x16x32_bf16 v[124:127], v[172:175], v[204:207], v[124:127]
    v_accvgpr_read_b32 v21, a245
    v_accvgpr_read_b32 v22, a246
    v_accvgpr_read_b32 v23, a247
    v_mfma_f32_16x16x32_bf16 v[64:67], v[176:179], v[192:195], v[64:67]
    ds_read_b64_tr_b16 v[172:173], v27 offset:40960
    v_cvt_pk_bf16_f32 v16, v16, v17
    v_cvt_pk_bf16_f32 v17, v18, v19
    v_mfma_f32_16x16x32_bf16 v[72:75], v[176:179], v[196:199], v[72:75]
    ds_read_b64_tr_b16 v[174:175], v27 offset:41984
    v_cvt_pk_bf16_f32 v18, v20, v21
    v_mfma_f32_16x16x32_bf16 v[128:131], v[176:179], v[200:203], v[128:131]
    buffer_load_dwordx4 v[248:251], v10, s[16:19], s97 offen offset:2048 sc1
    v_mfma_f32_16x16x32_bf16 v[136:139], v[176:179], v[204:207], v[136:139]
    v_cvt_pk_bf16_f32 v19, v22, v23
    v_mfma_f32_16x16x32_bf16 v[68:71], v[180:183], v[192:195], v[68:71]
    ds_read_b64_tr_b16 v[176:177], v28 offset:40960
    buffer_store_dwordx4 v[16:19], v2, s[16:19], s4 offen offset:2048 sc1
    v_mfma_f32_16x16x32_bf16 v[76:79], v[180:183], v[196:199], v[76:79]
    ds_read_b64_tr_b16 v[178:179], v28 offset:41984
    v_mfma_f32_16x16x32_bf16 v[132:135], v[180:183], v[200:203], v[132:135]
    s_waitcnt lgkmcnt(10)
    v_accvgpr_write_b32 a0, 0
    v_accvgpr_write_b32 a1, 0
    v_accvgpr_write_b32 a2, 0
    v_mfma_f32_16x16x32_bf16 v[140:143], v[180:183], v[204:207], v[140:143]
    buffer_load_dwordx4 v[252:255], v10, s[16:19], s97 offen offset:2304 sc1
    v_mfma_f32_16x16x32_bf16 v[80:83], v[184:187], v[192:195], v[80:83]
    ds_read_b64_tr_b16 v[180:181], v29 offset:40960
    v_mfma_f32_16x16x32_bf16 v[88:91], v[184:187], v[196:199], v[88:91]
    ds_read_b64_tr_b16 v[182:183], v29 offset:41984
    v_accvgpr_write_b32 a3, 0
    v_accvgpr_write_b32 a4, 0
    v_mfma_f32_16x16x32_bf16 v[144:147], v[184:187], v[200:203], v[144:147]
    v_accvgpr_write_b32 a5, 0
    v_accvgpr_write_b32 a6, 0
    v_mfma_f32_16x16x32_bf16 v[152:155], v[184:187], v[204:207], v[152:155]
    v_accvgpr_write_b32 a7, 0
    v_accvgpr_write_b32 a8, 0
    v_accvgpr_write_b32 a9, 0
    v_mfma_f32_16x16x32_bf16 v[84:87], v[188:191], v[192:195], v[84:87]
    ds_read_b64_tr_b16 v[184:185], v30 offset:40960
    v_accvgpr_write_b32 a10, 0
    v_mfma_f32_16x16x32_bf16 v[92:95], v[188:191], v[196:199], v[92:95]
    ds_read_b64_tr_b16 v[186:187], v30 offset:41984
    v_accvgpr_write_b32 a11, 0
    v_accvgpr_write_b32 a12, 0
    v_mfma_f32_16x16x32_bf16 v[148:151], v[188:191], v[200:203], v[148:151]
    s_waitcnt vmcnt(17) lgkmcnt(10)
    v_accvgpr_write_b32 a13, 0
    v_accvgpr_write_b32 a14, 0
    v_mfma_f32_16x16x32_bf16 v[156:159], v[188:191], v[204:207], v[156:159]
    ds_read_b64_tr_b16 v[188:189], v31 offset:40960
    ds_read_b64_tr_b16 v[190:191], v31 offset:41984
    v_accvgpr_write_b32 a15, 0
    v_mfma_f32_16x16x32_bf16 v[32:35], v[160:163], v[208:211], v[32:35]
    s_nop 0
    s_add_u32 s4, s99, 397312
    v_accvgpr_read_b32 v16, a248
    v_mfma_f32_16x16x32_bf16 v[40:43], v[160:163], v[212:215], v[40:43]
    v_accvgpr_read_b32 v17, a249
    v_accvgpr_read_b32 v18, a250
    v_mfma_f32_16x16x32_bf16 v[96:99], v[160:163], v[216:219], v[96:99]
    v_accvgpr_read_b32 v19, a251
    v_accvgpr_read_b32 v20, a252
    v_accvgpr_read_b32 v21, a253
    v_mfma_f32_16x16x32_bf16 v[104:107], v[160:163], v[220:223], v[104:107]
    s_barrier
    v_mfma_f32_16x16x32_bf16 v[36:39], v[164:167], v[208:211], v[36:39]
    ds_read_b64_tr_b16 v[160:161], v24 offset:49152
    v_accvgpr_read_b32 v22, a254
    v_accvgpr_read_b32 v23, a255
    v_mfma_f32_16x16x32_bf16 v[44:47], v[164:167], v[212:215], v[44:47]
    s_add_u32 s97, s78, 32768
    ds_read_b64_tr_b16 v[162:163], v24 offset:50176
    v_cvt_pk_bf16_f32 v16, v16, v17
    v_cvt_pk_bf16_f32 v17, v18, v19
    v_mfma_f32_16x16x32_bf16 v[100:103], v[164:167], v[216:219], v[100:103]
    s_waitcnt lgkmcnt(10)
    buffer_load_dwordx4 v[192:195], v9, s[16:19], s97 offen offset:0 sc1
    v_mfma_f32_16x16x32_bf16 v[108:111], v[164:167], v[220:223], v[108:111]
    v_cvt_pk_bf16_f32 v18, v20, v21
    v_mfma_f32_16x16x32_bf16 v[48:51], v[168:171], v[208:211], v[48:51]
    ds_read_b64_tr_b16 v[164:165], v25 offset:49152
    v_cvt_pk_bf16_f32 v19, v22, v23
    v_mfma_f32_16x16x32_bf16 v[56:59], v[168:171], v[212:215], v[56:59]
    ds_read_b64_tr_b16 v[166:167], v25 offset:50176
    buffer_store_dwordx4 v[16:19], v3, s[16:19], s4 offen offset:2048 sc1
    v_mfma_f32_16x16x32_bf16 v[112:115], v[168:171], v[216:219], v[112:115]
    buffer_load_dwordx4 v[196:199], v9, s[16:19], s97 offen offset:256 sc1
    v_mfma_f32_16x16x32_bf16 v[120:123], v[168:171], v[220:223], v[120:123]
    v_mfma_f32_16x16x32_bf16 v[52:55], v[172:175], v[208:211], v[52:55]
    ds_read_b64_tr_b16 v[168:169], v26 offset:49152
    v_accvgpr_write_b32 a16, 0
    v_mfma_f32_16x16x32_bf16 v[60:63], v[172:175], v[212:215], v[60:63]
    s_add_u32 m0, s98, 114688
    s_add_u32 s96, s75, 4194304
    ds_read_b64_tr_b16 v[170:171], v26 offset:50176
    v_accvgpr_write_b32 a17, 0
    v_mfma_f32_16x16x32_bf16 v[116:119], v[172:175], v[216:219], v[116:119]
    s_waitcnt lgkmcnt(10)
    buffer_load_dwordx4 v12, s[24:27], s96 offen offset:0 lds
    v_mfma_f32_16x16x32_bf16 v[124:127], v[172:175], v[220:223], v[124:127]
    buffer_load_dwordx4 v13, s[24:27], s96 offen offset:1024 lds
    v_mfma_f32_16x16x32_bf16 v[64:67], v[176:179], v[208:211], v[64:67]
    ds_read_b64_tr_b16 v[172:173], v27 offset:49152
    v_mfma_f32_16x16x32_bf16 v[72:75], v[176:179], v[212:215], v[72:75]
    ds_read_b64_tr_b16 v[174:175], v27 offset:50176
    v_accvgpr_write_b32 a18, 0
    v_mfma_f32_16x16x32_bf16 v[128:131], v[176:179], v[216:219], v[128:131]
    buffer_load_dwordx4 v14, s[24:27], s96 offen offset:2048 lds
    v_mfma_f32_16x16x32_bf16 v[136:139], v[176:179], v[220:223], v[136:139]
    v_accvgpr_write_b32 a19, 0
    v_mfma_f32_16x16x32_bf16 v[68:71], v[180:183], v[208:211], v[68:71]
    ds_read_b64_tr_b16 v[176:177], v28 offset:49152
    v_accvgpr_write_b32 a20, 0
    v_accvgpr_write_b32 a21, 0
    v_mfma_f32_16x16x32_bf16 v[76:79], v[180:183], v[212:215], v[76:79]
    ds_read_b64_tr_b16 v[178:179], v28 offset:50176
    v_accvgpr_write_b32 a22, 0
    v_mfma_f32_16x16x32_bf16 v[132:135], v[180:183], v[216:219], v[132:135]
    s_waitcnt lgkmcnt(10)
    buffer_load_dwordx4 v15, s[24:27], s96 offen offset:3072 lds
    v_mfma_f32_16x16x32_bf16 v[140:143], v[180:183], v[220:223], v[140:143]
    v_accvgpr_write_b32 a23, 0
    v_accvgpr_write_b32 a24, 0
    v_mfma_f32_16x16x32_bf16 v[80:83], v[184:187], v[208:211], v[80:83]
    ds_read_b64_tr_b16 v[180:181], v29 offset:49152
    v_accvgpr_write_b32 a25, 0
    v_mfma_f32_16x16x32_bf16 v[88:91], v[184:187], v[212:215], v[88:91]
    ds_read_b64_tr_b16 v[182:183], v29 offset:50176
    v_accvgpr_write_b32 a26, 0
    v_accvgpr_write_b32 a27, 0
    v_mfma_f32_16x16x32_bf16 v[144:147], v[184:187], v[216:219], v[144:147]
    buffer_load_dwordx4 v[200:203], v10, s[16:19], s97 offen offset:0 sc1
    v_mfma_f32_16x16x32_bf16 v[152:155], v[184:187], v[220:223], v[152:155]
    buffer_load_dwordx4 v[204:207], v10, s[16:19], s97 offen offset:256 sc1
    v_mfma_f32_16x16x32_bf16 v[84:87], v[188:191], v[208:211], v[84:87]
    ds_read_b64_tr_b16 v[184:185], v30 offset:49152
    v_mfma_f32_16x16x32_bf16 v[92:95], v[188:191], v[212:215], v[92:95]
    ds_read_b64_tr_b16 v[186:187], v30 offset:50176
    v_accvgpr_write_b32 a28, 0
    v_mfma_f32_16x16x32_bf16 v[148:151], v[188:191], v[216:219], v[148:151]
    s_waitcnt vmcnt(16) lgkmcnt(10)
    v_accvgpr_write_b32 a29, 0
    v_accvgpr_write_b32 a30, 0
    v_mfma_f32_16x16x32_bf16 v[156:159], v[188:191], v[220:223], v[156:159]
    ds_read_b64_tr_b16 v[188:189], v31 offset:49152
    ds_read_b64_tr_b16 v[190:191], v31 offset:50176
    v_accvgpr_write_b32 a31, 0
    v_mfma_f32_16x16x32_bf16 v[32:35], v[160:163], v[224:227], v[32:35]
    s_add_u32 s97, s78, 32768
    v_accvgpr_write_b32 a32, 0
    v_mfma_f32_16x16x32_bf16 v[40:43], v[160:163], v[228:231], v[40:43]
    buffer_load_dwordx4 v[208:211], v9, s[16:19], s97 offen offset:2048 sc1
    v_mfma_f32_16x16x32_bf16 v[96:99], v[160:163], v[232:235], v[96:99]
    v_mfma_f32_16x16x32_bf16 v[104:107], v[160:163], v[236:239], v[104:107]
    v_accvgpr_write_b32 a33, 0
    v_mfma_f32_16x16x32_bf16 v[36:39], v[164:167], v[224:227], v[36:39]
    ds_read_b64_tr_b16 v[160:161], v24 offset:57344
    v_accvgpr_write_b32 a34, 0
    v_mfma_f32_16x16x32_bf16 v[44:47], v[164:167], v[228:231], v[44:47]
    ds_read_b64_tr_b16 v[162:163], v24 offset:58368
    v_mfma_f32_16x16x32_bf16 v[100:103], v[164:167], v[232:235], v[100:103]
    s_waitcnt lgkmcnt(10)
    v_accvgpr_write_b32 a35, 0
    v_accvgpr_write_b32 a36, 0
    v_mfma_f32_16x16x32_bf16 v[108:111], v[164:167], v[236:239], v[108:111]
    v_accvgpr_write_b32 a37, 0
    v_mfma_f32_16x16x32_bf16 v[48:51], v[168:171], v[224:227], v[48:51]
    ds_read_b64_tr_b16 v[164:165], v25 offset:57344
    v_mfma_f32_16x16x32_bf16 v[56:59], v[168:171], v[228:231], v[56:59]
    ds_read_b64_tr_b16 v[166:167], v25 offset:58368
    v_accvgpr_write_b32 a38, 0
    v_mfma_f32_16x16x32_bf16 v[112:115], v[168:171], v[232:235], v[112:115]
    buffer_load_dwordx4 v[212:215], v9, s[16:19], s97 offen offset:2304 sc1
    v_mfma_f32_16x16x32_bf16 v[120:123], v[168:171], v[236:239], v[120:123]
    v_mfma_f32_16x16x32_bf16 v[52:55], v[172:175], v[224:227], v[52:55]
    ds_read_b64_tr_b16 v[168:169], v26 offset:57344
    v_mfma_f32_16x16x32_bf16 v[60:63], v[172:175], v[228:231], v[60:63]
    ds_read_b64_tr_b16 v[170:171], v26 offset:58368
    v_mfma_f32_16x16x32_bf16 v[116:119], v[172:175], v[232:235], v[116:119]
    s_waitcnt lgkmcnt(10)
    v_accvgpr_write_b32 a39, 0
    v_accvgpr_write_b32 a40, 0
    v_mfma_f32_16x16x32_bf16 v[124:127], v[172:175], v[236:239], v[124:127]
    v_accvgpr_write_b32 a41, 0
    v_mfma_f32_16x16x32_bf16 v[64:67], v[176:179], v[224:227], v[64:67]
    ds_read_b64_tr_b16 v[172:173], v27 offset:57344
    v_mfma_f32_16x16x32_bf16 v[72:75], v[176:179], v[228:231], v[72:75]
    ds_read_b64_tr_b16 v[174:175], v27 offset:58368
    v_accvgpr_write_b32 a42, 0
    v_mfma_f32_16x16x32_bf16 v[128:131], v[176:179], v[232:235], v[128:131]
    buffer_load_dwordx4 v[216:219], v10, s[16:19], s97 offen offset:2048 sc1
    v_mfma_f32_16x16x32_bf16 v[136:139], v[176:179], v[236:239], v[136:139]
    v_mfma_f32_16x16x32_bf16 v[68:71], v[180:183], v[224:227], v[68:71]
    ds_read_b64_tr_b16 v[176:177], v28 offset:57344
    v_mfma_f32_16x16x32_bf16 v[76:79], v[180:183], v[228:231], v[76:79]
    ds_read_b64_tr_b16 v[178:179], v28 offset:58368
    v_mfma_f32_16x16x32_bf16 v[132:135], v[180:183], v[232:235], v[132:135]
    s_waitcnt lgkmcnt(10)
    v_accvgpr_write_b32 a43, 0
    v_accvgpr_write_b32 a44, 0
    v_mfma_f32_16x16x32_bf16 v[140:143], v[180:183], v[236:239], v[140:143]
    buffer_load_dwordx4 v[220:223], v10, s[16:19], s97 offen offset:2304 sc1
    v_mfma_f32_16x16x32_bf16 v[80:83], v[184:187], v[224:227], v[80:83]
    ds_read_b64_tr_b16 v[180:181], v29 offset:57344
    v_mfma_f32_16x16x32_bf16 v[88:91], v[184:187], v[228:231], v[88:91]
    ds_read_b64_tr_b16 v[182:183], v29 offset:58368
    v_mfma_f32_16x16x32_bf16 v[144:147], v[184:187], v[232:235], v[144:147]
    v_mfma_f32_16x16x32_bf16 v[152:155], v[184:187], v[236:239], v[152:155]
    v_accvgpr_write_b32 a45, 0
    v_mfma_f32_16x16x32_bf16 v[84:87], v[188:191], v[224:227], v[84:87]
    ds_read_b64_tr_b16 v[184:185], v30 offset:57344
    v_accvgpr_write_b32 a46, 0
    v_mfma_f32_16x16x32_bf16 v[92:95], v[188:191], v[228:231], v[92:95]
    ds_read_b64_tr_b16 v[186:187], v30 offset:58368
    v_mfma_f32_16x16x32_bf16 v[148:151], v[188:191], v[232:235], v[148:151]
    s_waitcnt vmcnt(13) lgkmcnt(10)
    v_accvgpr_write_b32 a47, 0
    v_mfma_f32_16x16x32_bf16 v[156:159], v[188:191], v[236:239], v[156:159]
    ds_read_b64_tr_b16 v[188:189], v31 offset:57344
    ds_read_b64_tr_b16 v[190:191], v31 offset:58368
    v_mfma_f32_16x16x32_bf16 v[32:35], v[160:163], v[240:243], v[32:35]
    v_accvgpr_write_b32 a48, 0
    v_accvgpr_write_b32 a49, 0
    v_mfma_f32_16x16x32_bf16 v[40:43], v[160:163], v[244:247], v[40:43]
    v_accvgpr_write_b32 a50, 0
    v_accvgpr_write_b32 a51, 0
    v_mfma_f32_16x16x32_bf16 v[96:99], v[160:163], v[248:251], v[96:99]
    v_accvgpr_write_b32 a52, 0
    v_accvgpr_write_b32 a53, 0
    v_mfma_f32_16x16x32_bf16 v[104:107], v[160:163], v[252:255], v[104:107]
    s_barrier
    v_mfma_f32_16x16x32_bf16 v[36:39], v[164:167], v[240:243], v[36:39]
    ds_read_b64_tr_b16 v[160:161], v24 offset:0
    v_accvgpr_write_b32 a54, 0
    v_mfma_f32_16x16x32_bf16 v[44:47], v[164:167], v[244:247], v[44:47]
    s_add_u32 s97, s79, 32768
    ds_read_b64_tr_b16 v[162:163], v24 offset:1024
    v_accvgpr_write_b32 a55, 0
    v_mfma_f32_16x16x32_bf16 v[100:103], v[164:167], v[248:251], v[100:103]
    s_waitcnt lgkmcnt(10)
    buffer_load_dwordx4 v[224:227], v9, s[16:19], s97 offen offset:0 sc1
    v_mfma_f32_16x16x32_bf16 v[108:111], v[164:167], v[252:255], v[108:111]
    v_accvgpr_write_b32 a56, 0
    v_mfma_f32_16x16x32_bf16 v[48:51], v[168:171], v[240:243], v[48:51]
    ds_read_b64_tr_b16 v[164:165], v25 offset:0
    v_accvgpr_write_b32 a57, 0
    v_mfma_f32_16x16x32_bf16 v[56:59], v[168:171], v[244:247], v[56:59]
    ds_read_b64_tr_b16 v[166:167], v25 offset:1024
    v_accvgpr_write_b32 a58, 0
    v_mfma_f32_16x16x32_bf16 v[112:115], v[168:171], v[248:251], v[112:115]
    buffer_load_dwordx4 v[228:231], v9, s[16:19], s97 offen offset:256 sc1
    v_mfma_f32_16x16x32_bf16 v[120:123], v[168:171], v[252:255], v[120:123]
    v_mfma_f32_16x16x32_bf16 v[52:55], v[172:175], v[240:243], v[52:55]
    ds_read_b64_tr_b16 v[168:169], v26 offset:0
    v_accvgpr_write_b32 a59, 0
    v_mfma_f32_16x16x32_bf16 v[60:63], v[172:175], v[244:247], v[60:63]
    s_add_u32 m0, s98, 131072
    s_add_u32 s96, s72, 6291456
    ds_read_b64_tr_b16 v[170:171], v26 offset:1024
    v_mfma_f32_16x16x32_bf16 v[116:119], v[172:175], v[248:251], v[116:119]
    s_waitcnt lgkmcnt(10)
    buffer_load_dwordx4 v12, s[24:27], s96 offen offset:0 lds
    v_mfma_f32_16x16x32_bf16 v[124:127], v[172:175], v[252:255], v[124:127]
    buffer_load_dwordx4 v13, s[24:27], s96 offen offset:1024 lds
    v_mfma_f32_16x16x32_bf16 v[64:67], v[176:179], v[240:243], v[64:67]
    ds_read_b64_tr_b16 v[172:173], v27 offset:0
    v_mfma_f32_16x16x32_bf16 v[72:75], v[176:179], v[244:247], v[72:75]
    ds_read_b64_tr_b16 v[174:175], v27 offset:1024
    v_mfma_f32_16x16x32_bf16 v[128:131], v[176:179], v[248:251], v[128:131]
    buffer_load_dwordx4 v14, s[24:27], s96 offen offset:2048 lds
    v_mfma_f32_16x16x32_bf16 v[136:139], v[176:179], v[252:255], v[136:139]
    v_mfma_f32_16x16x32_bf16 v[68:71], v[180:183], v[240:243], v[68:71]
    ds_read_b64_tr_b16 v[176:177], v28 offset:0
    v_mfma_f32_16x16x32_bf16 v[76:79], v[180:183], v[244:247], v[76:79]
    ds_read_b64_tr_b16 v[178:179], v28 offset:1024
    v_accvgpr_write_b32 a60, 0
    v_mfma_f32_16x16x32_bf16 v[132:135], v[180:183], v[248:251], v[132:135]
    s_waitcnt lgkmcnt(10)
    buffer_load_dwordx4 v15, s[24:27], s96 offen offset:3072 lds
    v_mfma_f32_16x16x32_bf16 v[140:143], v[180:183], v[252:255], v[140:143]
    v_mfma_f32_16x16x32_bf16 v[80:83], v[184:187], v[240:243], v[80:83]
    ds_read_b64_tr_b16 v[180:181], v29 offset:0
    v_accvgpr_write_b32 a61, 0
    v_mfma_f32_16x16x32_bf16 v[88:91], v[184:187], v[244:247], v[88:91]
    ds_read_b64_tr_b16 v[182:183], v29 offset:1024
    v_accvgpr_write_b32 a62, 0
    v_mfma_f32_16x16x32_bf16 v[144:147], v[184:187], v[248:251], v[144:147]
    buffer_load_dwordx4 v[232:235], v10, s[16:19], s97 offen offset:0 sc1
    v_mfma_f32_16x16x32_bf16 v[152:155], v[184:187], v[252:255], v[152:155]
    buffer_load_dwordx4 v[236:239], v10, s[16:19], s97 offen offset:256 sc1
    v_mfma_f32_16x16x32_bf16 v[84:87], v[188:191], v[240:243], v[84:87]
    ds_read_b64_tr_b16 v[184:185], v30 offset:0
    v_mfma_f32_16x16x32_bf16 v[92:95], v[188:191], v[244:247], v[92:95]
    ds_read_b64_tr_b16 v[186:187], v30 offset:1024
    v_mfma_f32_16x16x32_bf16 v[148:151], v[188:191], v[248:251], v[148:151]
    s_waitcnt vmcnt(12) lgkmcnt(10)
    v_accvgpr_write_b32 a63, 0
    v_mfma_f32_16x16x32_bf16 v[156:159], v[188:191], v[252:255], v[156:159]
    ds_read_b64_tr_b16 v[188:189], v31 offset:0
    ds_read_b64_tr_b16 v[190:191], v31 offset:1024
    v_mfma_f32_16x16x32_bf16 v[32:35], v[160:163], v[192:195], v[32:35]
    s_add_u32 s97, s79, 32768
    v_mov_b32 v5, 2
    v_accvgpr_write_b32 a64, 0
    v_mfma_f32_16x16x32_bf16 v[40:43], v[160:163], v[196:199], v[40:43]
    buffer_load_dwordx4 v[240:243], v9, s[16:19], s97 offen offset:2048 sc1
    v_mfma_f32_16x16x32_bf16 v[96:99], v[160:163], v[200:203], v[96:99]
    v_mfma_f32_16x16x32_bf16 v[104:107], v[160:163], v[204:207], v[104:107]
    v_mfma_f32_16x16x32_bf16 v[36:39], v[164:167], v[192:195], v[36:39]
    ds_read_b64_tr_b16 v[160:161], v24 offset:8192
    v_accvgpr_write_b32 a65, 0
    v_mfma_f32_16x16x32_bf16 v[44:47], v[164:167], v[196:199], v[44:47]
    ds_read_b64_tr_b16 v[162:163], v24 offset:9216
    v_mfma_f32_16x16x32_bf16 v[100:103], v[164:167], v[200:203], v[100:103]
    s_waitcnt lgkmcnt(10)
    v_accvgpr_write_b32 a66, 0
    v_accvgpr_write_b32 a67, 0
    v_mfma_f32_16x16x32_bf16 v[108:111], v[164:167], v[204:207], v[108:111]
    v_accvgpr_write_b32 a68, 0
    v_mfma_f32_16x16x32_bf16 v[48:51], v[168:171], v[192:195], v[48:51]
    ds_read_b64_tr_b16 v[164:165], v25 offset:8192
    v_accvgpr_write_b32 a69, 0
    v_mfma_f32_16x16x32_bf16 v[56:59], v[168:171], v[196:199], v[56:59]
    ds_read_b64_tr_b16 v[166:167], v25 offset:9216
    v_mfma_f32_16x16x32_bf16 v[112:115], v[168:171], v[200:203], v[112:115]
    buffer_load_dwordx4 v[244:247], v9, s[16:19], s97 offen offset:2304 sc1
    v_mfma_f32_16x16x32_bf16 v[120:123], v[168:171], v[204:207], v[120:123]
    v_mfma_f32_16x16x32_bf16 v[52:55], v[172:175], v[192:195], v[52:55]
    ds_read_b64_tr_b16 v[168:169], v26 offset:8192
    v_mfma_f32_16x16x32_bf16 v[60:63], v[172:175], v[196:199], v[60:63]
    ds_read_b64_tr_b16 v[170:171], v26 offset:9216
    v_accvgpr_write_b32 a70, 0
    v_mfma_f32_16x16x32_bf16 v[116:119], v[172:175], v[200:203], v[116:119]
    s_waitcnt lgkmcnt(10)
    v_accvgpr_write_b32 a71, 0
    v_mfma_f32_16x16x32_bf16 v[124:127], v[172:175], v[204:207], v[124:127]
    v_accvgpr_write_b32 a72, 0
    v_accvgpr_write_b32 a73, 0
    v_mfma_f32_16x16x32_bf16 v[64:67], v[176:179], v[192:195], v[64:67]
    ds_read_b64_tr_b16 v[172:173], v27 offset:8192
    v_mfma_f32_16x16x32_bf16 v[72:75], v[176:179], v[196:199], v[72:75]
    ds_read_b64_tr_b16 v[174:175], v27 offset:9216
    v_accvgpr_write_b32 a74, 0
    v_mfma_f32_16x16x32_bf16 v[128:131], v[176:179], v[200:203], v[128:131]
    buffer_load_dwordx4 v[248:251], v10, s[16:19], s97 offen offset:2048 sc1
    v_mfma_f32_16x16x32_bf16 v[136:139], v[176:179], v[204:207], v[136:139]
    v_mfma_f32_16x16x32_bf16 v[68:71], v[180:183], v[192:195], v[68:71]
    ds_read_b64_tr_b16 v[176:177], v28 offset:8192
    v_mfma_f32_16x16x32_bf16 v[76:79], v[180:183], v[196:199], v[76:79]
    ds_read_b64_tr_b16 v[178:179], v28 offset:9216
    v_mfma_f32_16x16x32_bf16 v[132:135], v[180:183], v[200:203], v[132:135]
    s_waitcnt lgkmcnt(10)
    v_accvgpr_write_b32 a75, 0
    v_mfma_f32_16x16x32_bf16 v[140:143], v[180:183], v[204:207], v[140:143]
    buffer_load_dwordx4 v[252:255], v10, s[16:19], s97 offen offset:2304 sc1
    v_mfma_f32_16x16x32_bf16 v[80:83], v[184:187], v[192:195], v[80:83]
    ds_read_b64_tr_b16 v[180:181], v29 offset:8192
    v_mfma_f32_16x16x32_bf16 v[88:91], v[184:187], v[196:199], v[88:91]
    ds_read_b64_tr_b16 v[182:183], v29 offset:9216
    v_mfma_f32_16x16x32_bf16 v[144:147], v[184:187], v[200:203], v[144:147]
    v_accvgpr_write_b32 a76, 0
    v_mfma_f32_16x16x32_bf16 v[152:155], v[184:187], v[204:207], v[152:155]
    v_accvgpr_write_b32 a77, 0
    v_mfma_f32_16x16x32_bf16 v[84:87], v[188:191], v[192:195], v[84:87]
    ds_read_b64_tr_b16 v[184:185], v30 offset:8192
    v_accvgpr_write_b32 a78, 0
    v_mfma_f32_16x16x32_bf16 v[92:95], v[188:191], v[196:199], v[92:95]
    ds_read_b64_tr_b16 v[186:187], v30 offset:9216
    v_mfma_f32_16x16x32_bf16 v[148:151], v[188:191], v[200:203], v[148:151]
    s_waitcnt vmcnt(12) lgkmcnt(10)
    v_accvgpr_write_b32 a79, 0
    v_mfma_f32_16x16x32_bf16 v[156:159], v[188:191], v[204:207], v[156:159]
    ds_read_b64_tr_b16 v[188:189], v31 offset:8192
    ds_read_b64_tr_b16 v[190:191], v31 offset:9216
    v_mfma_f32_16x16x32_bf16 v[32:35], v[160:163], v[208:211], v[32:35]
    v_accvgpr_write_b32 a80, 0
    v_accvgpr_write_b32 a81, 0
    v_mfma_f32_16x16x32_bf16 v[40:43], v[160:163], v[212:215], v[40:43]
    v_accvgpr_write_b32 a82, 0
    v_accvgpr_write_b32 a83, 0
    v_mfma_f32_16x16x32_bf16 v[96:99], v[160:163], v[216:219], v[96:99]
    v_accvgpr_write_b32 a84, 0
    v_accvgpr_write_b32 a85, 0
    v_mfma_f32_16x16x32_bf16 v[104:107], v[160:163], v[220:223], v[104:107]
    v_accvgpr_write_b32 a86, 0
    s_barrier
    v_mfma_f32_16x16x32_bf16 v[36:39], v[164:167], v[208:211], v[36:39]
    ds_read_b64_tr_b16 v[160:161], v24 offset:16384
    v_accvgpr_write_b32 a87, 0
    v_mfma_f32_16x16x32_bf16 v[44:47], v[164:167], v[212:215], v[44:47]
    s_add_u32 s97, s76, 49152
    ds_read_b64_tr_b16 v[162:163], v24 offset:17408
    v_accvgpr_write_b32 a88, 0
    v_mfma_f32_16x16x32_bf16 v[100:103], v[164:167], v[216:219], v[100:103]
    s_waitcnt lgkmcnt(10)
    buffer_load_dwordx4 v[192:195], v9, s[16:19], s97 offen offset:0 sc1
    v_mfma_f32_16x16x32_bf16 v[108:111], v[164:167], v[220:223], v[108:111]
    v_mfma_f32_16x16x32_bf16 v[48:51], v[168:171], v[208:211], v[48:51]
    ds_read_b64_tr_b16 v[164:165], v25 offset:16384
    v_accvgpr_write_b32 a89, 0
    v_accvgpr_write_b32 a90, 0
    v_mfma_f32_16x16x32_bf16 v[56:59], v[168:171], v[212:215], v[56:59]
    ds_read_b64_tr_b16 v[166:167], v25 offset:17408
    v_accvgpr_write_b32 a91, 0
    v_mfma_f32_16x16x32_bf16 v[112:115], v[168:171], v[216:219], v[112:115]
    buffer_load_dwordx4 v[196:199], v9, s[16:19], s97 offen offset:256 sc1
    v_mfma_f32_16x16x32_bf16 v[120:123], v[168:171], v[220:223], v[120:123]
    s_add_u32 m0, s98, 147456
    s_add_u32 s96, s73, 6291456
    buffer_load_dwordx4 v12, s[24:27], s96 offen offset:0 lds
    v_mfma_f32_16x16x32_bf16 v[52:55], v[172:175], v[208:211], v[52:55]
    ds_read_b64_tr_b16 v[168:169], v26 offset:16384
    v_mfma_f32_16x16x32_bf16 v[60:63], v[172:175], v[212:215], v[60:63]
    ds_read_b64_tr_b16 v[170:171], v26 offset:17408
    v_mfma_f32_16x16x32_bf16 v[116:119], v[172:175], v[216:219], v[116:119]
    s_waitcnt lgkmcnt(10)
    buffer_load_dwordx4 v13, s[24:27], s96 offen offset:1024 lds
    v_mfma_f32_16x16x32_bf16 v[124:127], v[172:175], v[220:223], v[124:127]
    v_mfma_f32_16x16x32_bf16 v[64:67], v[176:179], v[208:211], v[64:67]
    ds_read_b64_tr_b16 v[172:173], v27 offset:16384
    v_mfma_f32_16x16x32_bf16 v[72:75], v[176:179], v[212:215], v[72:75]
    ds_read_b64_tr_b16 v[174:175], v27 offset:17408
    v_accvgpr_write_b32 a92, 0
    v_mfma_f32_16x16x32_bf16 v[128:131], v[176:179], v[216:219], v[128:131]
    buffer_load_dwordx4 v14, s[24:27], s96 offen offset:2048 lds
    v_mfma_f32_16x16x32_bf16 v[136:139], v[176:179], v[220:223], v[136:139]
    buffer_load_dwordx4 v15, s[24:27], s96 offen offset:3072 lds
    v_mfma_f32_16x16x32_bf16 v[68:71], v[180:183], v[208:211], v[68:71]
    ds_read_b64_tr_b16 v[176:177], v28 offset:16384
    v_mfma_f32_16x16x32_bf16 v[76:79], v[180:183], v[212:215], v[76:79]
    ds_read_b64_tr_b16 v[178:179], v28 offset:17408
    v_mfma_f32_16x16x32_bf16 v[132:135], v[180:183], v[216:219], v[132:135]
    s_waitcnt lgkmcnt(10)
    buffer_load_dwordx4 v[200:203], v10, s[16:19], s97 offen offset:0 sc1
    v_mfma_f32_16x16x32_bf16 v[140:143], v[180:183], v[220:223], v[140:143]
    v_mfma_f32_16x16x32_bf16 v[80:83], v[184:187], v[208:211], v[80:83]
    ds_read_b64_tr_b16 v[180:181], v29 offset:16384
    v_mfma_f32_16x16x32_bf16 v[88:91], v[184:187], v[212:215], v[88:91]
    ds_read_b64_tr_b16 v[182:183], v29 offset:17408
    v_accvgpr_write_b32 a93, 0
    v_accvgpr_write_b32 a94, 0
    v_mfma_f32_16x16x32_bf16 v[144:147], v[184:187], v[216:219], v[144:147]
    buffer_load_dwordx4 v[204:207], v10, s[16:19], s97 offen offset:256 sc1
    v_mfma_f32_16x16x32_bf16 v[152:155], v[184:187], v[220:223], v[152:155]
    v_mfma_f32_16x16x32_bf16 v[84:87], v[188:191], v[208:211], v[84:87]
    ds_read_b64_tr_b16 v[184:185], v30 offset:16384
    v_accvgpr_write_b32 a95, 0
    v_mfma_f32_16x16x32_bf16 v[92:95], v[188:191], v[212:215], v[92:95]
    ds_read_b64_tr_b16 v[186:187], v30 offset:17408
    v_mfma_f32_16x16x32_bf16 v[148:151], v[188:191], v[216:219], v[148:151]
    s_waitcnt vmcnt(12) lgkmcnt(10)
    buffer_store_dword v5, v11, s[16:19], 0 offen sc1
    v_mfma_f32_16x16x32_bf16 v[156:159], v[188:191], v[220:223], v[156:159]
    ds_read_b64_tr_b16 v[188:189], v31 offset:16384
    ds_read_b64_tr_b16 v[190:191], v31 offset:17408
    v_mfma_f32_16x16x32_bf16 v[32:35], v[160:163], v[224:227], v[32:35]
    s_add_u32 s97, s76, 49152
    v_accvgpr_write_b32 a96, 0
    v_mfma_f32_16x16x32_bf16 v[40:43], v[160:163], v[228:231], v[40:43]
    buffer_load_dwordx4 v[208:211], v9, s[16:19], s97 offen offset:2048 sc1
    v_mfma_f32_16x16x32_bf16 v[96:99], v[160:163], v[232:235], v[96:99]
    v_mfma_f32_16x16x32_bf16 v[104:107], v[160:163], v[236:239], v[104:107]
    v_accvgpr_write_b32 a97, 0
    v_mfma_f32_16x16x32_bf16 v[36:39], v[164:167], v[224:227], v[36:39]
    ds_read_b64_tr_b16 v[160:161], v24 offset:24576
    v_accvgpr_write_b32 a98, 0
    v_mfma_f32_16x16x32_bf16 v[44:47], v[164:167], v[228:231], v[44:47]
    ds_read_b64_tr_b16 v[162:163], v24 offset:25600
    v_mfma_f32_16x16x32_bf16 v[100:103], v[164:167], v[232:235], v[100:103]
    s_waitcnt lgkmcnt(10)
    v_accvgpr_write_b32 a99, 0
    v_accvgpr_write_b32 a100, 0
    v_mfma_f32_16x16x32_bf16 v[108:111], v[164:167], v[236:239], v[108:111]
    v_accvgpr_write_b32 a101, 0
    v_mfma_f32_16x16x32_bf16 v[48:51], v[168:171], v[224:227], v[48:51]
    ds_read_b64_tr_b16 v[164:165], v25 offset:24576
    v_mfma_f32_16x16x32_bf16 v[56:59], v[168:171], v[228:231], v[56:59]
    ds_read_b64_tr_b16 v[166:167], v25 offset:25600
    v_accvgpr_write_b32 a102, 0
    v_mfma_f32_16x16x32_bf16 v[112:115], v[168:171], v[232:235], v[112:115]
    buffer_load_dwordx4 v[212:215], v9, s[16:19], s97 offen offset:2304 sc1
    v_mfma_f32_16x16x32_bf16 v[120:123], v[168:171], v[236:239], v[120:123]
    v_mfma_f32_16x16x32_bf16 v[52:55], v[172:175], v[224:227], v[52:55]
    ds_read_b64_tr_b16 v[168:169], v26 offset:24576
    v_mfma_f32_16x16x32_bf16 v[60:63], v[172:175], v[228:231], v[60:63]
    ds_read_b64_tr_b16 v[170:171], v26 offset:25600
    v_mfma_f32_16x16x32_bf16 v[116:119], v[172:175], v[232:235], v[116:119]
    s_waitcnt lgkmcnt(10)
    v_accvgpr_write_b32 a103, 0
    v_accvgpr_write_b32 a104, 0
    v_mfma_f32_16x16x32_bf16 v[124:127], v[172:175], v[236:239], v[124:127]
    v_accvgpr_write_b32 a105, 0
    v_mfma_f32_16x16x32_bf16 v[64:67], v[176:179], v[224:227], v[64:67]
    ds_read_b64_tr_b16 v[172:173], v27 offset:24576
    v_mfma_f32_16x16x32_bf16 v[72:75], v[176:179], v[228:231], v[72:75]
    ds_read_b64_tr_b16 v[174:175], v27 offset:25600
    v_accvgpr_write_b32 a106, 0
    v_mfma_f32_16x16x32_bf16 v[128:131], v[176:179], v[232:235], v[128:131]
    buffer_load_dwordx4 v[216:219], v10, s[16:19], s97 offen offset:2048 sc1
    v_mfma_f32_16x16x32_bf16 v[136:139], v[176:179], v[236:239], v[136:139]
    v_mfma_f32_16x16x32_bf16 v[68:71], v[180:183], v[224:227], v[68:71]
    ds_read_b64_tr_b16 v[176:177], v28 offset:24576
    v_mfma_f32_16x16x32_bf16 v[76:79], v[180:183], v[228:231], v[76:79]
    ds_read_b64_tr_b16 v[178:179], v28 offset:25600
    v_mfma_f32_16x16x32_bf16 v[132:135], v[180:183], v[232:235], v[132:135]
    s_waitcnt lgkmcnt(10)
    v_accvgpr_write_b32 a107, 0
    v_accvgpr_write_b32 a108, 0
    v_mfma_f32_16x16x32_bf16 v[140:143], v[180:183], v[236:239], v[140:143]
    buffer_load_dwordx4 v[220:223], v10, s[16:19], s97 offen offset:2304 sc1
    v_mfma_f32_16x16x32_bf16 v[80:83], v[184:187], v[224:227], v[80:83]
    ds_read_b64_tr_b16 v[180:181], v29 offset:24576
    v_mfma_f32_16x16x32_bf16 v[88:91], v[184:187], v[228:231], v[88:91]
    ds_read_b64_tr_b16 v[182:183], v29 offset:25600
    v_mfma_f32_16x16x32_bf16 v[144:147], v[184:187], v[232:235], v[144:147]
    v_mfma_f32_16x16x32_bf16 v[152:155], v[184:187], v[236:239], v[152:155]
    v_accvgpr_write_b32 a109, 0
    v_mfma_f32_16x16x32_bf16 v[84:87], v[188:191], v[224:227], v[84:87]
    ds_read_b64_tr_b16 v[184:185], v30 offset:24576
    v_accvgpr_write_b32 a110, 0
    v_mfma_f32_16x16x32_bf16 v[92:95], v[188:191], v[228:231], v[92:95]
    ds_read_b64_tr_b16 v[186:187], v30 offset:25600
    v_mfma_f32_16x16x32_bf16 v[148:151], v[188:191], v[232:235], v[148:151]
    s_waitcnt vmcnt(13) lgkmcnt(10)
    v_accvgpr_write_b32 a111, 0
    v_mfma_f32_16x16x32_bf16 v[156:159], v[188:191], v[236:239], v[156:159]
    ds_read_b64_tr_b16 v[188:189], v31 offset:24576
    ds_read_b64_tr_b16 v[190:191], v31 offset:25600
    v_mfma_f32_16x16x32_bf16 v[32:35], v[160:163], v[240:243], v[32:35]
    v_accvgpr_write_b32 a112, 0
    v_accvgpr_write_b32 a113, 0
    v_mfma_f32_16x16x32_bf16 v[40:43], v[160:163], v[244:247], v[40:43]
    v_accvgpr_write_b32 a114, 0
    v_accvgpr_write_b32 a115, 0
    v_mfma_f32_16x16x32_bf16 v[96:99], v[160:163], v[248:251], v[96:99]
    v_accvgpr_write_b32 a116, 0
    v_accvgpr_write_b32 a117, 0
    v_mfma_f32_16x16x32_bf16 v[104:107], v[160:163], v[252:255], v[104:107]
    s_barrier
    v_mfma_f32_16x16x32_bf16 v[36:39], v[164:167], v[240:243], v[36:39]
    ds_read_b64_tr_b16 v[160:161], v24 offset:32768
    v_accvgpr_write_b32 a118, 0
    v_mfma_f32_16x16x32_bf16 v[44:47], v[164:167], v[244:247], v[44:47]
    s_add_u32 s97, s77, 49152
    ds_read_b64_tr_b16 v[162:163], v24 offset:33792
    v_accvgpr_write_b32 a119, 0
    v_mfma_f32_16x16x32_bf16 v[100:103], v[164:167], v[248:251], v[100:103]
    s_waitcnt lgkmcnt(10)
    buffer_load_dwordx4 v[224:227], v9, s[16:19], s97 offen offset:0 sc1
    v_mfma_f32_16x16x32_bf16 v[108:111], v[164:167], v[252:255], v[108:111]
    v_accvgpr_write_b32 a120, 0
    v_mfma_f32_16x16x32_bf16 v[48:51], v[168:171], v[240:243], v[48:51]
    ds_read_b64_tr_b16 v[164:165], v25 offset:32768
    v_accvgpr_write_b32 a121, 0
    v_mfma_f32_16x16x32_bf16 v[56:59], v[168:171], v[244:247], v[56:59]
    ds_read_b64_tr_b16 v[166:167], v25 offset:33792
    v_accvgpr_write_b32 a122, 0
    v_mfma_f32_16x16x32_bf16 v[112:115], v[168:171], v[248:251], v[112:115]
    buffer_load_dwordx4 v[228:231], v9, s[16:19], s97 offen offset:256 sc1
    v_mfma_f32_16x16x32_bf16 v[120:123], v[168:171], v[252:255], v[120:123]
    v_mfma_f32_16x16x32_bf16 v[52:55], v[172:175], v[240:243], v[52:55]
    ds_read_b64_tr_b16 v[168:169], v26 offset:32768
    v_accvgpr_write_b32 a123, 0
    v_mfma_f32_16x16x32_bf16 v[60:63], v[172:175], v[244:247], v[60:63]
    s_add_u32 m0, s98, 98304
    s_add_u32 s96, s74, 6291456
    ds_read_b64_tr_b16 v[170:171], v26 offset:33792
    v_mfma_f32_16x16x32_bf16 v[116:119], v[172:175], v[248:251], v[116:119]
    s_waitcnt lgkmcnt(10)
    buffer_load_dwordx4 v12, s[24:27], s96 offen offset:0 lds
    v_mfma_f32_16x16x32_bf16 v[124:127], v[172:175], v[252:255], v[124:127]
    buffer_load_dwordx4 v13, s[24:27], s96 offen offset:1024 lds
    v_mfma_f32_16x16x32_bf16 v[64:67], v[176:179], v[240:243], v[64:67]
    ds_read_b64_tr_b16 v[172:173], v27 offset:32768
    v_mfma_f32_16x16x32_bf16 v[72:75], v[176:179], v[244:247], v[72:75]
    ds_read_b64_tr_b16 v[174:175], v27 offset:33792
    v_mfma_f32_16x16x32_bf16 v[128:131], v[176:179], v[248:251], v[128:131]
    buffer_load_dwordx4 v14, s[24:27], s96 offen offset:2048 lds
    v_mfma_f32_16x16x32_bf16 v[136:139], v[176:179], v[252:255], v[136:139]
    v_mfma_f32_16x16x32_bf16 v[68:71], v[180:183], v[240:243], v[68:71]
    ds_read_b64_tr_b16 v[176:177], v28 offset:32768
    v_mfma_f32_16x16x32_bf16 v[76:79], v[180:183], v[244:247], v[76:79]
    ds_read_b64_tr_b16 v[178:179], v28 offset:33792
    v_accvgpr_write_b32 a124, 0
    v_mfma_f32_16x16x32_bf16 v[132:135], v[180:183], v[248:251], v[132:135]
    s_waitcnt lgkmcnt(10)
    buffer_load_dwordx4 v15, s[24:27], s96 offen offset:3072 lds
    v_mfma_f32_16x16x32_bf16 v[140:143], v[180:183], v[252:255], v[140:143]
    v_mfma_f32_16x16x32_bf16 v[80:83], v[184:187], v[240:243], v[80:83]
    ds_read_b64_tr_b16 v[180:181], v29 offset:32768
    v_accvgpr_write_b32 a125, 0
    v_mfma_f32_16x16x32_bf16 v[88:91], v[184:187], v[244:247], v[88:91]
    ds_read_b64_tr_b16 v[182:183], v29 offset:33792
    v_accvgpr_write_b32 a126, 0
    v_mfma_f32_16x16x32_bf16 v[144:147], v[184:187], v[248:251], v[144:147]
    buffer_load_dwordx4 v[232:235], v10, s[16:19], s97 offen offset:0 sc1
    v_mfma_f32_16x16x32_bf16 v[152:155], v[184:187], v[252:255], v[152:155]
    buffer_load_dwordx4 v[236:239], v10, s[16:19], s97 offen offset:256 sc1
    v_mfma_f32_16x16x32_bf16 v[84:87], v[188:191], v[240:243], v[84:87]
    ds_read_b64_tr_b16 v[184:185], v30 offset:32768
    v_mfma_f32_16x16x32_bf16 v[92:95], v[188:191], v[244:247], v[92:95]
    ds_read_b64_tr_b16 v[186:187], v30 offset:33792
    v_mfma_f32_16x16x32_bf16 v[148:151], v[188:191], v[248:251], v[148:151]
    s_waitcnt vmcnt(13) lgkmcnt(10)
    v_accvgpr_write_b32 a127, 0
    v_mfma_f32_16x16x32_bf16 v[156:159], v[188:191], v[252:255], v[156:159]
    ds_read_b64_tr_b16 v[188:189], v31 offset:32768
    ds_read_b64_tr_b16 v[190:191], v31 offset:33792
    v_mfma_f32_16x16x32_bf16 v[32:35], v[160:163], v[192:195], v[32:35]
    s_add_u32 s97, s77, 49152
    v_mfma_f32_16x16x32_bf16 v[40:43], v[160:163], v[196:199], v[40:43]
    buffer_load_dwordx4 v[240:243], v9, s[16:19], s97 offen offset:2048 sc1
    v_mfma_f32_16x16x32_bf16 v[96:99], v[160:163], v[200:203], v[96:99]
    v_mfma_f32_16x16x32_bf16 v[104:107], v[160:163], v[204:207], v[104:107]
    v_mfma_f32_16x16x32_bf16 v[36:39], v[164:167], v[192:195], v[36:39]
    ds_read_b64_tr_b16 v[160:161], v24 offset:40960
    v_mfma_f32_16x16x32_bf16 v[44:47], v[164:167], v[196:199], v[44:47]
    ds_read_b64_tr_b16 v[162:163], v24 offset:41984
    v_mfma_f32_16x16x32_bf16 v[100:103], v[164:167], v[200:203], v[100:103]
    s_waitcnt lgkmcnt(10)
    v_mfma_f32_16x16x32_bf16 v[108:111], v[164:167], v[204:207], v[108:111]
    buffer_load_dwordx4 v[244:247], v9, s[16:19], s97 offen offset:2304 sc1
    v_mfma_f32_16x16x32_bf16 v[48:51], v[168:171], v[192:195], v[48:51]
    ds_read_b64_tr_b16 v[164:165], v25 offset:40960
    v_mfma_f32_16x16x32_bf16 v[56:59], v[168:171], v[196:199], v[56:59]
    ds_read_b64_tr_b16 v[166:167], v25 offset:41984
    v_mfma_f32_16x16x32_bf16 v[112:115], v[168:171], v[200:203], v[112:115]
    v_mfma_f32_16x16x32_bf16 v[120:123], v[168:171], v[204:207], v[120:123]
    v_mfma_f32_16x16x32_bf16 v[52:55], v[172:175], v[192:195], v[52:55]
    ds_read_b64_tr_b16 v[168:169], v26 offset:40960
    v_mfma_f32_16x16x32_bf16 v[60:63], v[172:175], v[196:199], v[60:63]
    ds_read_b64_tr_b16 v[170:171], v26 offset:41984
    v_mfma_f32_16x16x32_bf16 v[116:119], v[172:175], v[200:203], v[116:119]
    s_waitcnt lgkmcnt(10)
    buffer_load_dwordx4 v[248:251], v10, s[16:19], s97 offen offset:2048 sc1
    v_mfma_f32_16x16x32_bf16 v[124:127], v[172:175], v[204:207], v[124:127]
    v_mfma_f32_16x16x32_bf16 v[64:67], v[176:179], v[192:195], v[64:67]
    ds_read_b64_tr_b16 v[172:173], v27 offset:40960
    v_mfma_f32_16x16x32_bf16 v[72:75], v[176:179], v[196:199], v[72:75]
    ds_read_b64_tr_b16 v[174:175], v27 offset:41984
    v_mfma_f32_16x16x32_bf16 v[128:131], v[176:179], v[200:203], v[128:131]
    v_mfma_f32_16x16x32_bf16 v[136:139], v[176:179], v[204:207], v[136:139]
    buffer_load_dwordx4 v[252:255], v10, s[16:19], s97 offen offset:2304 sc1
    v_mfma_f32_16x16x32_bf16 v[68:71], v[180:183], v[192:195], v[68:71]
    ds_read_b64_tr_b16 v[176:177], v28 offset:40960
    v_mfma_f32_16x16x32_bf16 v[76:79], v[180:183], v[196:199], v[76:79]
    ds_read_b64_tr_b16 v[178:179], v28 offset:41984
    v_mfma_f32_16x16x32_bf16 v[132:135], v[180:183], v[200:203], v[132:135]
    s_waitcnt lgkmcnt(10)
    v_mfma_f32_16x16x32_bf16 v[140:143], v[180:183], v[204:207], v[140:143]
    v_mfma_f32_16x16x32_bf16 v[80:83], v[184:187], v[192:195], v[80:83]
    ds_read_b64_tr_b16 v[180:181], v29 offset:40960
    v_mfma_f32_16x16x32_bf16 v[88:91], v[184:187], v[196:199], v[88:91]
    ds_read_b64_tr_b16 v[182:183], v29 offset:41984
    v_mfma_f32_16x16x32_bf16 v[144:147], v[184:187], v[200:203], v[144:147]
    s_getpc_b64 s[62:63]
ct_3:
    s_add_u32 s62, s62, fk_a0-ct_3
    s_addc_u32 s63, s63, 0
    s_lshr_b32 s58, s2, 3
    s_lshl_b32 s58, s58, 10
    v_and_b32 v4, 7, v0
    v_lshl_add_u32 v4, v4, 7, s58
    v_min_u32 v4, fk_fbstart-fk_a0-4, v4
    global_load_dword v4, v4, s[62:63]
    v_mfma_f32_16x16x32_bf16 v[152:155], v[184:187], v[204:207], v[152:155]
    v_mfma_f32_16x16x32_bf16 v[84:87], v[188:191], v[192:195], v[84:87]
    ds_read_b64_tr_b16 v[184:185], v30 offset:40960
    v_mfma_f32_16x16x32_bf16 v[92:95], v[188:191], v[196:199], v[92:95]
    ds_read_b64_tr_b16 v[186:187], v30 offset:41984
    v_mfma_f32_16x16x32_bf16 v[148:151], v[188:191], v[200:203], v[148:151]
    s_waitcnt vmcnt(13) lgkmcnt(10)
    v_mfma_f32_16x16x32_bf16 v[156:159], v[188:191], v[204:207], v[156:159]
    ds_read_b64_tr_b16 v[188:189], v31 offset:40960
    ds_read_b64_tr_b16 v[190:191], v31 offset:41984
    v_mfma_f32_16x16x32_bf16 v[32:35], v[160:163], v[208:211], v[32:35]
    v_mfma_f32_16x16x32_bf16 v[40:43], v[160:163], v[212:215], v[40:43]
    v_mfma_f32_16x16x32_bf16 v[96:99], v[160:163], v[216:219], v[96:99]
    v_mfma_f32_16x16x32_bf16 v[104:107], v[160:163], v[220:223], v[104:107]
    s_barrier
    v_mfma_f32_16x16x32_bf16 v[36:39], v[164:167], v[208:211], v[36:39]
    ds_read_b64_tr_b16 v[160:161], v24 offset:49152
    v_mfma_f32_16x16x32_bf16 v[44:47], v[164:167], v[212:215], v[44:47]
    s_add_u32 s97, s78, 49152
    ds_read_b64_tr_b16 v[162:163], v24 offset:50176
    v_mfma_f32_16x16x32_bf16 v[100:103], v[164:167], v[216:219], v[100:103]
    s_waitcnt lgkmcnt(10)
    buffer_load_dwordx4 v[192:195], v9, s[16:19], s97 offen offset:0 sc1
    v_mfma_f32_16x16x32_bf16 v[108:111], v[164:167], v[220:223], v[108:111]
    v_mfma_f32_16x16x32_bf16 v[48:51], v[168:171], v[208:211], v[48:51]
    ds_read_b64_tr_b16 v[164:165], v25 offset:49152
    v_mfma_f32_16x16x32_bf16 v[56:59], v[168:171], v[212:215], v[56:59]
    ds_read_b64_tr_b16 v[166:167], v25 offset:50176
    v_mfma_f32_16x16x32_bf16 v[112:115], v[168:171], v[216:219], v[112:115]
    buffer_load_dwordx4 v[196:199], v9, s[16:19], s97 offen offset:256 sc1
    v_mfma_f32_16x16x32_bf16 v[120:123], v[168:171], v[220:223], v[120:123]
    v_mfma_f32_16x16x32_bf16 v[52:55], v[172:175], v[208:211], v[52:55]
    ds_read_b64_tr_b16 v[168:169], v26 offset:49152
    v_mfma_f32_16x16x32_bf16 v[60:63], v[172:175], v[212:215], v[60:63]
    s_add_u32 m0, s98, 114688
    s_add_u32 s96, s75, 6291456
    ds_read_b64_tr_b16 v[170:171], v26 offset:50176
    v_mfma_f32_16x16x32_bf16 v[116:119], v[172:175], v[216:219], v[116:119]
    s_waitcnt lgkmcnt(10)
    buffer_load_dwordx4 v12, s[24:27], s96 offen offset:0 lds
    v_mfma_f32_16x16x32_bf16 v[124:127], v[172:175], v[220:223], v[124:127]
    buffer_load_dwordx4 v13, s[24:27], s96 offen offset:1024 lds
    v_mfma_f32_16x16x32_bf16 v[64:67], v[176:179], v[208:211], v[64:67]
    ds_read_b64_tr_b16 v[172:173], v27 offset:49152
    v_mfma_f32_16x16x32_bf16 v[72:75], v[176:179], v[212:215], v[72:75]
    ds_read_b64_tr_b16 v[174:175], v27 offset:50176
    v_mfma_f32_16x16x32_bf16 v[128:131], v[176:179], v[216:219], v[128:131]
    buffer_load_dwordx4 v14, s[24:27], s96 offen offset:2048 lds
    v_mfma_f32_16x16x32_bf16 v[136:139], v[176:179], v[220:223], v[136:139]
    v_mfma_f32_16x16x32_bf16 v[68:71], v[180:183], v[208:211], v[68:71]
    ds_read_b64_tr_b16 v[176:177], v28 offset:49152
    v_mfma_f32_16x16x32_bf16 v[76:79], v[180:183], v[212:215], v[76:79]
    ds_read_b64_tr_b16 v[178:179], v28 offset:50176
    v_mfma_f32_16x16x32_bf16 v[132:135], v[180:183], v[216:219], v[132:135]
    s_waitcnt lgkmcnt(10)
    buffer_load_dwordx4 v15, s[24:27], s96 offen offset:3072 lds
    v_mfma_f32_16x16x32_bf16 v[140:143], v[180:183], v[220:223], v[140:143]
    v_mfma_f32_16x16x32_bf16 v[80:83], v[184:187], v[208:211], v[80:83]
    ds_read_b64_tr_b16 v[180:181], v29 offset:49152
    v_mfma_f32_16x16x32_bf16 v[88:91], v[184:187], v[212:215], v[88:91]
    ds_read_b64_tr_b16 v[182:183], v29 offset:50176
    v_mfma_f32_16x16x32_bf16 v[144:147], v[184:187], v[216:219], v[144:147]
    buffer_load_dwordx4 v[200:203], v10, s[16:19], s97 offen offset:0 sc1
    v_mfma_f32_16x16x32_bf16 v[152:155], v[184:187], v[220:223], v[152:155]
    buffer_load_dwordx4 v[204:207], v10, s[16:19], s97 offen offset:256 sc1
    v_mfma_f32_16x16x32_bf16 v[84:87], v[188:191], v[208:211], v[84:87]
    ds_read_b64_tr_b16 v[184:185], v30 offset:49152
    v_mfma_f32_16x16x32_bf16 v[92:95], v[188:191], v[212:215], v[92:95]
    ds_read_b64_tr_b16 v[186:187], v30 offset:50176
    v_mfma_f32_16x16x32_bf16 v[148:151], v[188:191], v[216:219], v[148:151]
    s_waitcnt vmcnt(13) lgkmcnt(10)
    v_mfma_f32_16x16x32_bf16 v[156:159], v[188:191], v[220:223], v[156:159]
    ds_read_b64_tr_b16 v[188:189], v31 offset:49152
    ds_read_b64_tr_b16 v[190:191], v31 offset:50176
    v_mfma_f32_16x16x32_bf16 v[32:35], v[160:163], v[224:227], v[32:35]
    s_add_u32 s97, s78, 49152
    v_mfma_f32_16x16x32_bf16 v[40:43], v[160:163], v[228:231], v[40:43]
    buffer_load_dwordx4 v[208:211], v9, s[16:19], s97 offen offset:2048 sc1
    v_mfma_f32_16x16x32_bf16 v[96:99], v[160:163], v[232:235], v[96:99]
    v_mfma_f32_16x16x32_bf16 v[104:107], v[160:163], v[236:239], v[104:107]
    v_mfma_f32_16x16x32_bf16 v[36:39], v[164:167], v[224:227], v[36:39]
    ds_read_b64_tr_b16 v[160:161], v24 offset:57344
    v_mfma_f32_16x16x32_bf16 v[44:47], v[164:167], v[228:231], v[44:47]
    ds_read_b64_tr_b16 v[162:163], v24 offset:58368
    v_mfma_f32_16x16x32_bf16 v[100:103], v[164:167], v[232:235], v[100:103]
    s_waitcnt lgkmcnt(10)
    v_mfma_f32_16x16x32_bf16 v[108:111], v[164:167], v[236:239], v[108:111]
    v_mfma_f32_16x16x32_bf16 v[48:51], v[168:171], v[224:227], v[48:51]
    ds_read_b64_tr_b16 v[164:165], v25 offset:57344
    v_mfma_f32_16x16x32_bf16 v[56:59], v[168:171], v[228:231], v[56:59]
    ds_read_b64_tr_b16 v[166:167], v25 offset:58368
    v_mfma_f32_16x16x32_bf16 v[112:115], v[168:171], v[232:235], v[112:115]
    buffer_load_dwordx4 v[212:215], v9, s[16:19], s97 offen offset:2304 sc1
    v_mfma_f32_16x16x32_bf16 v[120:123], v[168:171], v[236:239], v[120:123]
    v_mfma_f32_16x16x32_bf16 v[52:55], v[172:175], v[224:227], v[52:55]
    ds_read_b64_tr_b16 v[168:169], v26 offset:57344
    v_mfma_f32_16x16x32_bf16 v[60:63], v[172:175], v[228:231], v[60:63]
    ds_read_b64_tr_b16 v[170:171], v26 offset:58368
    v_mfma_f32_16x16x32_bf16 v[116:119], v[172:175], v[232:235], v[116:119]
    s_waitcnt lgkmcnt(10)
    v_mfma_f32_16x16x32_bf16 v[124:127], v[172:175], v[236:239], v[124:127]
    v_mfma_f32_16x16x32_bf16 v[64:67], v[176:179], v[224:227], v[64:67]
    ds_read_b64_tr_b16 v[172:173], v27 offset:57344
    v_mfma_f32_16x16x32_bf16 v[72:75], v[176:179], v[228:231], v[72:75]
    ds_read_b64_tr_b16 v[174:175], v27 offset:58368
    v_mfma_f32_16x16x32_bf16 v[128:131], v[176:179], v[232:235], v[128:131]
    buffer_load_dwordx4 v[216:219], v10, s[16:19], s97 offen offset:2048 sc1
    v_mfma_f32_16x16x32_bf16 v[136:139], v[176:179], v[236:239], v[136:139]
    v_mfma_f32_16x16x32_bf16 v[68:71], v[180:183], v[224:227], v[68:71]
    ds_read_b64_tr_b16 v[176:177], v28 offset:57344
    v_mfma_f32_16x16x32_bf16 v[76:79], v[180:183], v[228:231], v[76:79]
    ds_read_b64_tr_b16 v[178:179], v28 offset:58368
    v_mfma_f32_16x16x32_bf16 v[132:135], v[180:183], v[232:235], v[132:135]
    s_waitcnt lgkmcnt(10)
    v_mfma_f32_16x16x32_bf16 v[140:143], v[180:183], v[236:239], v[140:143]
    buffer_load_dwordx4 v[220:223], v10, s[16:19], s97 offen offset:2304 sc1
    v_mfma_f32_16x16x32_bf16 v[80:83], v[184:187], v[224:227], v[80:83]
    ds_read_b64_tr_b16 v[180:181], v29 offset:57344
    v_mfma_f32_16x16x32_bf16 v[88:91], v[184:187], v[228:231], v[88:91]
    ds_read_b64_tr_b16 v[182:183], v29 offset:58368
    v_mfma_f32_16x16x32_bf16 v[144:147], v[184:187], v[232:235], v[144:147]
    v_mfma_f32_16x16x32_bf16 v[152:155], v[184:187], v[236:239], v[152:155]
    v_mfma_f32_16x16x32_bf16 v[84:87], v[188:191], v[224:227], v[84:87]
    ds_read_b64_tr_b16 v[184:185], v30 offset:57344
    v_mfma_f32_16x16x32_bf16 v[92:95], v[188:191], v[228:231], v[92:95]
    ds_read_b64_tr_b16 v[186:187], v30 offset:58368
    v_mfma_f32_16x16x32_bf16 v[148:151], v[188:191], v[232:235], v[148:151]
    s_waitcnt vmcnt(13) lgkmcnt(10)
    v_mfma_f32_16x16x32_bf16 v[156:159], v[188:191], v[236:239], v[156:159]
    ds_read_b64_tr_b16 v[188:189], v31 offset:57344
    ds_read_b64_tr_b16 v[190:191], v31 offset:58368
    v_mfma_f32_16x16x32_bf16 v[32:35], v[160:163], v[240:243], v[32:35]
    v_mfma_f32_16x16x32_bf16 v[40:43], v[160:163], v[244:247], v[40:43]
    v_mfma_f32_16x16x32_bf16 v[96:99], v[160:163], v[248:251], v[96:99]
    v_mfma_f32_16x16x32_bf16 v[104:107], v[160:163], v[252:255], v[104:107]
    s_barrier
    v_mfma_f32_16x16x32_bf16 v[36:39], v[164:167], v[240:243], v[36:39]
    ds_read_b64_tr_b16 v[160:161], v24 offset:0
    v_mfma_f32_16x16x32_bf16 v[44:47], v[164:167], v[244:247], v[44:47]
    s_add_u32 s97, s79, 49152
    ds_read_b64_tr_b16 v[162:163], v24 offset:1024
    v_mfma_f32_16x16x32_bf16 v[100:103], v[164:167], v[248:251], v[100:103]
    s_waitcnt lgkmcnt(10)
    buffer_load_dwordx4 v[224:227], v9, s[16:19], s97 offen offset:0 sc1
    v_mfma_f32_16x16x32_bf16 v[108:111], v[164:167], v[252:255], v[108:111]
    v_mfma_f32_16x16x32_bf16 v[48:51], v[168:171], v[240:243], v[48:51]
    ds_read_b64_tr_b16 v[164:165], v25 offset:0
    v_mfma_f32_16x16x32_bf16 v[56:59], v[168:171], v[244:247], v[56:59]
    ds_read_b64_tr_b16 v[166:167], v25 offset:1024
    v_mfma_f32_16x16x32_bf16 v[112:115], v[168:171], v[248:251], v[112:115]
    v_mfma_f32_16x16x32_bf16 v[120:123], v[168:171], v[252:255], v[120:123]
    buffer_load_dwordx4 v[228:231], v9, s[16:19], s97 offen offset:256 sc1
    v_mfma_f32_16x16x32_bf16 v[52:55], v[172:175], v[240:243], v[52:55]
    ds_read_b64_tr_b16 v[168:169], v26 offset:0
    v_mfma_f32_16x16x32_bf16 v[60:63], v[172:175], v[244:247], v[60:63]
    ds_read_b64_tr_b16 v[170:171], v26 offset:1024
    v_mfma_f32_16x16x32_bf16 v[116:119], v[172:175], v[248:251], v[116:119]
    s_waitcnt lgkmcnt(10)
    v_mfma_f32_16x16x32_bf16 v[124:127], v[172:175], v[252:255], v[124:127]
    v_mfma_f32_16x16x32_bf16 v[64:67], v[176:179], v[240:243], v[64:67]
    ds_read_b64_tr_b16 v[172:173], v27 offset:0
    v_mfma_f32_16x16x32_bf16 v[72:75], v[176:179], v[244:247], v[72:75]
    ds_read_b64_tr_b16 v[174:175], v27 offset:1024
    v_mfma_f32_16x16x32_bf16 v[128:131], v[176:179], v[248:251], v[128:131]
    buffer_load_dwordx4 v[232:235], v10, s[16:19], s97 offen offset:0 sc1
    v_mfma_f32_16x16x32_bf16 v[136:139], v[176:179], v[252:255], v[136:139]
    v_mfma_f32_16x16x32_bf16 v[68:71], v[180:183], v[240:243], v[68:71]
    ds_read_b64_tr_b16 v[176:177], v28 offset:0
    v_mfma_f32_16x16x32_bf16 v[76:79], v[180:183], v[244:247], v[76:79]
    ds_read_b64_tr_b16 v[178:179], v28 offset:1024
    v_mfma_f32_16x16x32_bf16 v[132:135], v[180:183], v[248:251], v[132:135]
    s_waitcnt lgkmcnt(10)
    buffer_load_dwordx4 v[236:239], v10, s[16:19], s97 offen offset:256 sc1
    v_mfma_f32_16x16x32_bf16 v[140:143], v[180:183], v[252:255], v[140:143]
    v_mfma_f32_16x16x32_bf16 v[80:83], v[184:187], v[240:243], v[80:83]
    ds_read_b64_tr_b16 v[180:181], v29 offset:0
    v_mfma_f32_16x16x32_bf16 v[88:91], v[184:187], v[244:247], v[88:91]
    ds_read_b64_tr_b16 v[182:183], v29 offset:1024
    v_mfma_f32_16x16x32_bf16 v[144:147], v[184:187], v[248:251], v[144:147]
    buffer_load_dword v7, v6, s[16:19], 0 offen sc1
    v_mfma_f32_16x16x32_bf16 v[152:155], v[184:187], v[252:255], v[152:155]
    v_mfma_f32_16x16x32_bf16 v[84:87], v[188:191], v[240:243], v[84:87]
    ds_read_b64_tr_b16 v[184:185], v30 offset:0
    v_mfma_f32_16x16x32_bf16 v[92:95], v[188:191], v[244:247], v[92:95]
    ds_read_b64_tr_b16 v[186:187], v30 offset:1024
    v_mfma_f32_16x16x32_bf16 v[148:151], v[188:191], v[248:251], v[148:151]
    s_waitcnt vmcnt(9) lgkmcnt(10)
    v_mfma_f32_16x16x32_bf16 v[156:159], v[188:191], v[252:255], v[156:159]
    ds_read_b64_tr_b16 v[188:189], v31 offset:0
    ds_read_b64_tr_b16 v[190:191], v31 offset:1024
    v_mfma_f32_16x16x32_bf16 v[32:35], v[160:163], v[192:195], v[32:35]
    s_add_u32 s97, s79, 49152
    s_mov_b32 s20, 0x49800000
    s_mov_b32 s22, 0xbf800000
    v_mfma_f32_16x16x32_bf16 v[40:43], v[160:163], v[196:199], v[40:43]
    buffer_load_dwordx4 v[240:243], v9, s[16:19], s97 offen offset:2048 sc1
    v_mfma_f32_16x16x32_bf16 v[96:99], v[160:163], v[200:203], v[96:99]
    v_mfma_f32_16x16x32_bf16 v[104:107], v[160:163], v[204:207], v[104:107]
    s_lshl_b32 s23, s32, 13
    s_lshl_b32 s5, s33, 19
    v_mfma_f32_16x16x32_bf16 v[36:39], v[164:167], v[192:195], v[36:39]
    ds_read_b64_tr_b16 v[160:161], v24 offset:8192
    s_mov_b32 s4, 20955136
    v_mfma_f32_16x16x32_bf16 v[44:47], v[164:167], v[196:199], v[44:47]
    ds_read_b64_tr_b16 v[162:163], v24 offset:9216
    s_cmp_lt_u32 s32, 2
    v_mfma_f32_16x16x32_bf16 v[100:103], v[164:167], v[200:203], v[100:103]
    s_waitcnt lgkmcnt(10)
    s_cselect_b32 s4, 4218880, s4
    v_mfma_f32_16x16x32_bf16 v[108:111], v[164:167], v[204:207], v[108:111]
    s_add_u32 s46, s5, s4
    s_add_u32 s46, s46, s23
    v_mfma_f32_16x16x32_bf16 v[48:51], v[168:171], v[192:195], v[48:51]
    ds_read_b64_tr_b16 v[164:165], v25 offset:8192
    s_lshl_b32 s4, s35, 13
    v_mfma_f32_16x16x32_bf16 v[56:59], v[168:171], v[196:199], v[56:59]
    ds_read_b64_tr_b16 v[166:167], v25 offset:9216
    s_sub_u32 s4, s4, 16384
    v_mfma_f32_16x16x32_bf16 v[112:115], v[168:171], v[200:203], v[112:115]
    buffer_load_dwordx4 v[244:247], v9, s[16:19], s97 offen offset:2304 sc1
    v_mfma_f32_16x16x32_bf16 v[120:123], v[168:171], v[204:207], v[120:123]
    v_mfma_f32_16x16x32_bf16 v[52:55], v[172:175], v[192:195], v[52:55]
    ds_read_b64_tr_b16 v[168:169], v26 offset:8192
    s_add_u32 s47, s46, s4
    v_mfma_f32_16x16x32_bf16 v[60:63], v[172:175], v[196:199], v[60:63]
    ds_read_b64_tr_b16 v[170:171], v26 offset:9216
    s_add_u32 s100, s5, 4194304
    v_mfma_f32_16x16x32_bf16 v[116:119], v[172:175], v[200:203], v[116:119]
    s_waitcnt lgkmcnt(10)
    s_add_u32 s100, s100, s23
    s_add_u32 s101, s23, 65536
    v_mfma_f32_16x16x32_bf16 v[124:127], v[172:175], v[204:207], v[124:127]
    s_mov_b32 s39, s23
    s_cmp_eq_u32 s32, 1
    v_mfma_f32_16x16x32_bf16 v[64:67], v[176:179], v[192:195], v[64:67]
    ds_read_b64_tr_b16 v[172:173], v27 offset:8192
    v_mfma_f32_16x16x32_bf16 v[72:75], v[176:179], v[196:199], v[72:75]
    ds_read_b64_tr_b16 v[174:175], v27 offset:9216
    s_cselect_b64 s[8:9], s[44:45], s[40:41]
    v_mfma_f32_16x16x32_bf16 v[128:131], v[176:179], v[200:203], v[128:131]
    buffer_load_dwordx4 v[248:251], v10, s[16:19], s97 offen offset:2048 sc1
    v_mfma_f32_16x16x32_bf16 v[136:139], v[176:179], v[204:207], v[136:139]
    v_mfma_f32_16x16x32_bf16 v[68:71], v[180:183], v[192:195], v[68:71]
    ds_read_b64_tr_b16 v[176:177], v28 offset:8192
    s_cmp_eq_u32 s32, 2
    v_mfma_f32_16x16x32_bf16 v[76:79], v[180:183], v[196:199], v[76:79]
    ds_read_b64_tr_b16 v[178:179], v28 offset:9216
    s_cselect_b64 s[8:9], s[42:43], s[8:9]
    v_mfma_f32_16x16x32_bf16 v[132:135], v[180:183], v[200:203], v[132:135]
    s_waitcnt lgkmcnt(10)
    s_cmp_eq_u32 s32, 3
    s_cselect_b64 s[8:9], s[6:7], s[8:9]
    v_mfma_f32_16x16x32_bf16 v[140:143], v[180:183], v[204:207], v[140:143]
    buffer_load_dwordx4 v[252:255], v10, s[16:19], s97 offen offset:2304 sc1
    v_mfma_f32_16x16x32_bf16 v[80:83], v[184:187], v[192:195], v[80:83]
    ds_read_b64_tr_b16 v[180:181], v29 offset:8192
    v_mfma_f32_16x16x32_bf16 v[88:91], v[184:187], v[196:199], v[88:91]
    ds_read_b64_tr_b16 v[182:183], v29 offset:9216
    v_mfma_f32_16x16x32_bf16 v[144:147], v[184:187], v[200:203], v[144:147]
    s_and_b32 s9, s9, 0xffff
    s_mov_b32 s10, 7340032
    v_mfma_f32_16x16x32_bf16 v[152:155], v[184:187], v[204:207], v[152:155]
    s_cmp_eq_u32 s32, 0
    s_cselect_b32 s10, 0x800000, s10
    v_mfma_f32_16x16x32_bf16 v[84:87], v[188:191], v[192:195], v[84:87]
    ds_read_b64_tr_b16 v[184:185], v30 offset:8192
    v_mfma_f32_16x16x32_bf16 v[92:95], v[188:191], v[196:199], v[92:95]
    ds_read_b64_tr_b16 v[186:187], v30 offset:9216
    s_cmp_eq_u32 s32, 3
    v_mfma_f32_16x16x32_bf16 v[148:151], v[188:191], v[200:203], v[148:151]
    s_waitcnt vmcnt(9) lgkmcnt(10)
    s_cselect_b32 s10, 4194304, s10
    s_mov_b32 s11, 0x20000
    v_mfma_f32_16x16x32_bf16 v[156:159], v[188:191], v[204:207], v[156:159]
    ds_read_b64_tr_b16 v[188:189], v31 offset:8192
    ds_read_b64_tr_b16 v[190:191], v31 offset:9216
    v_mfma_f32_16x16x32_bf16 v[32:35], v[160:163], v[208:211], v[32:35]
    s_waitcnt vmcnt(4)
    v_cmp_gt_u32 vcc, 1, v7
    v_mfma_f32_16x16x32_bf16 v[40:43], v[160:163], v[212:215], v[40:43]
    v_mfma_f32_16x16x32_bf16 v[96:99], v[160:163], v[216:219], v[96:99]
    v_mfma_f32_16x16x32_bf16 v[104:107], v[160:163], v[220:223], v[104:107]
    s_barrier
    v_mfma_f32_16x16x32_bf16 v[36:39], v[164:167], v[208:211], v[36:39]
    ds_read_b64_tr_b16 v[160:161], v24 offset:16384
    v_mfma_f32_16x16x32_bf16 v[44:47], v[164:167], v[212:215], v[44:47]
    ds_read_b64_tr_b16 v[162:163], v24 offset:17408
    v_mfma_f32_16x16x32_bf16 v[100:103], v[164:167], v[216:219], v[100:103]
    s_waitcnt lgkmcnt(10)
    v_mfma_f32_16x16x32_bf16 v[108:111], v[164:167], v[220:223], v[108:111]
    v_mfma_f32_16x16x32_bf16 v[48:51], v[168:171], v[208:211], v[48:51]
    ds_read_b64_tr_b16 v[164:165], v25 offset:16384
    v_mfma_f32_16x16x32_bf16 v[56:59], v[168:171], v[212:215], v[56:59]
    ds_read_b64_tr_b16 v[166:167], v25 offset:17408
    v_mfma_f32_16x16x32_bf16 v[112:115], v[168:171], v[216:219], v[112:115]
    v_mfma_f32_16x16x32_bf16 v[120:123], v[168:171], v[220:223], v[120:123]
    v_mfma_f32_16x16x32_bf16 v[52:55], v[172:175], v[208:211], v[52:55]
    ds_read_b64_tr_b16 v[168:169], v26 offset:16384
    v_mfma_f32_16x16x32_bf16 v[60:63], v[172:175], v[212:215], v[60:63]
    ds_read_b64_tr_b16 v[170:171], v26 offset:17408
    v_mfma_f32_16x16x32_bf16 v[116:119], v[172:175], v[216:219], v[116:119]
    s_waitcnt lgkmcnt(10)
    v_mfma_f32_16x16x32_bf16 v[124:127], v[172:175], v[220:223], v[124:127]
    v_mfma_f32_16x16x32_bf16 v[64:67], v[176:179], v[208:211], v[64:67]
    ds_read_b64_tr_b16 v[172:173], v27 offset:16384
    v_mfma_f32_16x16x32_bf16 v[72:75], v[176:179], v[212:215], v[72:75]
    ds_read_b64_tr_b16 v[174:175], v27 offset:17408
    v_mfma_f32_16x16x32_bf16 v[128:131], v[176:179], v[216:219], v[128:131]
    v_mfma_f32_16x16x32_bf16 v[136:139], v[176:179], v[220:223], v[136:139]
    v_mfma_f32_16x16x32_bf16 v[68:71], v[180:183], v[208:211], v[68:71]
    ds_read_b64_tr_b16 v[176:177], v28 offset:16384
    v_mfma_f32_16x16x32_bf16 v[76:79], v[180:183], v[212:215], v[76:79]
    ds_read_b64_tr_b16 v[178:179], v28 offset:17408
    v_mfma_f32_16x16x32_bf16 v[132:135], v[180:183], v[216:219], v[132:135]
    s_waitcnt lgkmcnt(10)
    v_mfma_f32_16x16x32_bf16 v[140:143], v[180:183], v[220:223], v[140:143]
    v_mfma_f32_16x16x32_bf16 v[80:83], v[184:187], v[208:211], v[80:83]
    ds_read_b64_tr_b16 v[180:181], v29 offset:16384
    v_mfma_f32_16x16x32_bf16 v[88:91], v[184:187], v[212:215], v[88:91]
    ds_read_b64_tr_b16 v[182:183], v29 offset:17408
    v_mfma_f32_16x16x32_bf16 v[144:147], v[184:187], v[216:219], v[144:147]
    v_mfma_f32_16x16x32_bf16 v[152:155], v[184:187], v[220:223], v[152:155]
    v_mfma_f32_16x16x32_bf16 v[84:87], v[188:191], v[208:211], v[84:87]
    ds_read_b64_tr_b16 v[184:185], v30 offset:16384
    v_mfma_f32_16x16x32_bf16 v[92:95], v[188:191], v[212:215], v[92:95]
    ds_read_b64_tr_b16 v[186:187], v30 offset:17408
    v_mfma_f32_16x16x32_bf16 v[148:151], v[188:191], v[216:219], v[148:151]
    s_waitcnt lgkmcnt(10)
    v_mfma_f32_16x16x32_bf16 v[156:159], v[188:191], v[220:223], v[156:159]
    ds_read_b64_tr_b16 v[188:189], v31 offset:16384
    ds_read_b64_tr_b16 v[190:191], v31 offset:17408
    s_cbranch_vccnz fk_kvw
fk_kvw_ret:
    v_mfma_f32_16x16x32_bf16 v[32:35], v[160:163], v[224:227], v[32:35]
    s_mov_b32 m0, s101
    v_and_b32 v4, 31, v1
    v_lshrrev_b32 v12, 5, v1
    v_lshlrev_b32 v12, 2, v12
    v_mfma_f32_16x16x32_bf16 v[40:43], v[160:163], v[228:231], v[40:43]
    buffer_load_dwordx4 v8, s[16:19], s100 offen offset:0 sc1 lds
    v_mfma_f32_16x16x32_bf16 v[96:99], v[160:163], v[232:235], v[96:99]
    buffer_load_dwordx4 v8, s[16:19], s100 offen offset:1024 sc1 lds
    v_mfma_f32_16x16x32_bf16 v[104:107], v[160:163], v[236:239], v[104:107]
    v_sub_u32 v4, v4, v12
    v_cmp_gt_i32 s[48:49], 0, v4
    v_mfma_f32_16x16x32_bf16 v[36:39], v[164:167], v[224:227], v[36:39]
    ds_read_b64_tr_b16 v[160:161], v24 offset:24576
    v_cmp_gt_i32 s[50:51], 1, v4
    v_cmp_gt_i32 s[52:53], 2, v4
    v_mfma_f32_16x16x32_bf16 v[44:47], v[164:167], v[228:231], v[44:47]
    ds_read_b64_tr_b16 v[162:163], v24 offset:25600
    v_cmp_gt_i32 s[54:55], 3, v4
    v_cmp_gt_i32 s[56:57], 16, v4
    v_mfma_f32_16x16x32_bf16 v[100:103], v[164:167], v[232:235], v[100:103]
    s_waitcnt lgkmcnt(10)
    buffer_load_dwordx4 v8, s[16:19], s100 offen offset:2048 sc1 lds
    v_mfma_f32_16x16x32_bf16 v[108:111], v[164:167], v[236:239], v[108:111]
    buffer_load_dwordx4 v8, s[16:19], s100 offen offset:3072 sc1 lds
    v_mfma_f32_16x16x32_bf16 v[48:51], v[168:171], v[224:227], v[48:51]
    ds_read_b64_tr_b16 v[164:165], v25 offset:24576
    v_cmp_gt_i32 s[58:59], 17, v4
    v_mfma_f32_16x16x32_bf16 v[56:59], v[168:171], v[228:231], v[56:59]
    s_add_u32 m0, s101, 4096
    s_add_u32 s3, s100, 4096
    ds_read_b64_tr_b16 v[166:167], v25 offset:25600
    v_cmp_gt_i32 s[60:61], 18, v4
    v_mfma_f32_16x16x32_bf16 v[112:115], v[168:171], v[232:235], v[112:115]
    buffer_load_dwordx4 v8, s[16:19], s3 offen offset:0 sc1 lds
    v_mfma_f32_16x16x32_bf16 v[120:123], v[168:171], v[236:239], v[120:123]
    buffer_load_dwordx4 v8, s[16:19], s3 offen offset:1024 sc1 lds
    v_mfma_f32_16x16x32_bf16 v[52:55], v[172:175], v[224:227], v[52:55]
    ds_read_b64_tr_b16 v[168:169], v26 offset:24576
    v_cmp_gt_i32 s[62:63], 19, v4
    v_mfma_f32_16x16x32_bf16 v[60:63], v[172:175], v[228:231], v[60:63]
    ds_read_b64_tr_b16 v[170:171], v26 offset:25600
    v_cmp_gt_i32 s[64:65], 8, v4
    v_cmp_gt_i32 s[66:67], 9, v4
    v_mfma_f32_16x16x32_bf16 v[116:119], v[172:175], v[232:235], v[116:119]
    s_waitcnt lgkmcnt(10)
    buffer_load_dwordx4 v8, s[16:19], s3 offen offset:2048 sc1 lds
    v_mfma_f32_16x16x32_bf16 v[124:127], v[172:175], v[236:239], v[124:127]
    buffer_load_dwordx4 v8, s[16:19], s3 offen offset:3072 sc1 lds
    v_mfma_f32_16x16x32_bf16 v[64:67], v[176:179], v[224:227], v[64:67]
    ds_read_b64_tr_b16 v[172:173], v27 offset:24576
    v_cmp_gt_i32 s[68:69], 10, v4
    v_mfma_f32_16x16x32_bf16 v[72:75], v[176:179], v[228:231], v[72:75]
    s_mov_b32 m0, s39
    ds_read_b64_tr_b16 v[174:175], v27 offset:25600
    v_cmp_gt_i32 s[70:71], 11, v4
    v_cmp_gt_i32 s[72:73], 24, v4
    v_mfma_f32_16x16x32_bf16 v[128:131], v[176:179], v[232:235], v[128:131]
    buffer_load_dwordx4 v8, s[16:19], s46 offen offset:0 sc1 lds
    v_mfma_f32_16x16x32_bf16 v[136:139], v[176:179], v[236:239], v[136:139]
    buffer_load_dwordx4 v8, s[16:19], s46 offen offset:1024 sc1 lds
    v_mfma_f32_16x16x32_bf16 v[68:71], v[180:183], v[224:227], v[68:71]
    ds_read_b64_tr_b16 v[176:177], v28 offset:24576
    v_cmp_gt_i32 s[74:75], 25, v4
    v_mfma_f32_16x16x32_bf16 v[76:79], v[180:183], v[228:231], v[76:79]
    ds_read_b64_tr_b16 v[178:179], v28 offset:25600
    v_cmp_gt_i32 s[76:77], 26, v4
    v_cmp_gt_i32 s[78:79], 27, v4
    v_mfma_f32_16x16x32_bf16 v[132:135], v[180:183], v[232:235], v[132:135]
    s_waitcnt lgkmcnt(10)
    buffer_load_dwordx4 v8, s[16:19], s46 offen offset:2048 sc1 lds
    v_mfma_f32_16x16x32_bf16 v[140:143], v[180:183], v[236:239], v[140:143]
    buffer_load_dwordx4 v8, s[16:19], s46 offen offset:3072 sc1 lds
    v_mfma_f32_16x16x32_bf16 v[80:83], v[184:187], v[224:227], v[80:83]
    ds_read_b64_tr_b16 v[180:181], v29 offset:24576
    v_mfma_f32_16x16x32_bf16 v[88:91], v[184:187], v[228:231], v[88:91]
    s_add_u32 m0, s39, 4096
    s_add_u32 s3, s46, 4096
    ds_read_b64_tr_b16 v[182:183], v29 offset:25600
    v_mfma_f32_16x16x32_bf16 v[144:147], v[184:187], v[232:235], v[144:147]
    buffer_load_dwordx4 v8, s[16:19], s3 offen offset:0 sc1 lds
    v_mfma_f32_16x16x32_bf16 v[152:155], v[184:187], v[236:239], v[152:155]
    buffer_load_dwordx4 v8, s[16:19], s3 offen offset:1024 sc1 lds
    v_mfma_f32_16x16x32_bf16 v[84:87], v[188:191], v[224:227], v[84:87]
    ds_read_b64_tr_b16 v[184:185], v30 offset:24576
    buffer_load_dwordx4 v8, s[16:19], s3 offen offset:2048 sc1 lds
    v_mfma_f32_16x16x32_bf16 v[92:95], v[188:191], v[228:231], v[92:95]
    ds_read_b64_tr_b16 v[186:187], v30 offset:25600
    v_mfma_f32_16x16x32_bf16 v[148:151], v[188:191], v[232:235], v[148:151]
    s_waitcnt vmcnt(15) lgkmcnt(10)
    buffer_load_dwordx4 v8, s[16:19], s3 offen offset:3072 sc1 lds
    s_add_u32 s46, s46, 16384
    s_add_u32 s39, s39, 32768
    v_mfma_f32_16x16x32_bf16 v[156:159], v[188:191], v[236:239], v[156:159]
    ds_read_b64_tr_b16 v[188:189], v31 offset:24576
    ds_read_b64_tr_b16 v[190:191], v31 offset:25600
    v_mfma_f32_16x16x32_bf16 v[32:35], v[160:163], v[240:243], v[32:35]
    v_mfma_f32_16x16x32_bf16 v[40:43], v[160:163], v[244:247], v[40:43]
    v_mfma_f32_16x16x32_bf16 v[96:99], v[160:163], v[248:251], v[96:99]
    v_mfma_f32_16x16x32_bf16 v[104:107], v[160:163], v[252:255], v[104:107]
    v_mfma_f32_16x16x32_bf16 v[36:39], v[164:167], v[240:243], v[36:39]
    v_mfma_f32_16x16x32_bf16 v[44:47], v[164:167], v[244:247], v[44:47]
    s_mov_b32 m0, s39
    v_mfma_f32_16x16x32_bf16 v[100:103], v[164:167], v[248:251], v[100:103]
    s_waitcnt lgkmcnt(8)
    buffer_load_dwordx4 v8, s[16:19], s46 offen offset:0 sc1 lds
    v_mfma_f32_16x16x32_bf16 v[108:111], v[164:167], v[252:255], v[108:111]
    v_mfma_f32_16x16x32_bf16 v[48:51], v[168:171], v[240:243], v[48:51]
    v_mfma_f32_16x16x32_bf16 v[56:59], v[168:171], v[244:247], v[56:59]
    buffer_load_dwordx4 v8, s[16:19], s46 offen offset:1024 sc1 lds
    v_mfma_f32_16x16x32_bf16 v[112:115], v[168:171], v[248:251], v[112:115]
    v_mfma_f32_16x16x32_bf16 v[120:123], v[168:171], v[252:255], v[120:123]
    v_mfma_f32_16x16x32_bf16 v[52:55], v[172:175], v[240:243], v[52:55]
    buffer_load_dwordx4 v8, s[16:19], s46 offen offset:2048 sc1 lds
    v_mfma_f32_16x16x32_bf16 v[60:63], v[172:175], v[244:247], v[60:63]
    v_mfma_f32_16x16x32_bf16 v[116:119], v[172:175], v[248:251], v[116:119]
    s_waitcnt lgkmcnt(4)
    v_mfma_f32_16x16x32_bf16 v[124:127], v[172:175], v[252:255], v[124:127]
    buffer_load_dwordx4 v8, s[16:19], s46 offen offset:3072 sc1 lds
    v_mfma_f32_16x16x32_bf16 v[64:67], v[176:179], v[240:243], v[64:67]
    v_mfma_f32_16x16x32_bf16 v[72:75], v[176:179], v[244:247], v[72:75]
    s_add_u32 m0, s39, 4096
    s_add_u32 s3, s46, 4096
    v_mfma_f32_16x16x32_bf16 v[128:131], v[176:179], v[248:251], v[128:131]
    buffer_load_dwordx4 v8, s[16:19], s3 offen offset:0 sc1 lds
    v_mfma_f32_16x16x32_bf16 v[136:139], v[176:179], v[252:255], v[136:139]
    v_mfma_f32_16x16x32_bf16 v[68:71], v[180:183], v[240:243], v[68:71]
    v_mfma_f32_16x16x32_bf16 v[76:79], v[180:183], v[244:247], v[76:79]
    buffer_load_dwordx4 v8, s[16:19], s3 offen offset:1024 sc1 lds
    v_mfma_f32_16x16x32_bf16 v[132:135], v[180:183], v[248:251], v[132:135]
    s_waitcnt lgkmcnt(0)
    v_mfma_f32_16x16x32_bf16 v[140:143], v[180:183], v[252:255], v[140:143]
    v_mfma_f32_16x16x32_bf16 v[80:83], v[184:187], v[240:243], v[80:83]
    buffer_load_dwordx4 v8, s[16:19], s3 offen offset:2048 sc1 lds
    v_mfma_f32_16x16x32_bf16 v[88:91], v[184:187], v[244:247], v[88:91]
    v_mfma_f32_16x16x32_bf16 v[144:147], v[184:187], v[248:251], v[144:147]
    v_mfma_f32_16x16x32_bf16 v[152:155], v[184:187], v[252:255], v[152:155]
    buffer_load_dwordx4 v8, s[16:19], s3 offen offset:3072 sc1 lds
    v_mfma_f32_16x16x32_bf16 v[84:87], v[188:191], v[240:243], v[84:87]
    s_add_u32 s46, s46, 16384
    s_add_u32 s39, s39, 32768
    v_mfma_f32_16x16x32_bf16 v[92:95], v[188:191], v[244:247], v[92:95]
    v_mfma_f32_16x16x32_bf16 v[148:151], v[188:191], v[248:251], v[148:151]
    v_mfma_f32_16x16x32_bf16 v[156:159], v[188:191], v[252:255], v[156:159]
fk_a0:
    v_mov_b32 v10, 0xff800000
    v_add_u32 v12, 4096, v8
    v_subrev_u32 v13, s23, v8
    v_mov_b32 v14, 0x10000
    v_add_u32 v9, 65536, v8
    s_lshr_b32 s4, s34, 2
    s_sub_u32 s4, s4, 1
    s_mul_i32 s5, s4, s4
    s_lshl_b32 s5, s5, 5
    s_lshl_b32 s4, s4, 1
    s_add_u32 s4, s4, 1
    s_mul_i32 s4, s4, s33
    s_add_u32 s4, s4, s5
    s_lshl_b32 s5, s4, 2
    s_add_u32 s5, s5, s32
    s_lshl_b32 s96, s5, 10
    s_add_u32 s96, s96, 75497472
    s_lshl_b32 s4, s4, 12
    s_mov_b32 s97, 0
    s_lshl_b32 s5, s2, 2
    s_add_u32 s5, s5, s32
    s_lshl_b32 s5, s5, 12
    s_add_u32 s96, s5, 75497472
    v_and_b32 v15, 31, v1
    v_lshlrev_b32 v15, 7, v15
    v_add_u32 v15, s4, v15
    s_sub_u32 s98, s34, 1
    s_sub_u32 s101, s35, 1
    s_min_u32 s12, s36, 64
    s_min_u32 s13, s37, 64
    s_mov_b32 s24, 6
    v_mov_b32 v20, -1
    v_mov_b32 v21, -1
    v_mov_b32 v22, -1
    v_mov_b32 v23, -1
    s_waitcnt vmcnt(16)
    s_barrier
    ds_read_b128 a[192:195], v9 offset:0
    ds_read_b128 a[196:199], v9 offset:1024
    ds_read_b128 a[200:203], v9 offset:2048
    ds_read_b128 a[204:207], v9 offset:3072
    ds_read_b128 a[208:211], v9 offset:4096
    ds_read_b128 a[212:215], v9 offset:5120
    ds_read_b128 a[216:219], v9 offset:6144
    ds_read_b128 a[220:223], v9 offset:7168
    ds_read_b128 a[224:227], v9 offset:8192
    ds_read_b128 a[228:231], v9 offset:9216
    ds_read_b128 a[232:235], v9 offset:10240
    ds_read_b128 a[236:239], v9 offset:11264
    ds_read_b128 a[240:243], v9 offset:12288
    ds_read_b128 a[244:247], v9 offset:13312
    ds_read_b128 a[248:251], v9 offset:14336
    ds_read_b128 a[252:255], v9 offset:15360
    buffer_load_dword v7, v6, s[16:19], 0 offen sc1
    v_cvt_pk_bf16_f32 v192, v32, v33
    v_cvt_pk_bf16_f32 v193, v34, v35
    v_cvt_pk_bf16_f32 v194, v36, v37
    v_cvt_pk_bf16_f32 v195, v38, v39
    v_cvt_pk_bf16_f32 v196, v40, v41
    v_cvt_pk_bf16_f32 v197, v42, v43
    v_cvt_pk_bf16_f32 v198, v44, v45
    v_cvt_pk_bf16_f32 v199, v46, v47
    v_cvt_pk_bf16_f32 v200, v48, v49
    v_cvt_pk_bf16_f32 v201, v50, v51
    v_cvt_pk_bf16_f32 v202, v52, v53
    v_cvt_pk_bf16_f32 v203, v54, v55
    v_cvt_pk_bf16_f32 v204, v56, v57
    v_cvt_pk_bf16_f32 v205, v58, v59
    v_cvt_pk_bf16_f32 v206, v60, v61
    v_cvt_pk_bf16_f32 v207, v62, v63
    v_cvt_pk_bf16_f32 v208, v64, v65
    v_cvt_pk_bf16_f32 v209, v66, v67
    v_cvt_pk_bf16_f32 v210, v68, v69
    v_cvt_pk_bf16_f32 v211, v70, v71
    v_cvt_pk_bf16_f32 v212, v72, v73
    v_cvt_pk_bf16_f32 v213, v74, v75
    v_cvt_pk_bf16_f32 v214, v76, v77
    v_cvt_pk_bf16_f32 v215, v78, v79
    v_cvt_pk_bf16_f32 v216, v80, v81
    v_cvt_pk_bf16_f32 v217, v82, v83
    v_cvt_pk_bf16_f32 v218, v84, v85
    v_cvt_pk_bf16_f32 v219, v86, v87
    v_cvt_pk_bf16_f32 v220, v88, v89
    v_cvt_pk_bf16_f32 v221, v90, v91
    v_cvt_pk_bf16_f32 v222, v92, v93
    v_cvt_pk_bf16_f32 v223, v94, v95
    v_permlane16_swap_b32 v192, v196
    v_permlane16_swap_b32 v193, v197
    v_permlane16_swap_b32 v194, v198
    v_permlane16_swap_b32 v195, v199
    v_permlane16_swap_b32 v200, v204
    v_permlane16_swap_b32 v201, v205
    v_permlane16_swap_b32 v202, v206
    v_permlane16_swap_b32 v203, v207
    v_permlane16_swap_b32 v208, v212
    v_permlane16_swap_b32 v209, v213
    v_permlane16_swap_b32 v210, v214
    v_permlane16_swap_b32 v211, v215
    v_permlane16_swap_b32 v216, v220
    v_permlane16_swap_b32 v217, v221
    v_permlane16_swap_b32 v218, v222
    v_permlane16_swap_b32 v219, v223
    v_cvt_pk_bf16_f32 v224, v96, v97
    v_cvt_pk_bf16_f32 v225, v98, v99
    v_cvt_pk_bf16_f32 v226, v100, v101
    v_cvt_pk_bf16_f32 v227, v102, v103
    v_cvt_pk_bf16_f32 v228, v104, v105
    v_cvt_pk_bf16_f32 v229, v106, v107
    v_cvt_pk_bf16_f32 v230, v108, v109
    v_cvt_pk_bf16_f32 v231, v110, v111
    v_cvt_pk_bf16_f32 v232, v112, v113
    v_cvt_pk_bf16_f32 v233, v114, v115
    v_cvt_pk_bf16_f32 v234, v116, v117
    v_cvt_pk_bf16_f32 v235, v118, v119
    v_cvt_pk_bf16_f32 v236, v120, v121
    v_cvt_pk_bf16_f32 v237, v122, v123
    v_cvt_pk_bf16_f32 v238, v124, v125
    v_cvt_pk_bf16_f32 v239, v126, v127
    v_cvt_pk_bf16_f32 v240, v128, v129
    v_cvt_pk_bf16_f32 v241, v130, v131
    v_cvt_pk_bf16_f32 v242, v132, v133
    v_cvt_pk_bf16_f32 v243, v134, v135
    v_cvt_pk_bf16_f32 v244, v136, v137
    v_cvt_pk_bf16_f32 v245, v138, v139
    v_cvt_pk_bf16_f32 v246, v140, v141
    v_cvt_pk_bf16_f32 v247, v142, v143
    v_cvt_pk_bf16_f32 v248, v144, v145
    v_cvt_pk_bf16_f32 v249, v146, v147
    v_cvt_pk_bf16_f32 v250, v148, v149
    v_cvt_pk_bf16_f32 v251, v150, v151
    v_cvt_pk_bf16_f32 v252, v152, v153
    v_cvt_pk_bf16_f32 v253, v154, v155
    v_cvt_pk_bf16_f32 v254, v156, v157
    v_cvt_pk_bf16_f32 v255, v158, v159
    v_permlane16_swap_b32 v224, v228
    v_permlane16_swap_b32 v225, v229
    v_permlane16_swap_b32 v226, v230
    v_permlane16_swap_b32 v227, v231
    v_permlane16_swap_b32 v232, v236
    v_permlane16_swap_b32 v233, v237
    v_permlane16_swap_b32 v234, v238
    v_permlane16_swap_b32 v235, v239
    v_permlane16_swap_b32 v240, v244
    v_permlane16_swap_b32 v241, v245
    v_permlane16_swap_b32 v242, v246
    v_permlane16_swap_b32 v243, v247
    v_permlane16_swap_b32 v248, v252
    v_permlane16_swap_b32 v249, v253
    v_permlane16_swap_b32 v250, v254
    v_permlane16_swap_b32 v251, v255
    s_nop 0
    s_waitcnt lgkmcnt(12)
    v_mfma_f32_32x32x16_bf16 v[32:47], a[192:195], v[192:195], 0
    v_mfma_f32_32x32x16_bf16 v[32:47], a[196:199], v[196:199], v[32:47]
    v_mfma_f32_32x32x16_bf16 v[32:47], a[200:203], v[200:203], v[32:47]
    v_mfma_f32_32x32x16_bf16 v[32:47], a[204:207], v[204:207], v[32:47]
    s_waitcnt lgkmcnt(8)
    v_mfma_f32_32x32x16_bf16 v[32:47], a[208:211], v[208:211], v[32:47]
    v_mfma_f32_32x32x16_bf16 v[32:47], a[212:215], v[212:215], v[32:47]
    v_mfma_f32_32x32x16_bf16 v[32:47], a[216:219], v[216:219], v[32:47]
    v_mfma_f32_32x32x16_bf16 v[32:47], a[220:223], v[220:223], v[32:47]
    v_mfma_f32_32x32x16_bf16 v[48:63], a[192:195], v[224:227], 0
    v_mfma_f32_32x32x16_bf16 v[48:63], a[196:199], v[228:231], v[48:63]
    v_mfma_f32_32x32x16_bf16 v[48:63], a[200:203], v[232:235], v[48:63]
    v_mfma_f32_32x32x16_bf16 v[48:63], a[204:207], v[236:239], v[48:63]
    s_mov_b32 s38, 0
    s_nop 5
    s_cmp_ge_u32 s38, s36
    s_cbranch_scc1 fk_mfp
fk_mfp_ret:
    v_mfma_f32_32x32x16_bf16 v[48:63], a[208:211], v[240:243], v[48:63]
    v_max3_f32 v180, v32, v33, v34
    v_max3_f32 v180, v180, v35, v36
    v_max3_f32 v180, v180, v37, v38
    v_max3_f32 v180, v180, v39, v40
    v_max3_f32 v180, v180, v41, v42
    v_max3_f32 v180, v180, v43, v44
    v_max3_f32 v180, v180, v45, v46
    v_max_f32 v180, v180, v47
    v_mfma_f32_32x32x16_bf16 v[48:63], a[212:215], v[244:247], v[48:63]
    v_mov_b32 v181, v180
    s_nop 1
    v_permlane32_swap_b32 v180, v181
    s_nop 0
    v_max_f32 v180, v180, v181
    v_sub_f32 v96, 0, v180
    v_mfma_f32_32x32x16_bf16 v[48:63], a[216:219], v[248:251], v[48:63]
    v_sub_f32 v97, 0, v180
    v_sub_f32 v98, 0, v180
    v_sub_f32 v99, 0, v180
    v_sub_f32 v100, 0, v180
    v_sub_f32 v101, 0, v180
    v_sub_f32 v102, 0, v180
    v_sub_f32 v103, 0, v180
    v_sub_f32 v104, 0, v180
    v_mfma_f32_32x32x16_bf16 v[48:63], a[220:223], v[252:255], v[48:63]
    v_sub_f32 v105, 0, v180
    v_sub_f32 v106, 0, v180
    v_sub_f32 v107, 0, v180
    v_sub_f32 v108, 0, v180
    v_sub_f32 v109, 0, v180
    v_sub_f32 v110, 0, v180
    v_sub_f32 v111, 0, v180
    ds_read_b128 a[192:195], v9 offset:16384
    ds_read_b128 a[196:199], v9 offset:17408
    ds_read_b128 a[200:203], v9 offset:18432
    ds_read_b128 a[204:207], v9 offset:19456
    ds_read_b128 a[208:211], v9 offset:20480
    ds_read_b128 a[212:215], v9 offset:21504
    ds_read_b128 a[216:219], v9 offset:22528
    ds_read_b128 a[220:223], v9 offset:23552
    s_nop 1
    s_waitcnt lgkmcnt(12)
    v_mfma_f32_32x32x16_bf16 v[64:79], a[224:227], v[192:195], v[96:111]
    v_sub_f32 v32, v32, v180
    v_sub_f32 v33, v33, v180
    v_sub_f32 v34, v34, v180
    v_sub_f32 v35, v35, v180
    v_sub_f32 v36, v36, v180
    v_sub_f32 v37, v37, v180
    v_mfma_f32_32x32x16_bf16 v[64:79], a[228:231], v[196:199], v[64:79]
    v_sub_f32 v38, v38, v180
    v_sub_f32 v39, v39, v180
    v_sub_f32 v40, v40, v180
    v_sub_f32 v41, v41, v180
    v_sub_f32 v42, v42, v180
    v_sub_f32 v43, v43, v180
    v_mfma_f32_32x32x16_bf16 v[64:79], a[232:235], v[200:203], v[64:79]
    v_sub_f32 v44, v44, v180
    v_sub_f32 v45, v45, v180
    v_sub_f32 v46, v46, v180
    v_sub_f32 v47, v47, v180
    v_max3_f32 v180, v48, v49, v50
    v_mfma_f32_32x32x16_bf16 v[64:79], a[236:239], v[204:207], v[64:79]
    v_max3_f32 v180, v180, v51, v52
    v_max3_f32 v180, v180, v53, v54
    v_max3_f32 v180, v180, v55, v56
    v_max3_f32 v180, v180, v57, v58
    v_max3_f32 v180, v180, v59, v60
    v_max3_f32 v180, v180, v61, v62
    s_waitcnt lgkmcnt(8)
    v_mfma_f32_32x32x16_bf16 v[64:79], a[240:243], v[208:211], v[64:79]
    v_max_f32 v180, v180, v63
    v_mov_b32 v181, v180
    s_nop 1
    v_permlane32_swap_b32 v180, v181
    s_nop 0
    v_mfma_f32_32x32x16_bf16 v[64:79], a[244:247], v[212:215], v[64:79]
    v_max_f32 v180, v180, v181
    v_sub_f32 v112, 0, v180
    v_sub_f32 v113, 0, v180
    v_sub_f32 v114, 0, v180
    v_sub_f32 v115, 0, v180
    v_sub_f32 v116, 0, v180
    v_mfma_f32_32x32x16_bf16 v[64:79], a[248:251], v[216:219], v[64:79]
    v_sub_f32 v117, 0, v180
    v_sub_f32 v118, 0, v180
    v_sub_f32 v119, 0, v180
    v_sub_f32 v120, 0, v180
    v_sub_f32 v121, 0, v180
    v_mfma_f32_32x32x16_bf16 v[64:79], a[252:255], v[220:223], v[64:79]
    v_sub_f32 v122, 0, v180
    v_sub_f32 v123, 0, v180
    v_sub_f32 v124, 0, v180
    v_sub_f32 v125, 0, v180
    v_sub_f32 v126, 0, v180
    v_sub_f32 v127, 0, v180
    s_nop 1
    v_mfma_f32_32x32x16_bf16 v[80:95], a[224:227], v[224:227], v[112:127]
    v_sub_f32 v48, v48, v180
    v_sub_f32 v49, v49, v180
    v_sub_f32 v50, v50, v180
    v_sub_f32 v51, v51, v180
    v_sub_f32 v52, v52, v180
    v_sub_f32 v53, v53, v180
    v_sub_f32 v54, v54, v180
    v_sub_f32 v55, v55, v180
    v_sub_f32 v56, v56, v180
    v_sub_f32 v57, v57, v180
    v_sub_f32 v58, v58, v180
    v_sub_f32 v59, v59, v180
    v_sub_f32 v60, v60, v180
    v_sub_f32 v61, v61, v180
    v_sub_f32 v62, v62, v180
    v_sub_f32 v63, v63, v180
    v_mfma_f32_32x32x16_bf16 v[80:95], a[228:231], v[228:231], v[80:95]
    v_exp_f32 v160, v32
    v_exp_f32 v161, v33
    v_exp_f32 v162, v48
    v_add_f32 v176, v160, v161
    v_exp_f32 v163, v49
    v_cvt_pk_bf16_f32 v128, v160, v161
    v_exp_f32 v164, v34
    v_add_f32 v177, v162, v163
    v_exp_f32 v165, v35
    v_cvt_pk_bf16_f32 v136, v162, v163
    v_mfma_f32_32x32x16_bf16 v[80:95], a[232:235], v[232:235], v[80:95]
    v_exp_f32 v166, v50
    v_add_f32 v176, v176, v164
    v_exp_f32 v167, v51
    v_cvt_pk_bf16_f32 v129, v164, v165
    v_add_f32 v176, v176, v165
    v_exp_f32 v168, v36
    v_add_f32 v177, v177, v166
    v_exp_f32 v169, v37
    v_cvt_pk_bf16_f32 v137, v166, v167
    v_add_f32 v177, v177, v167
    v_exp_f32 v170, v52
    v_mfma_f32_32x32x16_bf16 v[80:95], a[236:239], v[236:239], v[80:95]
    v_add_f32 v176, v176, v168
    v_exp_f32 v171, v53
    v_cvt_pk_bf16_f32 v130, v168, v169
    v_add_f32 v176, v176, v169
    v_exp_f32 v172, v38
    v_add_f32 v177, v177, v170
    v_exp_f32 v173, v39
    v_cvt_pk_bf16_f32 v138, v170, v171
    v_add_f32 v177, v177, v171
    v_exp_f32 v174, v54
    v_add_f32 v176, v176, v172
    v_mfma_f32_32x32x16_bf16 v[80:95], a[240:243], v[240:243], v[80:95]
    v_exp_f32 v175, v55
    v_cvt_pk_bf16_f32 v131, v172, v173
    v_add_f32 v176, v176, v173
    v_exp_f32 v160, v40
    v_add_f32 v177, v177, v174
    v_exp_f32 v161, v41
    v_cvt_pk_bf16_f32 v139, v174, v175
    v_add_f32 v177, v177, v175
    v_exp_f32 v162, v56
    v_add_f32 v176, v176, v160
    v_exp_f32 v163, v57
    v_mfma_f32_32x32x16_bf16 v[80:95], a[244:247], v[244:247], v[80:95]
    v_cvt_pk_bf16_f32 v132, v160, v161
    v_add_f32 v176, v176, v161
    v_exp_f32 v164, v42
    v_add_f32 v177, v177, v162
    v_exp_f32 v165, v43
    v_cvt_pk_bf16_f32 v140, v162, v163
    v_add_f32 v177, v177, v163
    v_exp_f32 v166, v58
    v_add_f32 v176, v176, v164
    v_exp_f32 v167, v59
    v_cvt_pk_bf16_f32 v133, v164, v165
    v_add_f32 v176, v176, v165
    v_mfma_f32_32x32x16_bf16 v[80:95], a[248:251], v[248:251], v[80:95]
    v_exp_f32 v168, v44
    v_add_f32 v177, v177, v166
    v_exp_f32 v169, v45
    v_cvt_pk_bf16_f32 v141, v166, v167
    v_add_f32 v177, v177, v167
    v_exp_f32 v170, v60
    v_add_f32 v176, v176, v168
    v_exp_f32 v171, v61
    v_cvt_pk_bf16_f32 v134, v168, v169
    v_add_f32 v176, v176, v169
    v_exp_f32 v172, v46
    v_mfma_f32_32x32x16_bf16 v[80:95], a[252:255], v[252:255], v[80:95]
    v_add_f32 v177, v177, v170
    v_exp_f32 v173, v47
    v_cvt_pk_bf16_f32 v142, v170, v171
    v_add_f32 v177, v177, v171
    v_exp_f32 v174, v62
    v_add_f32 v176, v176, v172
    v_exp_f32 v175, v63
    v_cvt_pk_bf16_f32 v135, v172, v173
    v_add_f32 v176, v176, v173
    v_add_f32 v177, v177, v174
    v_cvt_pk_bf16_f32 v143, v174, v175
    v_add_f32 v177, v177, v175
    v_mov_b32 v9, v8
    s_mov_b32 s38, 1
    s_waitcnt vmcnt(0) lgkmcnt(0)
    v_cmp_gt_u32 vcc, 2, v7
    s_cmp_ge_u32 s38, s36
    s_cbranch_scc1 fk_mfq
fk_mfq_ret:
    s_cbranch_vccnz fk_kvx
fk_kvx_ret:
.p2align 6
    s_nop 0
fk_dloop:
    v_mfma_f32_32x32x16_bf16 v[32:47], a[192:195], v[192:195], v[96:111]
    s_waitcnt vmcnt(10)
    s_barrier
    ds_read_b128 a[224:227], v9 offset:16384
    v_exp_f32 v160, v64
    v_mfma_f32_32x32x16_bf16 v[48:63], a[192:195], v[224:227], v[112:127]
    v_exp_f32 v161, v65
    v_exp_f32 v162, v80
    v_add_f32 v178, v176, v160
    v_mfma_f32_32x32x16_bf16 v[32:47], a[196:199], v[196:199], v[32:47]
    s_mov_b32 m0, s39
    ds_read_b128 a[232:235], v9 offset:18432
    buffer_load_dwordx4 v8, s[16:19], s46 offen offset:0 sc1 lds
    v_mfma_f32_32x32x16_bf16 v[48:63], a[196:199], v[228:231], v[48:63]
    v_exp_f32 v163, v81
    v_cvt_pk_bf16_f32 v144, v160, v161
    v_add_f32 v178, v178, v161
    v_exp_f32 v164, v66
    v_mfma_f32_32x32x16_bf16 v[32:47], a[200:203], v[200:203], v[32:47]
    s_add_u32 s38, s38, 1
    ds_read_b128 a[240:243], v9 offset:20480
    v_add_f32 v179, v177, v162
    v_exp_f32 v165, v67
    v_mfma_f32_32x32x16_bf16 v[48:63], a[200:203], v[232:235], v[48:63]
    v_cvt_pk_bf16_f32 v152, v162, v163
    v_add_f32 v179, v179, v163
    v_exp_f32 v166, v82
    v_add_f32 v178, v178, v164
    v_mfma_f32_32x32x16_bf16 v[32:47], a[204:207], v[204:207], v[32:47]
    ds_read_b128 a[248:251], v9 offset:22528
    v_exp_f32 v167, v83
    v_cvt_pk_bf16_f32 v145, v164, v165
    v_mfma_f32_32x32x16_bf16 v[48:63], a[204:207], v[236:239], v[48:63]
    s_waitcnt lgkmcnt(4)
    v_add_f32 v178, v178, v165
    v_exp_f32 v168, v68
    v_add_f32 v179, v179, v166
    v_mfma_f32_32x32x16_bf16 v[32:47], a[208:211], v[208:211], v[32:47]
    s_cmp_ge_u32 s38, s12
    ds_read_b128 a[228:231], v9 offset:17408
    v_exp_f32 v169, v69
    v_cvt_pk_bf16_f32 v153, v166, v167
    v_add_f32 v179, v179, v167
    v_mfma_f32_32x32x16_bf16 v[48:63], a[208:211], v[240:243], v[48:63]
    v_exp_f32 v170, v84
    v_add_f32 v178, v178, v168
    v_exp_f32 v171, v85
    v_mfma_f32_32x32x16_bf16 v[32:47], a[212:215], v[212:215], v[32:47]
    s_cselect_b32 s21, s22, s20
    ds_read_b128 a[236:239], v9 offset:19456
    buffer_load_dwordx4 v8, s[16:19], s46 offen offset:1024 sc1 lds
    v_mfma_f32_32x32x16_bf16 v[48:63], a[212:215], v[244:247], v[48:63]
    v_cvt_pk_bf16_f32 v146, v168, v169
    v_add_f32 v178, v178, v169
    v_exp_f32 v172, v70
    v_add_f32 v179, v179, v170
    v_mfma_f32_32x32x16_bf16 v[32:47], a[216:219], v[216:219], v[32:47]
    ds_read_b128 a[244:247], v9 offset:21504
    v_exp_f32 v173, v71
    v_cvt_pk_bf16_f32 v154, v170, v171
    v_add_f32 v179, v179, v171
    v_mfma_f32_32x32x16_bf16 v[48:63], a[216:219], v[248:251], v[48:63]
    v_exp_f32 v174, v86
    v_add_f32 v178, v178, v172
    v_exp_f32 v175, v87
    v_mfma_f32_32x32x16_bf16 v[32:47], a[220:223], v[220:223], v[32:47]
    ds_read_b128 a[252:255], v9 offset:23552
    v_cvt_pk_bf16_f32 v147, v172, v173
    v_add_f32 v178, v178, v173
    v_exp_f32 v160, v72
    v_mfma_f32_32x32x16_bf16 v[48:63], a[220:223], v[252:255], v[48:63]
    s_waitcnt lgkmcnt(4)
    v_add_f32 v179, v179, v174
    v_exp_f32 v161, v73
    v_cvt_pk_bf16_f32 v155, v174, v175
    v_mfma_f32_32x32x16_bf16 a[0:15], a[224:227], v[128:131], a[0:15]
    ds_read_b128 a[192:195], v9 offset:0
    v_add_f32 v179, v179, v175
    v_exp_f32 v162, v88
    v_add_f32 v178, v178, v160
    v_mfma_f32_32x32x16_bf16 a[64:79], a[224:227], v[136:139], a[64:79]
    v_exp_f32 v163, v89
    v_cvt_pk_bf16_f32 v148, v160, v161
    v_add_f32 v178, v178, v161
    v_mfma_f32_32x32x16_bf16 a[16:31], a[232:235], v[128:131], a[16:31]
    ds_read_b128 a[196:199], v9 offset:1024
    buffer_load_dwordx4 v8, s[16:19], s46 offen offset:2048 sc1 lds
    v_mfma_f32_32x32x16_bf16 a[80:95], a[232:235], v[136:139], a[80:95]
    v_exp_f32 v164, v74
    v_add_f32 v179, v179, v162
    v_exp_f32 v165, v75
    v_mfma_f32_32x32x16_bf16 a[32:47], a[240:243], v[128:131], a[32:47]
    ds_read_b128 a[200:203], v9 offset:2048
    v_cvt_pk_bf16_f32 v156, v162, v163
    v_add_f32 v179, v179, v163
    v_exp_f32 v166, v90
    v_mfma_f32_32x32x16_bf16 a[96:111], a[240:243], v[136:139], a[96:111]
    v_add_f32 v178, v178, v164
    v_exp_f32 v167, v91
    v_cvt_pk_bf16_f32 v149, v164, v165
    v_mfma_f32_32x32x16_bf16 a[48:63], a[248:251], v[128:131], a[48:63]
    ds_read_b128 a[204:207], v9 offset:3072
    v_add_f32 v178, v178, v165
    v_exp_f32 v168, v76
    v_add_f32 v179, v179, v166
    v_mfma_f32_32x32x16_bf16 a[112:127], a[248:251], v[136:139], a[112:127]
    s_waitcnt lgkmcnt(4)
    v_exp_f32 v169, v77
    v_cvt_pk_bf16_f32 v157, v166, v167
    v_add_f32 v179, v179, v167
    v_mfma_f32_32x32x16_bf16 a[0:15], a[228:231], v[132:135], a[0:15]
    ds_read_b128 a[208:211], v9 offset:4096
    v_exp_f32 v170, v92
    v_add_f32 v178, v178, v168
    v_exp_f32 v171, v93
    v_mfma_f32_32x32x16_bf16 a[64:79], a[228:231], v[140:143], a[64:79]
    v_cvt_pk_bf16_f32 v150, v168, v169
    v_add_f32 v178, v178, v169
    v_exp_f32 v172, v78
    v_mfma_f32_32x32x16_bf16 a[16:31], a[236:239], v[132:135], a[16:31]
    ds_read_b128 a[212:215], v9 offset:5120
    buffer_load_dwordx4 v8, s[16:19], s46 offen offset:3072 sc1 lds
    v_mfma_f32_32x32x16_bf16 a[80:95], a[236:239], v[140:143], a[80:95]
    v_add_f32 v179, v179, v170
    v_exp_f32 v173, v79
    v_cvt_pk_bf16_f32 v158, v170, v171
    v_add_f32 v179, v179, v171
    v_mfma_f32_32x32x16_bf16 a[32:47], a[244:247], v[132:135], a[32:47]
    ds_read_b128 a[216:219], v9 offset:6144
    v_exp_f32 v174, v94
    v_add_f32 v178, v178, v172
    v_mfma_f32_32x32x16_bf16 a[96:111], a[244:247], v[140:143], a[96:111]
    v_exp_f32 v175, v95
    v_cvt_pk_bf16_f32 v151, v172, v173
    v_add_f32 v178, v178, v173
    v_add_f32 v179, v179, v174
    v_mfma_f32_32x32x16_bf16 a[48:63], a[252:255], v[132:135], a[48:63]
    ds_read_b128 a[220:223], v9 offset:7168
    v_cvt_pk_bf16_f32 v159, v174, v175
    v_add_f32 v179, v179, v175
    v_max_f32 v180, v178, v179
    v_cmp_lt_f32 vcc, s21, v180
    v_mfma_f32_32x32x16_bf16 a[112:127], a[252:255], v[140:143], a[112:127]
    s_waitcnt lgkmcnt(4)
    s_cbranch_vccnz fk_hd0
fk_hd0_ret:
    v_mfma_f32_32x32x16_bf16 v[64:79], a[192:195], v[192:195], v[96:111]
    ds_read_b128 a[224:227], v9 offset:24576
    v_exp_f32 v160, v32
    v_exp_f32 v161, v33
    v_mfma_f32_32x32x16_bf16 v[80:95], a[192:195], v[224:227], v[112:127]
    v_exp_f32 v162, v48
    v_add_f32 v176, v178, v160
    v_exp_f32 v163, v49
    v_mfma_f32_32x32x16_bf16 v[64:79], a[196:199], v[196:199], v[64:79]
    s_add_u32 m0, s39, 4096
    ds_read_b128 a[232:235], v9 offset:26624
    buffer_load_dwordx4 v12, s[16:19], s46 offen offset:0 sc1 lds
    v_mfma_f32_32x32x16_bf16 v[80:95], a[196:199], v[228:231], v[80:95]
    v_cvt_pk_bf16_f32 v128, v160, v161
    v_add_f32 v176, v176, v161
    v_exp_f32 v164, v34
    v_mfma_f32_32x32x16_bf16 v[64:79], a[200:203], v[200:203], v[64:79]
    s_add_u32 s38, s38, 1
    ds_read_b128 a[240:243], v9 offset:28672
    v_add_f32 v177, v179, v162
    v_exp_f32 v165, v35
    v_cvt_pk_bf16_f32 v136, v162, v163
    v_mfma_f32_32x32x16_bf16 v[80:95], a[200:203], v[232:235], v[80:95]
    v_add_f32 v177, v177, v163
    v_exp_f32 v166, v50
    v_add_f32 v176, v176, v164
    v_exp_f32 v167, v51
    v_mfma_f32_32x32x16_bf16 v[64:79], a[204:207], v[204:207], v[64:79]
    ds_read_b128 a[248:251], v9 offset:30720
    v_cvt_pk_bf16_f32 v129, v164, v165
    v_add_f32 v176, v176, v165
    v_mfma_f32_32x32x16_bf16 v[80:95], a[204:207], v[236:239], v[80:95]
    s_waitcnt lgkmcnt(4)
    v_exp_f32 v168, v36
    v_add_f32 v177, v177, v166
    v_exp_f32 v169, v37
    v_cvt_pk_bf16_f32 v137, v166, v167
    v_mfma_f32_32x32x16_bf16 v[64:79], a[208:211], v[208:211], v[64:79]
    s_cmp_ge_u32 s38, s12
    ds_read_b128 a[228:231], v9 offset:25600
    buffer_load_dwordx4 v12, s[16:19], s46 offen offset:1024 sc1 lds
    v_mfma_f32_32x32x16_bf16 v[80:95], a[208:211], v[240:243], v[80:95]
    v_add_f32 v177, v177, v167
    v_exp_f32 v170, v52
    v_add_f32 v176, v176, v168
    v_mfma_f32_32x32x16_bf16 v[64:79], a[212:215], v[212:215], v[64:79]
    s_cselect_b32 s21, s22, s20
    ds_read_b128 a[236:239], v9 offset:27648
    v_exp_f32 v171, v53
    v_cvt_pk_bf16_f32 v130, v168, v169
    v_add_f32 v176, v176, v169
    v_mfma_f32_32x32x16_bf16 v[80:95], a[212:215], v[244:247], v[80:95]
    v_exp_f32 v172, v38
    v_add_f32 v177, v177, v170
    v_exp_f32 v173, v39
    v_mfma_f32_32x32x16_bf16 v[64:79], a[216:219], v[216:219], v[64:79]
    ds_read_b128 a[244:247], v9 offset:29696
    buffer_load_dwordx4 v12, s[16:19], s46 offen offset:2048 sc1 lds
    v_mfma_f32_32x32x16_bf16 v[80:95], a[216:219], v[248:251], v[80:95]
    v_cvt_pk_bf16_f32 v138, v170, v171
    v_add_f32 v177, v177, v171
    v_exp_f32 v174, v54
    v_add_f32 v176, v176, v172
    v_mfma_f32_32x32x16_bf16 v[64:79], a[220:223], v[220:223], v[64:79]
    ds_read_b128 a[252:255], v9 offset:31744
    v_exp_f32 v175, v55
    v_cvt_pk_bf16_f32 v131, v172, v173
    v_add_f32 v176, v176, v173
    v_mfma_f32_32x32x16_bf16 v[80:95], a[220:223], v[252:255], v[80:95]
    s_waitcnt lgkmcnt(4)
    v_exp_f32 v160, v40
    v_add_f32 v177, v177, v174
    v_exp_f32 v161, v41
    v_mfma_f32_32x32x16_bf16 a[0:15], a[224:227], v[144:147], a[0:15]
    ds_read_b128 a[192:195], v9 offset:8192
    v_cvt_pk_bf16_f32 v139, v174, v175
    v_add_f32 v177, v177, v175
    v_exp_f32 v162, v56
    v_mfma_f32_32x32x16_bf16 a[64:79], a[224:227], v[152:155], a[64:79]
    v_add_f32 v176, v176, v160
    v_exp_f32 v163, v57
    v_cvt_pk_bf16_f32 v132, v160, v161
    v_mfma_f32_32x32x16_bf16 a[16:31], a[232:235], v[144:147], a[16:31]
    ds_read_b128 a[196:199], v9 offset:9216
    buffer_load_dwordx4 v12, s[16:19], s46 offen offset:3072 sc1 lds
    v_mfma_f32_32x32x16_bf16 a[80:95], a[232:235], v[152:155], a[80:95]
    buffer_load_dword v16, v15, s[8:11], s97 offen
    v_add_f32 v176, v176, v161
    v_mfma_f32_32x32x16_bf16 a[32:47], a[240:243], v[144:147], a[32:47]
    s_add_u32 s46, s46, 16384
    ds_read_b128 a[200:203], v9 offset:10240
    v_exp_f32 v164, v42
    v_add_f32 v177, v177, v162
    v_exp_f32 v165, v43
    v_mfma_f32_32x32x16_bf16 a[96:111], a[240:243], v[152:155], a[96:111]
    v_cvt_pk_bf16_f32 v140, v162, v163
    v_add_f32 v177, v177, v163
    v_exp_f32 v166, v58
    v_mfma_f32_32x32x16_bf16 a[48:63], a[248:251], v[144:147], a[48:63]
    ds_read_b128 a[204:207], v9 offset:11264
    v_add_f32 v176, v176, v164
    v_exp_f32 v167, v59
    v_cvt_pk_bf16_f32 v133, v164, v165
    v_mfma_f32_32x32x16_bf16 a[112:127], a[248:251], v[152:155], a[112:127]
    s_waitcnt lgkmcnt(4)
    v_add_f32 v176, v176, v165
    v_exp_f32 v168, v44
    v_add_f32 v177, v177, v166
    v_mfma_f32_32x32x16_bf16 a[0:15], a[228:231], v[148:151], a[0:15]
    s_min_u32 s46, s46, s47
    ds_read_b128 a[208:211], v9 offset:12288
    v_exp_f32 v169, v45
    v_cvt_pk_bf16_f32 v141, v166, v167
    v_add_f32 v177, v177, v167
    v_mfma_f32_32x32x16_bf16 a[64:79], a[228:231], v[156:159], a[64:79]
    v_exp_f32 v170, v60
    v_add_f32 v176, v176, v168
    v_exp_f32 v171, v61
    v_mfma_f32_32x32x16_bf16 a[16:31], a[236:239], v[148:151], a[16:31]
    s_add_u32 s39, s39, 32768
    ds_read_b128 a[212:215], v9 offset:13312
    v_cvt_pk_bf16_f32 v134, v168, v169
    v_add_f32 v176, v176, v169
    v_exp_f32 v172, v46
    v_mfma_f32_32x32x16_bf16 a[80:95], a[236:239], v[156:159], a[80:95]
    v_add_f32 v177, v177, v170
    v_exp_f32 v173, v47
    v_cvt_pk_bf16_f32 v142, v170, v171
    v_add_f32 v177, v177, v171
    v_mfma_f32_32x32x16_bf16 a[32:47], a[244:247], v[148:151], a[32:47]
    s_and_b32 s39, s39, 0x1ffff
    ds_read_b128 a[216:219], v9 offset:14336
    v_exp_f32 v174, v62
    v_add_f32 v176, v176, v172
    v_mfma_f32_32x32x16_bf16 a[96:111], a[244:247], v[156:159], a[96:111]
    v_exp_f32 v175, v63
    v_cvt_pk_bf16_f32 v135, v172, v173
    v_add_f32 v176, v176, v173
    v_add_f32 v177, v177, v174
    v_mfma_f32_32x32x16_bf16 a[48:63], a[252:255], v[148:151], a[48:63]
    s_add_u32 s97, s97, 4096
    ds_read_b128 a[220:223], v9 offset:15360
    v_cvt_pk_bf16_f32 v143, v174, v175
    v_add_f32 v177, v177, v175
    v_max_f32 v180, v176, v177
    v_cmp_lt_f32 vcc, s21, v180
    v_mfma_f32_32x32x16_bf16 a[112:127], a[252:255], v[156:159], a[112:127]
    s_waitcnt lgkmcnt(4)
    v_xad_u32 v9, s39, v14, v13
    s_cbranch_vccnz fk_hd1
fk_hd1_ret:
    s_cmp_lt_u32 s38, s98
    s_cbranch_scc1 fk_dloop
    v_mfma_f32_32x32x16_bf16 v[48:63], a[192:195], v[224:227], v[112:127]
    s_waitcnt vmcnt(10)
    s_barrier
    ds_read_b128 a[224:227], v9 offset:16384
    v_exp_f32 v160, v64
    v_exp_f32 v161, v65
    v_mfma_f32_32x32x16_bf16 v[48:63], a[196:199], v[228:231], v[48:63]
    s_mov_b32 m0, s39
    ds_read_b128 a[232:235], v9 offset:18432
    buffer_load_dwordx4 v8, s[16:19], s46 offen offset:0 sc1 lds
    v_exp_f32 v162, v80
    v_add_f32 v178, v176, v160
    v_mfma_f32_32x32x16_bf16 v[48:63], a[200:203], v[232:235], v[48:63]
    s_add_u32 s38, s38, 1
    ds_read_b128 a[240:243], v9 offset:20480
    v_exp_f32 v163, v81
    v_cvt_pk_bf16_f32 v144, v160, v161
    v_add_f32 v178, v178, v161
    v_exp_f32 v164, v66
    v_mfma_f32_32x32x16_bf16 v[48:63], a[204:207], v[236:239], v[48:63]
    s_waitcnt lgkmcnt(3)
    ds_read_b128 a[248:251], v9 offset:22528
    v_add_f32 v179, v177, v162
    v_exp_f32 v165, v67
    v_cvt_pk_bf16_f32 v152, v162, v163
    v_add_f32 v179, v179, v163
    v_mfma_f32_32x32x16_bf16 v[48:63], a[208:211], v[240:243], v[48:63]
    s_cmp_ge_u32 s38, s13
    ds_read_b128 a[228:231], v9 offset:17408
    v_exp_f32 v166, v82
    v_add_f32 v178, v178, v164
    v_exp_f32 v167, v83
    v_cvt_pk_bf16_f32 v145, v164, v165
    v_mfma_f32_32x32x16_bf16 v[48:63], a[212:215], v[244:247], v[48:63]
    s_cselect_b32 s21, s22, s20
    ds_read_b128 a[236:239], v9 offset:19456
    buffer_load_dwordx4 v8, s[16:19], s46 offen offset:1024 sc1 lds
    v_add_f32 v178, v178, v165
    v_mfma_f32_32x32x16_bf16 v[48:63], a[216:219], v[248:251], v[48:63]
    ds_read_b128 a[244:247], v9 offset:21504
    v_exp_f32 v168, v68
    v_add_f32 v179, v179, v166
    v_exp_f32 v169, v69
    v_cvt_pk_bf16_f32 v153, v166, v167
    v_mfma_f32_32x32x16_bf16 v[48:63], a[220:223], v[252:255], v[48:63]
    s_waitcnt lgkmcnt(3)
    ds_read_b128 a[252:255], v9 offset:23552
    v_add_f32 v179, v179, v167
    v_exp_f32 v170, v84
    v_add_f32 v178, v178, v168
    v_exp_f32 v171, v85
    v_mfma_f32_32x32x16_bf16 a[0:15], a[224:227], v[128:131], a[0:15]
    ds_read_b128 a[192:195], v9 offset:0
    v_cvt_pk_bf16_f32 v146, v168, v169
    v_add_f32 v178, v178, v169
    v_exp_f32 v172, v70
    v_add_f32 v179, v179, v170
    v_mfma_f32_32x32x16_bf16 a[64:79], a[224:227], v[136:139], a[64:79]
    v_exp_f32 v173, v71
    v_cvt_pk_bf16_f32 v154, v170, v171
    v_add_f32 v179, v179, v171
    v_exp_f32 v174, v86
    v_add_f32 v178, v178, v172
    v_mfma_f32_32x32x16_bf16 a[16:31], a[232:235], v[128:131], a[16:31]
    ds_read_b128 a[196:199], v9 offset:1024
    buffer_load_dwordx4 v8, s[16:19], s46 offen offset:2048 sc1 lds
    v_exp_f32 v175, v87
    v_mfma_f32_32x32x16_bf16 a[80:95], a[232:235], v[136:139], a[80:95]
    buffer_store_dwordx4 v[20:23], v8, s[16:19], s96 offen offset:0 sc1
    v_cvt_pk_bf16_f32 v147, v172, v173
    v_add_f32 v178, v178, v173
    v_exp_f32 v160, v72
    v_mfma_f32_32x32x16_bf16 a[32:47], a[240:243], v[128:131], a[32:47]
    ds_read_b128 a[200:203], v9 offset:2048
    v_add_f32 v179, v179, v174
    v_exp_f32 v161, v73
    v_cvt_pk_bf16_f32 v155, v174, v175
    v_add_f32 v179, v179, v175
    v_mfma_f32_32x32x16_bf16 a[96:111], a[240:243], v[136:139], a[96:111]
    v_exp_f32 v162, v88
    v_add_f32 v178, v178, v160
    v_exp_f32 v163, v89
    v_cvt_pk_bf16_f32 v148, v160, v161
    v_mfma_f32_32x32x16_bf16 a[48:63], a[248:251], v[128:131], a[48:63]
    ds_read_b128 a[204:207], v9 offset:3072
    v_add_f32 v178, v178, v161
    v_exp_f32 v164, v74
    v_add_f32 v179, v179, v162
    v_exp_f32 v165, v75
    v_mfma_f32_32x32x16_bf16 a[112:127], a[248:251], v[136:139], a[112:127]
    s_waitcnt lgkmcnt(4)
    v_cvt_pk_bf16_f32 v156, v162, v163
    v_add_f32 v179, v179, v163
    v_exp_f32 v166, v90
    v_add_f32 v178, v178, v164
    v_exp_f32 v167, v91
    v_mfma_f32_32x32x16_bf16 a[0:15], a[228:231], v[132:135], a[0:15]
    ds_read_b128 a[208:211], v9 offset:4096
    v_cvt_pk_bf16_f32 v149, v164, v165
    v_add_f32 v178, v178, v165
    v_exp_f32 v168, v76
    v_add_f32 v179, v179, v166
    v_mfma_f32_32x32x16_bf16 a[64:79], a[228:231], v[140:143], a[64:79]
    buffer_store_dwordx4 v[20:23], v8, s[16:19], s96 offen offset:1024 sc1
    v_exp_f32 v169, v77
    v_cvt_pk_bf16_f32 v157, v166, v167
    v_mfma_f32_32x32x16_bf16 a[16:31], a[236:239], v[132:135], a[16:31]
    ds_read_b128 a[212:215], v9 offset:5120
    buffer_load_dwordx4 v8, s[16:19], s46 offen offset:3072 sc1 lds
    v_add_f32 v179, v179, v167
    v_exp_f32 v170, v92
    v_mfma_f32_32x32x16_bf16 a[80:95], a[236:239], v[140:143], a[80:95]
    v_add_f32 v178, v178, v168
    v_exp_f32 v171, v93
    v_cvt_pk_bf16_f32 v150, v168, v169
    v_add_f32 v178, v178, v169
    v_mfma_f32_32x32x16_bf16 a[32:47], a[244:247], v[132:135], a[32:47]
    ds_read_b128 a[216:219], v9 offset:6144
    v_exp_f32 v172, v78
    v_add_f32 v179, v179, v170
    v_exp_f32 v173, v79
    v_cvt_pk_bf16_f32 v158, v170, v171
    v_add_f32 v179, v179, v171
    v_mfma_f32_32x32x16_bf16 a[96:111], a[244:247], v[140:143], a[96:111]
    v_exp_f32 v174, v94
    v_add_f32 v178, v178, v172
    v_exp_f32 v175, v95
    v_cvt_pk_bf16_f32 v151, v172, v173
    v_mfma_f32_32x32x16_bf16 a[48:63], a[252:255], v[132:135], a[48:63]
    ds_read_b128 a[220:223], v9 offset:7168
    v_add_f32 v178, v178, v173
    v_add_f32 v179, v179, v174
    v_cvt_pk_bf16_f32 v159, v174, v175
    v_add_f32 v179, v179, v175
    v_max_f32 v180, v178, v179
    v_cmp_lt_f32 vcc, s21, v180
    v_mfma_f32_32x32x16_bf16 a[112:127], a[252:255], v[140:143], a[112:127]
    s_waitcnt lgkmcnt(4)
    s_cbranch_vccnz fk_he0
fk_he0_ret:
    v_mfma_f32_32x32x16_bf16 v[80:95], a[192:195], v[224:227], v[112:127]
    ds_read_b128 a[224:227], v9 offset:24576
    v_exp_f32 v160, v48
    v_exp_f32 v161, v49
    v_mfma_f32_32x32x16_bf16 v[80:95], a[196:199], v[228:231], v[80:95]
    s_add_u32 m0, s39, 4096
    ds_read_b128 a[232:235], v9 offset:26624
    buffer_load_dwordx4 v12, s[16:19], s46 offen offset:0 sc1 lds
    v_mfma_f32_32x32x16_bf16 v[80:95], a[200:203], v[232:235], v[80:95]
    s_add_u32 s38, s38, 1
    ds_read_b128 a[240:243], v9 offset:28672
    v_exp_f32 v162, v50
    v_mfma_f32_32x32x16_bf16 v[80:95], a[204:207], v[236:239], v[80:95]
    s_waitcnt lgkmcnt(3)
    ds_read_b128 a[248:251], v9 offset:30720
    v_add_f32 v177, v179, v160
    v_exp_f32 v163, v51
    v_mfma_f32_32x32x16_bf16 v[80:95], a[208:211], v[240:243], v[80:95]
    s_cmp_ge_u32 s38, s13
    ds_read_b128 a[228:231], v9 offset:25600
    buffer_load_dwordx4 v12, s[16:19], s46 offen offset:1024 sc1 lds
    v_mfma_f32_32x32x16_bf16 v[80:95], a[212:215], v[244:247], v[80:95]
    s_cselect_b32 s21, s22, s20
    ds_read_b128 a[236:239], v9 offset:27648
    v_cvt_pk_bf16_f32 v136, v160, v161
    v_add_f32 v177, v177, v161
    v_mfma_f32_32x32x16_bf16 v[80:95], a[216:219], v[248:251], v[80:95]
    ds_read_b128 a[244:247], v9 offset:29696
    buffer_load_dwordx4 v12, s[16:19], s46 offen offset:2048 sc1 lds
    v_mfma_f32_32x32x16_bf16 v[80:95], a[220:223], v[252:255], v[80:95]
    s_waitcnt lgkmcnt(3)
    ds_read_b128 a[252:255], v9 offset:31744
    v_exp_f32 v164, v52
    v_add_f32 v177, v177, v162
    v_mfma_f32_32x32x16_bf16 a[0:15], a[224:227], v[144:147], a[0:15]
    ds_read_b128 a[192:195], v9 offset:8192
    v_exp_f32 v165, v53
    v_cvt_pk_bf16_f32 v137, v162, v163
    v_mfma_f32_32x32x16_bf16 a[64:79], a[224:227], v[152:155], a[64:79]
    v_add_f32 v177, v177, v163
    v_exp_f32 v166, v54
    v_add_f32 v177, v177, v164
    v_mfma_f32_32x32x16_bf16 a[16:31], a[232:235], v[144:147], a[16:31]
    ds_read_b128 a[196:199], v9 offset:9216
    buffer_load_dwordx4 v12, s[16:19], s46 offen offset:3072 sc1 lds
    v_mfma_f32_32x32x16_bf16 a[80:95], a[232:235], v[152:155], a[80:95]
    buffer_store_dwordx4 v[20:23], v8, s[16:19], s96 offen offset:2048 sc1
    v_mfma_f32_32x32x16_bf16 a[32:47], a[240:243], v[144:147], a[32:47]
    s_add_u32 s46, s46, 16384
    ds_read_b128 a[200:203], v9 offset:10240
    v_exp_f32 v167, v55
    v_cvt_pk_bf16_f32 v138, v164, v165
    v_mfma_f32_32x32x16_bf16 a[96:111], a[240:243], v[152:155], a[96:111]
    v_add_f32 v177, v177, v165
    v_exp_f32 v168, v56
    v_add_f32 v177, v177, v166
    v_mfma_f32_32x32x16_bf16 a[48:63], a[248:251], v[144:147], a[48:63]
    ds_read_b128 a[204:207], v9 offset:11264
    v_exp_f32 v169, v57
    v_cvt_pk_bf16_f32 v139, v166, v167
    v_add_f32 v177, v177, v167
    v_mfma_f32_32x32x16_bf16 a[112:127], a[248:251], v[152:155], a[112:127]
    s_waitcnt lgkmcnt(4)
    v_exp_f32 v170, v58
    v_add_f32 v177, v177, v168
    v_mfma_f32_32x32x16_bf16 a[0:15], a[228:231], v[148:151], a[0:15]
    s_min_u32 s46, s46, s47
    ds_read_b128 a[208:211], v9 offset:12288
    v_exp_f32 v171, v59
    v_cvt_pk_bf16_f32 v140, v168, v169
    v_add_f32 v177, v177, v169
    v_mfma_f32_32x32x16_bf16 a[64:79], a[228:231], v[156:159], a[64:79]
    buffer_store_dwordx4 v[20:23], v8, s[16:19], s96 offen offset:3072 sc1
    v_mfma_f32_32x32x16_bf16 a[16:31], a[236:239], v[148:151], a[16:31]
    s_add_u32 s39, s39, 32768
    ds_read_b128 a[212:215], v9 offset:13312
    v_exp_f32 v172, v60
    v_add_f32 v177, v177, v170
    v_mfma_f32_32x32x16_bf16 a[80:95], a[236:239], v[156:159], a[80:95]
    v_exp_f32 v173, v61
    v_cvt_pk_bf16_f32 v141, v170, v171
    v_add_f32 v177, v177, v171
    v_mfma_f32_32x32x16_bf16 a[32:47], a[244:247], v[148:151], a[32:47]
    s_and_b32 s39, s39, 0x1ffff
    ds_read_b128 a[216:219], v9 offset:14336
    v_exp_f32 v174, v62
    v_add_f32 v177, v177, v172
    v_mfma_f32_32x32x16_bf16 a[96:111], a[244:247], v[156:159], a[96:111]
    v_exp_f32 v175, v63
    v_cvt_pk_bf16_f32 v142, v172, v173
    v_add_f32 v177, v177, v173
    v_add_f32 v177, v177, v174
    v_mfma_f32_32x32x16_bf16 a[48:63], a[252:255], v[148:151], a[48:63]
    ds_read_b128 a[220:223], v9 offset:15360
    v_cvt_pk_bf16_f32 v143, v174, v175
    v_add_f32 v177, v177, v175
    v_cmp_lt_f32 vcc, s21, v177
    v_mfma_f32_32x32x16_bf16 a[112:127], a[252:255], v[156:159], a[112:127]
    s_waitcnt lgkmcnt(4)
    v_xad_u32 v9, s39, v14, v13
    s_cbranch_vccnz fk_he1
fk_he1_ret:
    s_nop 7
    v_mov_b32 v180, v178
    s_nop 1
    v_permlane32_swap_b32 v178, v180
    s_nop 0
    v_add_f32 v178, v178, v180
    v_rcp_f32 v180, v178
    v_rcp_f32 v181, v178
    s_mul_i32 s4, s36, 262144
    s_lshl_b32 s5, s33, 13
    s_add_u32 s4, s4, s5
    s_add_u32 s4, s4, 37748736
    s_add_u32 s5, s4, 4096
    v_accvgpr_read_b32 v32, a0
    v_accvgpr_read_b32 v33, a1
    v_accvgpr_read_b32 v34, a2
    v_accvgpr_read_b32 v35, a3
    v_accvgpr_read_b32 v36, a4
    v_accvgpr_read_b32 v37, a5
    v_accvgpr_read_b32 v38, a6
    v_accvgpr_read_b32 v39, a7
    v_pk_mul_f32 v[32:33], v[32:33], v[180:181]
    v_pk_mul_f32 v[34:35], v[34:35], v[180:181]
    v_pk_mul_f32 v[36:37], v[36:37], v[180:181]
    v_pk_mul_f32 v[38:39], v[38:39], v[180:181]
    v_cvt_pk_bf16_f32 v128, v32, v33
    v_cvt_pk_bf16_f32 v129, v34, v35
    v_cvt_pk_bf16_f32 v130, v36, v37
    v_cvt_pk_bf16_f32 v131, v38, v39
    buffer_store_dwordx4 v[128:131], v8, s[16:19], s4 offen offset:0 sc1
    v_accvgpr_read_b32 v64, a8
    v_accvgpr_read_b32 v65, a9
    v_accvgpr_read_b32 v66, a10
    v_accvgpr_read_b32 v67, a11
    v_accvgpr_read_b32 v68, a12
    v_accvgpr_read_b32 v69, a13
    v_accvgpr_read_b32 v70, a14
    v_accvgpr_read_b32 v71, a15
    v_pk_mul_f32 v[64:65], v[64:65], v[180:181]
    v_pk_mul_f32 v[66:67], v[66:67], v[180:181]
    v_pk_mul_f32 v[68:69], v[68:69], v[180:181]
    v_pk_mul_f32 v[70:71], v[70:71], v[180:181]
    v_cvt_pk_bf16_f32 v132, v64, v65
    v_cvt_pk_bf16_f32 v133, v66, v67
    v_cvt_pk_bf16_f32 v134, v68, v69
    v_cvt_pk_bf16_f32 v135, v70, v71
    buffer_store_dwordx4 v[132:135], v8, s[16:19], s4 offen offset:1024 sc1
    v_accvgpr_read_b32 v32, a16
    v_accvgpr_read_b32 v33, a17
    v_accvgpr_read_b32 v34, a18
    v_accvgpr_read_b32 v35, a19
    v_accvgpr_read_b32 v36, a20
    v_accvgpr_read_b32 v37, a21
    v_accvgpr_read_b32 v38, a22
    v_accvgpr_read_b32 v39, a23
    v_pk_mul_f32 v[32:33], v[32:33], v[180:181]
    v_pk_mul_f32 v[34:35], v[34:35], v[180:181]
    v_pk_mul_f32 v[36:37], v[36:37], v[180:181]
    v_pk_mul_f32 v[38:39], v[38:39], v[180:181]
    v_cvt_pk_bf16_f32 v144, v32, v33
    v_cvt_pk_bf16_f32 v145, v34, v35
    v_cvt_pk_bf16_f32 v146, v36, v37
    v_cvt_pk_bf16_f32 v147, v38, v39
    buffer_store_dwordx4 v[144:147], v8, s[16:19], s4 offen offset:2048 sc1
    v_accvgpr_read_b32 v64, a24
    v_accvgpr_read_b32 v65, a25
    v_accvgpr_read_b32 v66, a26
    v_accvgpr_read_b32 v67, a27
    v_accvgpr_read_b32 v68, a28
    v_accvgpr_read_b32 v69, a29
    v_accvgpr_read_b32 v70, a30
    v_accvgpr_read_b32 v71, a31
    v_pk_mul_f32 v[64:65], v[64:65], v[180:181]
    v_pk_mul_f32 v[66:67], v[66:67], v[180:181]
    v_pk_mul_f32 v[68:69], v[68:69], v[180:181]
    v_pk_mul_f32 v[70:71], v[70:71], v[180:181]
    v_cvt_pk_bf16_f32 v148, v64, v65
    v_cvt_pk_bf16_f32 v149, v66, v67
    v_cvt_pk_bf16_f32 v150, v68, v69
    v_cvt_pk_bf16_f32 v151, v70, v71
    buffer_store_dwordx4 v[148:151], v8, s[16:19], s4 offen offset:3072 sc1
    v_accvgpr_read_b32 v32, a32
    v_accvgpr_read_b32 v33, a33
    v_accvgpr_read_b32 v34, a34
    v_accvgpr_read_b32 v35, a35
    v_accvgpr_read_b32 v36, a36
    v_accvgpr_read_b32 v37, a37
    v_accvgpr_read_b32 v38, a38
    v_accvgpr_read_b32 v39, a39
    v_pk_mul_f32 v[32:33], v[32:33], v[180:181]
    v_pk_mul_f32 v[34:35], v[34:35], v[180:181]
    v_pk_mul_f32 v[36:37], v[36:37], v[180:181]
    v_pk_mul_f32 v[38:39], v[38:39], v[180:181]
    v_cvt_pk_bf16_f32 v128, v32, v33
    v_cvt_pk_bf16_f32 v129, v34, v35
    v_cvt_pk_bf16_f32 v130, v36, v37
    v_cvt_pk_bf16_f32 v131, v38, v39
    buffer_store_dwordx4 v[128:131], v8, s[16:19], s5 offen offset:0 sc1
    v_accvgpr_read_b32 v64, a40
    v_accvgpr_read_b32 v65, a41
    v_accvgpr_read_b32 v66, a42
    v_accvgpr_read_b32 v67, a43
    v_accvgpr_read_b32 v68, a44
    v_accvgpr_read_b32 v69, a45
    v_accvgpr_read_b32 v70, a46
    v_accvgpr_read_b32 v71, a47
    v_pk_mul_f32 v[64:65], v[64:65], v[180:181]
    v_pk_mul_f32 v[66:67], v[66:67], v[180:181]
    v_pk_mul_f32 v[68:69], v[68:69], v[180:181]
    v_pk_mul_f32 v[70:71], v[70:71], v[180:181]
    v_cvt_pk_bf16_f32 v132, v64, v65
    v_cvt_pk_bf16_f32 v133, v66, v67
    v_cvt_pk_bf16_f32 v134, v68, v69
    v_cvt_pk_bf16_f32 v135, v70, v71
    buffer_store_dwordx4 v[132:135], v8, s[16:19], s5 offen offset:1024 sc1
    v_accvgpr_read_b32 v32, a48
    v_accvgpr_read_b32 v33, a49
    v_accvgpr_read_b32 v34, a50
    v_accvgpr_read_b32 v35, a51
    v_accvgpr_read_b32 v36, a52
    v_accvgpr_read_b32 v37, a53
    v_accvgpr_read_b32 v38, a54
    v_accvgpr_read_b32 v39, a55
    v_pk_mul_f32 v[32:33], v[32:33], v[180:181]
    v_pk_mul_f32 v[34:35], v[34:35], v[180:181]
    v_pk_mul_f32 v[36:37], v[36:37], v[180:181]
    v_pk_mul_f32 v[38:39], v[38:39], v[180:181]
    v_cvt_pk_bf16_f32 v144, v32, v33
    v_cvt_pk_bf16_f32 v145, v34, v35
    v_cvt_pk_bf16_f32 v146, v36, v37
    v_cvt_pk_bf16_f32 v147, v38, v39
    buffer_store_dwordx4 v[144:147], v8, s[16:19], s5 offen offset:2048 sc1
    v_accvgpr_read_b32 v64, a56
    v_accvgpr_read_b32 v65, a57
    v_accvgpr_read_b32 v66, a58
    v_accvgpr_read_b32 v67, a59
    v_accvgpr_read_b32 v68, a60
    v_accvgpr_read_b32 v69, a61
    v_accvgpr_read_b32 v70, a62
    v_accvgpr_read_b32 v71, a63
    v_pk_mul_f32 v[64:65], v[64:65], v[180:181]
    v_pk_mul_f32 v[66:67], v[66:67], v[180:181]
    v_pk_mul_f32 v[68:69], v[68:69], v[180:181]
    v_pk_mul_f32 v[70:71], v[70:71], v[180:181]
    v_cvt_pk_bf16_f32 v148, v64, v65
    v_cvt_pk_bf16_f32 v149, v66, v67
    v_cvt_pk_bf16_f32 v150, v68, v69
    v_cvt_pk_bf16_f32 v151, v70, v71
    buffer_store_dwordx4 v[148:151], v8, s[16:19], s5 offen offset:3072 sc1
.p2align 6
    s_nop 0
    s_nop 0
fk_sloop:
    v_mfma_f32_32x32x16_bf16 v[48:63], a[192:195], v[224:227], v[112:127]
    s_waitcnt vmcnt(8)
    s_barrier
    ds_read_b128 a[224:227], v9 offset:16384
    v_exp_f32 v160, v80
    v_exp_f32 v161, v81
    v_mfma_f32_32x32x16_bf16 v[48:63], a[196:199], v[228:231], v[48:63]
    s_mov_b32 m0, s39
    ds_read_b128 a[232:235], v9 offset:18432
    buffer_load_dwordx4 v8, s[16:19], s46 offen offset:0 sc1 lds
    v_mfma_f32_32x32x16_bf16 v[48:63], a[200:203], v[232:235], v[48:63]
    s_add_u32 s38, s38, 1
    ds_read_b128 a[240:243], v9 offset:20480
    v_exp_f32 v162, v82
    v_add_f32 v179, v177, v160
    v_exp_f32 v163, v83
    v_cvt_pk_bf16_f32 v152, v160, v161
    v_mfma_f32_32x32x16_bf16 v[48:63], a[204:207], v[236:239], v[48:63]
    s_waitcnt lgkmcnt(3)
    ds_read_b128 a[248:251], v9 offset:22528
    v_add_f32 v179, v179, v161
    v_exp_f32 v164, v84
    v_add_f32 v179, v179, v162
    v_mfma_f32_32x32x16_bf16 v[48:63], a[208:211], v[240:243], v[48:63]
    s_cmp_ge_u32 s38, s13
    ds_read_b128 a[228:231], v9 offset:17408
    v_exp_f32 v165, v85
    v_cvt_pk_bf16_f32 v153, v162, v163
    v_add_f32 v179, v179, v163
    v_exp_f32 v166, v86
    v_mfma_f32_32x32x16_bf16 v[48:63], a[212:215], v[244:247], v[48:63]
    s_cselect_b32 s21, s22, s20
    ds_read_b128 a[236:239], v9 offset:19456
    buffer_load_dwordx4 v8, s[16:19], s46 offen offset:1024 sc1 lds
    v_add_f32 v179, v179, v164
    v_mfma_f32_32x32x16_bf16 v[48:63], a[216:219], v[248:251], v[48:63]
    ds_read_b128 a[244:247], v9 offset:21504
    v_exp_f32 v167, v87
    v_cvt_pk_bf16_f32 v154, v164, v165
    v_add_f32 v179, v179, v165
    v_mfma_f32_32x32x16_bf16 v[48:63], a[220:223], v[252:255], v[48:63]
    s_waitcnt lgkmcnt(3)
    ds_read_b128 a[252:255], v9 offset:23552
    v_exp_f32 v168, v88
    v_add_f32 v179, v179, v166
    v_exp_f32 v169, v89
    v_mfma_f32_32x32x16_bf16 a[64:79], a[224:227], v[136:139], a[64:79]
    ds_read_b128 a[192:195], v9 offset:0
    v_cvt_pk_bf16_f32 v155, v166, v167
    v_add_f32 v179, v179, v167
    v_exp_f32 v170, v90
    v_add_f32 v179, v179, v168
    v_mfma_f32_32x32x16_bf16 a[80:95], a[232:235], v[136:139], a[80:95]
    ds_read_b128 a[196:199], v9 offset:1024
    buffer_load_dwordx4 v8, s[16:19], s46 offen offset:2048 sc1 lds
    v_exp_f32 v171, v91
    v_mfma_f32_32x32x16_bf16 a[96:111], a[240:243], v[136:139], a[96:111]
    ds_read_b128 a[200:203], v9 offset:2048
    v_cvt_pk_bf16_f32 v156, v168, v169
    v_add_f32 v179, v179, v169
    v_exp_f32 v172, v92
    v_mfma_f32_32x32x16_bf16 a[112:127], a[248:251], v[136:139], a[112:127]
    s_waitcnt lgkmcnt(3)
    ds_read_b128 a[204:207], v9 offset:3072
    v_add_f32 v179, v179, v170
    v_exp_f32 v173, v93
    v_cvt_pk_bf16_f32 v157, v170, v171
    v_add_f32 v179, v179, v171
    v_mfma_f32_32x32x16_bf16 a[64:79], a[228:231], v[140:143], a[64:79]
    ds_read_b128 a[208:211], v9 offset:4096
    v_exp_f32 v174, v94
    v_add_f32 v179, v179, v172
    v_exp_f32 v175, v95
    v_mfma_f32_32x32x16_bf16 a[80:95], a[236:239], v[140:143], a[80:95]
    ds_read_b128 a[212:215], v9 offset:5120
    buffer_load_dwordx4 v8, s[16:19], s46 offen offset:3072 sc1 lds
    v_cvt_pk_bf16_f32 v158, v172, v173
    v_mfma_f32_32x32x16_bf16 a[96:111], a[244:247], v[140:143], a[96:111]
    ds_read_b128 a[216:219], v9 offset:6144
    v_add_f32 v179, v179, v173
    v_add_f32 v179, v179, v174
    v_cvt_pk_bf16_f32 v159, v174, v175
    v_add_f32 v179, v179, v175
    v_cmp_lt_f32 vcc, s21, v179
    v_mfma_f32_32x32x16_bf16 a[112:127], a[252:255], v[140:143], a[112:127]
    s_waitcnt lgkmcnt(3)
    ds_read_b128 a[220:223], v9 offset:7168
    s_cbranch_vccnz fk_hs0
fk_hs0_ret:
    v_mfma_f32_32x32x16_bf16 v[80:95], a[192:195], v[224:227], v[112:127]
    ds_read_b128 a[224:227], v9 offset:24576
    v_exp_f32 v160, v48
    v_exp_f32 v161, v49
    v_mfma_f32_32x32x16_bf16 v[80:95], a[196:199], v[228:231], v[80:95]
    s_add_u32 m0, s39, 4096
    ds_read_b128 a[232:235], v9 offset:26624
    buffer_load_dwordx4 v12, s[16:19], s46 offen offset:0 sc1 lds
    v_exp_f32 v162, v50
    v_mfma_f32_32x32x16_bf16 v[80:95], a[200:203], v[232:235], v[80:95]
    s_add_u32 s38, s38, 1
    ds_read_b128 a[240:243], v9 offset:28672
    v_add_f32 v177, v179, v160
    v_exp_f32 v163, v51
    v_cvt_pk_bf16_f32 v136, v160, v161
    v_add_f32 v177, v177, v161
    v_mfma_f32_32x32x16_bf16 v[80:95], a[204:207], v[236:239], v[80:95]
    s_waitcnt lgkmcnt(3)
    ds_read_b128 a[248:251], v9 offset:30720
    v_exp_f32 v164, v52
    v_add_f32 v177, v177, v162
    v_exp_f32 v165, v53
    v_mfma_f32_32x32x16_bf16 v[80:95], a[208:211], v[240:243], v[80:95]
    s_cmp_ge_u32 s38, s13
    ds_read_b128 a[228:231], v9 offset:25600
    buffer_load_dwordx4 v12, s[16:19], s46 offen offset:1024 sc1 lds
    v_cvt_pk_bf16_f32 v137, v162, v163
    v_mfma_f32_32x32x16_bf16 v[80:95], a[212:215], v[244:247], v[80:95]
    s_cselect_b32 s21, s22, s20
    ds_read_b128 a[236:239], v9 offset:27648
    v_add_f32 v177, v177, v163
    v_exp_f32 v166, v54
    v_add_f32 v177, v177, v164
    v_mfma_f32_32x32x16_bf16 v[80:95], a[216:219], v[248:251], v[80:95]
    ds_read_b128 a[244:247], v9 offset:29696
    buffer_load_dwordx4 v12, s[16:19], s46 offen offset:2048 sc1 lds
    v_exp_f32 v167, v55
    v_mfma_f32_32x32x16_bf16 v[80:95], a[220:223], v[252:255], v[80:95]
    s_waitcnt lgkmcnt(3)
    ds_read_b128 a[252:255], v9 offset:31744
    v_cvt_pk_bf16_f32 v138, v164, v165
    v_add_f32 v177, v177, v165
    v_exp_f32 v168, v56
    v_mfma_f32_32x32x16_bf16 a[64:79], a[224:227], v[152:155], a[64:79]
    ds_read_b128 a[192:195], v9 offset:8192
    v_add_f32 v177, v177, v166
    v_exp_f32 v169, v57
    v_cvt_pk_bf16_f32 v139, v166, v167
    v_add_f32 v177, v177, v167
    v_mfma_f32_32x32x16_bf16 a[80:95], a[232:235], v[152:155], a[80:95]
    ds_read_b128 a[196:199], v9 offset:9216
    buffer_load_dwordx4 v12, s[16:19], s46 offen offset:3072 sc1 lds
    v_exp_f32 v170, v58
    v_mfma_f32_32x32x16_bf16 a[96:111], a[240:243], v[152:155], a[96:111]
    s_add_u32 s46, s46, 16384
    ds_read_b128 a[200:203], v9 offset:10240
    v_add_f32 v177, v177, v168
    v_exp_f32 v171, v59
    v_cvt_pk_bf16_f32 v140, v168, v169
    v_mfma_f32_32x32x16_bf16 a[112:127], a[248:251], v[152:155], a[112:127]
    s_waitcnt lgkmcnt(3)
    ds_read_b128 a[204:207], v9 offset:11264
    v_add_f32 v177, v177, v169
    v_exp_f32 v172, v60
    v_add_f32 v177, v177, v170
    v_mfma_f32_32x32x16_bf16 a[64:79], a[228:231], v[156:159], a[64:79]
    s_min_u32 s46, s46, s47
    ds_read_b128 a[208:211], v9 offset:12288
    v_exp_f32 v173, v61
    v_cvt_pk_bf16_f32 v141, v170, v171
    v_add_f32 v177, v177, v171
    v_exp_f32 v174, v62
    v_mfma_f32_32x32x16_bf16 a[80:95], a[236:239], v[156:159], a[80:95]
    s_add_u32 s39, s39, 32768
    ds_read_b128 a[212:215], v9 offset:13312
    v_add_f32 v177, v177, v172
    v_exp_f32 v175, v63
    v_cvt_pk_bf16_f32 v142, v172, v173
    v_mfma_f32_32x32x16_bf16 a[96:111], a[244:247], v[156:159], a[96:111]
    s_and_b32 s39, s39, 0x1ffff
    ds_read_b128 a[216:219], v9 offset:14336
    v_add_f32 v177, v177, v173
    v_add_f32 v177, v177, v174
    v_cvt_pk_bf16_f32 v143, v174, v175
    v_add_f32 v177, v177, v175
    v_cmp_lt_f32 vcc, s21, v177
    v_mfma_f32_32x32x16_bf16 a[112:127], a[252:255], v[156:159], a[112:127]
    s_waitcnt lgkmcnt(3)
    ds_read_b128 a[220:223], v9 offset:15360
    v_xad_u32 v9, s39, v14, v13
    s_cbranch_vccnz fk_hs1
fk_hs1_ret:
    s_cmp_lt_u32 s38, s101
    s_cbranch_scc1 fk_sloop
    s_waitcnt vmcnt(8)
    s_barrier
    ds_read_b128 a[224:227], v9 offset:16384
    ds_read_b128 a[232:235], v9 offset:18432
    ds_read_b128 a[240:243], v9 offset:20480
    ds_read_b128 a[248:251], v9 offset:22528
    ds_read_b128 a[228:231], v9 offset:17408
    ds_read_b128 a[236:239], v9 offset:19456
    ds_read_b128 a[244:247], v9 offset:21504
    ds_read_b128 a[252:255], v9 offset:23552
    v_mov_b32 v5, 1
    s_mov_b32 s3, 32768
    buffer_store_dword v5, v11, s[16:19], s3 offen sc1
    v_exp_f32 v160, v80
    v_exp_f32 v161, v81
    v_exp_f32 v162, v82
    v_add_f32 v179, v177, v160
    v_exp_f32 v163, v83
    v_cvt_pk_bf16_f32 v152, v160, v161
    v_add_f32 v179, v179, v161
    v_exp_f32 v164, v84
    v_add_f32 v179, v179, v162
    v_exp_f32 v165, v85
    v_cvt_pk_bf16_f32 v153, v162, v163
    v_add_f32 v179, v179, v163
    s_waitcnt lgkmcnt(4)
    v_mfma_f32_32x32x16_bf16 a[64:79], a[224:227], v[136:139], a[64:79]
    ds_read_b128 a[192:195], v9 offset:24576
    v_exp_f32 v166, v86
    v_add_f32 v179, v179, v164
    v_exp_f32 v167, v87
    v_cvt_pk_bf16_f32 v154, v164, v165
    v_mfma_f32_32x32x16_bf16 a[80:95], a[232:235], v[136:139], a[80:95]
    ds_read_b128 a[200:203], v9 offset:26624
    v_add_f32 v179, v179, v165
    v_exp_f32 v168, v88
    v_add_f32 v179, v179, v166
    v_exp_f32 v169, v89
    v_mfma_f32_32x32x16_bf16 a[96:111], a[240:243], v[136:139], a[96:111]
    ds_read_b128 a[208:211], v9 offset:28672
    v_cvt_pk_bf16_f32 v155, v166, v167
    v_add_f32 v179, v179, v167
    v_exp_f32 v170, v90
    v_add_f32 v179, v179, v168
    v_mfma_f32_32x32x16_bf16 a[112:127], a[248:251], v[136:139], a[112:127]
    ds_read_b128 a[216:219], v9 offset:30720
    v_exp_f32 v171, v91
    v_cvt_pk_bf16_f32 v156, v168, v169
    v_add_f32 v179, v179, v169
    v_exp_f32 v172, v92
    s_waitcnt lgkmcnt(4)
    v_mfma_f32_32x32x16_bf16 a[64:79], a[228:231], v[140:143], a[64:79]
    ds_read_b128 a[196:199], v9 offset:25600
    v_add_f32 v179, v179, v170
    v_exp_f32 v173, v93
    v_cvt_pk_bf16_f32 v157, v170, v171
    v_add_f32 v179, v179, v171
    v_mfma_f32_32x32x16_bf16 a[80:95], a[236:239], v[140:143], a[80:95]
    ds_read_b128 a[204:207], v9 offset:27648
    v_exp_f32 v174, v94
    v_add_f32 v179, v179, v172
    v_exp_f32 v175, v95
    v_mfma_f32_32x32x16_bf16 a[96:111], a[244:247], v[140:143], a[96:111]
    ds_read_b128 a[212:215], v9 offset:29696
    v_cvt_pk_bf16_f32 v158, v172, v173
    v_add_f32 v179, v179, v173
    v_add_f32 v179, v179, v174
    v_cvt_pk_bf16_f32 v159, v174, v175
    v_add_f32 v179, v179, v175
    v_cmp_lt_f32 vcc, s20, v179
    v_mfma_f32_32x32x16_bf16 a[112:127], a[252:255], v[140:143], a[112:127]
    ds_read_b128 a[220:223], v9 offset:31744
    s_cbranch_vccnz fk_ht0
fk_ht0_ret:
    s_waitcnt lgkmcnt(7)
    v_mfma_f32_32x32x16_bf16 a[64:79], a[192:195], v[152:155], a[64:79]
    s_waitcnt lgkmcnt(6)
    v_mfma_f32_32x32x16_bf16 a[80:95], a[200:203], v[152:155], a[80:95]
    s_waitcnt lgkmcnt(5)
    v_mfma_f32_32x32x16_bf16 a[96:111], a[208:211], v[152:155], a[96:111]
    s_waitcnt lgkmcnt(4)
    v_mfma_f32_32x32x16_bf16 a[112:127], a[216:219], v[152:155], a[112:127]
    s_waitcnt lgkmcnt(3)
    v_mfma_f32_32x32x16_bf16 a[64:79], a[196:199], v[156:159], a[64:79]
    s_waitcnt lgkmcnt(2)
    v_mfma_f32_32x32x16_bf16 a[80:95], a[204:207], v[156:159], a[80:95]
    s_waitcnt lgkmcnt(1)
    v_mfma_f32_32x32x16_bf16 a[96:111], a[212:215], v[156:159], a[96:111]
    s_waitcnt lgkmcnt(0)
    v_mfma_f32_32x32x16_bf16 a[112:127], a[220:223], v[156:159], a[112:127]
    s_getpc_b64 s[4:5]
fk_pcb:
    s_add_u32 s4, s4, back_code-fk_pcb
    s_addc_u32 s5, s5, 0
    s_lshr_b32 s3, s2, 3
    s_lshl_b32 s3, s3, 9
    v_and_b32 v16, 3, v0
    v_lshl_add_u32 v16, v16, 7, s3
    v_min_u32 v16, back_p4-back_code-4, v16
    global_load_dword v17, v16, s[4:5]
    s_nop 7
    v_mov_b32 v180, v179
    s_nop 1
    v_permlane32_swap_b32 v179, v180
    s_nop 0
    v_add_f32 v179, v179, v180
    v_rcp_f32 v180, v179
    v_rcp_f32 v181, v179
    s_mul_i32 s4, s37, 262144
    s_lshl_b32 s5, s33, 13
    s_add_u32 s4, s4, s5
    s_add_u32 s4, s4, 37748736
    s_add_u32 s5, s4, 4096
    v_accvgpr_read_b32 v32, a64
    v_accvgpr_read_b32 v33, a65
    v_accvgpr_read_b32 v34, a66
    v_accvgpr_read_b32 v35, a67
    v_accvgpr_read_b32 v36, a68
    v_accvgpr_read_b32 v37, a69
    v_accvgpr_read_b32 v38, a70
    v_accvgpr_read_b32 v39, a71
    v_pk_mul_f32 v[32:33], v[32:33], v[180:181]
    v_pk_mul_f32 v[34:35], v[34:35], v[180:181]
    v_pk_mul_f32 v[36:37], v[36:37], v[180:181]
    v_pk_mul_f32 v[38:39], v[38:39], v[180:181]
    v_cvt_pk_bf16_f32 v128, v32, v33
    v_cvt_pk_bf16_f32 v129, v34, v35
    v_cvt_pk_bf16_f32 v130, v36, v37
    v_cvt_pk_bf16_f32 v131, v38, v39
    buffer_store_dwordx4 v[128:131], v8, s[16:19], s4 offen offset:0 sc1
    v_accvgpr_read_b32 v64, a72
    v_accvgpr_read_b32 v65, a73
    v_accvgpr_read_b32 v66, a74
    v_accvgpr_read_b32 v67, a75
    v_accvgpr_read_b32 v68, a76
    v_accvgpr_read_b32 v69, a77
    v_accvgpr_read_b32 v70, a78
    v_accvgpr_read_b32 v71, a79
    v_pk_mul_f32 v[64:65], v[64:65], v[180:181]
    v_pk_mul_f32 v[66:67], v[66:67], v[180:181]
    v_pk_mul_f32 v[68:69], v[68:69], v[180:181]
    v_pk_mul_f32 v[70:71], v[70:71], v[180:181]
    v_cvt_pk_bf16_f32 v132, v64, v65
    v_cvt_pk_bf16_f32 v133, v66, v67
    v_cvt_pk_bf16_f32 v134, v68, v69
    v_cvt_pk_bf16_f32 v135, v70, v71
    buffer_store_dwordx4 v[132:135], v8, s[16:19], s4 offen offset:1024 sc1
    v_accvgpr_read_b32 v32, a80
    v_accvgpr_read_b32 v33, a81
    v_accvgpr_read_b32 v34, a82
    v_accvgpr_read_b32 v35, a83
    v_accvgpr_read_b32 v36, a84
    v_accvgpr_read_b32 v37, a85
    v_accvgpr_read_b32 v38, a86
    v_accvgpr_read_b32 v39, a87
    v_pk_mul_f32 v[32:33], v[32:33], v[180:181]
    v_pk_mul_f32 v[34:35], v[34:35], v[180:181]
    v_pk_mul_f32 v[36:37], v[36:37], v[180:181]
    v_pk_mul_f32 v[38:39], v[38:39], v[180:181]
    v_cvt_pk_bf16_f32 v144, v32, v33
    v_cvt_pk_bf16_f32 v145, v34, v35
    v_cvt_pk_bf16_f32 v146, v36, v37
    v_cvt_pk_bf16_f32 v147, v38, v39
    buffer_store_dwordx4 v[144:147], v8, s[16:19], s4 offen offset:2048 sc1
    v_accvgpr_read_b32 v64, a88
    v_accvgpr_read_b32 v65, a89
    v_accvgpr_read_b32 v66, a90
    v_accvgpr_read_b32 v67, a91
    v_accvgpr_read_b32 v68, a92
    v_accvgpr_read_b32 v69, a93
    v_accvgpr_read_b32 v70, a94
    v_accvgpr_read_b32 v71, a95
    v_pk_mul_f32 v[64:65], v[64:65], v[180:181]
    v_pk_mul_f32 v[66:67], v[66:67], v[180:181]
    v_pk_mul_f32 v[68:69], v[68:69], v[180:181]
    v_pk_mul_f32 v[70:71], v[70:71], v[180:181]
    v_cvt_pk_bf16_f32 v148, v64, v65
    v_cvt_pk_bf16_f32 v149, v66, v67
    v_cvt_pk_bf16_f32 v150, v68, v69
    v_cvt_pk_bf16_f32 v151, v70, v71
    buffer_store_dwordx4 v[148:151], v8, s[16:19], s4 offen offset:3072 sc1
    v_accvgpr_read_b32 v32, a96
    v_accvgpr_read_b32 v33, a97
    v_accvgpr_read_b32 v34, a98
    v_accvgpr_read_b32 v35, a99
    v_accvgpr_read_b32 v36, a100
    v_accvgpr_read_b32 v37, a101
    v_accvgpr_read_b32 v38, a102
    v_accvgpr_read_b32 v39, a103
    v_pk_mul_f32 v[32:33], v[32:33], v[180:181]
    v_pk_mul_f32 v[34:35], v[34:35], v[180:181]
    v_pk_mul_f32 v[36:37], v[36:37], v[180:181]
    v_pk_mul_f32 v[38:39], v[38:39], v[180:181]
    v_cvt_pk_bf16_f32 v128, v32, v33
    v_cvt_pk_bf16_f32 v129, v34, v35
    v_cvt_pk_bf16_f32 v130, v36, v37
    v_cvt_pk_bf16_f32 v131, v38, v39
    buffer_store_dwordx4 v[128:131], v8, s[16:19], s5 offen offset:0 sc1
    v_accvgpr_read_b32 v64, a104
    v_accvgpr_read_b32 v65, a105
    v_accvgpr_read_b32 v66, a106
    v_accvgpr_read_b32 v67, a107
    v_accvgpr_read_b32 v68, a108
    v_accvgpr_read_b32 v69, a109
    v_accvgpr_read_b32 v70, a110
    v_accvgpr_read_b32 v71, a111
    v_pk_mul_f32 v[64:65], v[64:65], v[180:181]
    v_pk_mul_f32 v[66:67], v[66:67], v[180:181]
    v_pk_mul_f32 v[68:69], v[68:69], v[180:181]
    v_pk_mul_f32 v[70:71], v[70:71], v[180:181]
    v_cvt_pk_bf16_f32 v132, v64, v65
    v_cvt_pk_bf16_f32 v133, v66, v67
    v_cvt_pk_bf16_f32 v134, v68, v69
    v_cvt_pk_bf16_f32 v135, v70, v71
    buffer_store_dwordx4 v[132:135], v8, s[16:19], s5 offen offset:1024 sc1
    v_accvgpr_read_b32 v32, a112
    v_accvgpr_read_b32 v33, a113
    v_accvgpr_read_b32 v34, a114
    v_accvgpr_read_b32 v35, a115
    v_accvgpr_read_b32 v36, a116
    v_accvgpr_read_b32 v37, a117
    v_accvgpr_read_b32 v38, a118
    v_accvgpr_read_b32 v39, a119
    v_pk_mul_f32 v[32:33], v[32:33], v[180:181]
    v_pk_mul_f32 v[34:35], v[34:35], v[180:181]
    v_pk_mul_f32 v[36:37], v[36:37], v[180:181]
    v_pk_mul_f32 v[38:39], v[38:39], v[180:181]
    v_cvt_pk_bf16_f32 v144, v32, v33
    v_cvt_pk_bf16_f32 v145, v34, v35
    v_cvt_pk_bf16_f32 v146, v36, v37
    v_cvt_pk_bf16_f32 v147, v38, v39
    buffer_store_dwordx4 v[144:147], v8, s[16:19], s5 offen offset:2048 sc1
    v_accvgpr_read_b32 v64, a120
    v_accvgpr_read_b32 v65, a121
    v_accvgpr_read_b32 v66, a122
    v_accvgpr_read_b32 v67, a123
    v_accvgpr_read_b32 v68, a124
    v_accvgpr_read_b32 v69, a125
    v_accvgpr_read_b32 v70, a126
    v_accvgpr_read_b32 v71, a127
    v_pk_mul_f32 v[64:65], v[64:65], v[180:181]
    v_pk_mul_f32 v[66:67], v[66:67], v[180:181]
    v_pk_mul_f32 v[68:69], v[68:69], v[180:181]
    v_pk_mul_f32 v[70:71], v[70:71], v[180:181]
    v_cvt_pk_bf16_f32 v148, v64, v65
    v_cvt_pk_bf16_f32 v149, v66, v67
    v_cvt_pk_bf16_f32 v150, v68, v69
    v_cvt_pk_bf16_f32 v151, v70, v71
    buffer_store_dwordx4 v[148:151], v8, s[16:19], s5 offen offset:3072 sc1
    s_branch back_code
fk_end:
    s_endpgm
fk_lnw0:
    s_mov_b32 s5, 100000
fk_lnw0_l:
    s_sleep 8
    buffer_load_dword v47, v44, s[28:31], 0 offen sc1
    s_waitcnt vmcnt(0)
    v_cmp_ne_u32 vcc, 0x01010101, v47
    s_sub_u32 s5, s5, 1
    s_cbranch_vccz fk_lnw0_ret
    s_cmp_lg_u32 s5, 0
    s_cbranch_scc1 fk_lnw0_l
    s_branch fk_lnw0_ret
fk_lnw1:
    s_mov_b32 s5, 100000
fk_lnw1_l:
    s_sleep 8
    buffer_load_dword v47, v44, s[28:31], 0 offen sc1
    s_waitcnt vmcnt(0)
    v_cmp_ne_u32 vcc, 0x01010101, v47
    s_sub_u32 s5, s5, 1
    s_cbranch_vccz fk_lnw1_ret
    s_cmp_lg_u32 s5, 0
    s_cbranch_scc1 fk_lnw1_l
    s_branch fk_lnw1_ret
fk_kvw:
    s_mov_b32 s5, 100000
fk_kvw_l:
    s_sleep 8
    buffer_load_dword v7, v6, s[16:19], 0 offen sc1
    s_waitcnt vmcnt(0)
    v_cmp_gt_u32 vcc, 1, v7
    s_sub_u32 s5, s5, 1
    s_cbranch_vccz fk_kvw_ret
    s_cmp_lg_u32 s5, 0
    s_cbranch_scc1 fk_kvw_l
    s_branch fk_kvw_ret
fk_mfp:
    s_cmp_lt_u32 s38, s36
    s_cbranch_scc1 fk_mfp_n0
    s_cmp_gt_u32 s38, s36
    s_cbranch_scc1 fk_mfp_f0
    v_cndmask_b32 v32, v32, v10, s[48:49]
    v_cndmask_b32 v33, v33, v10, s[50:51]
    v_cndmask_b32 v34, v34, v10, s[52:53]
    v_cndmask_b32 v35, v35, v10, s[54:55]
    v_cndmask_b32 v36, v36, v10, s[56:57]
    v_cndmask_b32 v37, v37, v10, s[58:59]
    v_cndmask_b32 v38, v38, v10, s[60:61]
    v_cndmask_b32 v39, v39, v10, s[62:63]
    v_cndmask_b32 v40, v40, v10, s[64:65]
    v_cndmask_b32 v41, v41, v10, s[66:67]
    v_cndmask_b32 v42, v42, v10, s[68:69]
    v_cndmask_b32 v43, v43, v10, s[70:71]
    v_cndmask_b32 v44, v44, v10, s[72:73]
    v_cndmask_b32 v45, v45, v10, s[74:75]
    v_cndmask_b32 v46, v46, v10, s[76:77]
    v_cndmask_b32 v47, v47, v10, s[78:79]
    s_branch fk_mfp_n0
fk_mfp_f0:
    v_mov_b32 v32, v10
    v_mov_b32 v33, v10
    v_mov_b32 v34, v10
    v_mov_b32 v35, v10
    v_mov_b32 v36, v10
    v_mov_b32 v37, v10
    v_mov_b32 v38, v10
    v_mov_b32 v39, v10
    v_mov_b32 v40, v10
    v_mov_b32 v41, v10
    v_mov_b32 v42, v10
    v_mov_b32 v43, v10
    v_mov_b32 v44, v10
    v_mov_b32 v45, v10
    v_mov_b32 v46, v10
    v_mov_b32 v47, v10
fk_mfp_n0:
    s_branch fk_mfp_ret
fk_mfq:
    s_cmp_lt_u32 s38, s36
    s_cbranch_scc1 fk_mfq_n0
    s_cmp_gt_u32 s38, s36
    s_cbranch_scc1 fk_mfq_f0
    v_cndmask_b32 v64, v64, v10, s[48:49]
    v_cndmask_b32 v65, v65, v10, s[50:51]
    v_cndmask_b32 v66, v66, v10, s[52:53]
    v_cndmask_b32 v67, v67, v10, s[54:55]
    v_cndmask_b32 v68, v68, v10, s[56:57]
    v_cndmask_b32 v69, v69, v10, s[58:59]
    v_cndmask_b32 v70, v70, v10, s[60:61]
    v_cndmask_b32 v71, v71, v10, s[62:63]
    v_cndmask_b32 v72, v72, v10, s[64:65]
    v_cndmask_b32 v73, v73, v10, s[66:67]
    v_cndmask_b32 v74, v74, v10, s[68:69]
    v_cndmask_b32 v75, v75, v10, s[70:71]
    v_cndmask_b32 v76, v76, v10, s[72:73]
    v_cndmask_b32 v77, v77, v10, s[74:75]
    v_cndmask_b32 v78, v78, v10, s[76:77]
    v_cndmask_b32 v79, v79, v10, s[78:79]
    s_branch fk_mfq_n0
fk_mfq_f0:
    v_mov_b32 v64, v10
    v_mov_b32 v65, v10
    v_mov_b32 v66, v10
    v_mov_b32 v67, v10
    v_mov_b32 v68, v10
    v_mov_b32 v69, v10
    v_mov_b32 v70, v10
    v_mov_b32 v71, v10
    v_mov_b32 v72, v10
    v_mov_b32 v73, v10
    v_mov_b32 v74, v10
    v_mov_b32 v75, v10
    v_mov_b32 v76, v10
    v_mov_b32 v77, v10
    v_mov_b32 v78, v10
    v_mov_b32 v79, v10
fk_mfq_n0:
    s_branch fk_mfq_ret
fk_kvx:
    s_mov_b32 s5, 100000
fk_kvx_l:
    s_sleep 8
    buffer_load_dword v7, v6, s[16:19], 0 offen sc1
    s_waitcnt vmcnt(0)
    v_cmp_gt_u32 vcc, 2, v7
    s_sub_u32 s5, s5, 1
    s_cbranch_vccz fk_kvx_ret
    s_cmp_lg_u32 s5, 0
    s_cbranch_scc1 fk_kvx_l
    s_branch fk_kvx_ret
fk_hd0:
    v_cmp_lt_f32 vcc, s20, v180
    s_cmp_lt_u32 s38, s36
    s_cbranch_scc1 fk_hd0_n0
    s_cmp_gt_u32 s38, s36
    s_cbranch_scc1 fk_hd0_f0
    v_cndmask_b32 v32, v32, v10, s[48:49]
    v_cndmask_b32 v33, v33, v10, s[50:51]
    v_cndmask_b32 v34, v34, v10, s[52:53]
    v_cndmask_b32 v35, v35, v10, s[54:55]
    v_cndmask_b32 v36, v36, v10, s[56:57]
    v_cndmask_b32 v37, v37, v10, s[58:59]
    v_cndmask_b32 v38, v38, v10, s[60:61]
    v_cndmask_b32 v39, v39, v10, s[62:63]
    v_cndmask_b32 v40, v40, v10, s[64:65]
    v_cndmask_b32 v41, v41, v10, s[66:67]
    v_cndmask_b32 v42, v42, v10, s[68:69]
    v_cndmask_b32 v43, v43, v10, s[70:71]
    v_cndmask_b32 v44, v44, v10, s[72:73]
    v_cndmask_b32 v45, v45, v10, s[74:75]
    v_cndmask_b32 v46, v46, v10, s[76:77]
    v_cndmask_b32 v47, v47, v10, s[78:79]
    s_branch fk_hd0_n0
fk_hd0_f0:
    v_mov_b32 v32, v10
    v_mov_b32 v33, v10
    v_mov_b32 v34, v10
    v_mov_b32 v35, v10
    v_mov_b32 v36, v10
    v_mov_b32 v37, v10
    v_mov_b32 v38, v10
    v_mov_b32 v39, v10
    v_mov_b32 v40, v10
    v_mov_b32 v41, v10
    v_mov_b32 v42, v10
    v_mov_b32 v43, v10
    v_mov_b32 v44, v10
    v_mov_b32 v45, v10
    v_mov_b32 v46, v10
    v_mov_b32 v47, v10
fk_hd0_n0:
    s_cmp_lt_u32 s38, s37
    s_cbranch_scc1 fk_hd0_n1
    s_cmp_gt_u32 s38, s37
    s_cbranch_scc1 fk_hd0_f1
    v_cndmask_b32 v48, v48, v10, s[48:49]
    v_cndmask_b32 v49, v49, v10, s[50:51]
    v_cndmask_b32 v50, v50, v10, s[52:53]
    v_cndmask_b32 v51, v51, v10, s[54:55]
    v_cndmask_b32 v52, v52, v10, s[56:57]
    v_cndmask_b32 v53, v53, v10, s[58:59]
    v_cndmask_b32 v54, v54, v10, s[60:61]
    v_cndmask_b32 v55, v55, v10, s[62:63]
    v_cndmask_b32 v56, v56, v10, s[64:65]
    v_cndmask_b32 v57, v57, v10, s[66:67]
    v_cndmask_b32 v58, v58, v10, s[68:69]
    v_cndmask_b32 v59, v59, v10, s[70:71]
    v_cndmask_b32 v60, v60, v10, s[72:73]
    v_cndmask_b32 v61, v61, v10, s[74:75]
    v_cndmask_b32 v62, v62, v10, s[76:77]
    v_cndmask_b32 v63, v63, v10, s[78:79]
    s_branch fk_hd0_n1
fk_hd0_f1:
    v_mov_b32 v48, v10
    v_mov_b32 v49, v10
    v_mov_b32 v50, v10
    v_mov_b32 v51, v10
    v_mov_b32 v52, v10
    v_mov_b32 v53, v10
    v_mov_b32 v54, v10
    v_mov_b32 v55, v10
    v_mov_b32 v56, v10
    v_mov_b32 v57, v10
    v_mov_b32 v58, v10
    v_mov_b32 v59, v10
    v_mov_b32 v60, v10
    v_mov_b32 v61, v10
    v_mov_b32 v62, v10
    v_mov_b32 v63, v10
fk_hd0_n1:
    s_cbranch_vccz fk_hd0_ret
    s_branch fk_hd0_fb
fk_hd1:
    v_cmp_lt_f32 vcc, s20, v180
    s_cmp_lt_u32 s38, s36
    s_cbranch_scc1 fk_hd1_n0
    s_cmp_gt_u32 s38, s36
    s_cbranch_scc1 fk_hd1_f0
    v_cndmask_b32 v64, v64, v10, s[48:49]
    v_cndmask_b32 v65, v65, v10, s[50:51]
    v_cndmask_b32 v66, v66, v10, s[52:53]
    v_cndmask_b32 v67, v67, v10, s[54:55]
    v_cndmask_b32 v68, v68, v10, s[56:57]
    v_cndmask_b32 v69, v69, v10, s[58:59]
    v_cndmask_b32 v70, v70, v10, s[60:61]
    v_cndmask_b32 v71, v71, v10, s[62:63]
    v_cndmask_b32 v72, v72, v10, s[64:65]
    v_cndmask_b32 v73, v73, v10, s[66:67]
    v_cndmask_b32 v74, v74, v10, s[68:69]
    v_cndmask_b32 v75, v75, v10, s[70:71]
    v_cndmask_b32 v76, v76, v10, s[72:73]
    v_cndmask_b32 v77, v77, v10, s[74:75]
    v_cndmask_b32 v78, v78, v10, s[76:77]
    v_cndmask_b32 v79, v79, v10, s[78:79]
    s_branch fk_hd1_n0
fk_hd1_f0:
    v_mov_b32 v64, v10
    v_mov_b32 v65, v10
    v_mov_b32 v66, v10
    v_mov_b32 v67, v10
    v_mov_b32 v68, v10
    v_mov_b32 v69, v10
    v_mov_b32 v70, v10
    v_mov_b32 v71, v10
    v_mov_b32 v72, v10
    v_mov_b32 v73, v10
    v_mov_b32 v74, v10
    v_mov_b32 v75, v10
    v_mov_b32 v76, v10
    v_mov_b32 v77, v10
    v_mov_b32 v78, v10
    v_mov_b32 v79, v10
fk_hd1_n0:
    s_cmp_lt_u32 s38, s37
    s_cbranch_scc1 fk_hd1_n1
    s_cmp_gt_u32 s38, s37
    s_cbranch_scc1 fk_hd1_f1
    v_cndmask_b32 v80, v80, v10, s[48:49]
    v_cndmask_b32 v81, v81, v10, s[50:51]
    v_cndmask_b32 v82, v82, v10, s[52:53]
    v_cndmask_b32 v83, v83, v10, s[54:55]
    v_cndmask_b32 v84, v84, v10, s[56:57]
    v_cndmask_b32 v85, v85, v10, s[58:59]
    v_cndmask_b32 v86, v86, v10, s[60:61]
    v_cndmask_b32 v87, v87, v10, s[62:63]
    v_cndmask_b32 v88, v88, v10, s[64:65]
    v_cndmask_b32 v89, v89, v10, s[66:67]
    v_cndmask_b32 v90, v90, v10, s[68:69]
    v_cndmask_b32 v91, v91, v10, s[70:71]
    v_cndmask_b32 v92, v92, v10, s[72:73]
    v_cndmask_b32 v93, v93, v10, s[74:75]
    v_cndmask_b32 v94, v94, v10, s[76:77]
    v_cndmask_b32 v95, v95, v10, s[78:79]
    s_branch fk_hd1_n1
fk_hd1_f1:
    v_mov_b32 v80, v10
    v_mov_b32 v81, v10
    v_mov_b32 v82, v10
    v_mov_b32 v83, v10
    v_mov_b32 v84, v10
    v_mov_b32 v85, v10
    v_mov_b32 v86, v10
    v_mov_b32 v87, v10
    v_mov_b32 v88, v10
    v_mov_b32 v89, v10
    v_mov_b32 v90, v10
    v_mov_b32 v91, v10
    v_mov_b32 v92, v10
    v_mov_b32 v93, v10
    v_mov_b32 v94, v10
    v_mov_b32 v95, v10
fk_hd1_n1:
    s_cbranch_vccz fk_hd1_ret
    s_branch fk_hd1_fb
fk_he0:
    v_cmp_lt_f32 vcc, s20, v180
    s_cmp_lt_u32 s38, s37
    s_cbranch_scc1 fk_he0_n1
    s_cmp_gt_u32 s38, s37
    s_cbranch_scc1 fk_he0_f1
    v_cndmask_b32 v48, v48, v10, s[48:49]
    v_cndmask_b32 v49, v49, v10, s[50:51]
    v_cndmask_b32 v50, v50, v10, s[52:53]
    v_cndmask_b32 v51, v51, v10, s[54:55]
    v_cndmask_b32 v52, v52, v10, s[56:57]
    v_cndmask_b32 v53, v53, v10, s[58:59]
    v_cndmask_b32 v54, v54, v10, s[60:61]
    v_cndmask_b32 v55, v55, v10, s[62:63]
    v_cndmask_b32 v56, v56, v10, s[64:65]
    v_cndmask_b32 v57, v57, v10, s[66:67]
    v_cndmask_b32 v58, v58, v10, s[68:69]
    v_cndmask_b32 v59, v59, v10, s[70:71]
    v_cndmask_b32 v60, v60, v10, s[72:73]
    v_cndmask_b32 v61, v61, v10, s[74:75]
    v_cndmask_b32 v62, v62, v10, s[76:77]
    v_cndmask_b32 v63, v63, v10, s[78:79]
    s_branch fk_he0_n1
fk_he0_f1:
    v_mov_b32 v48, v10
    v_mov_b32 v49, v10
    v_mov_b32 v50, v10
    v_mov_b32 v51, v10
    v_mov_b32 v52, v10
    v_mov_b32 v53, v10
    v_mov_b32 v54, v10
    v_mov_b32 v55, v10
    v_mov_b32 v56, v10
    v_mov_b32 v57, v10
    v_mov_b32 v58, v10
    v_mov_b32 v59, v10
    v_mov_b32 v60, v10
    v_mov_b32 v61, v10
    v_mov_b32 v62, v10
    v_mov_b32 v63, v10
fk_he0_n1:
    s_cbranch_vccz fk_he0_ret
    s_branch fk_he0_fb
fk_he1:
    v_cmp_lt_f32 vcc, s20, v177
    s_cmp_lt_u32 s38, s37
    s_cbranch_scc1 fk_he1_n1
    s_cmp_gt_u32 s38, s37
    s_cbranch_scc1 fk_he1_f1
    v_cndmask_b32 v80, v80, v10, s[48:49]
    v_cndmask_b32 v81, v81, v10, s[50:51]
    v_cndmask_b32 v82, v82, v10, s[52:53]
    v_cndmask_b32 v83, v83, v10, s[54:55]
    v_cndmask_b32 v84, v84, v10, s[56:57]
    v_cndmask_b32 v85, v85, v10, s[58:59]
    v_cndmask_b32 v86, v86, v10, s[60:61]
    v_cndmask_b32 v87, v87, v10, s[62:63]
    v_cndmask_b32 v88, v88, v10, s[64:65]
    v_cndmask_b32 v89, v89, v10, s[66:67]
    v_cndmask_b32 v90, v90, v10, s[68:69]
    v_cndmask_b32 v91, v91, v10, s[70:71]
    v_cndmask_b32 v92, v92, v10, s[72:73]
    v_cndmask_b32 v93, v93, v10, s[74:75]
    v_cndmask_b32 v94, v94, v10, s[76:77]
    v_cndmask_b32 v95, v95, v10, s[78:79]
    s_branch fk_he1_n1
fk_he1_f1:
    v_mov_b32 v80, v10
    v_mov_b32 v81, v10
    v_mov_b32 v82, v10
    v_mov_b32 v83, v10
    v_mov_b32 v84, v10
    v_mov_b32 v85, v10
    v_mov_b32 v86, v10
    v_mov_b32 v87, v10
    v_mov_b32 v88, v10
    v_mov_b32 v89, v10
    v_mov_b32 v90, v10
    v_mov_b32 v91, v10
    v_mov_b32 v92, v10
    v_mov_b32 v93, v10
    v_mov_b32 v94, v10
    v_mov_b32 v95, v10
fk_he1_n1:
    s_cbranch_vccz fk_he1_ret
    s_branch fk_he1_fb
fk_hs0:
    v_cmp_lt_f32 vcc, s20, v179
    s_cmp_lt_u32 s38, s37
    s_cbranch_scc1 fk_hs0_n1
    s_cmp_gt_u32 s38, s37
    s_cbranch_scc1 fk_hs0_f1
    v_cndmask_b32 v48, v48, v10, s[48:49]
    v_cndmask_b32 v49, v49, v10, s[50:51]
    v_cndmask_b32 v50, v50, v10, s[52:53]
    v_cndmask_b32 v51, v51, v10, s[54:55]
    v_cndmask_b32 v52, v52, v10, s[56:57]
    v_cndmask_b32 v53, v53, v10, s[58:59]
    v_cndmask_b32 v54, v54, v10, s[60:61]
    v_cndmask_b32 v55, v55, v10, s[62:63]
    v_cndmask_b32 v56, v56, v10, s[64:65]
    v_cndmask_b32 v57, v57, v10, s[66:67]
    v_cndmask_b32 v58, v58, v10, s[68:69]
    v_cndmask_b32 v59, v59, v10, s[70:71]
    v_cndmask_b32 v60, v60, v10, s[72:73]
    v_cndmask_b32 v61, v61, v10, s[74:75]
    v_cndmask_b32 v62, v62, v10, s[76:77]
    v_cndmask_b32 v63, v63, v10, s[78:79]
    s_branch fk_hs0_n1
fk_hs0_f1:
    v_mov_b32 v48, v10
    v_mov_b32 v49, v10
    v_mov_b32 v50, v10
    v_mov_b32 v51, v10
    v_mov_b32 v52, v10
    v_mov_b32 v53, v10
    v_mov_b32 v54, v10
    v_mov_b32 v55, v10
    v_mov_b32 v56, v10
    v_mov_b32 v57, v10
    v_mov_b32 v58, v10
    v_mov_b32 v59, v10
    v_mov_b32 v60, v10
    v_mov_b32 v61, v10
    v_mov_b32 v62, v10
    v_mov_b32 v63, v10
fk_hs0_n1:
    s_cbranch_vccz fk_hs0_ret
    s_branch fk_hs0_fb
fk_hs1:
    v_cmp_lt_f32 vcc, s20, v177
    s_cmp_lt_u32 s38, s37
    s_cbranch_scc1 fk_hs1_n1
    s_cmp_gt_u32 s38, s37
    s_cbranch_scc1 fk_hs1_f1
    v_cndmask_b32 v80, v80, v10, s[48:49]
    v_cndmask_b32 v81, v81, v10, s[50:51]
    v_cndmask_b32 v82, v82, v10, s[52:53]
    v_cndmask_b32 v83, v83, v10, s[54:55]
    v_cndmask_b32 v84, v84, v10, s[56:57]
    v_cndmask_b32 v85, v85, v10, s[58:59]
    v_cndmask_b32 v86, v86, v10, s[60:61]
    v_cndmask_b32 v87, v87, v10, s[62:63]
    v_cndmask_b32 v88, v88, v10, s[64:65]
    v_cndmask_b32 v89, v89, v10, s[66:67]
    v_cndmask_b32 v90, v90, v10, s[68:69]
    v_cndmask_b32 v91, v91, v10, s[70:71]
    v_cndmask_b32 v92, v92, v10, s[72:73]
    v_cndmask_b32 v93, v93, v10, s[74:75]
    v_cndmask_b32 v94, v94, v10, s[76:77]
    v_cndmask_b32 v95, v95, v10, s[78:79]
    s_branch fk_hs1_n1
fk_hs1_f1:
    v_mov_b32 v80, v10
    v_mov_b32 v81, v10
    v_mov_b32 v82, v10
    v_mov_b32 v83, v10
    v_mov_b32 v84, v10
    v_mov_b32 v85, v10
    v_mov_b32 v86, v10
    v_mov_b32 v87, v10
    v_mov_b32 v88, v10
    v_mov_b32 v89, v10
    v_mov_b32 v90, v10
    v_mov_b32 v91, v10
    v_mov_b32 v92, v10
    v_mov_b32 v93, v10
    v_mov_b32 v94, v10
    v_mov_b32 v95, v10
fk_hs1_n1:
    s_cbranch_vccz fk_hs1_ret
    s_branch fk_hs1_fb
fk_ht0:
    v_cmp_lt_f32 vcc, s20, v179
    s_cbranch_vccz fk_ht0_ret
    s_branch fk_ht0_fb
fk_fbstart:
fk_hd0_fb:
    s_nop 15
    v_max3_f32 v180, v64, v65, v66
    v_max3_f32 v180, v180, v67, v68
    v_max3_f32 v180, v180, v69, v70
    v_max3_f32 v180, v180, v71, v72
    v_max3_f32 v180, v180, v73, v74
    v_max3_f32 v180, v180, v75, v76
    v_max3_f32 v180, v180, v77, v78
    v_max_f32 v180, v180, v79
    v_mov_b32 v181, v180
    s_nop 1
    v_permlane32_swap_b32 v180, v181
    s_nop 0
    v_max_f32 v180, v180, v181
    v_max_f32 v180, 0, v180
    v_sub_f32 v64, v64, v180
    v_sub_f32 v65, v65, v180
    v_sub_f32 v66, v66, v180
    v_sub_f32 v67, v67, v180
    v_sub_f32 v68, v68, v180
    v_sub_f32 v69, v69, v180
    v_sub_f32 v70, v70, v180
    v_sub_f32 v71, v71, v180
    v_sub_f32 v72, v72, v180
    v_sub_f32 v73, v73, v180
    v_sub_f32 v74, v74, v180
    v_sub_f32 v75, v75, v180
    v_sub_f32 v76, v76, v180
    v_sub_f32 v77, v77, v180
    v_sub_f32 v78, v78, v180
    v_sub_f32 v79, v79, v180
    v_sub_f32 v32, v32, v180
    v_sub_f32 v33, v33, v180
    v_sub_f32 v34, v34, v180
    v_sub_f32 v35, v35, v180
    v_sub_f32 v36, v36, v180
    v_sub_f32 v37, v37, v180
    v_sub_f32 v38, v38, v180
    v_sub_f32 v39, v39, v180
    v_sub_f32 v40, v40, v180
    v_sub_f32 v41, v41, v180
    v_sub_f32 v42, v42, v180
    v_sub_f32 v43, v43, v180
    v_sub_f32 v44, v44, v180
    v_sub_f32 v45, v45, v180
    v_sub_f32 v46, v46, v180
    v_sub_f32 v47, v47, v180
    v_sub_f32 v96, v96, v180
    v_sub_f32 v97, v97, v180
    v_sub_f32 v98, v98, v180
    v_sub_f32 v99, v99, v180
    v_sub_f32 v100, v100, v180
    v_sub_f32 v101, v101, v180
    v_sub_f32 v102, v102, v180
    v_sub_f32 v103, v103, v180
    v_sub_f32 v104, v104, v180
    v_sub_f32 v105, v105, v180
    v_sub_f32 v106, v106, v180
    v_sub_f32 v107, v107, v180
    v_sub_f32 v108, v108, v180
    v_sub_f32 v109, v109, v180
    v_sub_f32 v110, v110, v180
    v_sub_f32 v111, v111, v180
    v_sub_f32 v180, 0, v180
    v_exp_f32 v180, v180
    s_nop 0
    v_mul_f32 v176, v176, v180
    v_accvgpr_read_b32 v160, a0
    v_accvgpr_read_b32 v161, a1
    v_accvgpr_read_b32 v162, a2
    v_accvgpr_read_b32 v163, a3
    v_mul_f32 v160, v160, v180
    v_mul_f32 v161, v161, v180
    v_mul_f32 v162, v162, v180
    v_mul_f32 v163, v163, v180
    v_accvgpr_write_b32 a0, v160
    v_accvgpr_write_b32 a1, v161
    v_accvgpr_write_b32 a2, v162
    v_accvgpr_write_b32 a3, v163
    v_accvgpr_read_b32 v160, a4
    v_accvgpr_read_b32 v161, a5
    v_accvgpr_read_b32 v162, a6
    v_accvgpr_read_b32 v163, a7
    v_mul_f32 v160, v160, v180
    v_mul_f32 v161, v161, v180
    v_mul_f32 v162, v162, v180
    v_mul_f32 v163, v163, v180
    v_accvgpr_write_b32 a4, v160
    v_accvgpr_write_b32 a5, v161
    v_accvgpr_write_b32 a6, v162
    v_accvgpr_write_b32 a7, v163
    v_accvgpr_read_b32 v160, a8
    v_accvgpr_read_b32 v161, a9
    v_accvgpr_read_b32 v162, a10
    v_accvgpr_read_b32 v163, a11
    v_mul_f32 v160, v160, v180
    v_mul_f32 v161, v161, v180
    v_mul_f32 v162, v162, v180
    v_mul_f32 v163, v163, v180
    v_accvgpr_write_b32 a8, v160
    v_accvgpr_write_b32 a9, v161
    v_accvgpr_write_b32 a10, v162
    v_accvgpr_write_b32 a11, v163
    v_accvgpr_read_b32 v160, a12
    v_accvgpr_read_b32 v161, a13
    v_accvgpr_read_b32 v162, a14
    v_accvgpr_read_b32 v163, a15
    v_mul_f32 v160, v160, v180
    v_mul_f32 v161, v161, v180
    v_mul_f32 v162, v162, v180
    v_mul_f32 v163, v163, v180
    v_accvgpr_write_b32 a12, v160
    v_accvgpr_write_b32 a13, v161
    v_accvgpr_write_b32 a14, v162
    v_accvgpr_write_b32 a15, v163
    v_accvgpr_read_b32 v160, a16
    v_accvgpr_read_b32 v161, a17
    v_accvgpr_read_b32 v162, a18
    v_accvgpr_read_b32 v163, a19
    v_mul_f32 v160, v160, v180
    v_mul_f32 v161, v161, v180
    v_mul_f32 v162, v162, v180
    v_mul_f32 v163, v163, v180
    v_accvgpr_write_b32 a16, v160
    v_accvgpr_write_b32 a17, v161
    v_accvgpr_write_b32 a18, v162
    v_accvgpr_write_b32 a19, v163
    v_accvgpr_read_b32 v160, a20
    v_accvgpr_read_b32 v161, a21
    v_accvgpr_read_b32 v162, a22
    v_accvgpr_read_b32 v163, a23
    v_mul_f32 v160, v160, v180
    v_mul_f32 v161, v161, v180
    v_mul_f32 v162, v162, v180
    v_mul_f32 v163, v163, v180
    v_accvgpr_write_b32 a20, v160
    v_accvgpr_write_b32 a21, v161
    v_accvgpr_write_b32 a22, v162
    v_accvgpr_write_b32 a23, v163
    v_accvgpr_read_b32 v160, a24
    v_accvgpr_read_b32 v161, a25
    v_accvgpr_read_b32 v162, a26
    v_accvgpr_read_b32 v163, a27
    v_mul_f32 v160, v160, v180
    v_mul_f32 v161, v161, v180
    v_mul_f32 v162, v162, v180
    v_mul_f32 v163, v163, v180
    v_accvgpr_write_b32 a24, v160
    v_accvgpr_write_b32 a25, v161
    v_accvgpr_write_b32 a26, v162
    v_accvgpr_write_b32 a27, v163
    v_accvgpr_read_b32 v160, a28
    v_accvgpr_read_b32 v161, a29
    v_accvgpr_read_b32 v162, a30
    v_accvgpr_read_b32 v163, a31
    v_mul_f32 v160, v160, v180
    v_mul_f32 v161, v161, v180
    v_mul_f32 v162, v162, v180
    v_mul_f32 v163, v163, v180
    v_accvgpr_write_b32 a28, v160
    v_accvgpr_write_b32 a29, v161
    v_accvgpr_write_b32 a30, v162
    v_accvgpr_write_b32 a31, v163
    v_accvgpr_read_b32 v160, a32
    v_accvgpr_read_b32 v161, a33
    v_accvgpr_read_b32 v162, a34
    v_accvgpr_read_b32 v163, a35
    v_mul_f32 v160, v160, v180
    v_mul_f32 v161, v161, v180
    v_mul_f32 v162, v162, v180
    v_mul_f32 v163, v163, v180
    v_accvgpr_write_b32 a32, v160
    v_accvgpr_write_b32 a33, v161
    v_accvgpr_write_b32 a34, v162
    v_accvgpr_write_b32 a35, v163
    v_accvgpr_read_b32 v160, a36
    v_accvgpr_read_b32 v161, a37
    v_accvgpr_read_b32 v162, a38
    v_accvgpr_read_b32 v163, a39
    v_mul_f32 v160, v160, v180
    v_mul_f32 v161, v161, v180
    v_mul_f32 v162, v162, v180
    v_mul_f32 v163, v163, v180
    v_accvgpr_write_b32 a36, v160
    v_accvgpr_write_b32 a37, v161
    v_accvgpr_write_b32 a38, v162
    v_accvgpr_write_b32 a39, v163
    v_accvgpr_read_b32 v160, a40
    v_accvgpr_read_b32 v161, a41
    v_accvgpr_read_b32 v162, a42
    v_accvgpr_read_b32 v163, a43
    v_mul_f32 v160, v160, v180
    v_mul_f32 v161, v161, v180
    v_mul_f32 v162, v162, v180
    v_mul_f32 v163, v163, v180
    v_accvgpr_write_b32 a40, v160
    v_accvgpr_write_b32 a41, v161
    v_accvgpr_write_b32 a42, v162
    v_accvgpr_write_b32 a43, v163
    v_accvgpr_read_b32 v160, a44
    v_accvgpr_read_b32 v161, a45
    v_accvgpr_read_b32 v162, a46
    v_accvgpr_read_b32 v163, a47
    v_mul_f32 v160, v160, v180
    v_mul_f32 v161, v161, v180
    v_mul_f32 v162, v162, v180
    v_mul_f32 v163, v163, v180
    v_accvgpr_write_b32 a44, v160
    v_accvgpr_write_b32 a45, v161
    v_accvgpr_write_b32 a46, v162
    v_accvgpr_write_b32 a47, v163
    v_accvgpr_read_b32 v160, a48
    v_accvgpr_read_b32 v161, a49
    v_accvgpr_read_b32 v162, a50
    v_accvgpr_read_b32 v163, a51
    v_mul_f32 v160, v160, v180
    v_mul_f32 v161, v161, v180
    v_mul_f32 v162, v162, v180
    v_mul_f32 v163, v163, v180
    v_accvgpr_write_b32 a48, v160
    v_accvgpr_write_b32 a49, v161
    v_accvgpr_write_b32 a50, v162
    v_accvgpr_write_b32 a51, v163
    v_accvgpr_read_b32 v160, a52
    v_accvgpr_read_b32 v161, a53
    v_accvgpr_read_b32 v162, a54
    v_accvgpr_read_b32 v163, a55
    v_mul_f32 v160, v160, v180
    v_mul_f32 v161, v161, v180
    v_mul_f32 v162, v162, v180
    v_mul_f32 v163, v163, v180
    v_accvgpr_write_b32 a52, v160
    v_accvgpr_write_b32 a53, v161
    v_accvgpr_write_b32 a54, v162
    v_accvgpr_write_b32 a55, v163
    v_accvgpr_read_b32 v160, a56
    v_accvgpr_read_b32 v161, a57
    v_accvgpr_read_b32 v162, a58
    v_accvgpr_read_b32 v163, a59
    v_mul_f32 v160, v160, v180
    v_mul_f32 v161, v161, v180
    v_mul_f32 v162, v162, v180
    v_mul_f32 v163, v163, v180
    v_accvgpr_write_b32 a56, v160
    v_accvgpr_write_b32 a57, v161
    v_accvgpr_write_b32 a58, v162
    v_accvgpr_write_b32 a59, v163
    v_accvgpr_read_b32 v160, a60
    v_accvgpr_read_b32 v161, a61
    v_accvgpr_read_b32 v162, a62
    v_accvgpr_read_b32 v163, a63
    v_mul_f32 v160, v160, v180
    v_mul_f32 v161, v161, v180
    v_mul_f32 v162, v162, v180
    v_mul_f32 v163, v163, v180
    v_accvgpr_write_b32 a60, v160
    v_accvgpr_write_b32 a61, v161
    v_accvgpr_write_b32 a62, v162
    v_accvgpr_write_b32 a63, v163
    v_exp_f32 v160, v64
    v_exp_f32 v161, v65
    v_exp_f32 v162, v66
    v_add_f32 v178, v176, v160
    v_exp_f32 v163, v67
    v_cvt_pk_bf16_f32 v144, v160, v161
    v_add_f32 v178, v178, v161
    v_exp_f32 v164, v68
    v_add_f32 v178, v178, v162
    v_exp_f32 v165, v69
    v_cvt_pk_bf16_f32 v145, v162, v163
    v_add_f32 v178, v178, v163
    v_exp_f32 v166, v70
    v_add_f32 v178, v178, v164
    v_exp_f32 v167, v71
    v_cvt_pk_bf16_f32 v146, v164, v165
    v_add_f32 v178, v178, v165
    v_exp_f32 v168, v72
    v_add_f32 v178, v178, v166
    v_exp_f32 v169, v73
    v_cvt_pk_bf16_f32 v147, v166, v167
    v_add_f32 v178, v178, v167
    v_exp_f32 v170, v74
    v_add_f32 v178, v178, v168
    v_exp_f32 v171, v75
    v_cvt_pk_bf16_f32 v148, v168, v169
    v_add_f32 v178, v178, v169
    v_exp_f32 v172, v76
    v_add_f32 v178, v178, v170
    v_exp_f32 v173, v77
    v_cvt_pk_bf16_f32 v149, v170, v171
    v_add_f32 v178, v178, v171
    v_exp_f32 v174, v78
    v_add_f32 v178, v178, v172
    v_exp_f32 v175, v79
    v_cvt_pk_bf16_f32 v150, v172, v173
    v_add_f32 v178, v178, v173
    v_add_f32 v178, v178, v174
    v_cvt_pk_bf16_f32 v151, v174, v175
    v_add_f32 v178, v178, v175
    v_max3_f32 v180, v80, v81, v82
    v_max3_f32 v180, v180, v83, v84
    v_max3_f32 v180, v180, v85, v86
    v_max3_f32 v180, v180, v87, v88
    v_max3_f32 v180, v180, v89, v90
    v_max3_f32 v180, v180, v91, v92
    v_max3_f32 v180, v180, v93, v94
    v_max_f32 v180, v180, v95
    v_mov_b32 v181, v180
    s_nop 1
    v_permlane32_swap_b32 v180, v181
    s_nop 0
    v_max_f32 v180, v180, v181
    v_max_f32 v180, 0, v180
    v_sub_f32 v80, v80, v180
    v_sub_f32 v81, v81, v180
    v_sub_f32 v82, v82, v180
    v_sub_f32 v83, v83, v180
    v_sub_f32 v84, v84, v180
    v_sub_f32 v85, v85, v180
    v_sub_f32 v86, v86, v180
    v_sub_f32 v87, v87, v180
    v_sub_f32 v88, v88, v180
    v_sub_f32 v89, v89, v180
    v_sub_f32 v90, v90, v180
    v_sub_f32 v91, v91, v180
    v_sub_f32 v92, v92, v180
    v_sub_f32 v93, v93, v180
    v_sub_f32 v94, v94, v180
    v_sub_f32 v95, v95, v180
    v_sub_f32 v48, v48, v180
    v_sub_f32 v49, v49, v180
    v_sub_f32 v50, v50, v180
    v_sub_f32 v51, v51, v180
    v_sub_f32 v52, v52, v180
    v_sub_f32 v53, v53, v180
    v_sub_f32 v54, v54, v180
    v_sub_f32 v55, v55, v180
    v_sub_f32 v56, v56, v180
    v_sub_f32 v57, v57, v180
    v_sub_f32 v58, v58, v180
    v_sub_f32 v59, v59, v180
    v_sub_f32 v60, v60, v180
    v_sub_f32 v61, v61, v180
    v_sub_f32 v62, v62, v180
    v_sub_f32 v63, v63, v180
    v_sub_f32 v112, v112, v180
    v_sub_f32 v113, v113, v180
    v_sub_f32 v114, v114, v180
    v_sub_f32 v115, v115, v180
    v_sub_f32 v116, v116, v180
    v_sub_f32 v117, v117, v180
    v_sub_f32 v118, v118, v180
    v_sub_f32 v119, v119, v180
    v_sub_f32 v120, v120, v180
    v_sub_f32 v121, v121, v180
    v_sub_f32 v122, v122, v180
    v_sub_f32 v123, v123, v180
    v_sub_f32 v124, v124, v180
    v_sub_f32 v125, v125, v180
    v_sub_f32 v126, v126, v180
    v_sub_f32 v127, v127, v180
    v_sub_f32 v180, 0, v180
    v_exp_f32 v180, v180
    s_nop 0
    v_mul_f32 v177, v177, v180
    v_accvgpr_read_b32 v160, a64
    v_accvgpr_read_b32 v161, a65
    v_accvgpr_read_b32 v162, a66
    v_accvgpr_read_b32 v163, a67
    v_mul_f32 v160, v160, v180
    v_mul_f32 v161, v161, v180
    v_mul_f32 v162, v162, v180
    v_mul_f32 v163, v163, v180
    v_accvgpr_write_b32 a64, v160
    v_accvgpr_write_b32 a65, v161
    v_accvgpr_write_b32 a66, v162
    v_accvgpr_write_b32 a67, v163
    v_accvgpr_read_b32 v160, a68
    v_accvgpr_read_b32 v161, a69
    v_accvgpr_read_b32 v162, a70
    v_accvgpr_read_b32 v163, a71
    v_mul_f32 v160, v160, v180
    v_mul_f32 v161, v161, v180
    v_mul_f32 v162, v162, v180
    v_mul_f32 v163, v163, v180
    v_accvgpr_write_b32 a68, v160
    v_accvgpr_write_b32 a69, v161
    v_accvgpr_write_b32 a70, v162
    v_accvgpr_write_b32 a71, v163
    v_accvgpr_read_b32 v160, a72
    v_accvgpr_read_b32 v161, a73
    v_accvgpr_read_b32 v162, a74
    v_accvgpr_read_b32 v163, a75
    v_mul_f32 v160, v160, v180
    v_mul_f32 v161, v161, v180
    v_mul_f32 v162, v162, v180
    v_mul_f32 v163, v163, v180
    v_accvgpr_write_b32 a72, v160
    v_accvgpr_write_b32 a73, v161
    v_accvgpr_write_b32 a74, v162
    v_accvgpr_write_b32 a75, v163
    v_accvgpr_read_b32 v160, a76
    v_accvgpr_read_b32 v161, a77
    v_accvgpr_read_b32 v162, a78
    v_accvgpr_read_b32 v163, a79
    v_mul_f32 v160, v160, v180
    v_mul_f32 v161, v161, v180
    v_mul_f32 v162, v162, v180
    v_mul_f32 v163, v163, v180
    v_accvgpr_write_b32 a76, v160
    v_accvgpr_write_b32 a77, v161
    v_accvgpr_write_b32 a78, v162
    v_accvgpr_write_b32 a79, v163
    v_accvgpr_read_b32 v160, a80
    v_accvgpr_read_b32 v161, a81
    v_accvgpr_read_b32 v162, a82
    v_accvgpr_read_b32 v163, a83
    v_mul_f32 v160, v160, v180
    v_mul_f32 v161, v161, v180
    v_mul_f32 v162, v162, v180
    v_mul_f32 v163, v163, v180
    v_accvgpr_write_b32 a80, v160
    v_accvgpr_write_b32 a81, v161
    v_accvgpr_write_b32 a82, v162
    v_accvgpr_write_b32 a83, v163
    v_accvgpr_read_b32 v160, a84
    v_accvgpr_read_b32 v161, a85
    v_accvgpr_read_b32 v162, a86
    v_accvgpr_read_b32 v163, a87
    v_mul_f32 v160, v160, v180
    v_mul_f32 v161, v161, v180
    v_mul_f32 v162, v162, v180
    v_mul_f32 v163, v163, v180
    v_accvgpr_write_b32 a84, v160
    v_accvgpr_write_b32 a85, v161
    v_accvgpr_write_b32 a86, v162
    v_accvgpr_write_b32 a87, v163
    v_accvgpr_read_b32 v160, a88
    v_accvgpr_read_b32 v161, a89
    v_accvgpr_read_b32 v162, a90
    v_accvgpr_read_b32 v163, a91
    v_mul_f32 v160, v160, v180
    v_mul_f32 v161, v161, v180
    v_mul_f32 v162, v162, v180
    v_mul_f32 v163, v163, v180
    v_accvgpr_write_b32 a88, v160
    v_accvgpr_write_b32 a89, v161
    v_accvgpr_write_b32 a90, v162
    v_accvgpr_write_b32 a91, v163
    v_accvgpr_read_b32 v160, a92
    v_accvgpr_read_b32 v161, a93
    v_accvgpr_read_b32 v162, a94
    v_accvgpr_read_b32 v163, a95
    v_mul_f32 v160, v160, v180
    v_mul_f32 v161, v161, v180
    v_mul_f32 v162, v162, v180
    v_mul_f32 v163, v163, v180
    v_accvgpr_write_b32 a92, v160
    v_accvgpr_write_b32 a93, v161
    v_accvgpr_write_b32 a94, v162
    v_accvgpr_write_b32 a95, v163
    v_accvgpr_read_b32 v160, a96
    v_accvgpr_read_b32 v161, a97
    v_accvgpr_read_b32 v162, a98
    v_accvgpr_read_b32 v163, a99
    v_mul_f32 v160, v160, v180
    v_mul_f32 v161, v161, v180
    v_mul_f32 v162, v162, v180
    v_mul_f32 v163, v163, v180
    v_accvgpr_write_b32 a96, v160
    v_accvgpr_write_b32 a97, v161
    v_accvgpr_write_b32 a98, v162
    v_accvgpr_write_b32 a99, v163
    v_accvgpr_read_b32 v160, a100
    v_accvgpr_read_b32 v161, a101
    v_accvgpr_read_b32 v162, a102
    v_accvgpr_read_b32 v163, a103
    v_mul_f32 v160, v160, v180
    v_mul_f32 v161, v161, v180
    v_mul_f32 v162, v162, v180
    v_mul_f32 v163, v163, v180
    v_accvgpr_write_b32 a100, v160
    v_accvgpr_write_b32 a101, v161
    v_accvgpr_write_b32 a102, v162
    v_accvgpr_write_b32 a103, v163
    v_accvgpr_read_b32 v160, a104
    v_accvgpr_read_b32 v161, a105
    v_accvgpr_read_b32 v162, a106
    v_accvgpr_read_b32 v163, a107
    v_mul_f32 v160, v160, v180
    v_mul_f32 v161, v161, v180
    v_mul_f32 v162, v162, v180
    v_mul_f32 v163, v163, v180
    v_accvgpr_write_b32 a104, v160
    v_accvgpr_write_b32 a105, v161
    v_accvgpr_write_b32 a106, v162
    v_accvgpr_write_b32 a107, v163
    v_accvgpr_read_b32 v160, a108
    v_accvgpr_read_b32 v161, a109
    v_accvgpr_read_b32 v162, a110
    v_accvgpr_read_b32 v163, a111
    v_mul_f32 v160, v160, v180
    v_mul_f32 v161, v161, v180
    v_mul_f32 v162, v162, v180
    v_mul_f32 v163, v163, v180
    v_accvgpr_write_b32 a108, v160
    v_accvgpr_write_b32 a109, v161
    v_accvgpr_write_b32 a110, v162
    v_accvgpr_write_b32 a111, v163
    v_accvgpr_read_b32 v160, a112
    v_accvgpr_read_b32 v161, a113
    v_accvgpr_read_b32 v162, a114
    v_accvgpr_read_b32 v163, a115
    v_mul_f32 v160, v160, v180
    v_mul_f32 v161, v161, v180
    v_mul_f32 v162, v162, v180
    v_mul_f32 v163, v163, v180
    v_accvgpr_write_b32 a112, v160
    v_accvgpr_write_b32 a113, v161
    v_accvgpr_write_b32 a114, v162
    v_accvgpr_write_b32 a115, v163
    v_accvgpr_read_b32 v160, a116
    v_accvgpr_read_b32 v161, a117
    v_accvgpr_read_b32 v162, a118
    v_accvgpr_read_b32 v163, a119
    v_mul_f32 v160, v160, v180
    v_mul_f32 v161, v161, v180
    v_mul_f32 v162, v162, v180
    v_mul_f32 v163, v163, v180
    v_accvgpr_write_b32 a116, v160
    v_accvgpr_write_b32 a117, v161
    v_accvgpr_write_b32 a118, v162
    v_accvgpr_write_b32 a119, v163
    v_accvgpr_read_b32 v160, a120
    v_accvgpr_read_b32 v161, a121
    v_accvgpr_read_b32 v162, a122
    v_accvgpr_read_b32 v163, a123
    v_mul_f32 v160, v160, v180
    v_mul_f32 v161, v161, v180
    v_mul_f32 v162, v162, v180
    v_mul_f32 v163, v163, v180
    v_accvgpr_write_b32 a120, v160
    v_accvgpr_write_b32 a121, v161
    v_accvgpr_write_b32 a122, v162
    v_accvgpr_write_b32 a123, v163
    v_accvgpr_read_b32 v160, a124
    v_accvgpr_read_b32 v161, a125
    v_accvgpr_read_b32 v162, a126
    v_accvgpr_read_b32 v163, a127
    v_mul_f32 v160, v160, v180
    v_mul_f32 v161, v161, v180
    v_mul_f32 v162, v162, v180
    v_mul_f32 v163, v163, v180
    v_accvgpr_write_b32 a124, v160
    v_accvgpr_write_b32 a125, v161
    v_accvgpr_write_b32 a126, v162
    v_accvgpr_write_b32 a127, v163
    v_exp_f32 v160, v80
    v_exp_f32 v161, v81
    v_exp_f32 v162, v82
    v_add_f32 v179, v177, v160
    v_exp_f32 v163, v83
    v_cvt_pk_bf16_f32 v152, v160, v161
    v_add_f32 v179, v179, v161
    v_exp_f32 v164, v84
    v_add_f32 v179, v179, v162
    v_exp_f32 v165, v85
    v_cvt_pk_bf16_f32 v153, v162, v163
    v_add_f32 v179, v179, v163
    v_exp_f32 v166, v86
    v_add_f32 v179, v179, v164
    v_exp_f32 v167, v87
    v_cvt_pk_bf16_f32 v154, v164, v165
    v_add_f32 v179, v179, v165
    v_exp_f32 v168, v88
    v_add_f32 v179, v179, v166
    v_exp_f32 v169, v89
    v_cvt_pk_bf16_f32 v155, v166, v167
    v_add_f32 v179, v179, v167
    v_exp_f32 v170, v90
    v_add_f32 v179, v179, v168
    v_exp_f32 v171, v91
    v_cvt_pk_bf16_f32 v156, v168, v169
    v_add_f32 v179, v179, v169
    v_exp_f32 v172, v92
    v_add_f32 v179, v179, v170
    v_exp_f32 v173, v93
    v_cvt_pk_bf16_f32 v157, v170, v171
    v_add_f32 v179, v179, v171
    v_exp_f32 v174, v94
    v_add_f32 v179, v179, v172
    v_exp_f32 v175, v95
    v_cvt_pk_bf16_f32 v158, v172, v173
    v_add_f32 v179, v179, v173
    v_add_f32 v179, v179, v174
    v_cvt_pk_bf16_f32 v159, v174, v175
    v_add_f32 v179, v179, v175
    s_nop 1
    s_branch fk_hd0_ret
fk_hd1_fb:
    s_nop 15
    v_max3_f32 v180, v32, v33, v34
    v_max3_f32 v180, v180, v35, v36
    v_max3_f32 v180, v180, v37, v38
    v_max3_f32 v180, v180, v39, v40
    v_max3_f32 v180, v180, v41, v42
    v_max3_f32 v180, v180, v43, v44
    v_max3_f32 v180, v180, v45, v46
    v_max_f32 v180, v180, v47
    v_mov_b32 v181, v180
    s_nop 1
    v_permlane32_swap_b32 v180, v181
    s_nop 0
    v_max_f32 v180, v180, v181
    v_max_f32 v180, 0, v180
    v_sub_f32 v32, v32, v180
    v_sub_f32 v33, v33, v180
    v_sub_f32 v34, v34, v180
    v_sub_f32 v35, v35, v180
    v_sub_f32 v36, v36, v180
    v_sub_f32 v37, v37, v180
    v_sub_f32 v38, v38, v180
    v_sub_f32 v39, v39, v180
    v_sub_f32 v40, v40, v180
    v_sub_f32 v41, v41, v180
    v_sub_f32 v42, v42, v180
    v_sub_f32 v43, v43, v180
    v_sub_f32 v44, v44, v180
    v_sub_f32 v45, v45, v180
    v_sub_f32 v46, v46, v180
    v_sub_f32 v47, v47, v180
    v_sub_f32 v64, v64, v180
    v_sub_f32 v65, v65, v180
    v_sub_f32 v66, v66, v180
    v_sub_f32 v67, v67, v180
    v_sub_f32 v68, v68, v180
    v_sub_f32 v69, v69, v180
    v_sub_f32 v70, v70, v180
    v_sub_f32 v71, v71, v180
    v_sub_f32 v72, v72, v180
    v_sub_f32 v73, v73, v180
    v_sub_f32 v74, v74, v180
    v_sub_f32 v75, v75, v180
    v_sub_f32 v76, v76, v180
    v_sub_f32 v77, v77, v180
    v_sub_f32 v78, v78, v180
    v_sub_f32 v79, v79, v180
    v_sub_f32 v96, v96, v180
    v_sub_f32 v97, v97, v180
    v_sub_f32 v98, v98, v180
    v_sub_f32 v99, v99, v180
    v_sub_f32 v100, v100, v180
    v_sub_f32 v101, v101, v180
    v_sub_f32 v102, v102, v180
    v_sub_f32 v103, v103, v180
    v_sub_f32 v104, v104, v180
    v_sub_f32 v105, v105, v180
    v_sub_f32 v106, v106, v180
    v_sub_f32 v107, v107, v180
    v_sub_f32 v108, v108, v180
    v_sub_f32 v109, v109, v180
    v_sub_f32 v110, v110, v180
    v_sub_f32 v111, v111, v180
    v_sub_f32 v180, 0, v180
    v_exp_f32 v180, v180
    s_nop 0
    v_mul_f32 v178, v178, v180
    v_accvgpr_read_b32 v160, a0
    v_accvgpr_read_b32 v161, a1
    v_accvgpr_read_b32 v162, a2
    v_accvgpr_read_b32 v163, a3
    v_mul_f32 v160, v160, v180
    v_mul_f32 v161, v161, v180
    v_mul_f32 v162, v162, v180
    v_mul_f32 v163, v163, v180
    v_accvgpr_write_b32 a0, v160
    v_accvgpr_write_b32 a1, v161
    v_accvgpr_write_b32 a2, v162
    v_accvgpr_write_b32 a3, v163
    v_accvgpr_read_b32 v160, a4
    v_accvgpr_read_b32 v161, a5
    v_accvgpr_read_b32 v162, a6
    v_accvgpr_read_b32 v163, a7
    v_mul_f32 v160, v160, v180
    v_mul_f32 v161, v161, v180
    v_mul_f32 v162, v162, v180
    v_mul_f32 v163, v163, v180
    v_accvgpr_write_b32 a4, v160
    v_accvgpr_write_b32 a5, v161
    v_accvgpr_write_b32 a6, v162
    v_accvgpr_write_b32 a7, v163
    v_accvgpr_read_b32 v160, a8
    v_accvgpr_read_b32 v161, a9
    v_accvgpr_read_b32 v162, a10
    v_accvgpr_read_b32 v163, a11
    v_mul_f32 v160, v160, v180
    v_mul_f32 v161, v161, v180
    v_mul_f32 v162, v162, v180
    v_mul_f32 v163, v163, v180
    v_accvgpr_write_b32 a8, v160
    v_accvgpr_write_b32 a9, v161
    v_accvgpr_write_b32 a10, v162
    v_accvgpr_write_b32 a11, v163
    v_accvgpr_read_b32 v160, a12
    v_accvgpr_read_b32 v161, a13
    v_accvgpr_read_b32 v162, a14
    v_accvgpr_read_b32 v163, a15
    v_mul_f32 v160, v160, v180
    v_mul_f32 v161, v161, v180
    v_mul_f32 v162, v162, v180
    v_mul_f32 v163, v163, v180
    v_accvgpr_write_b32 a12, v160
    v_accvgpr_write_b32 a13, v161
    v_accvgpr_write_b32 a14, v162
    v_accvgpr_write_b32 a15, v163
    v_accvgpr_read_b32 v160, a16
    v_accvgpr_read_b32 v161, a17
    v_accvgpr_read_b32 v162, a18
    v_accvgpr_read_b32 v163, a19
    v_mul_f32 v160, v160, v180
    v_mul_f32 v161, v161, v180
    v_mul_f32 v162, v162, v180
    v_mul_f32 v163, v163, v180
    v_accvgpr_write_b32 a16, v160
    v_accvgpr_write_b32 a17, v161
    v_accvgpr_write_b32 a18, v162
    v_accvgpr_write_b32 a19, v163
    v_accvgpr_read_b32 v160, a20
    v_accvgpr_read_b32 v161, a21
    v_accvgpr_read_b32 v162, a22
    v_accvgpr_read_b32 v163, a23
    v_mul_f32 v160, v160, v180
    v_mul_f32 v161, v161, v180
    v_mul_f32 v162, v162, v180
    v_mul_f32 v163, v163, v180
    v_accvgpr_write_b32 a20, v160
    v_accvgpr_write_b32 a21, v161
    v_accvgpr_write_b32 a22, v162
    v_accvgpr_write_b32 a23, v163
    v_accvgpr_read_b32 v160, a24
    v_accvgpr_read_b32 v161, a25
    v_accvgpr_read_b32 v162, a26
    v_accvgpr_read_b32 v163, a27
    v_mul_f32 v160, v160, v180
    v_mul_f32 v161, v161, v180
    v_mul_f32 v162, v162, v180
    v_mul_f32 v163, v163, v180
    v_accvgpr_write_b32 a24, v160
    v_accvgpr_write_b32 a25, v161
    v_accvgpr_write_b32 a26, v162
    v_accvgpr_write_b32 a27, v163
    v_accvgpr_read_b32 v160, a28
    v_accvgpr_read_b32 v161, a29
    v_accvgpr_read_b32 v162, a30
    v_accvgpr_read_b32 v163, a31
    v_mul_f32 v160, v160, v180
    v_mul_f32 v161, v161, v180
    v_mul_f32 v162, v162, v180
    v_mul_f32 v163, v163, v180
    v_accvgpr_write_b32 a28, v160
    v_accvgpr_write_b32 a29, v161
    v_accvgpr_write_b32 a30, v162
    v_accvgpr_write_b32 a31, v163
    v_accvgpr_read_b32 v160, a32
    v_accvgpr_read_b32 v161, a33
    v_accvgpr_read_b32 v162, a34
    v_accvgpr_read_b32 v163, a35
    v_mul_f32 v160, v160, v180
    v_mul_f32 v161, v161, v180
    v_mul_f32 v162, v162, v180
    v_mul_f32 v163, v163, v180
    v_accvgpr_write_b32 a32, v160
    v_accvgpr_write_b32 a33, v161
    v_accvgpr_write_b32 a34, v162
    v_accvgpr_write_b32 a35, v163
    v_accvgpr_read_b32 v160, a36
    v_accvgpr_read_b32 v161, a37
    v_accvgpr_read_b32 v162, a38
    v_accvgpr_read_b32 v163, a39
    v_mul_f32 v160, v160, v180
    v_mul_f32 v161, v161, v180
    v_mul_f32 v162, v162, v180
    v_mul_f32 v163, v163, v180
    v_accvgpr_write_b32 a36, v160
    v_accvgpr_write_b32 a37, v161
    v_accvgpr_write_b32 a38, v162
    v_accvgpr_write_b32 a39, v163
    v_accvgpr_read_b32 v160, a40
    v_accvgpr_read_b32 v161, a41
    v_accvgpr_read_b32 v162, a42
    v_accvgpr_read_b32 v163, a43
    v_mul_f32 v160, v160, v180
    v_mul_f32 v161, v161, v180
    v_mul_f32 v162, v162, v180
    v_mul_f32 v163, v163, v180
    v_accvgpr_write_b32 a40, v160
    v_accvgpr_write_b32 a41, v161
    v_accvgpr_write_b32 a42, v162
    v_accvgpr_write_b32 a43, v163
    v_accvgpr_read_b32 v160, a44
    v_accvgpr_read_b32 v161, a45
    v_accvgpr_read_b32 v162, a46
    v_accvgpr_read_b32 v163, a47
    v_mul_f32 v160, v160, v180
    v_mul_f32 v161, v161, v180
    v_mul_f32 v162, v162, v180
    v_mul_f32 v163, v163, v180
    v_accvgpr_write_b32 a44, v160
    v_accvgpr_write_b32 a45, v161
    v_accvgpr_write_b32 a46, v162
    v_accvgpr_write_b32 a47, v163
    v_accvgpr_read_b32 v160, a48
    v_accvgpr_read_b32 v161, a49
    v_accvgpr_read_b32 v162, a50
    v_accvgpr_read_b32 v163, a51
    v_mul_f32 v160, v160, v180
    v_mul_f32 v161, v161, v180
    v_mul_f32 v162, v162, v180
    v_mul_f32 v163, v163, v180
    v_accvgpr_write_b32 a48, v160
    v_accvgpr_write_b32 a49, v161
    v_accvgpr_write_b32 a50, v162
    v_accvgpr_write_b32 a51, v163
    v_accvgpr_read_b32 v160, a52
    v_accvgpr_read_b32 v161, a53
    v_accvgpr_read_b32 v162, a54
    v_accvgpr_read_b32 v163, a55
    v_mul_f32 v160, v160, v180
    v_mul_f32 v161, v161, v180
    v_mul_f32 v162, v162, v180
    v_mul_f32 v163, v163, v180
    v_accvgpr_write_b32 a52, v160
    v_accvgpr_write_b32 a53, v161
    v_accvgpr_write_b32 a54, v162
    v_accvgpr_write_b32 a55, v163
    v_accvgpr_read_b32 v160, a56
    v_accvgpr_read_b32 v161, a57
    v_accvgpr_read_b32 v162, a58
    v_accvgpr_read_b32 v163, a59
    v_mul_f32 v160, v160, v180
    v_mul_f32 v161, v161, v180
    v_mul_f32 v162, v162, v180
    v_mul_f32 v163, v163, v180
    v_accvgpr_write_b32 a56, v160
    v_accvgpr_write_b32 a57, v161
    v_accvgpr_write_b32 a58, v162
    v_accvgpr_write_b32 a59, v163
    v_accvgpr_read_b32 v160, a60
    v_accvgpr_read_b32 v161, a61
    v_accvgpr_read_b32 v162, a62
    v_accvgpr_read_b32 v163, a63
    v_mul_f32 v160, v160, v180
    v_mul_f32 v161, v161, v180
    v_mul_f32 v162, v162, v180
    v_mul_f32 v163, v163, v180
    v_accvgpr_write_b32 a60, v160
    v_accvgpr_write_b32 a61, v161
    v_accvgpr_write_b32 a62, v162
    v_accvgpr_write_b32 a63, v163
    v_exp_f32 v160, v32
    v_exp_f32 v161, v33
    v_exp_f32 v162, v34
    v_add_f32 v176, v178, v160
    v_exp_f32 v163, v35
    v_cvt_pk_bf16_f32 v128, v160, v161
    v_add_f32 v176, v176, v161
    v_exp_f32 v164, v36
    v_add_f32 v176, v176, v162
    v_exp_f32 v165, v37
    v_cvt_pk_bf16_f32 v129, v162, v163
    v_add_f32 v176, v176, v163
    v_exp_f32 v166, v38
    v_add_f32 v176, v176, v164
    v_exp_f32 v167, v39
    v_cvt_pk_bf16_f32 v130, v164, v165
    v_add_f32 v176, v176, v165
    v_exp_f32 v168, v40
    v_add_f32 v176, v176, v166
    v_exp_f32 v169, v41
    v_cvt_pk_bf16_f32 v131, v166, v167
    v_add_f32 v176, v176, v167
    v_exp_f32 v170, v42
    v_add_f32 v176, v176, v168
    v_exp_f32 v171, v43
    v_cvt_pk_bf16_f32 v132, v168, v169
    v_add_f32 v176, v176, v169
    v_exp_f32 v172, v44
    v_add_f32 v176, v176, v170
    v_exp_f32 v173, v45
    v_cvt_pk_bf16_f32 v133, v170, v171
    v_add_f32 v176, v176, v171
    v_exp_f32 v174, v46
    v_add_f32 v176, v176, v172
    v_exp_f32 v175, v47
    v_cvt_pk_bf16_f32 v134, v172, v173
    v_add_f32 v176, v176, v173
    v_add_f32 v176, v176, v174
    v_cvt_pk_bf16_f32 v135, v174, v175
    v_add_f32 v176, v176, v175
    v_max3_f32 v180, v48, v49, v50
    v_max3_f32 v180, v180, v51, v52
    v_max3_f32 v180, v180, v53, v54
    v_max3_f32 v180, v180, v55, v56
    v_max3_f32 v180, v180, v57, v58
    v_max3_f32 v180, v180, v59, v60
    v_max3_f32 v180, v180, v61, v62
    v_max_f32 v180, v180, v63
    v_mov_b32 v181, v180
    s_nop 1
    v_permlane32_swap_b32 v180, v181
    s_nop 0
    v_max_f32 v180, v180, v181
    v_max_f32 v180, 0, v180
    v_sub_f32 v48, v48, v180
    v_sub_f32 v49, v49, v180
    v_sub_f32 v50, v50, v180
    v_sub_f32 v51, v51, v180
    v_sub_f32 v52, v52, v180
    v_sub_f32 v53, v53, v180
    v_sub_f32 v54, v54, v180
    v_sub_f32 v55, v55, v180
    v_sub_f32 v56, v56, v180
    v_sub_f32 v57, v57, v180
    v_sub_f32 v58, v58, v180
    v_sub_f32 v59, v59, v180
    v_sub_f32 v60, v60, v180
    v_sub_f32 v61, v61, v180
    v_sub_f32 v62, v62, v180
    v_sub_f32 v63, v63, v180
    v_sub_f32 v80, v80, v180
    v_sub_f32 v81, v81, v180
    v_sub_f32 v82, v82, v180
    v_sub_f32 v83, v83, v180
    v_sub_f32 v84, v84, v180
    v_sub_f32 v85, v85, v180
    v_sub_f32 v86, v86, v180
    v_sub_f32 v87, v87, v180
    v_sub_f32 v88, v88, v180
    v_sub_f32 v89, v89, v180
    v_sub_f32 v90, v90, v180
    v_sub_f32 v91, v91, v180
    v_sub_f32 v92, v92, v180
    v_sub_f32 v93, v93, v180
    v_sub_f32 v94, v94, v180
    v_sub_f32 v95, v95, v180
    v_sub_f32 v112, v112, v180
    v_sub_f32 v113, v113, v180
    v_sub_f32 v114, v114, v180
    v_sub_f32 v115, v115, v180
    v_sub_f32 v116, v116, v180
    v_sub_f32 v117, v117, v180
    v_sub_f32 v118, v118, v180
    v_sub_f32 v119, v119, v180
    v_sub_f32 v120, v120, v180
    v_sub_f32 v121, v121, v180
    v_sub_f32 v122, v122, v180
    v_sub_f32 v123, v123, v180
    v_sub_f32 v124, v124, v180
    v_sub_f32 v125, v125, v180
    v_sub_f32 v126, v126, v180
    v_sub_f32 v127, v127, v180
    v_sub_f32 v180, 0, v180
    v_exp_f32 v180, v180
    s_nop 0
    v_mul_f32 v179, v179, v180
    v_accvgpr_read_b32 v160, a64
    v_accvgpr_read_b32 v161, a65
    v_accvgpr_read_b32 v162, a66
    v_accvgpr_read_b32 v163, a67
    v_mul_f32 v160, v160, v180
    v_mul_f32 v161, v161, v180
    v_mul_f32 v162, v162, v180
    v_mul_f32 v163, v163, v180
    v_accvgpr_write_b32 a64, v160
    v_accvgpr_write_b32 a65, v161
    v_accvgpr_write_b32 a66, v162
    v_accvgpr_write_b32 a67, v163
    v_accvgpr_read_b32 v160, a68
    v_accvgpr_read_b32 v161, a69
    v_accvgpr_read_b32 v162, a70
    v_accvgpr_read_b32 v163, a71
    v_mul_f32 v160, v160, v180
    v_mul_f32 v161, v161, v180
    v_mul_f32 v162, v162, v180
    v_mul_f32 v163, v163, v180
    v_accvgpr_write_b32 a68, v160
    v_accvgpr_write_b32 a69, v161
    v_accvgpr_write_b32 a70, v162
    v_accvgpr_write_b32 a71, v163
    v_accvgpr_read_b32 v160, a72
    v_accvgpr_read_b32 v161, a73
    v_accvgpr_read_b32 v162, a74
    v_accvgpr_read_b32 v163, a75
    v_mul_f32 v160, v160, v180
    v_mul_f32 v161, v161, v180
    v_mul_f32 v162, v162, v180
    v_mul_f32 v163, v163, v180
    v_accvgpr_write_b32 a72, v160
    v_accvgpr_write_b32 a73, v161
    v_accvgpr_write_b32 a74, v162
    v_accvgpr_write_b32 a75, v163
    v_accvgpr_read_b32 v160, a76
    v_accvgpr_read_b32 v161, a77
    v_accvgpr_read_b32 v162, a78
    v_accvgpr_read_b32 v163, a79
    v_mul_f32 v160, v160, v180
    v_mul_f32 v161, v161, v180
    v_mul_f32 v162, v162, v180
    v_mul_f32 v163, v163, v180
    v_accvgpr_write_b32 a76, v160
    v_accvgpr_write_b32 a77, v161
    v_accvgpr_write_b32 a78, v162
    v_accvgpr_write_b32 a79, v163
    v_accvgpr_read_b32 v160, a80
    v_accvgpr_read_b32 v161, a81
    v_accvgpr_read_b32 v162, a82
    v_accvgpr_read_b32 v163, a83
    v_mul_f32 v160, v160, v180
    v_mul_f32 v161, v161, v180
    v_mul_f32 v162, v162, v180
    v_mul_f32 v163, v163, v180
    v_accvgpr_write_b32 a80, v160
    v_accvgpr_write_b32 a81, v161
    v_accvgpr_write_b32 a82, v162
    v_accvgpr_write_b32 a83, v163
    v_accvgpr_read_b32 v160, a84
    v_accvgpr_read_b32 v161, a85
    v_accvgpr_read_b32 v162, a86
    v_accvgpr_read_b32 v163, a87
    v_mul_f32 v160, v160, v180
    v_mul_f32 v161, v161, v180
    v_mul_f32 v162, v162, v180
    v_mul_f32 v163, v163, v180
    v_accvgpr_write_b32 a84, v160
    v_accvgpr_write_b32 a85, v161
    v_accvgpr_write_b32 a86, v162
    v_accvgpr_write_b32 a87, v163
    v_accvgpr_read_b32 v160, a88
    v_accvgpr_read_b32 v161, a89
    v_accvgpr_read_b32 v162, a90
    v_accvgpr_read_b32 v163, a91
    v_mul_f32 v160, v160, v180
    v_mul_f32 v161, v161, v180
    v_mul_f32 v162, v162, v180
    v_mul_f32 v163, v163, v180
    v_accvgpr_write_b32 a88, v160
    v_accvgpr_write_b32 a89, v161
    v_accvgpr_write_b32 a90, v162
    v_accvgpr_write_b32 a91, v163
    v_accvgpr_read_b32 v160, a92
    v_accvgpr_read_b32 v161, a93
    v_accvgpr_read_b32 v162, a94
    v_accvgpr_read_b32 v163, a95
    v_mul_f32 v160, v160, v180
    v_mul_f32 v161, v161, v180
    v_mul_f32 v162, v162, v180
    v_mul_f32 v163, v163, v180
    v_accvgpr_write_b32 a92, v160
    v_accvgpr_write_b32 a93, v161
    v_accvgpr_write_b32 a94, v162
    v_accvgpr_write_b32 a95, v163
    v_accvgpr_read_b32 v160, a96
    v_accvgpr_read_b32 v161, a97
    v_accvgpr_read_b32 v162, a98
    v_accvgpr_read_b32 v163, a99
    v_mul_f32 v160, v160, v180
    v_mul_f32 v161, v161, v180
    v_mul_f32 v162, v162, v180
    v_mul_f32 v163, v163, v180
    v_accvgpr_write_b32 a96, v160
    v_accvgpr_write_b32 a97, v161
    v_accvgpr_write_b32 a98, v162
    v_accvgpr_write_b32 a99, v163
    v_accvgpr_read_b32 v160, a100
    v_accvgpr_read_b32 v161, a101
    v_accvgpr_read_b32 v162, a102
    v_accvgpr_read_b32 v163, a103
    v_mul_f32 v160, v160, v180
    v_mul_f32 v161, v161, v180
    v_mul_f32 v162, v162, v180
    v_mul_f32 v163, v163, v180
    v_accvgpr_write_b32 a100, v160
    v_accvgpr_write_b32 a101, v161
    v_accvgpr_write_b32 a102, v162
    v_accvgpr_write_b32 a103, v163
    v_accvgpr_read_b32 v160, a104
    v_accvgpr_read_b32 v161, a105
    v_accvgpr_read_b32 v162, a106
    v_accvgpr_read_b32 v163, a107
    v_mul_f32 v160, v160, v180
    v_mul_f32 v161, v161, v180
    v_mul_f32 v162, v162, v180
    v_mul_f32 v163, v163, v180
    v_accvgpr_write_b32 a104, v160
    v_accvgpr_write_b32 a105, v161
    v_accvgpr_write_b32 a106, v162
    v_accvgpr_write_b32 a107, v163
    v_accvgpr_read_b32 v160, a108
    v_accvgpr_read_b32 v161, a109
    v_accvgpr_read_b32 v162, a110
    v_accvgpr_read_b32 v163, a111
    v_mul_f32 v160, v160, v180
    v_mul_f32 v161, v161, v180
    v_mul_f32 v162, v162, v180
    v_mul_f32 v163, v163, v180
    v_accvgpr_write_b32 a108, v160
    v_accvgpr_write_b32 a109, v161
    v_accvgpr_write_b32 a110, v162
    v_accvgpr_write_b32 a111, v163
    v_accvgpr_read_b32 v160, a112
    v_accvgpr_read_b32 v161, a113
    v_accvgpr_read_b32 v162, a114
    v_accvgpr_read_b32 v163, a115
    v_mul_f32 v160, v160, v180
    v_mul_f32 v161, v161, v180
    v_mul_f32 v162, v162, v180
    v_mul_f32 v163, v163, v180
    v_accvgpr_write_b32 a112, v160
    v_accvgpr_write_b32 a113, v161
    v_accvgpr_write_b32 a114, v162
    v_accvgpr_write_b32 a115, v163
    v_accvgpr_read_b32 v160, a116
    v_accvgpr_read_b32 v161, a117
    v_accvgpr_read_b32 v162, a118
    v_accvgpr_read_b32 v163, a119
    v_mul_f32 v160, v160, v180
    v_mul_f32 v161, v161, v180
    v_mul_f32 v162, v162, v180
    v_mul_f32 v163, v163, v180
    v_accvgpr_write_b32 a116, v160
    v_accvgpr_write_b32 a117, v161
    v_accvgpr_write_b32 a118, v162
    v_accvgpr_write_b32 a119, v163
    v_accvgpr_read_b32 v160, a120
    v_accvgpr_read_b32 v161, a121
    v_accvgpr_read_b32 v162, a122
    v_accvgpr_read_b32 v163, a123
    v_mul_f32 v160, v160, v180
    v_mul_f32 v161, v161, v180
    v_mul_f32 v162, v162, v180
    v_mul_f32 v163, v163, v180
    v_accvgpr_write_b32 a120, v160
    v_accvgpr_write_b32 a121, v161
    v_accvgpr_write_b32 a122, v162
    v_accvgpr_write_b32 a123, v163
    v_accvgpr_read_b32 v160, a124
    v_accvgpr_read_b32 v161, a125
    v_accvgpr_read_b32 v162, a126
    v_accvgpr_read_b32 v163, a127
    v_mul_f32 v160, v160, v180
    v_mul_f32 v161, v161, v180
    v_mul_f32 v162, v162, v180
    v_mul_f32 v163, v163, v180
    v_accvgpr_write_b32 a124, v160
    v_accvgpr_write_b32 a125, v161
    v_accvgpr_write_b32 a126, v162
    v_accvgpr_write_b32 a127, v163
    v_exp_f32 v160, v48
    v_exp_f32 v161, v49
    v_exp_f32 v162, v50
    v_add_f32 v177, v179, v160
    v_exp_f32 v163, v51
    v_cvt_pk_bf16_f32 v136, v160, v161
    v_add_f32 v177, v177, v161
    v_exp_f32 v164, v52
    v_add_f32 v177, v177, v162
    v_exp_f32 v165, v53
    v_cvt_pk_bf16_f32 v137, v162, v163
    v_add_f32 v177, v177, v163
    v_exp_f32 v166, v54
    v_add_f32 v177, v177, v164
    v_exp_f32 v167, v55
    v_cvt_pk_bf16_f32 v138, v164, v165
    v_add_f32 v177, v177, v165
    v_exp_f32 v168, v56
    v_add_f32 v177, v177, v166
    v_exp_f32 v169, v57
    v_cvt_pk_bf16_f32 v139, v166, v167
    v_add_f32 v177, v177, v167
    v_exp_f32 v170, v58
    v_add_f32 v177, v177, v168
    v_exp_f32 v171, v59
    v_cvt_pk_bf16_f32 v140, v168, v169
    v_add_f32 v177, v177, v169
    v_exp_f32 v172, v60
    v_add_f32 v177, v177, v170
    v_exp_f32 v173, v61
    v_cvt_pk_bf16_f32 v141, v170, v171
    v_add_f32 v177, v177, v171
    v_exp_f32 v174, v62
    v_add_f32 v177, v177, v172
    v_exp_f32 v175, v63
    v_cvt_pk_bf16_f32 v142, v172, v173
    v_add_f32 v177, v177, v173
    v_add_f32 v177, v177, v174
    v_cvt_pk_bf16_f32 v143, v174, v175
    v_add_f32 v177, v177, v175
    s_nop 1
    s_branch fk_hd1_ret
fk_he0_fb:
    s_nop 15
    v_max3_f32 v180, v64, v65, v66
    v_max3_f32 v180, v180, v67, v68
    v_max3_f32 v180, v180, v69, v70
    v_max3_f32 v180, v180, v71, v72
    v_max3_f32 v180, v180, v73, v74
    v_max3_f32 v180, v180, v75, v76
    v_max3_f32 v180, v180, v77, v78
    v_max_f32 v180, v180, v79
    v_mov_b32 v181, v180
    s_nop 1
    v_permlane32_swap_b32 v180, v181
    s_nop 0
    v_max_f32 v180, v180, v181
    v_max_f32 v180, 0, v180
    v_sub_f32 v64, v64, v180
    v_sub_f32 v65, v65, v180
    v_sub_f32 v66, v66, v180
    v_sub_f32 v67, v67, v180
    v_sub_f32 v68, v68, v180
    v_sub_f32 v69, v69, v180
    v_sub_f32 v70, v70, v180
    v_sub_f32 v71, v71, v180
    v_sub_f32 v72, v72, v180
    v_sub_f32 v73, v73, v180
    v_sub_f32 v74, v74, v180
    v_sub_f32 v75, v75, v180
    v_sub_f32 v76, v76, v180
    v_sub_f32 v77, v77, v180
    v_sub_f32 v78, v78, v180
    v_sub_f32 v79, v79, v180
    v_sub_f32 v32, v32, v180
    v_sub_f32 v33, v33, v180
    v_sub_f32 v34, v34, v180
    v_sub_f32 v35, v35, v180
    v_sub_f32 v36, v36, v180
    v_sub_f32 v37, v37, v180
    v_sub_f32 v38, v38, v180
    v_sub_f32 v39, v39, v180
    v_sub_f32 v40, v40, v180
    v_sub_f32 v41, v41, v180
    v_sub_f32 v42, v42, v180
    v_sub_f32 v43, v43, v180
    v_sub_f32 v44, v44, v180
    v_sub_f32 v45, v45, v180
    v_sub_f32 v46, v46, v180
    v_sub_f32 v47, v47, v180
    v_sub_f32 v96, v96, v180
    v_sub_f32 v97, v97, v180
    v_sub_f32 v98, v98, v180
    v_sub_f32 v99, v99, v180
    v_sub_f32 v100, v100, v180
    v_sub_f32 v101, v101, v180
    v_sub_f32 v102, v102, v180
    v_sub_f32 v103, v103, v180
    v_sub_f32 v104, v104, v180
    v_sub_f32 v105, v105, v180
    v_sub_f32 v106, v106, v180
    v_sub_f32 v107, v107, v180
    v_sub_f32 v108, v108, v180
    v_sub_f32 v109, v109, v180
    v_sub_f32 v110, v110, v180
    v_sub_f32 v111, v111, v180
    v_sub_f32 v180, 0, v180
    v_exp_f32 v180, v180
    s_nop 0
    v_mul_f32 v176, v176, v180
    v_accvgpr_read_b32 v160, a0
    v_accvgpr_read_b32 v161, a1
    v_accvgpr_read_b32 v162, a2
    v_accvgpr_read_b32 v163, a3
    v_mul_f32 v160, v160, v180
    v_mul_f32 v161, v161, v180
    v_mul_f32 v162, v162, v180
    v_mul_f32 v163, v163, v180
    v_accvgpr_write_b32 a0, v160
    v_accvgpr_write_b32 a1, v161
    v_accvgpr_write_b32 a2, v162
    v_accvgpr_write_b32 a3, v163
    v_accvgpr_read_b32 v160, a4
    v_accvgpr_read_b32 v161, a5
    v_accvgpr_read_b32 v162, a6
    v_accvgpr_read_b32 v163, a7
    v_mul_f32 v160, v160, v180
    v_mul_f32 v161, v161, v180
    v_mul_f32 v162, v162, v180
    v_mul_f32 v163, v163, v180
    v_accvgpr_write_b32 a4, v160
    v_accvgpr_write_b32 a5, v161
    v_accvgpr_write_b32 a6, v162
    v_accvgpr_write_b32 a7, v163
    v_accvgpr_read_b32 v160, a8
    v_accvgpr_read_b32 v161, a9
    v_accvgpr_read_b32 v162, a10
    v_accvgpr_read_b32 v163, a11
    v_mul_f32 v160, v160, v180
    v_mul_f32 v161, v161, v180
    v_mul_f32 v162, v162, v180
    v_mul_f32 v163, v163, v180
    v_accvgpr_write_b32 a8, v160
    v_accvgpr_write_b32 a9, v161
    v_accvgpr_write_b32 a10, v162
    v_accvgpr_write_b32 a11, v163
    v_accvgpr_read_b32 v160, a12
    v_accvgpr_read_b32 v161, a13
    v_accvgpr_read_b32 v162, a14
    v_accvgpr_read_b32 v163, a15
    v_mul_f32 v160, v160, v180
    v_mul_f32 v161, v161, v180
    v_mul_f32 v162, v162, v180
    v_mul_f32 v163, v163, v180
    v_accvgpr_write_b32 a12, v160
    v_accvgpr_write_b32 a13, v161
    v_accvgpr_write_b32 a14, v162
    v_accvgpr_write_b32 a15, v163
    v_accvgpr_read_b32 v160, a16
    v_accvgpr_read_b32 v161, a17
    v_accvgpr_read_b32 v162, a18
    v_accvgpr_read_b32 v163, a19
    v_mul_f32 v160, v160, v180
    v_mul_f32 v161, v161, v180
    v_mul_f32 v162, v162, v180
    v_mul_f32 v163, v163, v180
    v_accvgpr_write_b32 a16, v160
    v_accvgpr_write_b32 a17, v161
    v_accvgpr_write_b32 a18, v162
    v_accvgpr_write_b32 a19, v163
    v_accvgpr_read_b32 v160, a20
    v_accvgpr_read_b32 v161, a21
    v_accvgpr_read_b32 v162, a22
    v_accvgpr_read_b32 v163, a23
    v_mul_f32 v160, v160, v180
    v_mul_f32 v161, v161, v180
    v_mul_f32 v162, v162, v180
    v_mul_f32 v163, v163, v180
    v_accvgpr_write_b32 a20, v160
    v_accvgpr_write_b32 a21, v161
    v_accvgpr_write_b32 a22, v162
    v_accvgpr_write_b32 a23, v163
    v_accvgpr_read_b32 v160, a24
    v_accvgpr_read_b32 v161, a25
    v_accvgpr_read_b32 v162, a26
    v_accvgpr_read_b32 v163, a27
    v_mul_f32 v160, v160, v180
    v_mul_f32 v161, v161, v180
    v_mul_f32 v162, v162, v180
    v_mul_f32 v163, v163, v180
    v_accvgpr_write_b32 a24, v160
    v_accvgpr_write_b32 a25, v161
    v_accvgpr_write_b32 a26, v162
    v_accvgpr_write_b32 a27, v163
    v_accvgpr_read_b32 v160, a28
    v_accvgpr_read_b32 v161, a29
    v_accvgpr_read_b32 v162, a30
    v_accvgpr_read_b32 v163, a31
    v_mul_f32 v160, v160, v180
    v_mul_f32 v161, v161, v180
    v_mul_f32 v162, v162, v180
    v_mul_f32 v163, v163, v180
    v_accvgpr_write_b32 a28, v160
    v_accvgpr_write_b32 a29, v161
    v_accvgpr_write_b32 a30, v162
    v_accvgpr_write_b32 a31, v163
    v_accvgpr_read_b32 v160, a32
    v_accvgpr_read_b32 v161, a33
    v_accvgpr_read_b32 v162, a34
    v_accvgpr_read_b32 v163, a35
    v_mul_f32 v160, v160, v180
    v_mul_f32 v161, v161, v180
    v_mul_f32 v162, v162, v180
    v_mul_f32 v163, v163, v180
    v_accvgpr_write_b32 a32, v160
    v_accvgpr_write_b32 a33, v161
    v_accvgpr_write_b32 a34, v162
    v_accvgpr_write_b32 a35, v163
    v_accvgpr_read_b32 v160, a36
    v_accvgpr_read_b32 v161, a37
    v_accvgpr_read_b32 v162, a38
    v_accvgpr_read_b32 v163, a39
    v_mul_f32 v160, v160, v180
    v_mul_f32 v161, v161, v180
    v_mul_f32 v162, v162, v180
    v_mul_f32 v163, v163, v180
    v_accvgpr_write_b32 a36, v160
    v_accvgpr_write_b32 a37, v161
    v_accvgpr_write_b32 a38, v162
    v_accvgpr_write_b32 a39, v163
    v_accvgpr_read_b32 v160, a40
    v_accvgpr_read_b32 v161, a41
    v_accvgpr_read_b32 v162, a42
    v_accvgpr_read_b32 v163, a43
    v_mul_f32 v160, v160, v180
    v_mul_f32 v161, v161, v180
    v_mul_f32 v162, v162, v180
    v_mul_f32 v163, v163, v180
    v_accvgpr_write_b32 a40, v160
    v_accvgpr_write_b32 a41, v161
    v_accvgpr_write_b32 a42, v162
    v_accvgpr_write_b32 a43, v163
    v_accvgpr_read_b32 v160, a44
    v_accvgpr_read_b32 v161, a45
    v_accvgpr_read_b32 v162, a46
    v_accvgpr_read_b32 v163, a47
    v_mul_f32 v160, v160, v180
    v_mul_f32 v161, v161, v180
    v_mul_f32 v162, v162, v180
    v_mul_f32 v163, v163, v180
    v_accvgpr_write_b32 a44, v160
    v_accvgpr_write_b32 a45, v161
    v_accvgpr_write_b32 a46, v162
    v_accvgpr_write_b32 a47, v163
    v_accvgpr_read_b32 v160, a48
    v_accvgpr_read_b32 v161, a49
    v_accvgpr_read_b32 v162, a50
    v_accvgpr_read_b32 v163, a51
    v_mul_f32 v160, v160, v180
    v_mul_f32 v161, v161, v180
    v_mul_f32 v162, v162, v180
    v_mul_f32 v163, v163, v180
    v_accvgpr_write_b32 a48, v160
    v_accvgpr_write_b32 a49, v161
    v_accvgpr_write_b32 a50, v162
    v_accvgpr_write_b32 a51, v163
    v_accvgpr_read_b32 v160, a52
    v_accvgpr_read_b32 v161, a53
    v_accvgpr_read_b32 v162, a54
    v_accvgpr_read_b32 v163, a55
    v_mul_f32 v160, v160, v180
    v_mul_f32 v161, v161, v180
    v_mul_f32 v162, v162, v180
    v_mul_f32 v163, v163, v180
    v_accvgpr_write_b32 a52, v160
    v_accvgpr_write_b32 a53, v161
    v_accvgpr_write_b32 a54, v162
    v_accvgpr_write_b32 a55, v163
    v_accvgpr_read_b32 v160, a56
    v_accvgpr_read_b32 v161, a57
    v_accvgpr_read_b32 v162, a58
    v_accvgpr_read_b32 v163, a59
    v_mul_f32 v160, v160, v180
    v_mul_f32 v161, v161, v180
    v_mul_f32 v162, v162, v180
    v_mul_f32 v163, v163, v180
    v_accvgpr_write_b32 a56, v160
    v_accvgpr_write_b32 a57, v161
    v_accvgpr_write_b32 a58, v162
    v_accvgpr_write_b32 a59, v163
    v_accvgpr_read_b32 v160, a60
    v_accvgpr_read_b32 v161, a61
    v_accvgpr_read_b32 v162, a62
    v_accvgpr_read_b32 v163, a63
    v_mul_f32 v160, v160, v180
    v_mul_f32 v161, v161, v180
    v_mul_f32 v162, v162, v180
    v_mul_f32 v163, v163, v180
    v_accvgpr_write_b32 a60, v160
    v_accvgpr_write_b32 a61, v161
    v_accvgpr_write_b32 a62, v162
    v_accvgpr_write_b32 a63, v163
    v_exp_f32 v160, v64
    v_exp_f32 v161, v65
    v_exp_f32 v162, v66
    v_add_f32 v178, v176, v160
    v_exp_f32 v163, v67
    v_cvt_pk_bf16_f32 v144, v160, v161
    v_add_f32 v178, v178, v161
    v_exp_f32 v164, v68
    v_add_f32 v178, v178, v162
    v_exp_f32 v165, v69
    v_cvt_pk_bf16_f32 v145, v162, v163
    v_add_f32 v178, v178, v163
    v_exp_f32 v166, v70
    v_add_f32 v178, v178, v164
    v_exp_f32 v167, v71
    v_cvt_pk_bf16_f32 v146, v164, v165
    v_add_f32 v178, v178, v165
    v_exp_f32 v168, v72
    v_add_f32 v178, v178, v166
    v_exp_f32 v169, v73
    v_cvt_pk_bf16_f32 v147, v166, v167
    v_add_f32 v178, v178, v167
    v_exp_f32 v170, v74
    v_add_f32 v178, v178, v168
    v_exp_f32 v171, v75
    v_cvt_pk_bf16_f32 v148, v168, v169
    v_add_f32 v178, v178, v169
    v_exp_f32 v172, v76
    v_add_f32 v178, v178, v170
    v_exp_f32 v173, v77
    v_cvt_pk_bf16_f32 v149, v170, v171
    v_add_f32 v178, v178, v171
    v_exp_f32 v174, v78
    v_add_f32 v178, v178, v172
    v_exp_f32 v175, v79
    v_cvt_pk_bf16_f32 v150, v172, v173
    v_add_f32 v178, v178, v173
    v_add_f32 v178, v178, v174
    v_cvt_pk_bf16_f32 v151, v174, v175
    v_add_f32 v178, v178, v175
    v_max3_f32 v180, v80, v81, v82
    v_max3_f32 v180, v180, v83, v84
    v_max3_f32 v180, v180, v85, v86
    v_max3_f32 v180, v180, v87, v88
    v_max3_f32 v180, v180, v89, v90
    v_max3_f32 v180, v180, v91, v92
    v_max3_f32 v180, v180, v93, v94
    v_max_f32 v180, v180, v95
    v_mov_b32 v181, v180
    s_nop 1
    v_permlane32_swap_b32 v180, v181
    s_nop 0
    v_max_f32 v180, v180, v181
    v_max_f32 v180, 0, v180
    v_sub_f32 v80, v80, v180
    v_sub_f32 v81, v81, v180
    v_sub_f32 v82, v82, v180
    v_sub_f32 v83, v83, v180
    v_sub_f32 v84, v84, v180
    v_sub_f32 v85, v85, v180
    v_sub_f32 v86, v86, v180
    v_sub_f32 v87, v87, v180
    v_sub_f32 v88, v88, v180
    v_sub_f32 v89, v89, v180
    v_sub_f32 v90, v90, v180
    v_sub_f32 v91, v91, v180
    v_sub_f32 v92, v92, v180
    v_sub_f32 v93, v93, v180
    v_sub_f32 v94, v94, v180
    v_sub_f32 v95, v95, v180
    v_sub_f32 v48, v48, v180
    v_sub_f32 v49, v49, v180
    v_sub_f32 v50, v50, v180
    v_sub_f32 v51, v51, v180
    v_sub_f32 v52, v52, v180
    v_sub_f32 v53, v53, v180
    v_sub_f32 v54, v54, v180
    v_sub_f32 v55, v55, v180
    v_sub_f32 v56, v56, v180
    v_sub_f32 v57, v57, v180
    v_sub_f32 v58, v58, v180
    v_sub_f32 v59, v59, v180
    v_sub_f32 v60, v60, v180
    v_sub_f32 v61, v61, v180
    v_sub_f32 v62, v62, v180
    v_sub_f32 v63, v63, v180
    v_sub_f32 v112, v112, v180
    v_sub_f32 v113, v113, v180
    v_sub_f32 v114, v114, v180
    v_sub_f32 v115, v115, v180
    v_sub_f32 v116, v116, v180
    v_sub_f32 v117, v117, v180
    v_sub_f32 v118, v118, v180
    v_sub_f32 v119, v119, v180
    v_sub_f32 v120, v120, v180
    v_sub_f32 v121, v121, v180
    v_sub_f32 v122, v122, v180
    v_sub_f32 v123, v123, v180
    v_sub_f32 v124, v124, v180
    v_sub_f32 v125, v125, v180
    v_sub_f32 v126, v126, v180
    v_sub_f32 v127, v127, v180
    v_sub_f32 v180, 0, v180
    v_exp_f32 v180, v180
    s_nop 0
    v_mul_f32 v177, v177, v180
    v_accvgpr_read_b32 v160, a64
    v_accvgpr_read_b32 v161, a65
    v_accvgpr_read_b32 v162, a66
    v_accvgpr_read_b32 v163, a67
    v_mul_f32 v160, v160, v180
    v_mul_f32 v161, v161, v180
    v_mul_f32 v162, v162, v180
    v_mul_f32 v163, v163, v180
    v_accvgpr_write_b32 a64, v160
    v_accvgpr_write_b32 a65, v161
    v_accvgpr_write_b32 a66, v162
    v_accvgpr_write_b32 a67, v163
    v_accvgpr_read_b32 v160, a68
    v_accvgpr_read_b32 v161, a69
    v_accvgpr_read_b32 v162, a70
    v_accvgpr_read_b32 v163, a71
    v_mul_f32 v160, v160, v180
    v_mul_f32 v161, v161, v180
    v_mul_f32 v162, v162, v180
    v_mul_f32 v163, v163, v180
    v_accvgpr_write_b32 a68, v160
    v_accvgpr_write_b32 a69, v161
    v_accvgpr_write_b32 a70, v162
    v_accvgpr_write_b32 a71, v163
    v_accvgpr_read_b32 v160, a72
    v_accvgpr_read_b32 v161, a73
    v_accvgpr_read_b32 v162, a74
    v_accvgpr_read_b32 v163, a75
    v_mul_f32 v160, v160, v180
    v_mul_f32 v161, v161, v180
    v_mul_f32 v162, v162, v180
    v_mul_f32 v163, v163, v180
    v_accvgpr_write_b32 a72, v160
    v_accvgpr_write_b32 a73, v161
    v_accvgpr_write_b32 a74, v162
    v_accvgpr_write_b32 a75, v163
    v_accvgpr_read_b32 v160, a76
    v_accvgpr_read_b32 v161, a77
    v_accvgpr_read_b32 v162, a78
    v_accvgpr_read_b32 v163, a79
    v_mul_f32 v160, v160, v180
    v_mul_f32 v161, v161, v180
    v_mul_f32 v162, v162, v180
    v_mul_f32 v163, v163, v180
    v_accvgpr_write_b32 a76, v160
    v_accvgpr_write_b32 a77, v161
    v_accvgpr_write_b32 a78, v162
    v_accvgpr_write_b32 a79, v163
    v_accvgpr_read_b32 v160, a80
    v_accvgpr_read_b32 v161, a81
    v_accvgpr_read_b32 v162, a82
    v_accvgpr_read_b32 v163, a83
    v_mul_f32 v160, v160, v180
    v_mul_f32 v161, v161, v180
    v_mul_f32 v162, v162, v180
    v_mul_f32 v163, v163, v180
    v_accvgpr_write_b32 a80, v160
    v_accvgpr_write_b32 a81, v161
    v_accvgpr_write_b32 a82, v162
    v_accvgpr_write_b32 a83, v163
    v_accvgpr_read_b32 v160, a84
    v_accvgpr_read_b32 v161, a85
    v_accvgpr_read_b32 v162, a86
    v_accvgpr_read_b32 v163, a87
    v_mul_f32 v160, v160, v180
    v_mul_f32 v161, v161, v180
    v_mul_f32 v162, v162, v180
    v_mul_f32 v163, v163, v180
    v_accvgpr_write_b32 a84, v160
    v_accvgpr_write_b32 a85, v161
    v_accvgpr_write_b32 a86, v162
    v_accvgpr_write_b32 a87, v163
    v_accvgpr_read_b32 v160, a88
    v_accvgpr_read_b32 v161, a89
    v_accvgpr_read_b32 v162, a90
    v_accvgpr_read_b32 v163, a91
    v_mul_f32 v160, v160, v180
    v_mul_f32 v161, v161, v180
    v_mul_f32 v162, v162, v180
    v_mul_f32 v163, v163, v180
    v_accvgpr_write_b32 a88, v160
    v_accvgpr_write_b32 a89, v161
    v_accvgpr_write_b32 a90, v162
    v_accvgpr_write_b32 a91, v163
    v_accvgpr_read_b32 v160, a92
    v_accvgpr_read_b32 v161, a93
    v_accvgpr_read_b32 v162, a94
    v_accvgpr_read_b32 v163, a95
    v_mul_f32 v160, v160, v180
    v_mul_f32 v161, v161, v180
    v_mul_f32 v162, v162, v180
    v_mul_f32 v163, v163, v180
    v_accvgpr_write_b32 a92, v160
    v_accvgpr_write_b32 a93, v161
    v_accvgpr_write_b32 a94, v162
    v_accvgpr_write_b32 a95, v163
    v_accvgpr_read_b32 v160, a96
    v_accvgpr_read_b32 v161, a97
    v_accvgpr_read_b32 v162, a98
    v_accvgpr_read_b32 v163, a99
    v_mul_f32 v160, v160, v180
    v_mul_f32 v161, v161, v180
    v_mul_f32 v162, v162, v180
    v_mul_f32 v163, v163, v180
    v_accvgpr_write_b32 a96, v160
    v_accvgpr_write_b32 a97, v161
    v_accvgpr_write_b32 a98, v162
    v_accvgpr_write_b32 a99, v163
    v_accvgpr_read_b32 v160, a100
    v_accvgpr_read_b32 v161, a101
    v_accvgpr_read_b32 v162, a102
    v_accvgpr_read_b32 v163, a103
    v_mul_f32 v160, v160, v180
    v_mul_f32 v161, v161, v180
    v_mul_f32 v162, v162, v180
    v_mul_f32 v163, v163, v180
    v_accvgpr_write_b32 a100, v160
    v_accvgpr_write_b32 a101, v161
    v_accvgpr_write_b32 a102, v162
    v_accvgpr_write_b32 a103, v163
    v_accvgpr_read_b32 v160, a104
    v_accvgpr_read_b32 v161, a105
    v_accvgpr_read_b32 v162, a106
    v_accvgpr_read_b32 v163, a107
    v_mul_f32 v160, v160, v180
    v_mul_f32 v161, v161, v180
    v_mul_f32 v162, v162, v180
    v_mul_f32 v163, v163, v180
    v_accvgpr_write_b32 a104, v160
    v_accvgpr_write_b32 a105, v161
    v_accvgpr_write_b32 a106, v162
    v_accvgpr_write_b32 a107, v163
    v_accvgpr_read_b32 v160, a108
    v_accvgpr_read_b32 v161, a109
    v_accvgpr_read_b32 v162, a110
    v_accvgpr_read_b32 v163, a111
    v_mul_f32 v160, v160, v180
    v_mul_f32 v161, v161, v180
    v_mul_f32 v162, v162, v180
    v_mul_f32 v163, v163, v180
    v_accvgpr_write_b32 a108, v160
    v_accvgpr_write_b32 a109, v161
    v_accvgpr_write_b32 a110, v162
    v_accvgpr_write_b32 a111, v163
    v_accvgpr_read_b32 v160, a112
    v_accvgpr_read_b32 v161, a113
    v_accvgpr_read_b32 v162, a114
    v_accvgpr_read_b32 v163, a115
    v_mul_f32 v160, v160, v180
    v_mul_f32 v161, v161, v180
    v_mul_f32 v162, v162, v180
    v_mul_f32 v163, v163, v180
    v_accvgpr_write_b32 a112, v160
    v_accvgpr_write_b32 a113, v161
    v_accvgpr_write_b32 a114, v162
    v_accvgpr_write_b32 a115, v163
    v_accvgpr_read_b32 v160, a116
    v_accvgpr_read_b32 v161, a117
    v_accvgpr_read_b32 v162, a118
    v_accvgpr_read_b32 v163, a119
    v_mul_f32 v160, v160, v180
    v_mul_f32 v161, v161, v180
    v_mul_f32 v162, v162, v180
    v_mul_f32 v163, v163, v180
    v_accvgpr_write_b32 a116, v160
    v_accvgpr_write_b32 a117, v161
    v_accvgpr_write_b32 a118, v162
    v_accvgpr_write_b32 a119, v163
    v_accvgpr_read_b32 v160, a120
    v_accvgpr_read_b32 v161, a121
    v_accvgpr_read_b32 v162, a122
    v_accvgpr_read_b32 v163, a123
    v_mul_f32 v160, v160, v180
    v_mul_f32 v161, v161, v180
    v_mul_f32 v162, v162, v180
    v_mul_f32 v163, v163, v180
    v_accvgpr_write_b32 a120, v160
    v_accvgpr_write_b32 a121, v161
    v_accvgpr_write_b32 a122, v162
    v_accvgpr_write_b32 a123, v163
    v_accvgpr_read_b32 v160, a124
    v_accvgpr_read_b32 v161, a125
    v_accvgpr_read_b32 v162, a126
    v_accvgpr_read_b32 v163, a127
    v_mul_f32 v160, v160, v180
    v_mul_f32 v161, v161, v180
    v_mul_f32 v162, v162, v180
    v_mul_f32 v163, v163, v180
    v_accvgpr_write_b32 a124, v160
    v_accvgpr_write_b32 a125, v161
    v_accvgpr_write_b32 a126, v162
    v_accvgpr_write_b32 a127, v163
    v_exp_f32 v160, v80
    v_exp_f32 v161, v81
    v_exp_f32 v162, v82
    v_add_f32 v179, v177, v160
    v_exp_f32 v163, v83
    v_cvt_pk_bf16_f32 v152, v160, v161
    v_add_f32 v179, v179, v161
    v_exp_f32 v164, v84
    v_add_f32 v179, v179, v162
    v_exp_f32 v165, v85
    v_cvt_pk_bf16_f32 v153, v162, v163
    v_add_f32 v179, v179, v163
    v_exp_f32 v166, v86
    v_add_f32 v179, v179, v164
    v_exp_f32 v167, v87
    v_cvt_pk_bf16_f32 v154, v164, v165
    v_add_f32 v179, v179, v165
    v_exp_f32 v168, v88
    v_add_f32 v179, v179, v166
    v_exp_f32 v169, v89
    v_cvt_pk_bf16_f32 v155, v166, v167
    v_add_f32 v179, v179, v167
    v_exp_f32 v170, v90
    v_add_f32 v179, v179, v168
    v_exp_f32 v171, v91
    v_cvt_pk_bf16_f32 v156, v168, v169
    v_add_f32 v179, v179, v169
    v_exp_f32 v172, v92
    v_add_f32 v179, v179, v170
    v_exp_f32 v173, v93
    v_cvt_pk_bf16_f32 v157, v170, v171
    v_add_f32 v179, v179, v171
    v_exp_f32 v174, v94
    v_add_f32 v179, v179, v172
    v_exp_f32 v175, v95
    v_cvt_pk_bf16_f32 v158, v172, v173
    v_add_f32 v179, v179, v173
    v_add_f32 v179, v179, v174
    v_cvt_pk_bf16_f32 v159, v174, v175
    v_add_f32 v179, v179, v175
    s_nop 1
    s_branch fk_he0_ret
fk_he1_fb:
    s_nop 15
    v_max3_f32 v180, v48, v49, v50
    v_max3_f32 v180, v180, v51, v52
    v_max3_f32 v180, v180, v53, v54
    v_max3_f32 v180, v180, v55, v56
    v_max3_f32 v180, v180, v57, v58
    v_max3_f32 v180, v180, v59, v60
    v_max3_f32 v180, v180, v61, v62
    v_max_f32 v180, v180, v63
    v_mov_b32 v181, v180
    s_nop 1
    v_permlane32_swap_b32 v180, v181
    s_nop 0
    v_max_f32 v180, v180, v181
    v_max_f32 v180, 0, v180
    v_sub_f32 v48, v48, v180
    v_sub_f32 v49, v49, v180
    v_sub_f32 v50, v50, v180
    v_sub_f32 v51, v51, v180
    v_sub_f32 v52, v52, v180
    v_sub_f32 v53, v53, v180
    v_sub_f32 v54, v54, v180
    v_sub_f32 v55, v55, v180
    v_sub_f32 v56, v56, v180
    v_sub_f32 v57, v57, v180
    v_sub_f32 v58, v58, v180
    v_sub_f32 v59, v59, v180
    v_sub_f32 v60, v60, v180
    v_sub_f32 v61, v61, v180
    v_sub_f32 v62, v62, v180
    v_sub_f32 v63, v63, v180
    v_sub_f32 v80, v80, v180
    v_sub_f32 v81, v81, v180
    v_sub_f32 v82, v82, v180
    v_sub_f32 v83, v83, v180
    v_sub_f32 v84, v84, v180
    v_sub_f32 v85, v85, v180
    v_sub_f32 v86, v86, v180
    v_sub_f32 v87, v87, v180
    v_sub_f32 v88, v88, v180
    v_sub_f32 v89, v89, v180
    v_sub_f32 v90, v90, v180
    v_sub_f32 v91, v91, v180
    v_sub_f32 v92, v92, v180
    v_sub_f32 v93, v93, v180
    v_sub_f32 v94, v94, v180
    v_sub_f32 v95, v95, v180
    v_sub_f32 v112, v112, v180
    v_sub_f32 v113, v113, v180
    v_sub_f32 v114, v114, v180
    v_sub_f32 v115, v115, v180
    v_sub_f32 v116, v116, v180
    v_sub_f32 v117, v117, v180
    v_sub_f32 v118, v118, v180
    v_sub_f32 v119, v119, v180
    v_sub_f32 v120, v120, v180
    v_sub_f32 v121, v121, v180
    v_sub_f32 v122, v122, v180
    v_sub_f32 v123, v123, v180
    v_sub_f32 v124, v124, v180
    v_sub_f32 v125, v125, v180
    v_sub_f32 v126, v126, v180
    v_sub_f32 v127, v127, v180
    v_sub_f32 v180, 0, v180
    v_exp_f32 v180, v180
    s_nop 0
    v_mul_f32 v179, v179, v180
    v_accvgpr_read_b32 v160, a64
    v_accvgpr_read_b32 v161, a65
    v_accvgpr_read_b32 v162, a66
    v_accvgpr_read_b32 v163, a67
    v_mul_f32 v160, v160, v180
    v_mul_f32 v161, v161, v180
    v_mul_f32 v162, v162, v180
    v_mul_f32 v163, v163, v180
    v_accvgpr_write_b32 a64, v160
    v_accvgpr_write_b32 a65, v161
    v_accvgpr_write_b32 a66, v162
    v_accvgpr_write_b32 a67, v163
    v_accvgpr_read_b32 v160, a68
    v_accvgpr_read_b32 v161, a69
    v_accvgpr_read_b32 v162, a70
    v_accvgpr_read_b32 v163, a71
    v_mul_f32 v160, v160, v180
    v_mul_f32 v161, v161, v180
    v_mul_f32 v162, v162, v180
    v_mul_f32 v163, v163, v180
    v_accvgpr_write_b32 a68, v160
    v_accvgpr_write_b32 a69, v161
    v_accvgpr_write_b32 a70, v162
    v_accvgpr_write_b32 a71, v163
    v_accvgpr_read_b32 v160, a72
    v_accvgpr_read_b32 v161, a73
    v_accvgpr_read_b32 v162, a74
    v_accvgpr_read_b32 v163, a75
    v_mul_f32 v160, v160, v180
    v_mul_f32 v161, v161, v180
    v_mul_f32 v162, v162, v180
    v_mul_f32 v163, v163, v180
    v_accvgpr_write_b32 a72, v160
    v_accvgpr_write_b32 a73, v161
    v_accvgpr_write_b32 a74, v162
    v_accvgpr_write_b32 a75, v163
    v_accvgpr_read_b32 v160, a76
    v_accvgpr_read_b32 v161, a77
    v_accvgpr_read_b32 v162, a78
    v_accvgpr_read_b32 v163, a79
    v_mul_f32 v160, v160, v180
    v_mul_f32 v161, v161, v180
    v_mul_f32 v162, v162, v180
    v_mul_f32 v163, v163, v180
    v_accvgpr_write_b32 a76, v160
    v_accvgpr_write_b32 a77, v161
    v_accvgpr_write_b32 a78, v162
    v_accvgpr_write_b32 a79, v163
    v_accvgpr_read_b32 v160, a80
    v_accvgpr_read_b32 v161, a81
    v_accvgpr_read_b32 v162, a82
    v_accvgpr_read_b32 v163, a83
    v_mul_f32 v160, v160, v180
    v_mul_f32 v161, v161, v180
    v_mul_f32 v162, v162, v180
    v_mul_f32 v163, v163, v180
    v_accvgpr_write_b32 a80, v160
    v_accvgpr_write_b32 a81, v161
    v_accvgpr_write_b32 a82, v162
    v_accvgpr_write_b32 a83, v163
    v_accvgpr_read_b32 v160, a84
    v_accvgpr_read_b32 v161, a85
    v_accvgpr_read_b32 v162, a86
    v_accvgpr_read_b32 v163, a87
    v_mul_f32 v160, v160, v180
    v_mul_f32 v161, v161, v180
    v_mul_f32 v162, v162, v180
    v_mul_f32 v163, v163, v180
    v_accvgpr_write_b32 a84, v160
    v_accvgpr_write_b32 a85, v161
    v_accvgpr_write_b32 a86, v162
    v_accvgpr_write_b32 a87, v163
    v_accvgpr_read_b32 v160, a88
    v_accvgpr_read_b32 v161, a89
    v_accvgpr_read_b32 v162, a90
    v_accvgpr_read_b32 v163, a91
    v_mul_f32 v160, v160, v180
    v_mul_f32 v161, v161, v180
    v_mul_f32 v162, v162, v180
    v_mul_f32 v163, v163, v180
    v_accvgpr_write_b32 a88, v160
    v_accvgpr_write_b32 a89, v161
    v_accvgpr_write_b32 a90, v162
    v_accvgpr_write_b32 a91, v163
    v_accvgpr_read_b32 v160, a92
    v_accvgpr_read_b32 v161, a93
    v_accvgpr_read_b32 v162, a94
    v_accvgpr_read_b32 v163, a95
    v_mul_f32 v160, v160, v180
    v_mul_f32 v161, v161, v180
    v_mul_f32 v162, v162, v180
    v_mul_f32 v163, v163, v180
    v_accvgpr_write_b32 a92, v160
    v_accvgpr_write_b32 a93, v161
    v_accvgpr_write_b32 a94, v162
    v_accvgpr_write_b32 a95, v163
    v_accvgpr_read_b32 v160, a96
    v_accvgpr_read_b32 v161, a97
    v_accvgpr_read_b32 v162, a98
    v_accvgpr_read_b32 v163, a99
    v_mul_f32 v160, v160, v180
    v_mul_f32 v161, v161, v180
    v_mul_f32 v162, v162, v180
    v_mul_f32 v163, v163, v180
    v_accvgpr_write_b32 a96, v160
    v_accvgpr_write_b32 a97, v161
    v_accvgpr_write_b32 a98, v162
    v_accvgpr_write_b32 a99, v163
    v_accvgpr_read_b32 v160, a100
    v_accvgpr_read_b32 v161, a101
    v_accvgpr_read_b32 v162, a102
    v_accvgpr_read_b32 v163, a103
    v_mul_f32 v160, v160, v180
    v_mul_f32 v161, v161, v180
    v_mul_f32 v162, v162, v180
    v_mul_f32 v163, v163, v180
    v_accvgpr_write_b32 a100, v160
    v_accvgpr_write_b32 a101, v161
    v_accvgpr_write_b32 a102, v162
    v_accvgpr_write_b32 a103, v163
    v_accvgpr_read_b32 v160, a104
    v_accvgpr_read_b32 v161, a105
    v_accvgpr_read_b32 v162, a106
    v_accvgpr_read_b32 v163, a107
    v_mul_f32 v160, v160, v180
    v_mul_f32 v161, v161, v180
    v_mul_f32 v162, v162, v180
    v_mul_f32 v163, v163, v180
    v_accvgpr_write_b32 a104, v160
    v_accvgpr_write_b32 a105, v161
    v_accvgpr_write_b32 a106, v162
    v_accvgpr_write_b32 a107, v163
    v_accvgpr_read_b32 v160, a108
    v_accvgpr_read_b32 v161, a109
    v_accvgpr_read_b32 v162, a110
    v_accvgpr_read_b32 v163, a111
    v_mul_f32 v160, v160, v180
    v_mul_f32 v161, v161, v180
    v_mul_f32 v162, v162, v180
    v_mul_f32 v163, v163, v180
    v_accvgpr_write_b32 a108, v160
    v_accvgpr_write_b32 a109, v161
    v_accvgpr_write_b32 a110, v162
    v_accvgpr_write_b32 a111, v163
    v_accvgpr_read_b32 v160, a112
    v_accvgpr_read_b32 v161, a113
    v_accvgpr_read_b32 v162, a114
    v_accvgpr_read_b32 v163, a115
    v_mul_f32 v160, v160, v180
    v_mul_f32 v161, v161, v180
    v_mul_f32 v162, v162, v180
    v_mul_f32 v163, v163, v180
    v_accvgpr_write_b32 a112, v160
    v_accvgpr_write_b32 a113, v161
    v_accvgpr_write_b32 a114, v162
    v_accvgpr_write_b32 a115, v163
    v_accvgpr_read_b32 v160, a116
    v_accvgpr_read_b32 v161, a117
    v_accvgpr_read_b32 v162, a118
    v_accvgpr_read_b32 v163, a119
    v_mul_f32 v160, v160, v180
    v_mul_f32 v161, v161, v180
    v_mul_f32 v162, v162, v180
    v_mul_f32 v163, v163, v180
    v_accvgpr_write_b32 a116, v160
    v_accvgpr_write_b32 a117, v161
    v_accvgpr_write_b32 a118, v162
    v_accvgpr_write_b32 a119, v163
    v_accvgpr_read_b32 v160, a120
    v_accvgpr_read_b32 v161, a121
    v_accvgpr_read_b32 v162, a122
    v_accvgpr_read_b32 v163, a123
    v_mul_f32 v160, v160, v180
    v_mul_f32 v161, v161, v180
    v_mul_f32 v162, v162, v180
    v_mul_f32 v163, v163, v180
    v_accvgpr_write_b32 a120, v160
    v_accvgpr_write_b32 a121, v161
    v_accvgpr_write_b32 a122, v162
    v_accvgpr_write_b32 a123, v163
    v_accvgpr_read_b32 v160, a124
    v_accvgpr_read_b32 v161, a125
    v_accvgpr_read_b32 v162, a126
    v_accvgpr_read_b32 v163, a127
    v_mul_f32 v160, v160, v180
    v_mul_f32 v161, v161, v180
    v_mul_f32 v162, v162, v180
    v_mul_f32 v163, v163, v180
    v_accvgpr_write_b32 a124, v160
    v_accvgpr_write_b32 a125, v161
    v_accvgpr_write_b32 a126, v162
    v_accvgpr_write_b32 a127, v163
    v_exp_f32 v160, v48
    v_exp_f32 v161, v49
    v_exp_f32 v162, v50
    v_add_f32 v177, v179, v160
    v_exp_f32 v163, v51
    v_cvt_pk_bf16_f32 v136, v160, v161
    v_add_f32 v177, v177, v161
    v_exp_f32 v164, v52
    v_add_f32 v177, v177, v162
    v_exp_f32 v165, v53
    v_cvt_pk_bf16_f32 v137, v162, v163
    v_add_f32 v177, v177, v163
    v_exp_f32 v166, v54
    v_add_f32 v177, v177, v164
    v_exp_f32 v167, v55
    v_cvt_pk_bf16_f32 v138, v164, v165
    v_add_f32 v177, v177, v165
    v_exp_f32 v168, v56
    v_add_f32 v177, v177, v166
    v_exp_f32 v169, v57
    v_cvt_pk_bf16_f32 v139, v166, v167
    v_add_f32 v177, v177, v167
    v_exp_f32 v170, v58
    v_add_f32 v177, v177, v168
    v_exp_f32 v171, v59
    v_cvt_pk_bf16_f32 v140, v168, v169
    v_add_f32 v177, v177, v169
    v_exp_f32 v172, v60
    v_add_f32 v177, v177, v170
    v_exp_f32 v173, v61
    v_cvt_pk_bf16_f32 v141, v170, v171
    v_add_f32 v177, v177, v171
    v_exp_f32 v174, v62
    v_add_f32 v177, v177, v172
    v_exp_f32 v175, v63
    v_cvt_pk_bf16_f32 v142, v172, v173
    v_add_f32 v177, v177, v173
    v_add_f32 v177, v177, v174
    v_cvt_pk_bf16_f32 v143, v174, v175
    v_add_f32 v177, v177, v175
    s_nop 1
    s_branch fk_he1_ret
fk_hs0_fb:
    s_nop 15
    v_max3_f32 v180, v80, v81, v82
    v_max3_f32 v180, v180, v83, v84
    v_max3_f32 v180, v180, v85, v86
    v_max3_f32 v180, v180, v87, v88
    v_max3_f32 v180, v180, v89, v90
    v_max3_f32 v180, v180, v91, v92
    v_max3_f32 v180, v180, v93, v94
    v_max_f32 v180, v180, v95
    v_mov_b32 v181, v180
    s_nop 1
    v_permlane32_swap_b32 v180, v181
    s_nop 0
    v_max_f32 v180, v180, v181
    v_max_f32 v180, 0, v180
    v_sub_f32 v80, v80, v180
    v_sub_f32 v81, v81, v180
    v_sub_f32 v82, v82, v180
    v_sub_f32 v83, v83, v180
    v_sub_f32 v84, v84, v180
    v_sub_f32 v85, v85, v180
    v_sub_f32 v86, v86, v180
    v_sub_f32 v87, v87, v180
    v_sub_f32 v88, v88, v180
    v_sub_f32 v89, v89, v180
    v_sub_f32 v90, v90, v180
    v_sub_f32 v91, v91, v180
    v_sub_f32 v92, v92, v180
    v_sub_f32 v93, v93, v180
    v_sub_f32 v94, v94, v180
    v_sub_f32 v95, v95, v180
    v_sub_f32 v48, v48, v180
    v_sub_f32 v49, v49, v180
    v_sub_f32 v50, v50, v180
    v_sub_f32 v51, v51, v180
    v_sub_f32 v52, v52, v180
    v_sub_f32 v53, v53, v180
    v_sub_f32 v54, v54, v180
    v_sub_f32 v55, v55, v180
    v_sub_f32 v56, v56, v180
    v_sub_f32 v57, v57, v180
    v_sub_f32 v58, v58, v180
    v_sub_f32 v59, v59, v180
    v_sub_f32 v60, v60, v180
    v_sub_f32 v61, v61, v180
    v_sub_f32 v62, v62, v180
    v_sub_f32 v63, v63, v180
    v_sub_f32 v112, v112, v180
    v_sub_f32 v113, v113, v180
    v_sub_f32 v114, v114, v180
    v_sub_f32 v115, v115, v180
    v_sub_f32 v116, v116, v180
    v_sub_f32 v117, v117, v180
    v_sub_f32 v118, v118, v180
    v_sub_f32 v119, v119, v180
    v_sub_f32 v120, v120, v180
    v_sub_f32 v121, v121, v180
    v_sub_f32 v122, v122, v180
    v_sub_f32 v123, v123, v180
    v_sub_f32 v124, v124, v180
    v_sub_f32 v125, v125, v180
    v_sub_f32 v126, v126, v180
    v_sub_f32 v127, v127, v180
    v_sub_f32 v180, 0, v180
    v_exp_f32 v180, v180
    s_nop 0
    v_mul_f32 v177, v177, v180
    v_accvgpr_read_b32 v160, a64
    v_accvgpr_read_b32 v161, a65
    v_accvgpr_read_b32 v162, a66
    v_accvgpr_read_b32 v163, a67
    v_mul_f32 v160, v160, v180
    v_mul_f32 v161, v161, v180
    v_mul_f32 v162, v162, v180
    v_mul_f32 v163, v163, v180
    v_accvgpr_write_b32 a64, v160
    v_accvgpr_write_b32 a65, v161
    v_accvgpr_write_b32 a66, v162
    v_accvgpr_write_b32 a67, v163
    v_accvgpr_read_b32 v160, a68
    v_accvgpr_read_b32 v161, a69
    v_accvgpr_read_b32 v162, a70
    v_accvgpr_read_b32 v163, a71
    v_mul_f32 v160, v160, v180
    v_mul_f32 v161, v161, v180
    v_mul_f32 v162, v162, v180
    v_mul_f32 v163, v163, v180
    v_accvgpr_write_b32 a68, v160
    v_accvgpr_write_b32 a69, v161
    v_accvgpr_write_b32 a70, v162
    v_accvgpr_write_b32 a71, v163
    v_accvgpr_read_b32 v160, a72
    v_accvgpr_read_b32 v161, a73
    v_accvgpr_read_b32 v162, a74
    v_accvgpr_read_b32 v163, a75
    v_mul_f32 v160, v160, v180
    v_mul_f32 v161, v161, v180
    v_mul_f32 v162, v162, v180
    v_mul_f32 v163, v163, v180
    v_accvgpr_write_b32 a72, v160
    v_accvgpr_write_b32 a73, v161
    v_accvgpr_write_b32 a74, v162
    v_accvgpr_write_b32 a75, v163
    v_accvgpr_read_b32 v160, a76
    v_accvgpr_read_b32 v161, a77
    v_accvgpr_read_b32 v162, a78
    v_accvgpr_read_b32 v163, a79
    v_mul_f32 v160, v160, v180
    v_mul_f32 v161, v161, v180
    v_mul_f32 v162, v162, v180
    v_mul_f32 v163, v163, v180
    v_accvgpr_write_b32 a76, v160
    v_accvgpr_write_b32 a77, v161
    v_accvgpr_write_b32 a78, v162
    v_accvgpr_write_b32 a79, v163
    v_accvgpr_read_b32 v160, a80
    v_accvgpr_read_b32 v161, a81
    v_accvgpr_read_b32 v162, a82
    v_accvgpr_read_b32 v163, a83
    v_mul_f32 v160, v160, v180
    v_mul_f32 v161, v161, v180
    v_mul_f32 v162, v162, v180
    v_mul_f32 v163, v163, v180
    v_accvgpr_write_b32 a80, v160
    v_accvgpr_write_b32 a81, v161
    v_accvgpr_write_b32 a82, v162
    v_accvgpr_write_b32 a83, v163
    v_accvgpr_read_b32 v160, a84
    v_accvgpr_read_b32 v161, a85
    v_accvgpr_read_b32 v162, a86
    v_accvgpr_read_b32 v163, a87
    v_mul_f32 v160, v160, v180
    v_mul_f32 v161, v161, v180
    v_mul_f32 v162, v162, v180
    v_mul_f32 v163, v163, v180
    v_accvgpr_write_b32 a84, v160
    v_accvgpr_write_b32 a85, v161
    v_accvgpr_write_b32 a86, v162
    v_accvgpr_write_b32 a87, v163
    v_accvgpr_read_b32 v160, a88
    v_accvgpr_read_b32 v161, a89
    v_accvgpr_read_b32 v162, a90
    v_accvgpr_read_b32 v163, a91
    v_mul_f32 v160, v160, v180
    v_mul_f32 v161, v161, v180
    v_mul_f32 v162, v162, v180
    v_mul_f32 v163, v163, v180
    v_accvgpr_write_b32 a88, v160
    v_accvgpr_write_b32 a89, v161
    v_accvgpr_write_b32 a90, v162
    v_accvgpr_write_b32 a91, v163
    v_accvgpr_read_b32 v160, a92
    v_accvgpr_read_b32 v161, a93
    v_accvgpr_read_b32 v162, a94
    v_accvgpr_read_b32 v163, a95
    v_mul_f32 v160, v160, v180
    v_mul_f32 v161, v161, v180
    v_mul_f32 v162, v162, v180
    v_mul_f32 v163, v163, v180
    v_accvgpr_write_b32 a92, v160
    v_accvgpr_write_b32 a93, v161
    v_accvgpr_write_b32 a94, v162
    v_accvgpr_write_b32 a95, v163
    v_accvgpr_read_b32 v160, a96
    v_accvgpr_read_b32 v161, a97
    v_accvgpr_read_b32 v162, a98
    v_accvgpr_read_b32 v163, a99
    v_mul_f32 v160, v160, v180
    v_mul_f32 v161, v161, v180
    v_mul_f32 v162, v162, v180
    v_mul_f32 v163, v163, v180
    v_accvgpr_write_b32 a96, v160
    v_accvgpr_write_b32 a97, v161
    v_accvgpr_write_b32 a98, v162
    v_accvgpr_write_b32 a99, v163
    v_accvgpr_read_b32 v160, a100
    v_accvgpr_read_b32 v161, a101
    v_accvgpr_read_b32 v162, a102
    v_accvgpr_read_b32 v163, a103
    v_mul_f32 v160, v160, v180
    v_mul_f32 v161, v161, v180
    v_mul_f32 v162, v162, v180
    v_mul_f32 v163, v163, v180
    v_accvgpr_write_b32 a100, v160
    v_accvgpr_write_b32 a101, v161
    v_accvgpr_write_b32 a102, v162
    v_accvgpr_write_b32 a103, v163
    v_accvgpr_read_b32 v160, a104
    v_accvgpr_read_b32 v161, a105
    v_accvgpr_read_b32 v162, a106
    v_accvgpr_read_b32 v163, a107
    v_mul_f32 v160, v160, v180
    v_mul_f32 v161, v161, v180
    v_mul_f32 v162, v162, v180
    v_mul_f32 v163, v163, v180
    v_accvgpr_write_b32 a104, v160
    v_accvgpr_write_b32 a105, v161
    v_accvgpr_write_b32 a106, v162
    v_accvgpr_write_b32 a107, v163
    v_accvgpr_read_b32 v160, a108
    v_accvgpr_read_b32 v161, a109
    v_accvgpr_read_b32 v162, a110
    v_accvgpr_read_b32 v163, a111
    v_mul_f32 v160, v160, v180
    v_mul_f32 v161, v161, v180
    v_mul_f32 v162, v162, v180
    v_mul_f32 v163, v163, v180
    v_accvgpr_write_b32 a108, v160
    v_accvgpr_write_b32 a109, v161
    v_accvgpr_write_b32 a110, v162
    v_accvgpr_write_b32 a111, v163
    v_accvgpr_read_b32 v160, a112
    v_accvgpr_read_b32 v161, a113
    v_accvgpr_read_b32 v162, a114
    v_accvgpr_read_b32 v163, a115
    v_mul_f32 v160, v160, v180
    v_mul_f32 v161, v161, v180
    v_mul_f32 v162, v162, v180
    v_mul_f32 v163, v163, v180
    v_accvgpr_write_b32 a112, v160
    v_accvgpr_write_b32 a113, v161
    v_accvgpr_write_b32 a114, v162
    v_accvgpr_write_b32 a115, v163
    v_accvgpr_read_b32 v160, a116
    v_accvgpr_read_b32 v161, a117
    v_accvgpr_read_b32 v162, a118
    v_accvgpr_read_b32 v163, a119
    v_mul_f32 v160, v160, v180
    v_mul_f32 v161, v161, v180
    v_mul_f32 v162, v162, v180
    v_mul_f32 v163, v163, v180
    v_accvgpr_write_b32 a116, v160
    v_accvgpr_write_b32 a117, v161
    v_accvgpr_write_b32 a118, v162
    v_accvgpr_write_b32 a119, v163
    v_accvgpr_read_b32 v160, a120
    v_accvgpr_read_b32 v161, a121
    v_accvgpr_read_b32 v162, a122
    v_accvgpr_read_b32 v163, a123
    v_mul_f32 v160, v160, v180
    v_mul_f32 v161, v161, v180
    v_mul_f32 v162, v162, v180
    v_mul_f32 v163, v163, v180
    v_accvgpr_write_b32 a120, v160
    v_accvgpr_write_b32 a121, v161
    v_accvgpr_write_b32 a122, v162
    v_accvgpr_write_b32 a123, v163
    v_accvgpr_read_b32 v160, a124
    v_accvgpr_read_b32 v161, a125
    v_accvgpr_read_b32 v162, a126
    v_accvgpr_read_b32 v163, a127
    v_mul_f32 v160, v160, v180
    v_mul_f32 v161, v161, v180
    v_mul_f32 v162, v162, v180
    v_mul_f32 v163, v163, v180
    v_accvgpr_write_b32 a124, v160
    v_accvgpr_write_b32 a125, v161
    v_accvgpr_write_b32 a126, v162
    v_accvgpr_write_b32 a127, v163
    v_exp_f32 v160, v80
    v_exp_f32 v161, v81
    v_exp_f32 v162, v82
    v_add_f32 v179, v177, v160
    v_exp_f32 v163, v83
    v_cvt_pk_bf16_f32 v152, v160, v161
    v_add_f32 v179, v179, v161
    v_exp_f32 v164, v84
    v_add_f32 v179, v179, v162
    v_exp_f32 v165, v85
    v_cvt_pk_bf16_f32 v153, v162, v163
    v_add_f32 v179, v179, v163
    v_exp_f32 v166, v86
    v_add_f32 v179, v179, v164
    v_exp_f32 v167, v87
    v_cvt_pk_bf16_f32 v154, v164, v165
    v_add_f32 v179, v179, v165
    v_exp_f32 v168, v88
    v_add_f32 v179, v179, v166
    v_exp_f32 v169, v89
    v_cvt_pk_bf16_f32 v155, v166, v167
    v_add_f32 v179, v179, v167
    v_exp_f32 v170, v90
    v_add_f32 v179, v179, v168
    v_exp_f32 v171, v91
    v_cvt_pk_bf16_f32 v156, v168, v169
    v_add_f32 v179, v179, v169
    v_exp_f32 v172, v92
    v_add_f32 v179, v179, v170
    v_exp_f32 v173, v93
    v_cvt_pk_bf16_f32 v157, v170, v171
    v_add_f32 v179, v179, v171
    v_exp_f32 v174, v94
    v_add_f32 v179, v179, v172
    v_exp_f32 v175, v95
    v_cvt_pk_bf16_f32 v158, v172, v173
    v_add_f32 v179, v179, v173
    v_add_f32 v179, v179, v174
    v_cvt_pk_bf16_f32 v159, v174, v175
    v_add_f32 v179, v179, v175
    s_nop 1
    s_branch fk_hs0_ret
fk_hs1_fb:
    s_nop 15
    v_max3_f32 v180, v48, v49, v50
    v_max3_f32 v180, v180, v51, v52
    v_max3_f32 v180, v180, v53, v54
    v_max3_f32 v180, v180, v55, v56
    v_max3_f32 v180, v180, v57, v58
    v_max3_f32 v180, v180, v59, v60
    v_max3_f32 v180, v180, v61, v62
    v_max_f32 v180, v180, v63
    v_mov_b32 v181, v180
    s_nop 1
    v_permlane32_swap_b32 v180, v181
    s_nop 0
    v_max_f32 v180, v180, v181
    v_max_f32 v180, 0, v180
    v_sub_f32 v48, v48, v180
    v_sub_f32 v49, v49, v180
    v_sub_f32 v50, v50, v180
    v_sub_f32 v51, v51, v180
    v_sub_f32 v52, v52, v180
    v_sub_f32 v53, v53, v180
    v_sub_f32 v54, v54, v180
    v_sub_f32 v55, v55, v180
    v_sub_f32 v56, v56, v180
    v_sub_f32 v57, v57, v180
    v_sub_f32 v58, v58, v180
    v_sub_f32 v59, v59, v180
    v_sub_f32 v60, v60, v180
    v_sub_f32 v61, v61, v180
    v_sub_f32 v62, v62, v180
    v_sub_f32 v63, v63, v180
    v_sub_f32 v80, v80, v180
    v_sub_f32 v81, v81, v180
    v_sub_f32 v82, v82, v180
    v_sub_f32 v83, v83, v180
    v_sub_f32 v84, v84, v180
    v_sub_f32 v85, v85, v180
    v_sub_f32 v86, v86, v180
    v_sub_f32 v87, v87, v180
    v_sub_f32 v88, v88, v180
    v_sub_f32 v89, v89, v180
    v_sub_f32 v90, v90, v180
    v_sub_f32 v91, v91, v180
    v_sub_f32 v92, v92, v180
    v_sub_f32 v93, v93, v180
    v_sub_f32 v94, v94, v180
    v_sub_f32 v95, v95, v180
    v_sub_f32 v112, v112, v180
    v_sub_f32 v113, v113, v180
    v_sub_f32 v114, v114, v180
    v_sub_f32 v115, v115, v180
    v_sub_f32 v116, v116, v180
    v_sub_f32 v117, v117, v180
    v_sub_f32 v118, v118, v180
    v_sub_f32 v119, v119, v180
    v_sub_f32 v120, v120, v180
    v_sub_f32 v121, v121, v180
    v_sub_f32 v122, v122, v180
    v_sub_f32 v123, v123, v180
    v_sub_f32 v124, v124, v180
    v_sub_f32 v125, v125, v180
    v_sub_f32 v126, v126, v180
    v_sub_f32 v127, v127, v180
    v_sub_f32 v180, 0, v180
    v_exp_f32 v180, v180
    s_nop 0
    v_mul_f32 v179, v179, v180
    v_accvgpr_read_b32 v160, a64
    v_accvgpr_read_b32 v161, a65
    v_accvgpr_read_b32 v162, a66
    v_accvgpr_read_b32 v163, a67
    v_mul_f32 v160, v160, v180
    v_mul_f32 v161, v161, v180
    v_mul_f32 v162, v162, v180
    v_mul_f32 v163, v163, v180
    v_accvgpr_write_b32 a64, v160
    v_accvgpr_write_b32 a65, v161
    v_accvgpr_write_b32 a66, v162
    v_accvgpr_write_b32 a67, v163
    v_accvgpr_read_b32 v160, a68
    v_accvgpr_read_b32 v161, a69
    v_accvgpr_read_b32 v162, a70
    v_accvgpr_read_b32 v163, a71
    v_mul_f32 v160, v160, v180
    v_mul_f32 v161, v161, v180
    v_mul_f32 v162, v162, v180
    v_mul_f32 v163, v163, v180
    v_accvgpr_write_b32 a68, v160
    v_accvgpr_write_b32 a69, v161
    v_accvgpr_write_b32 a70, v162
    v_accvgpr_write_b32 a71, v163
    v_accvgpr_read_b32 v160, a72
    v_accvgpr_read_b32 v161, a73
    v_accvgpr_read_b32 v162, a74
    v_accvgpr_read_b32 v163, a75
    v_mul_f32 v160, v160, v180
    v_mul_f32 v161, v161, v180
    v_mul_f32 v162, v162, v180
    v_mul_f32 v163, v163, v180
    v_accvgpr_write_b32 a72, v160
    v_accvgpr_write_b32 a73, v161
    v_accvgpr_write_b32 a74, v162
    v_accvgpr_write_b32 a75, v163
    v_accvgpr_read_b32 v160, a76
    v_accvgpr_read_b32 v161, a77
    v_accvgpr_read_b32 v162, a78
    v_accvgpr_read_b32 v163, a79
    v_mul_f32 v160, v160, v180
    v_mul_f32 v161, v161, v180
    v_mul_f32 v162, v162, v180
    v_mul_f32 v163, v163, v180
    v_accvgpr_write_b32 a76, v160
    v_accvgpr_write_b32 a77, v161
    v_accvgpr_write_b32 a78, v162
    v_accvgpr_write_b32 a79, v163
    v_accvgpr_read_b32 v160, a80
    v_accvgpr_read_b32 v161, a81
    v_accvgpr_read_b32 v162, a82
    v_accvgpr_read_b32 v163, a83
    v_mul_f32 v160, v160, v180
    v_mul_f32 v161, v161, v180
    v_mul_f32 v162, v162, v180
    v_mul_f32 v163, v163, v180
    v_accvgpr_write_b32 a80, v160
    v_accvgpr_write_b32 a81, v161
    v_accvgpr_write_b32 a82, v162
    v_accvgpr_write_b32 a83, v163
    v_accvgpr_read_b32 v160, a84
    v_accvgpr_read_b32 v161, a85
    v_accvgpr_read_b32 v162, a86
    v_accvgpr_read_b32 v163, a87
    v_mul_f32 v160, v160, v180
    v_mul_f32 v161, v161, v180
    v_mul_f32 v162, v162, v180
    v_mul_f32 v163, v163, v180
    v_accvgpr_write_b32 a84, v160
    v_accvgpr_write_b32 a85, v161
    v_accvgpr_write_b32 a86, v162
    v_accvgpr_write_b32 a87, v163
    v_accvgpr_read_b32 v160, a88
    v_accvgpr_read_b32 v161, a89
    v_accvgpr_read_b32 v162, a90
    v_accvgpr_read_b32 v163, a91
    v_mul_f32 v160, v160, v180
    v_mul_f32 v161, v161, v180
    v_mul_f32 v162, v162, v180
    v_mul_f32 v163, v163, v180
    v_accvgpr_write_b32 a88, v160
    v_accvgpr_write_b32 a89, v161
    v_accvgpr_write_b32 a90, v162
    v_accvgpr_write_b32 a91, v163
    v_accvgpr_read_b32 v160, a92
    v_accvgpr_read_b32 v161, a93
    v_accvgpr_read_b32 v162, a94
    v_accvgpr_read_b32 v163, a95
    v_mul_f32 v160, v160, v180
    v_mul_f32 v161, v161, v180
    v_mul_f32 v162, v162, v180
    v_mul_f32 v163, v163, v180
    v_accvgpr_write_b32 a92, v160
    v_accvgpr_write_b32 a93, v161
    v_accvgpr_write_b32 a94, v162
    v_accvgpr_write_b32 a95, v163
    v_accvgpr_read_b32 v160, a96
    v_accvgpr_read_b32 v161, a97
    v_accvgpr_read_b32 v162, a98
    v_accvgpr_read_b32 v163, a99
    v_mul_f32 v160, v160, v180
    v_mul_f32 v161, v161, v180
    v_mul_f32 v162, v162, v180
    v_mul_f32 v163, v163, v180
    v_accvgpr_write_b32 a96, v160
    v_accvgpr_write_b32 a97, v161
    v_accvgpr_write_b32 a98, v162
    v_accvgpr_write_b32 a99, v163
    v_accvgpr_read_b32 v160, a100
    v_accvgpr_read_b32 v161, a101
    v_accvgpr_read_b32 v162, a102
    v_accvgpr_read_b32 v163, a103
    v_mul_f32 v160, v160, v180
    v_mul_f32 v161, v161, v180
    v_mul_f32 v162, v162, v180
    v_mul_f32 v163, v163, v180
    v_accvgpr_write_b32 a100, v160
    v_accvgpr_write_b32 a101, v161
    v_accvgpr_write_b32 a102, v162
    v_accvgpr_write_b32 a103, v163
    v_accvgpr_read_b32 v160, a104
    v_accvgpr_read_b32 v161, a105
    v_accvgpr_read_b32 v162, a106
    v_accvgpr_read_b32 v163, a107
    v_mul_f32 v160, v160, v180
    v_mul_f32 v161, v161, v180
    v_mul_f32 v162, v162, v180
    v_mul_f32 v163, v163, v180
    v_accvgpr_write_b32 a104, v160
    v_accvgpr_write_b32 a105, v161
    v_accvgpr_write_b32 a106, v162
    v_accvgpr_write_b32 a107, v163
    v_accvgpr_read_b32 v160, a108
    v_accvgpr_read_b32 v161, a109
    v_accvgpr_read_b32 v162, a110
    v_accvgpr_read_b32 v163, a111
    v_mul_f32 v160, v160, v180
    v_mul_f32 v161, v161, v180
    v_mul_f32 v162, v162, v180
    v_mul_f32 v163, v163, v180
    v_accvgpr_write_b32 a108, v160
    v_accvgpr_write_b32 a109, v161
    v_accvgpr_write_b32 a110, v162
    v_accvgpr_write_b32 a111, v163
    v_accvgpr_read_b32 v160, a112
    v_accvgpr_read_b32 v161, a113
    v_accvgpr_read_b32 v162, a114
    v_accvgpr_read_b32 v163, a115
    v_mul_f32 v160, v160, v180
    v_mul_f32 v161, v161, v180
    v_mul_f32 v162, v162, v180
    v_mul_f32 v163, v163, v180
    v_accvgpr_write_b32 a112, v160
    v_accvgpr_write_b32 a113, v161
    v_accvgpr_write_b32 a114, v162
    v_accvgpr_write_b32 a115, v163
    v_accvgpr_read_b32 v160, a116
    v_accvgpr_read_b32 v161, a117
    v_accvgpr_read_b32 v162, a118
    v_accvgpr_read_b32 v163, a119
    v_mul_f32 v160, v160, v180
    v_mul_f32 v161, v161, v180
    v_mul_f32 v162, v162, v180
    v_mul_f32 v163, v163, v180
    v_accvgpr_write_b32 a116, v160
    v_accvgpr_write_b32 a117, v161
    v_accvgpr_write_b32 a118, v162
    v_accvgpr_write_b32 a119, v163
    v_accvgpr_read_b32 v160, a120
    v_accvgpr_read_b32 v161, a121
    v_accvgpr_read_b32 v162, a122
    v_accvgpr_read_b32 v163, a123
    v_mul_f32 v160, v160, v180
    v_mul_f32 v161, v161, v180
    v_mul_f32 v162, v162, v180
    v_mul_f32 v163, v163, v180
    v_accvgpr_write_b32 a120, v160
    v_accvgpr_write_b32 a121, v161
    v_accvgpr_write_b32 a122, v162
    v_accvgpr_write_b32 a123, v163
    v_accvgpr_read_b32 v160, a124
    v_accvgpr_read_b32 v161, a125
    v_accvgpr_read_b32 v162, a126
    v_accvgpr_read_b32 v163, a127
    v_mul_f32 v160, v160, v180
    v_mul_f32 v161, v161, v180
    v_mul_f32 v162, v162, v180
    v_mul_f32 v163, v163, v180
    v_accvgpr_write_b32 a124, v160
    v_accvgpr_write_b32 a125, v161
    v_accvgpr_write_b32 a126, v162
    v_accvgpr_write_b32 a127, v163
    v_exp_f32 v160, v48
    v_exp_f32 v161, v49
    v_exp_f32 v162, v50
    v_add_f32 v177, v179, v160
    v_exp_f32 v163, v51
    v_cvt_pk_bf16_f32 v136, v160, v161
    v_add_f32 v177, v177, v161
    v_exp_f32 v164, v52
    v_add_f32 v177, v177, v162
    v_exp_f32 v165, v53
    v_cvt_pk_bf16_f32 v137, v162, v163
    v_add_f32 v177, v177, v163
    v_exp_f32 v166, v54
    v_add_f32 v177, v177, v164
    v_exp_f32 v167, v55
    v_cvt_pk_bf16_f32 v138, v164, v165
    v_add_f32 v177, v177, v165
    v_exp_f32 v168, v56
    v_add_f32 v177, v177, v166
    v_exp_f32 v169, v57
    v_cvt_pk_bf16_f32 v139, v166, v167
    v_add_f32 v177, v177, v167
    v_exp_f32 v170, v58
    v_add_f32 v177, v177, v168
    v_exp_f32 v171, v59
    v_cvt_pk_bf16_f32 v140, v168, v169
    v_add_f32 v177, v177, v169
    v_exp_f32 v172, v60
    v_add_f32 v177, v177, v170
    v_exp_f32 v173, v61
    v_cvt_pk_bf16_f32 v141, v170, v171
    v_add_f32 v177, v177, v171
    v_exp_f32 v174, v62
    v_add_f32 v177, v177, v172
    v_exp_f32 v175, v63
    v_cvt_pk_bf16_f32 v142, v172, v173
    v_add_f32 v177, v177, v173
    v_add_f32 v177, v177, v174
    v_cvt_pk_bf16_f32 v143, v174, v175
    v_add_f32 v177, v177, v175
    s_nop 1
    s_branch fk_hs1_ret
fk_ht0_fb:
    s_nop 15
    v_max3_f32 v180, v80, v81, v82
    v_max3_f32 v180, v180, v83, v84
    v_max3_f32 v180, v180, v85, v86
    v_max3_f32 v180, v180, v87, v88
    v_max3_f32 v180, v180, v89, v90
    v_max3_f32 v180, v180, v91, v92
    v_max3_f32 v180, v180, v93, v94
    v_max_f32 v180, v180, v95
    v_mov_b32 v181, v180
    s_nop 1
    v_permlane32_swap_b32 v180, v181
    s_nop 0
    v_max_f32 v180, v180, v181
    v_max_f32 v180, 0, v180
    v_sub_f32 v80, v80, v180
    v_sub_f32 v81, v81, v180
    v_sub_f32 v82, v82, v180
    v_sub_f32 v83, v83, v180
    v_sub_f32 v84, v84, v180
    v_sub_f32 v85, v85, v180
    v_sub_f32 v86, v86, v180
    v_sub_f32 v87, v87, v180
    v_sub_f32 v88, v88, v180
    v_sub_f32 v89, v89, v180
    v_sub_f32 v90, v90, v180
    v_sub_f32 v91, v91, v180
    v_sub_f32 v92, v92, v180
    v_sub_f32 v93, v93, v180
    v_sub_f32 v94, v94, v180
    v_sub_f32 v95, v95, v180
    v_sub_f32 v48, v48, v180
    v_sub_f32 v49, v49, v180
    v_sub_f32 v50, v50, v180
    v_sub_f32 v51, v51, v180
    v_sub_f32 v52, v52, v180
    v_sub_f32 v53, v53, v180
    v_sub_f32 v54, v54, v180
    v_sub_f32 v55, v55, v180
    v_sub_f32 v56, v56, v180
    v_sub_f32 v57, v57, v180
    v_sub_f32 v58, v58, v180
    v_sub_f32 v59, v59, v180
    v_sub_f32 v60, v60, v180
    v_sub_f32 v61, v61, v180
    v_sub_f32 v62, v62, v180
    v_sub_f32 v63, v63, v180
    v_sub_f32 v112, v112, v180
    v_sub_f32 v113, v113, v180
    v_sub_f32 v114, v114, v180
    v_sub_f32 v115, v115, v180
    v_sub_f32 v116, v116, v180
    v_sub_f32 v117, v117, v180
    v_sub_f32 v118, v118, v180
    v_sub_f32 v119, v119, v180
    v_sub_f32 v120, v120, v180
    v_sub_f32 v121, v121, v180
    v_sub_f32 v122, v122, v180
    v_sub_f32 v123, v123, v180
    v_sub_f32 v124, v124, v180
    v_sub_f32 v125, v125, v180
    v_sub_f32 v126, v126, v180
    v_sub_f32 v127, v127, v180
    v_sub_f32 v180, 0, v180
    v_exp_f32 v180, v180
    s_nop 0
    v_mul_f32 v177, v177, v180
    v_accvgpr_read_b32 v160, a64
    v_accvgpr_read_b32 v161, a65
    v_accvgpr_read_b32 v162, a66
    v_accvgpr_read_b32 v163, a67
    v_mul_f32 v160, v160, v180
    v_mul_f32 v161, v161, v180
    v_mul_f32 v162, v162, v180
    v_mul_f32 v163, v163, v180
    v_accvgpr_write_b32 a64, v160
    v_accvgpr_write_b32 a65, v161
    v_accvgpr_write_b32 a66, v162
    v_accvgpr_write_b32 a67, v163
    v_accvgpr_read_b32 v160, a68
    v_accvgpr_read_b32 v161, a69
    v_accvgpr_read_b32 v162, a70
    v_accvgpr_read_b32 v163, a71
    v_mul_f32 v160, v160, v180
    v_mul_f32 v161, v161, v180
    v_mul_f32 v162, v162, v180
    v_mul_f32 v163, v163, v180
    v_accvgpr_write_b32 a68, v160
    v_accvgpr_write_b32 a69, v161
    v_accvgpr_write_b32 a70, v162
    v_accvgpr_write_b32 a71, v163
    v_accvgpr_read_b32 v160, a72
    v_accvgpr_read_b32 v161, a73
    v_accvgpr_read_b32 v162, a74
    v_accvgpr_read_b32 v163, a75
    v_mul_f32 v160, v160, v180
    v_mul_f32 v161, v161, v180
    v_mul_f32 v162, v162, v180
    v_mul_f32 v163, v163, v180
    v_accvgpr_write_b32 a72, v160
    v_accvgpr_write_b32 a73, v161
    v_accvgpr_write_b32 a74, v162
    v_accvgpr_write_b32 a75, v163
    v_accvgpr_read_b32 v160, a76
    v_accvgpr_read_b32 v161, a77
    v_accvgpr_read_b32 v162, a78
    v_accvgpr_read_b32 v163, a79
    v_mul_f32 v160, v160, v180
    v_mul_f32 v161, v161, v180
    v_mul_f32 v162, v162, v180
    v_mul_f32 v163, v163, v180
    v_accvgpr_write_b32 a76, v160
    v_accvgpr_write_b32 a77, v161
    v_accvgpr_write_b32 a78, v162
    v_accvgpr_write_b32 a79, v163
    v_accvgpr_read_b32 v160, a80
    v_accvgpr_read_b32 v161, a81
    v_accvgpr_read_b32 v162, a82
    v_accvgpr_read_b32 v163, a83
    v_mul_f32 v160, v160, v180
    v_mul_f32 v161, v161, v180
    v_mul_f32 v162, v162, v180
    v_mul_f32 v163, v163, v180
    v_accvgpr_write_b32 a80, v160
    v_accvgpr_write_b32 a81, v161
    v_accvgpr_write_b32 a82, v162
    v_accvgpr_write_b32 a83, v163
    v_accvgpr_read_b32 v160, a84
    v_accvgpr_read_b32 v161, a85
    v_accvgpr_read_b32 v162, a86
    v_accvgpr_read_b32 v163, a87
    v_mul_f32 v160, v160, v180
    v_mul_f32 v161, v161, v180
    v_mul_f32 v162, v162, v180
    v_mul_f32 v163, v163, v180
    v_accvgpr_write_b32 a84, v160
    v_accvgpr_write_b32 a85, v161
    v_accvgpr_write_b32 a86, v162
    v_accvgpr_write_b32 a87, v163
    v_accvgpr_read_b32 v160, a88
    v_accvgpr_read_b32 v161, a89
    v_accvgpr_read_b32 v162, a90
    v_accvgpr_read_b32 v163, a91
    v_mul_f32 v160, v160, v180
    v_mul_f32 v161, v161, v180
    v_mul_f32 v162, v162, v180
    v_mul_f32 v163, v163, v180
    v_accvgpr_write_b32 a88, v160
    v_accvgpr_write_b32 a89, v161
    v_accvgpr_write_b32 a90, v162
    v_accvgpr_write_b32 a91, v163
    v_accvgpr_read_b32 v160, a92
    v_accvgpr_read_b32 v161, a93
    v_accvgpr_read_b32 v162, a94
    v_accvgpr_read_b32 v163, a95
    v_mul_f32 v160, v160, v180
    v_mul_f32 v161, v161, v180
    v_mul_f32 v162, v162, v180
    v_mul_f32 v163, v163, v180
    v_accvgpr_write_b32 a92, v160
    v_accvgpr_write_b32 a93, v161
    v_accvgpr_write_b32 a94, v162
    v_accvgpr_write_b32 a95, v163
    v_accvgpr_read_b32 v160, a96
    v_accvgpr_read_b32 v161, a97
    v_accvgpr_read_b32 v162, a98
    v_accvgpr_read_b32 v163, a99
    v_mul_f32 v160, v160, v180
    v_mul_f32 v161, v161, v180
    v_mul_f32 v162, v162, v180
    v_mul_f32 v163, v163, v180
    v_accvgpr_write_b32 a96, v160
    v_accvgpr_write_b32 a97, v161
    v_accvgpr_write_b32 a98, v162
    v_accvgpr_write_b32 a99, v163
    v_accvgpr_read_b32 v160, a100
    v_accvgpr_read_b32 v161, a101
    v_accvgpr_read_b32 v162, a102
    v_accvgpr_read_b32 v163, a103
    v_mul_f32 v160, v160, v180
    v_mul_f32 v161, v161, v180
    v_mul_f32 v162, v162, v180
    v_mul_f32 v163, v163, v180
    v_accvgpr_write_b32 a100, v160
    v_accvgpr_write_b32 a101, v161
    v_accvgpr_write_b32 a102, v162
    v_accvgpr_write_b32 a103, v163
    v_accvgpr_read_b32 v160, a104
    v_accvgpr_read_b32 v161, a105
    v_accvgpr_read_b32 v162, a106
    v_accvgpr_read_b32 v163, a107
    v_mul_f32 v160, v160, v180
    v_mul_f32 v161, v161, v180
    v_mul_f32 v162, v162, v180
    v_mul_f32 v163, v163, v180
    v_accvgpr_write_b32 a104, v160
    v_accvgpr_write_b32 a105, v161
    v_accvgpr_write_b32 a106, v162
    v_accvgpr_write_b32 a107, v163
    v_accvgpr_read_b32 v160, a108
    v_accvgpr_read_b32 v161, a109
    v_accvgpr_read_b32 v162, a110
    v_accvgpr_read_b32 v163, a111
    v_mul_f32 v160, v160, v180
    v_mul_f32 v161, v161, v180
    v_mul_f32 v162, v162, v180
    v_mul_f32 v163, v163, v180
    v_accvgpr_write_b32 a108, v160
    v_accvgpr_write_b32 a109, v161
    v_accvgpr_write_b32 a110, v162
    v_accvgpr_write_b32 a111, v163
    v_accvgpr_read_b32 v160, a112
    v_accvgpr_read_b32 v161, a113
    v_accvgpr_read_b32 v162, a114
    v_accvgpr_read_b32 v163, a115
    v_mul_f32 v160, v160, v180
    v_mul_f32 v161, v161, v180
    v_mul_f32 v162, v162, v180
    v_mul_f32 v163, v163, v180
    v_accvgpr_write_b32 a112, v160
    v_accvgpr_write_b32 a113, v161
    v_accvgpr_write_b32 a114, v162
    v_accvgpr_write_b32 a115, v163
    v_accvgpr_read_b32 v160, a116
    v_accvgpr_read_b32 v161, a117
    v_accvgpr_read_b32 v162, a118
    v_accvgpr_read_b32 v163, a119
    v_mul_f32 v160, v160, v180
    v_mul_f32 v161, v161, v180
    v_mul_f32 v162, v162, v180
    v_mul_f32 v163, v163, v180
    v_accvgpr_write_b32 a116, v160
    v_accvgpr_write_b32 a117, v161
    v_accvgpr_write_b32 a118, v162
    v_accvgpr_write_b32 a119, v163
    v_accvgpr_read_b32 v160, a120
    v_accvgpr_read_b32 v161, a121
    v_accvgpr_read_b32 v162, a122
    v_accvgpr_read_b32 v163, a123
    v_mul_f32 v160, v160, v180
    v_mul_f32 v161, v161, v180
    v_mul_f32 v162, v162, v180
    v_mul_f32 v163, v163, v180
    v_accvgpr_write_b32 a120, v160
    v_accvgpr_write_b32 a121, v161
    v_accvgpr_write_b32 a122, v162
    v_accvgpr_write_b32 a123, v163
    v_accvgpr_read_b32 v160, a124
    v_accvgpr_read_b32 v161, a125
    v_accvgpr_read_b32 v162, a126
    v_accvgpr_read_b32 v163, a127
    v_mul_f32 v160, v160, v180
    v_mul_f32 v161, v161, v180
    v_mul_f32 v162, v162, v180
    v_mul_f32 v163, v163, v180
    v_accvgpr_write_b32 a124, v160
    v_accvgpr_write_b32 a125, v161
    v_accvgpr_write_b32 a126, v162
    v_accvgpr_write_b32 a127, v163
    v_exp_f32 v160, v80
    v_exp_f32 v161, v81
    v_exp_f32 v162, v82
    v_add_f32 v179, v177, v160
    v_exp_f32 v163, v83
    v_cvt_pk_bf16_f32 v152, v160, v161
    v_add_f32 v179, v179, v161
    v_exp_f32 v164, v84
    v_add_f32 v179, v179, v162
    v_exp_f32 v165, v85
    v_cvt_pk_bf16_f32 v153, v162, v163
    v_add_f32 v179, v179, v163
    v_exp_f32 v166, v86
    v_add_f32 v179, v179, v164
    v_exp_f32 v167, v87
    v_cvt_pk_bf16_f32 v154, v164, v165
    v_add_f32 v179, v179, v165
    v_exp_f32 v168, v88
    v_add_f32 v179, v179, v166
    v_exp_f32 v169, v89
    v_cvt_pk_bf16_f32 v155, v166, v167
    v_add_f32 v179, v179, v167
    v_exp_f32 v170, v90
    v_add_f32 v179, v179, v168
    v_exp_f32 v171, v91
    v_cvt_pk_bf16_f32 v156, v168, v169
    v_add_f32 v179, v179, v169
    v_exp_f32 v172, v92
    v_add_f32 v179, v179, v170
    v_exp_f32 v173, v93
    v_cvt_pk_bf16_f32 v157, v170, v171
    v_add_f32 v179, v179, v171
    v_exp_f32 v174, v94
    v_add_f32 v179, v179, v172
    v_exp_f32 v175, v95
    v_cvt_pk_bf16_f32 v158, v172, v173
    v_add_f32 v179, v179, v173
    v_add_f32 v179, v179, v174
    v_cvt_pk_bf16_f32 v159, v174, v175
    v_add_f32 v179, v179, v175
    s_nop 1
    s_branch fk_ht0_ret
back_code:
    s_load_dwordx8 s[68:75], s[0:1], 40
    s_load_dwordx2 s[78:79], s[0:1], 88
    s_load_dwordx2 s[64:65], s[0:1], 0
    s_load_dwordx2 s[76:77], s[0:1], 72
    v_and_b32 v1, 63, v0
    v_lshrrev_b32 v2, 6, v0
    v_lshlrev_b32 v8, 4, v1
    s_mov_b32 s28, s32
    v_lshrrev_b32 v2, 4, v1
    v_and_b32 v3, 15, v1
    v_lshlrev_b32 v3, 4, v3
    v_lshl_add_u32 v27, v2, 9, v3
    s_lshr_b32 s3, s2, 3
    s_bfe_u32 s29, s2, 0x10001
    s_lshl_b32 s36, s2, 3
    s_and_b32 s36, s36, 8
    s_xor_b32 s36, s36, 8
    s_and_b32 s37, s3, 7
    s_add_u32 s36, s36, s37
    s_and_b32 s31, s2, 4
    s_lshr_b32 s3, s3, 3
    s_add_u32 s31, s31, s3
    s_lshl_b32 s30, s36, 2
    s_add_u32 s30, s30, s28
    v_lshrrev_b32 v2, 4, v1
    v_and_b32 v3, 15, v1
    v_lshlrev_b32 v4, 1, v2
    v_xor_b32 v3, v3, v4
    s_lshl_b32 s3, s28, 4
    s_mul_i32 s36, s29, 2048
    s_add_u32 s3, s3, s36
    v_add_u32 v2, s3, v2
    v_lshlrev_b32 v2, 11, v2
    s_lshl_b32 s3, s31, 8
    v_add_u32 v2, s3, v2
    v_lshl_add_u32 v4, v3, 4, v2
    v_xor_b32 v3, 8, v3
    v_lshl_add_u32 v2, v3, 4, v2
    v_add_u32 v12, 0, v4
    v_add_u32 v13, 7168, v2
    v_add_u32 v14, 14336, v4
    v_add_u32 v15, 21504, v2
    s_mul_i32 s3, s30, 262144
    s_mul_i32 s36, s29, 131072
    s_add_u32 s3, s3, s36
    s_add_u32 s3, s3, 37748736
    v_add_u32 v9, s3, v27
    s_lshl_b32 s34, s28, 12
    s_add_u32 s41, s34, 0x10000
    s_mov_b32 s48, 0
    s_mov_b32 s52, 0
    s_waitcnt lgkmcnt(0)
    s_mov_b32 s8, s68
    s_and_b32 s9, s69, 0xffff
    s_mov_b32 s10, 0x800000
    s_mov_b32 s11, 0x20000
    s_mov_b32 s16, s78
    s_and_b32 s17, s79, 0xffff
    s_mov_b32 s18, 0x5000000
    s_mov_b32 s19, 0x20000
    s_lshl_b32 s3, s2, 7
    s_add_u32 s3, s3, 74186752
    v_mov_b32 v6, s3
    v_mov_b32 v2, 0x5000000
    v_cmp_eq_u32 vcc, 0, v0
    s_nop 1
    v_cndmask_b32 v6, v2, v6, vcc
    v_mov_b32 v32, 0
    v_mov_b32 v33, 0
    v_mov_b32 v34, 0
    v_mov_b32 v35, 0
    v_mov_b32 v36, 0
    v_mov_b32 v37, 0
    v_mov_b32 v38, 0
    v_mov_b32 v39, 0
    v_mov_b32 v40, 0
    v_mov_b32 v41, 0
    v_mov_b32 v42, 0
    v_mov_b32 v43, 0
    v_mov_b32 v44, 0
    v_mov_b32 v45, 0
    v_mov_b32 v46, 0
    v_mov_b32 v47, 0
    v_mov_b32 v48, 0
    v_mov_b32 v49, 0
    v_mov_b32 v50, 0
    v_mov_b32 v51, 0
    v_mov_b32 v52, 0
    v_mov_b32 v53, 0
    v_mov_b32 v54, 0
    v_mov_b32 v55, 0
    v_mov_b32 v56, 0
    v_mov_b32 v57, 0
    v_mov_b32 v58, 0
    v_mov_b32 v59, 0
    v_mov_b32 v60, 0
    v_mov_b32 v61, 0
    v_mov_b32 v62, 0
    v_mov_b32 v63, 0
    v_mov_b32 v64, 0
    v_mov_b32 v65, 0
    v_mov_b32 v66, 0
    v_mov_b32 v67, 0
    v_mov_b32 v68, 0
    v_mov_b32 v69, 0
    v_mov_b32 v70, 0
    v_mov_b32 v71, 0
    v_mov_b32 v72, 0
    v_mov_b32 v73, 0
    v_mov_b32 v74, 0
    v_mov_b32 v75, 0
    v_mov_b32 v76, 0
    v_mov_b32 v77, 0
    v_mov_b32 v78, 0
    v_mov_b32 v79, 0
    v_mov_b32 v80, 0
    v_mov_b32 v81, 0
    v_mov_b32 v82, 0
    v_mov_b32 v83, 0
    v_mov_b32 v84, 0
    v_mov_b32 v85, 0
    v_mov_b32 v86, 0
    v_mov_b32 v87, 0
    v_mov_b32 v88, 0
    v_mov_b32 v89, 0
    v_mov_b32 v90, 0
    v_mov_b32 v91, 0
    v_mov_b32 v92, 0
    v_mov_b32 v93, 0
    v_mov_b32 v94, 0
    v_mov_b32 v95, 0
    v_mov_b32 v5, 2
    s_mov_b32 s3, 98304
    s_waitcnt vmcnt(0)
    s_barrier
    buffer_store_dword v5, v6, s[16:19], s3 offen sc1
    s_add_u32 m0, s34, 0
    s_nop 0
    buffer_load_dwordx4 v12, s[8:11], s48 offen offset:0 lds
    buffer_load_dwordx4 v13, s[8:11], s48 offen offset:1024 lds
    buffer_load_dwordx4 v14, s[8:11], s48 offen offset:2048 lds
    buffer_load_dwordx4 v15, s[8:11], s48 offen offset:3072 lds
    s_add_u32 s48, s48, 131072
    s_add_u32 m0, s34, 16384
    s_nop 0
    buffer_load_dwordx4 v12, s[8:11], s48 offen offset:0 lds
    buffer_load_dwordx4 v13, s[8:11], s48 offen offset:1024 lds
    buffer_load_dwordx4 v14, s[8:11], s48 offen offset:2048 lds
    buffer_load_dwordx4 v15, s[8:11], s48 offen offset:3072 lds
    s_add_u32 s48, s48, 131072
    s_add_u32 m0, s34, 32768
    s_nop 0
    buffer_load_dwordx4 v12, s[8:11], s48 offen offset:0 lds
    buffer_load_dwordx4 v13, s[8:11], s48 offen offset:1024 lds
    s_mov_b32 s20, s64
    s_and_b32 s21, s65, 0xffff
    s_mov_b32 s22, 0x400000
    s_mov_b32 s23, 0x20000
    v_bfe_u32 v2, v1, 2, 3
    v_lshrrev_b32 v3, 5, v1
    v_lshl_add_u32 v3, v3, 4, v2
    v_lshlrev_b32 v3, 8, v3
    v_and_b32 v4, 3, v1
    v_lshl_add_u32 v3, v4, 3, v3
    s_lshl_b32 s3, s29, 2
    v_xor_b32 v2, s3, v2
    v_xor_b32 v4, 0, v2
    v_lshl_add_u32 v208, v4, 5, v3
    v_xor_b32 v4, 1, v2
    v_lshl_add_u32 v209, v4, 5, v3
    v_xor_b32 v4, 2, v2
    v_lshl_add_u32 v210, v4, 5, v3
    v_xor_b32 v4, 3, v2
    v_lshl_add_u32 v211, v4, 5, v3
    v_xor_b32 v4, 4, v2
    v_lshl_add_u32 v212, v4, 5, v3
    v_xor_b32 v4, 5, v2
    v_lshl_add_u32 v213, v4, 5, v3
    v_xor_b32 v4, 6, v2
    v_lshl_add_u32 v214, v4, 5, v3
    v_xor_b32 v4, 7, v2
    v_lshl_add_u32 v215, v4, 5, v3
    v_and_b32 v2, 15, v1
    s_lshl_b32 s3, s30, 5
    v_add_u32 v2, s3, v2
    v_lshlrev_b32 v2, 11, v2
    v_bfe_u32 v3, v1, 4, 1
    v_lshl_add_u32 v2, v3, 5, v2
    v_lshrrev_b32 v3, 5, v1
    v_lshl_add_u32 v2, v3, 4, v2
    s_lshl_b32 s3, s31, 8
    s_lshl_b32 s36, s29, 7
    s_add_u32 s3, s3, s36
    v_add_u32 v10, s3, v2
    s_mov_b32 s33, 0x8000
    s_mul_i32 s3, s30, 65536
    s_lshl_b32 s36, s31, 13
    s_add_u32 s3, s3, s36
    s_lshl_b32 s36, s29, 12
    s_add_u32 s3, s3, s36
    s_add_u32 s3, s3, 54525952
    v_add_u32 v11, s3, v27
    s_lshl_b32 s3, s2, 2
    s_add_u32 s3, s3, s28
    s_lshl_b32 s3, s3, 12
    s_add_u32 s38, s3, 75497472
    s_xor_b32 s3, s3, 0x8000
    s_add_u32 s40, s3, 75497472
    v_mov_b32 v20, 0x3f80
    v_mov_b32 v21, 0x3f800000
    s_lshr_b32 s3, s30, 2
    s_sub_u32 s36, 15, s3
    s_min_u32 s3, s3, s36
    s_lshl_b32 s3, s3, 3
    s_lshl_b32 s36, s29, 2
    s_add_u32 s3, s3, s36
    s_xor_b32 s36, s2, 2
    v_and_b32 v2, 3, v1
    v_lshlrev_b32 v2, 6, v2
    v_bfe_u32 v3, v1, 2, 2
    v_add3_u32 v2, v2, v3, s3
    v_mov_b32 v3, s36
    v_cmp_gt_u32 vcc, 16, v1
    s_nop 1
    v_cndmask_b32 v2, v3, v2, vcc
    v_lshlrev_b32 v2, 7, v2
    v_add_u32 v7, 74285056, v2
    s_lshr_b32 s43, s30, 5
    s_add_u32 s43, s43, 1
    s_cmp_lt_u32 s30, 32
    s_cbranch_scc1 bk_nocs
    s_mov_b32 s44, s72
    s_and_b32 s45, s73, 0xffff
    s_mov_b32 s46, 0x700000
    s_mov_b32 s47, 0x20000
    s_lshr_b32 s3, s2, 1
    s_lshl_b32 s3, s3, 2
    s_add_u32 s3, s3, s28
    s_mul_hi_u32 s42, s3, 76695845
    s_mul_i32 s36, s42, 56
    s_sub_u32 s43, s3, s36
    s_lshl_b32 s36, s42, 7
    v_lshrrev_b32 v2, 3, v1
    v_add_u32 v2, s36, v2
    v_mul_u32_u24 v2, 7168, v2
    v_and_b32 v3, 7, v1
    v_lshl_add_u32 v2, v3, 4, v2
    s_lshl_b32 s36, s43, 7
    v_add_u32 v2, s36, v2
    s_mul_i32 s36, s42, 14336
    s_lshl_b32 s43, s43, 8
    s_add_u32 s36, s36, s43
    s_add_u32 s36, s36, 73400320
    s_cmp_lt_u32 s3, 448
    s_cselect_b32 s36, s36, 0x5000000
    v_lshrrev_b32 v4, 3, v1
    v_lshlrev_b32 v4, 27, v4
    v_lshl_add_u32 v3, v3, 5, v4
    v_add_u32 v22, s36, v3
    s_mov_b32 s3, 0
    buffer_load_dwordx4 v[176:179], v2, s[44:47], s3 offen
    s_mov_b32 s3, 57344
    buffer_load_dwordx4 v[180:183], v2, s[44:47], s3 offen
    s_mov_b32 s3, 114688
    buffer_load_dwordx4 v[184:187], v2, s[44:47], s3 offen
    s_mov_b32 s3, 172032
    buffer_load_dwordx4 v[188:191], v2, s[44:47], s3 offen
    s_mov_b32 s3, 229376
    buffer_load_dwordx4 v[192:195], v2, s[44:47], s3 offen
    s_mov_b32 s3, 286720
    buffer_load_dwordx4 v[196:199], v2, s[44:47], s3 offen
    s_mov_b32 s3, 344064
    buffer_load_dwordx4 v[200:203], v2, s[44:47], s3 offen
    s_mov_b32 s3, 401408
    buffer_load_dwordx4 v[204:207], v2, s[44:47], s3 offen
    s_mov_b32 s3, 458752
    buffer_load_dwordx4 v[216:219], v2, s[44:47], s3 offen
    s_mov_b32 s3, 516096
    buffer_load_dwordx4 v[220:223], v2, s[44:47], s3 offen
    s_mov_b32 s3, 573440
    buffer_load_dwordx4 v[224:227], v2, s[44:47], s3 offen
    s_mov_b32 s3, 630784
    buffer_load_dwordx4 v[228:231], v2, s[44:47], s3 offen
    s_mov_b32 s3, 688128
    buffer_load_dwordx4 v[232:235], v2, s[44:47], s3 offen
    s_mov_b32 s3, 745472
    buffer_load_dwordx4 v[236:239], v2, s[44:47], s3 offen
    s_mov_b32 s3, 802816
    buffer_load_dwordx4 v[240:243], v2, s[44:47], s3 offen
    s_mov_b32 s3, 860160
    buffer_load_dwordx4 v[244:247], v2, s[44:47], s3 offen
    s_waitcnt vmcnt(0)
    v_mov_b32 v248, 0
    v_mov_b32 v249, 0
    v_mov_b32 v250, 0
    v_mov_b32 v251, 0
    v_mov_b32 v252, 0
    v_mov_b32 v253, 0
    v_mov_b32 v254, 0
    v_mov_b32 v255, 0
    v_lshlrev_b32 v2, 16, v176
    v_and_b32 v3, 0xffff0000, v176
    v_add_f32 v248, v248, v2
    v_add_f32 v249, v249, v3
    v_lshlrev_b32 v2, 16, v177
    v_and_b32 v3, 0xffff0000, v177
    v_add_f32 v250, v250, v2
    v_add_f32 v251, v251, v3
    v_lshlrev_b32 v2, 16, v178
    v_and_b32 v3, 0xffff0000, v178
    v_add_f32 v252, v252, v2
    v_add_f32 v253, v253, v3
    v_lshlrev_b32 v2, 16, v179
    v_and_b32 v3, 0xffff0000, v179
    v_add_f32 v254, v254, v2
    v_add_f32 v255, v255, v3
    v_lshlrev_b32 v2, 16, v180
    v_and_b32 v3, 0xffff0000, v180
    v_add_f32 v248, v248, v2
    v_add_f32 v249, v249, v3
    v_lshlrev_b32 v2, 16, v181
    v_and_b32 v3, 0xffff0000, v181
    v_add_f32 v250, v250, v2
    v_add_f32 v251, v251, v3
    v_lshlrev_b32 v2, 16, v182
    v_and_b32 v3, 0xffff0000, v182
    v_add_f32 v252, v252, v2
    v_add_f32 v253, v253, v3
    v_lshlrev_b32 v2, 16, v183
    v_and_b32 v3, 0xffff0000, v183
    v_add_f32 v254, v254, v2
    v_add_f32 v255, v255, v3
    v_lshlrev_b32 v2, 16, v184
    v_and_b32 v3, 0xffff0000, v184
    v_add_f32 v248, v248, v2
    v_add_f32 v249, v249, v3
    v_lshlrev_b32 v2, 16, v185
    v_and_b32 v3, 0xffff0000, v185
    v_add_f32 v250, v250, v2
    v_add_f32 v251, v251, v3
    v_lshlrev_b32 v2, 16, v186
    v_and_b32 v3, 0xffff0000, v186
    v_add_f32 v252, v252, v2
    v_add_f32 v253, v253, v3
    v_lshlrev_b32 v2, 16, v187
    v_and_b32 v3, 0xffff0000, v187
    v_add_f32 v254, v254, v2
    v_add_f32 v255, v255, v3
    v_lshlrev_b32 v2, 16, v188
    v_and_b32 v3, 0xffff0000, v188
    v_add_f32 v248, v248, v2
    v_add_f32 v249, v249, v3
    v_lshlrev_b32 v2, 16, v189
    v_and_b32 v3, 0xffff0000, v189
    v_add_f32 v250, v250, v2
    v_add_f32 v251, v251, v3
    v_lshlrev_b32 v2, 16, v190
    v_and_b32 v3, 0xffff0000, v190
    v_add_f32 v252, v252, v2
    v_add_f32 v253, v253, v3
    v_lshlrev_b32 v2, 16, v191
    v_and_b32 v3, 0xffff0000, v191
    v_add_f32 v254, v254, v2
    v_add_f32 v255, v255, v3
    v_lshlrev_b32 v2, 16, v192
    v_and_b32 v3, 0xffff0000, v192
    v_add_f32 v248, v248, v2
    v_add_f32 v249, v249, v3
    v_lshlrev_b32 v2, 16, v193
    v_and_b32 v3, 0xffff0000, v193
    v_add_f32 v250, v250, v2
    v_add_f32 v251, v251, v3
    v_lshlrev_b32 v2, 16, v194
    v_and_b32 v3, 0xffff0000, v194
    v_add_f32 v252, v252, v2
    v_add_f32 v253, v253, v3
    v_lshlrev_b32 v2, 16, v195
    v_and_b32 v3, 0xffff0000, v195
    v_add_f32 v254, v254, v2
    v_add_f32 v255, v255, v3
    v_lshlrev_b32 v2, 16, v196
    v_and_b32 v3, 0xffff0000, v196
    v_add_f32 v248, v248, v2
    v_add_f32 v249, v249, v3
    v_lshlrev_b32 v2, 16, v197
    v_and_b32 v3, 0xffff0000, v197
    v_add_f32 v250, v250, v2
    v_add_f32 v251, v251, v3
    v_lshlrev_b32 v2, 16, v198
    v_and_b32 v3, 0xffff0000, v198
    v_add_f32 v252, v252, v2
    v_add_f32 v253, v253, v3
    v_lshlrev_b32 v2, 16, v199
    v_and_b32 v3, 0xffff0000, v199
    v_add_f32 v254, v254, v2
    v_add_f32 v255, v255, v3
    v_lshlrev_b32 v2, 16, v200
    v_and_b32 v3, 0xffff0000, v200
    v_add_f32 v248, v248, v2
    v_add_f32 v249, v249, v3
    v_lshlrev_b32 v2, 16, v201
    v_and_b32 v3, 0xffff0000, v201
    v_add_f32 v250, v250, v2
    v_add_f32 v251, v251, v3
    v_lshlrev_b32 v2, 16, v202
    v_and_b32 v3, 0xffff0000, v202
    v_add_f32 v252, v252, v2
    v_add_f32 v253, v253, v3
    v_lshlrev_b32 v2, 16, v203
    v_and_b32 v3, 0xffff0000, v203
    v_add_f32 v254, v254, v2
    v_add_f32 v255, v255, v3
    v_lshlrev_b32 v2, 16, v204
    v_and_b32 v3, 0xffff0000, v204
    v_add_f32 v248, v248, v2
    v_add_f32 v249, v249, v3
    v_lshlrev_b32 v2, 16, v205
    v_and_b32 v3, 0xffff0000, v205
    v_add_f32 v250, v250, v2
    v_add_f32 v251, v251, v3
    v_lshlrev_b32 v2, 16, v206
    v_and_b32 v3, 0xffff0000, v206
    v_add_f32 v252, v252, v2
    v_add_f32 v253, v253, v3
    v_lshlrev_b32 v2, 16, v207
    v_and_b32 v3, 0xffff0000, v207
    v_add_f32 v254, v254, v2
    v_add_f32 v255, v255, v3
    v_lshlrev_b32 v2, 16, v216
    v_and_b32 v3, 0xffff0000, v216
    v_add_f32 v248, v248, v2
    v_add_f32 v249, v249, v3
    v_lshlrev_b32 v2, 16, v217
    v_and_b32 v3, 0xffff0000, v217
    v_add_f32 v250, v250, v2
    v_add_f32 v251, v251, v3
    v_lshlrev_b32 v2, 16, v218
    v_and_b32 v3, 0xffff0000, v218
    v_add_f32 v252, v252, v2
    v_add_f32 v253, v253, v3
    v_lshlrev_b32 v2, 16, v219
    v_and_b32 v3, 0xffff0000, v219
    v_add_f32 v254, v254, v2
    v_add_f32 v255, v255, v3
    v_lshlrev_b32 v2, 16, v220
    v_and_b32 v3, 0xffff0000, v220
    v_add_f32 v248, v248, v2
    v_add_f32 v249, v249, v3
    v_lshlrev_b32 v2, 16, v221
    v_and_b32 v3, 0xffff0000, v221
    v_add_f32 v250, v250, v2
    v_add_f32 v251, v251, v3
    v_lshlrev_b32 v2, 16, v222
    v_and_b32 v3, 0xffff0000, v222
    v_add_f32 v252, v252, v2
    v_add_f32 v253, v253, v3
    v_lshlrev_b32 v2, 16, v223
    v_and_b32 v3, 0xffff0000, v223
    v_add_f32 v254, v254, v2
    v_add_f32 v255, v255, v3
    v_lshlrev_b32 v2, 16, v224
    v_and_b32 v3, 0xffff0000, v224
    v_add_f32 v248, v248, v2
    v_add_f32 v249, v249, v3
    v_lshlrev_b32 v2, 16, v225
    v_and_b32 v3, 0xffff0000, v225
    v_add_f32 v250, v250, v2
    v_add_f32 v251, v251, v3
    v_lshlrev_b32 v2, 16, v226
    v_and_b32 v3, 0xffff0000, v226
    v_add_f32 v252, v252, v2
    v_add_f32 v253, v253, v3
    v_lshlrev_b32 v2, 16, v227
    v_and_b32 v3, 0xffff0000, v227
    v_add_f32 v254, v254, v2
    v_add_f32 v255, v255, v3
    v_lshlrev_b32 v2, 16, v228
    v_and_b32 v3, 0xffff0000, v228
    v_add_f32 v248, v248, v2
    v_add_f32 v249, v249, v3
    v_lshlrev_b32 v2, 16, v229
    v_and_b32 v3, 0xffff0000, v229
    v_add_f32 v250, v250, v2
    v_add_f32 v251, v251, v3
    v_lshlrev_b32 v2, 16, v230
    v_and_b32 v3, 0xffff0000, v230
    v_add_f32 v252, v252, v2
    v_add_f32 v253, v253, v3
    v_lshlrev_b32 v2, 16, v231
    v_and_b32 v3, 0xffff0000, v231
    v_add_f32 v254, v254, v2
    v_add_f32 v255, v255, v3
    v_lshlrev_b32 v2, 16, v232
    v_and_b32 v3, 0xffff0000, v232
    v_add_f32 v248, v248, v2
    v_add_f32 v249, v249, v3
    v_lshlrev_b32 v2, 16, v233
    v_and_b32 v3, 0xffff0000, v233
    v_add_f32 v250, v250, v2
    v_add_f32 v251, v251, v3
    v_lshlrev_b32 v2, 16, v234
    v_and_b32 v3, 0xffff0000, v234
    v_add_f32 v252, v252, v2
    v_add_f32 v253, v253, v3
    v_lshlrev_b32 v2, 16, v235
    v_and_b32 v3, 0xffff0000, v235
    v_add_f32 v254, v254, v2
    v_add_f32 v255, v255, v3
    v_lshlrev_b32 v2, 16, v236
    v_and_b32 v3, 0xffff0000, v236
    v_add_f32 v248, v248, v2
    v_add_f32 v249, v249, v3
    v_lshlrev_b32 v2, 16, v237
    v_and_b32 v3, 0xffff0000, v237
    v_add_f32 v250, v250, v2
    v_add_f32 v251, v251, v3
    v_lshlrev_b32 v2, 16, v238
    v_and_b32 v3, 0xffff0000, v238
    v_add_f32 v252, v252, v2
    v_add_f32 v253, v253, v3
    v_lshlrev_b32 v2, 16, v239
    v_and_b32 v3, 0xffff0000, v239
    v_add_f32 v254, v254, v2
    v_add_f32 v255, v255, v3
    v_lshlrev_b32 v2, 16, v240
    v_and_b32 v3, 0xffff0000, v240
    v_add_f32 v248, v248, v2
    v_add_f32 v249, v249, v3
    v_lshlrev_b32 v2, 16, v241
    v_and_b32 v3, 0xffff0000, v241
    v_add_f32 v250, v250, v2
    v_add_f32 v251, v251, v3
    v_lshlrev_b32 v2, 16, v242
    v_and_b32 v3, 0xffff0000, v242
    v_add_f32 v252, v252, v2
    v_add_f32 v253, v253, v3
    v_lshlrev_b32 v2, 16, v243
    v_and_b32 v3, 0xffff0000, v243
    v_add_f32 v254, v254, v2
    v_add_f32 v255, v255, v3
    v_lshlrev_b32 v2, 16, v244
    v_and_b32 v3, 0xffff0000, v244
    v_add_f32 v248, v248, v2
    v_add_f32 v249, v249, v3
    v_lshlrev_b32 v2, 16, v245
    v_and_b32 v3, 0xffff0000, v245
    v_add_f32 v250, v250, v2
    v_add_f32 v251, v251, v3
    v_lshlrev_b32 v2, 16, v246
    v_and_b32 v3, 0xffff0000, v246
    v_add_f32 v252, v252, v2
    v_add_f32 v253, v253, v3
    v_lshlrev_b32 v2, 16, v247
    v_and_b32 v3, 0xffff0000, v247
    v_add_f32 v254, v254, v2
    v_add_f32 v255, v255, v3
    s_nop 2
    v_add_f32_dpp v248, v248, v248 row_ror:8 row_mask:0xf bank_mask:0xf
    v_add_f32_dpp v249, v249, v249 row_ror:8 row_mask:0xf bank_mask:0xf
    v_add_f32_dpp v250, v250, v250 row_ror:8 row_mask:0xf bank_mask:0xf
    v_add_f32_dpp v251, v251, v251 row_ror:8 row_mask:0xf bank_mask:0xf
    v_add_f32_dpp v252, v252, v252 row_ror:8 row_mask:0xf bank_mask:0xf
    v_add_f32_dpp v253, v253, v253 row_ror:8 row_mask:0xf bank_mask:0xf
    v_add_f32_dpp v254, v254, v254 row_ror:8 row_mask:0xf bank_mask:0xf
    v_add_f32_dpp v255, v255, v255 row_ror:8 row_mask:0xf bank_mask:0xf
    v_mov_b32 v216, v248
    v_mov_b32 v217, v249
    v_mov_b32 v218, v250
    v_mov_b32 v219, v251
    v_mov_b32 v220, v252
    v_mov_b32 v221, v253
    v_mov_b32 v222, v254
    v_mov_b32 v223, v255
    s_nop 1
    v_permlane16_swap_b32 v248, v216
    v_permlane16_swap_b32 v249, v217
    v_permlane16_swap_b32 v250, v218
    v_permlane16_swap_b32 v251, v219
    v_permlane16_swap_b32 v252, v220
    v_permlane16_swap_b32 v253, v221
    v_permlane16_swap_b32 v254, v222
    v_permlane16_swap_b32 v255, v223
    s_nop 0
    v_add_f32 v248, v248, v216
    v_add_f32 v249, v249, v217
    v_add_f32 v250, v250, v218
    v_add_f32 v251, v251, v219
    v_add_f32 v252, v252, v220
    v_add_f32 v253, v253, v221
    v_add_f32 v254, v254, v222
    v_add_f32 v255, v255, v223
    v_mov_b32 v216, v248
    v_mov_b32 v217, v249
    v_mov_b32 v218, v250
    v_mov_b32 v219, v251
    v_mov_b32 v220, v252
    v_mov_b32 v221, v253
    v_mov_b32 v222, v254
    v_mov_b32 v223, v255
    s_nop 1
    v_permlane32_swap_b32 v248, v216
    v_permlane32_swap_b32 v249, v217
    v_permlane32_swap_b32 v250, v218
    v_permlane32_swap_b32 v251, v219
    v_permlane32_swap_b32 v252, v220
    v_permlane32_swap_b32 v253, v221
    v_permlane32_swap_b32 v254, v222
    v_permlane32_swap_b32 v255, v223
    s_nop 0
    v_add_f32 v248, v248, v216
    v_add_f32 v249, v249, v217
    v_add_f32 v250, v250, v218
    v_add_f32 v251, v251, v219
    v_add_f32 v252, v252, v220
    v_add_f32 v253, v253, v221
    v_add_f32 v254, v254, v222
    v_add_f32 v255, v255, v223
    buffer_store_dwordx4 v[248:251], v22, s[16:19], 0 offen sc1
    buffer_store_dwordx4 v[252:255], v22, s[16:19], 0 offen offset:16 sc1
bk_nocs:
    s_lshr_b32 s43, s30, 5
    s_add_u32 s43, s43, 1
    buffer_load_dword v4, v7, s[16:19], 0 offen sc1
    s_mov_b32 s35, 100000
    s_waitcnt vmcnt(0)
    s_branch bk_w3_c
bk_w3:
    s_sleep 4
    buffer_load_dword v4, v7, s[16:19], 0 offen sc1
    s_waitcnt vmcnt(0)
bk_w3_c:
    v_cmp_gt_u32 vcc, s43, v4
    s_sub_u32 s35, s35, 1
    s_cbranch_vccz bk_w3_ok
    s_cmp_lg_u32 s35, 0
    s_cbranch_scc1 bk_w3
bk_w3_ok:
    buffer_load_dwordx4 a[0:3], v9, s[16:19], s52 offen offset:0 sc1
    buffer_load_dwordx4 a[4:7], v9, s[16:19], s52 offen offset:256 sc1
    buffer_load_dwordx4 a[8:11], v9, s[16:19], s52 offen offset:2048 sc1
    buffer_load_dwordx4 a[12:15], v9, s[16:19], s52 offen offset:2304 sc1
    s_add_u32 s52, s52, 4096
    buffer_load_dwordx4 a[16:19], v9, s[16:19], s52 offen offset:0 sc1
    buffer_load_dwordx4 a[20:23], v9, s[16:19], s52 offen offset:256 sc1
    buffer_load_dwordx4 a[24:27], v9, s[16:19], s52 offen offset:2048 sc1
    buffer_load_dwordx4 a[28:31], v9, s[16:19], s52 offen offset:2304 sc1
    s_add_u32 s52, s52, 4096
    buffer_load_dwordx4 v[160:163], v10, s[20:23], 0 offen offset:0
    buffer_load_dwordx4 v[164:167], v10, s[20:23], s33 offen offset:0
    buffer_load_dwordx4 v[168:171], v10, s[20:23], 0 offen offset:64
    buffer_load_dwordx4 v[172:175], v10, s[20:23], s33 offen offset:64
    s_waitcnt vmcnt(4)
    s_waitcnt vmcnt(12)
    s_barrier
    ds_read_b64_tr_b16 v[96:97], v208 offset:0
    ds_read_b64_tr_b16 v[98:99], v208 offset:2048
    ds_read_b64_tr_b16 v[100:101], v209 offset:0
    ds_read_b64_tr_b16 v[102:103], v209 offset:2048
    ds_read_b64_tr_b16 v[104:105], v210 offset:0
    ds_read_b64_tr_b16 v[106:107], v210 offset:2048
    ds_read_b64_tr_b16 v[108:109], v211 offset:0
    ds_read_b64_tr_b16 v[110:111], v211 offset:2048
    ds_read_b64_tr_b16 v[112:113], v212 offset:0
    ds_read_b64_tr_b16 v[114:115], v212 offset:2048
    ds_read_b64_tr_b16 v[116:117], v213 offset:0
    ds_read_b64_tr_b16 v[118:119], v213 offset:2048
    ds_read_b64_tr_b16 v[120:121], v214 offset:0
    ds_read_b64_tr_b16 v[122:123], v214 offset:2048
    ds_read_b64_tr_b16 v[124:125], v215 offset:0
    ds_read_b64_tr_b16 v[126:127], v215 offset:2048
    s_waitcnt lgkmcnt(8)
    v_mov_b32 v5, 1
    buffer_store_dword v5, v6, s[16:19], 0 offen sc1
    s_mov_b32 s35, 7
.p2align 6
    s_nop 0
    s_nop 0
bk3_loop:
    v_mfma_f32_16x16x32_bf16 v[32:35], v[96:99], a[0:3], v[32:35]
    ds_read_b64_tr_b16 v[128:129], v208 offset:8192
    ds_read_b64_tr_b16 v[130:131], v208 offset:10240
    v_mfma_f32_16x16x32_bf16 v[36:39], v[96:99], a[4:7], v[36:39]
    ds_read_b64_tr_b16 v[132:133], v209 offset:8192
    ds_read_b64_tr_b16 v[134:135], v209 offset:10240
    v_mfma_f32_16x16x32_bf16 v[40:43], v[100:103], a[0:3], v[40:43]
    buffer_load_dwordx4 a[32:35], v9, s[16:19], s52 offen offset:0 sc1
    v_mfma_f32_16x16x32_bf16 v[44:47], v[100:103], a[4:7], v[44:47]
    ds_read_b64_tr_b16 v[136:137], v210 offset:8192
    v_mfma_f32_16x16x32_bf16 v[48:51], v[104:107], a[0:3], v[48:51]
    ds_read_b64_tr_b16 v[138:139], v210 offset:10240
    ds_read_b64_tr_b16 v[140:141], v211 offset:8192
    v_mfma_f32_16x16x32_bf16 v[52:55], v[104:107], a[4:7], v[52:55]
    buffer_load_dwordx4 a[36:39], v9, s[16:19], s52 offen offset:256 sc1
    v_mfma_f32_16x16x32_bf16 v[56:59], v[108:111], a[0:3], v[56:59]
    ds_read_b64_tr_b16 v[142:143], v211 offset:10240
    ds_read_b64_tr_b16 v[144:145], v212 offset:8192
    v_mfma_f32_16x16x32_bf16 v[60:63], v[108:111], a[4:7], v[60:63]
    s_waitcnt lgkmcnt(9)
    ds_read_b64_tr_b16 v[146:147], v212 offset:10240
    ds_read_b64_tr_b16 v[148:149], v213 offset:8192
    v_mfma_f32_16x16x32_bf16 v[64:67], v[112:115], a[0:3], v[64:67]
    buffer_load_dwordx4 v14, s[8:11], s48 offen offset:2048 lds
    v_mfma_f32_16x16x32_bf16 v[68:71], v[112:115], a[4:7], v[68:71]
    ds_read_b64_tr_b16 v[150:151], v213 offset:10240
    v_mfma_f32_16x16x32_bf16 v[72:75], v[116:119], a[0:3], v[72:75]
    ds_read_b64_tr_b16 v[152:153], v214 offset:8192
    ds_read_b64_tr_b16 v[154:155], v214 offset:10240
    v_mfma_f32_16x16x32_bf16 v[76:79], v[116:119], a[4:7], v[76:79]
    buffer_load_dwordx4 v15, s[8:11], s48 offen offset:3072 lds
    v_mfma_f32_16x16x32_bf16 v[80:83], v[120:123], a[0:3], v[80:83]
    s_add_u32 s48, s48, 131072
    ds_read_b64_tr_b16 v[156:157], v215 offset:8192
    v_mfma_f32_16x16x32_bf16 v[84:87], v[120:123], a[4:7], v[84:87]
    ds_read_b64_tr_b16 v[158:159], v215 offset:10240
    v_mfma_f32_16x16x32_bf16 v[88:91], v[124:127], a[0:3], v[88:91]
    v_mfma_f32_16x16x32_bf16 v[92:95], v[124:127], a[4:7], v[92:95]
    s_waitcnt vmcnt(14) lgkmcnt(8)
    s_waitcnt vmcnt(8)
    s_barrier
    v_mfma_f32_16x16x32_bf16 v[32:35], v[128:131], a[8:11], v[32:35]
    ds_read_b64_tr_b16 v[96:97], v208 offset:16384
    ds_read_b64_tr_b16 v[98:99], v208 offset:18432
    v_mfma_f32_16x16x32_bf16 v[36:39], v[128:131], a[12:15], v[36:39]
    ds_read_b64_tr_b16 v[100:101], v209 offset:16384
    ds_read_b64_tr_b16 v[102:103], v209 offset:18432
    v_mfma_f32_16x16x32_bf16 v[40:43], v[132:135], a[8:11], v[40:43]
    buffer_load_dwordx4 a[40:43], v9, s[16:19], s52 offen offset:2048 sc1
    v_mfma_f32_16x16x32_bf16 v[44:47], v[132:135], a[12:15], v[44:47]
    ds_read_b64_tr_b16 v[104:105], v210 offset:16384
    v_mfma_f32_16x16x32_bf16 v[48:51], v[136:139], a[8:11], v[48:51]
    ds_read_b64_tr_b16 v[106:107], v210 offset:18432
    ds_read_b64_tr_b16 v[108:109], v211 offset:16384
    v_mfma_f32_16x16x32_bf16 v[52:55], v[136:139], a[12:15], v[52:55]
    buffer_load_dwordx4 a[44:47], v9, s[16:19], s52 offen offset:2304 sc1
    v_mfma_f32_16x16x32_bf16 v[56:59], v[140:143], a[8:11], v[56:59]
    s_add_u32 s52, s52, 4096
    ds_read_b64_tr_b16 v[110:111], v211 offset:18432
    ds_read_b64_tr_b16 v[112:113], v212 offset:16384
    v_mfma_f32_16x16x32_bf16 v[60:63], v[140:143], a[12:15], v[60:63]
    s_add_u32 m0, s34, 49152
    s_waitcnt lgkmcnt(9)
    ds_read_b64_tr_b16 v[114:115], v212 offset:18432
    ds_read_b64_tr_b16 v[116:117], v213 offset:16384
    v_mfma_f32_16x16x32_bf16 v[64:67], v[144:147], a[8:11], v[64:67]
    buffer_load_dwordx4 v12, s[8:11], s48 offen offset:0 lds
    v_mfma_f32_16x16x32_bf16 v[68:71], v[144:147], a[12:15], v[68:71]
    ds_read_b64_tr_b16 v[118:119], v213 offset:18432
    v_mfma_f32_16x16x32_bf16 v[72:75], v[148:151], a[8:11], v[72:75]
    ds_read_b64_tr_b16 v[120:121], v214 offset:16384
    ds_read_b64_tr_b16 v[122:123], v214 offset:18432
    v_mfma_f32_16x16x32_bf16 v[76:79], v[148:151], a[12:15], v[76:79]
    buffer_load_dwordx4 v13, s[8:11], s48 offen offset:1024 lds
    v_mfma_f32_16x16x32_bf16 v[80:83], v[152:155], a[8:11], v[80:83]
    ds_read_b64_tr_b16 v[124:125], v215 offset:16384
    v_mfma_f32_16x16x32_bf16 v[84:87], v[152:155], a[12:15], v[84:87]
    ds_read_b64_tr_b16 v[126:127], v215 offset:18432
    v_mfma_f32_16x16x32_bf16 v[88:91], v[156:159], a[8:11], v[88:91]
    v_mfma_f32_16x16x32_bf16 v[92:95], v[156:159], a[12:15], v[92:95]
    s_waitcnt lgkmcnt(8)
    v_mfma_f32_16x16x32_bf16 v[32:35], v[96:99], a[16:19], v[32:35]
    ds_read_b64_tr_b16 v[128:129], v208 offset:24576
    ds_read_b64_tr_b16 v[130:131], v208 offset:26624
    v_mfma_f32_16x16x32_bf16 v[36:39], v[96:99], a[20:23], v[36:39]
    ds_read_b64_tr_b16 v[132:133], v209 offset:24576
    ds_read_b64_tr_b16 v[134:135], v209 offset:26624
    v_mfma_f32_16x16x32_bf16 v[40:43], v[100:103], a[16:19], v[40:43]
    buffer_load_dwordx4 a[48:51], v9, s[16:19], s52 offen offset:0 sc1
    v_mfma_f32_16x16x32_bf16 v[44:47], v[100:103], a[20:23], v[44:47]
    ds_read_b64_tr_b16 v[136:137], v210 offset:24576
    v_mfma_f32_16x16x32_bf16 v[48:51], v[104:107], a[16:19], v[48:51]
    ds_read_b64_tr_b16 v[138:139], v210 offset:26624
    ds_read_b64_tr_b16 v[140:141], v211 offset:24576
    v_mfma_f32_16x16x32_bf16 v[52:55], v[104:107], a[20:23], v[52:55]
    buffer_load_dwordx4 a[52:55], v9, s[16:19], s52 offen offset:256 sc1
    v_mfma_f32_16x16x32_bf16 v[56:59], v[108:111], a[16:19], v[56:59]
    ds_read_b64_tr_b16 v[142:143], v211 offset:26624
    ds_read_b64_tr_b16 v[144:145], v212 offset:24576
    v_mfma_f32_16x16x32_bf16 v[60:63], v[108:111], a[20:23], v[60:63]
    s_waitcnt lgkmcnt(9)
    ds_read_b64_tr_b16 v[146:147], v212 offset:26624
    ds_read_b64_tr_b16 v[148:149], v213 offset:24576
    v_mfma_f32_16x16x32_bf16 v[64:67], v[112:115], a[16:19], v[64:67]
    buffer_load_dwordx4 v14, s[8:11], s48 offen offset:2048 lds
    v_mfma_f32_16x16x32_bf16 v[68:71], v[112:115], a[20:23], v[68:71]
    ds_read_b64_tr_b16 v[150:151], v213 offset:26624
    v_mfma_f32_16x16x32_bf16 v[72:75], v[116:119], a[16:19], v[72:75]
    ds_read_b64_tr_b16 v[152:153], v214 offset:24576
    ds_read_b64_tr_b16 v[154:155], v214 offset:26624
    v_mfma_f32_16x16x32_bf16 v[76:79], v[116:119], a[20:23], v[76:79]
    buffer_load_dwordx4 v15, s[8:11], s48 offen offset:3072 lds
    v_mfma_f32_16x16x32_bf16 v[80:83], v[120:123], a[16:19], v[80:83]
    s_add_u32 s48, s48, 131072
    ds_read_b64_tr_b16 v[156:157], v215 offset:24576
    v_mfma_f32_16x16x32_bf16 v[84:87], v[120:123], a[20:23], v[84:87]
    ds_read_b64_tr_b16 v[158:159], v215 offset:26624
    v_mfma_f32_16x16x32_bf16 v[88:91], v[124:127], a[16:19], v[88:91]
    v_mfma_f32_16x16x32_bf16 v[92:95], v[124:127], a[20:23], v[92:95]
    s_waitcnt vmcnt(14) lgkmcnt(8)
    s_waitcnt vmcnt(8)
    s_barrier
    v_mfma_f32_16x16x32_bf16 v[32:35], v[128:131], a[24:27], v[32:35]
    ds_read_b64_tr_b16 v[96:97], v208 offset:32768
    ds_read_b64_tr_b16 v[98:99], v208 offset:34816
    v_mfma_f32_16x16x32_bf16 v[36:39], v[128:131], a[28:31], v[36:39]
    ds_read_b64_tr_b16 v[100:101], v209 offset:32768
    ds_read_b64_tr_b16 v[102:103], v209 offset:34816
    v_mfma_f32_16x16x32_bf16 v[40:43], v[132:135], a[24:27], v[40:43]
    buffer_load_dwordx4 a[56:59], v9, s[16:19], s52 offen offset:2048 sc1
    v_mfma_f32_16x16x32_bf16 v[44:47], v[132:135], a[28:31], v[44:47]
    ds_read_b64_tr_b16 v[104:105], v210 offset:32768
    v_mfma_f32_16x16x32_bf16 v[48:51], v[136:139], a[24:27], v[48:51]
    ds_read_b64_tr_b16 v[106:107], v210 offset:34816
    ds_read_b64_tr_b16 v[108:109], v211 offset:32768
    v_mfma_f32_16x16x32_bf16 v[52:55], v[136:139], a[28:31], v[52:55]
    buffer_load_dwordx4 a[60:63], v9, s[16:19], s52 offen offset:2304 sc1
    v_mfma_f32_16x16x32_bf16 v[56:59], v[140:143], a[24:27], v[56:59]
    s_add_u32 s52, s52, 4096
    ds_read_b64_tr_b16 v[110:111], v211 offset:34816
    ds_read_b64_tr_b16 v[112:113], v212 offset:32768
    v_mfma_f32_16x16x32_bf16 v[60:63], v[140:143], a[28:31], v[60:63]
    s_add_u32 m0, s34, 0
    s_waitcnt lgkmcnt(9)
    ds_read_b64_tr_b16 v[114:115], v212 offset:34816
    ds_read_b64_tr_b16 v[116:117], v213 offset:32768
    v_mfma_f32_16x16x32_bf16 v[64:67], v[144:147], a[24:27], v[64:67]
    buffer_load_dwordx4 v12, s[8:11], s48 offen offset:0 lds
    v_mfma_f32_16x16x32_bf16 v[68:71], v[144:147], a[28:31], v[68:71]
    ds_read_b64_tr_b16 v[118:119], v213 offset:34816
    v_mfma_f32_16x16x32_bf16 v[72:75], v[148:151], a[24:27], v[72:75]
    ds_read_b64_tr_b16 v[120:121], v214 offset:32768
    ds_read_b64_tr_b16 v[122:123], v214 offset:34816
    v_mfma_f32_16x16x32_bf16 v[76:79], v[148:151], a[28:31], v[76:79]
    buffer_load_dwordx4 v13, s[8:11], s48 offen offset:1024 lds
    v_mfma_f32_16x16x32_bf16 v[80:83], v[152:155], a[24:27], v[80:83]
    ds_read_b64_tr_b16 v[124:125], v215 offset:32768
    v_mfma_f32_16x16x32_bf16 v[84:87], v[152:155], a[28:31], v[84:87]
    ds_read_b64_tr_b16 v[126:127], v215 offset:34816
    v_mfma_f32_16x16x32_bf16 v[88:91], v[156:159], a[24:27], v[88:91]
    v_mfma_f32_16x16x32_bf16 v[92:95], v[156:159], a[28:31], v[92:95]
    s_waitcnt lgkmcnt(8)
    v_mfma_f32_16x16x32_bf16 v[32:35], v[96:99], a[32:35], v[32:35]
    ds_read_b64_tr_b16 v[128:129], v208 offset:40960
    ds_read_b64_tr_b16 v[130:131], v208 offset:43008
    v_mfma_f32_16x16x32_bf16 v[36:39], v[96:99], a[36:39], v[36:39]
    ds_read_b64_tr_b16 v[132:133], v209 offset:40960
    ds_read_b64_tr_b16 v[134:135], v209 offset:43008
    v_mfma_f32_16x16x32_bf16 v[40:43], v[100:103], a[32:35], v[40:43]
    buffer_load_dwordx4 a[0:3], v9, s[16:19], s52 offen offset:0 sc1
    v_mfma_f32_16x16x32_bf16 v[44:47], v[100:103], a[36:39], v[44:47]
    ds_read_b64_tr_b16 v[136:137], v210 offset:40960
    v_mfma_f32_16x16x32_bf16 v[48:51], v[104:107], a[32:35], v[48:51]
    ds_read_b64_tr_b16 v[138:139], v210 offset:43008
    ds_read_b64_tr_b16 v[140:141], v211 offset:40960
    v_mfma_f32_16x16x32_bf16 v[52:55], v[104:107], a[36:39], v[52:55]
    buffer_load_dwordx4 a[4:7], v9, s[16:19], s52 offen offset:256 sc1
    v_mfma_f32_16x16x32_bf16 v[56:59], v[108:111], a[32:35], v[56:59]
    ds_read_b64_tr_b16 v[142:143], v211 offset:43008
    ds_read_b64_tr_b16 v[144:145], v212 offset:40960
    v_mfma_f32_16x16x32_bf16 v[60:63], v[108:111], a[36:39], v[60:63]
    s_waitcnt lgkmcnt(9)
    ds_read_b64_tr_b16 v[146:147], v212 offset:43008
    ds_read_b64_tr_b16 v[148:149], v213 offset:40960
    v_mfma_f32_16x16x32_bf16 v[64:67], v[112:115], a[32:35], v[64:67]
    buffer_load_dwordx4 v14, s[8:11], s48 offen offset:2048 lds
    v_mfma_f32_16x16x32_bf16 v[68:71], v[112:115], a[36:39], v[68:71]
    ds_read_b64_tr_b16 v[150:151], v213 offset:43008
    v_mfma_f32_16x16x32_bf16 v[72:75], v[116:119], a[32:35], v[72:75]
    ds_read_b64_tr_b16 v[152:153], v214 offset:40960
    ds_read_b64_tr_b16 v[154:155], v214 offset:43008
    v_mfma_f32_16x16x32_bf16 v[76:79], v[116:119], a[36:39], v[76:79]
    buffer_load_dwordx4 v15, s[8:11], s48 offen offset:3072 lds
    v_mfma_f32_16x16x32_bf16 v[80:83], v[120:123], a[32:35], v[80:83]
    s_add_u32 s48, s48, 131072
    ds_read_b64_tr_b16 v[156:157], v215 offset:40960
    v_mfma_f32_16x16x32_bf16 v[84:87], v[120:123], a[36:39], v[84:87]
    ds_read_b64_tr_b16 v[158:159], v215 offset:43008
    v_mfma_f32_16x16x32_bf16 v[88:91], v[124:127], a[32:35], v[88:91]
    v_mfma_f32_16x16x32_bf16 v[92:95], v[124:127], a[36:39], v[92:95]
    s_waitcnt vmcnt(14) lgkmcnt(8)
    s_waitcnt vmcnt(8)
    s_barrier
    v_mfma_f32_16x16x32_bf16 v[32:35], v[128:131], a[40:43], v[32:35]
    ds_read_b64_tr_b16 v[96:97], v208 offset:49152
    ds_read_b64_tr_b16 v[98:99], v208 offset:51200
    v_mfma_f32_16x16x32_bf16 v[36:39], v[128:131], a[44:47], v[36:39]
    ds_read_b64_tr_b16 v[100:101], v209 offset:49152
    ds_read_b64_tr_b16 v[102:103], v209 offset:51200
    v_mfma_f32_16x16x32_bf16 v[40:43], v[132:135], a[40:43], v[40:43]
    buffer_load_dwordx4 a[8:11], v9, s[16:19], s52 offen offset:2048 sc1
    v_mfma_f32_16x16x32_bf16 v[44:47], v[132:135], a[44:47], v[44:47]
    ds_read_b64_tr_b16 v[104:105], v210 offset:49152
    v_mfma_f32_16x16x32_bf16 v[48:51], v[136:139], a[40:43], v[48:51]
    ds_read_b64_tr_b16 v[106:107], v210 offset:51200
    ds_read_b64_tr_b16 v[108:109], v211 offset:49152
    v_mfma_f32_16x16x32_bf16 v[52:55], v[136:139], a[44:47], v[52:55]
    buffer_load_dwordx4 a[12:15], v9, s[16:19], s52 offen offset:2304 sc1
    v_mfma_f32_16x16x32_bf16 v[56:59], v[140:143], a[40:43], v[56:59]
    s_add_u32 s52, s52, 4096
    ds_read_b64_tr_b16 v[110:111], v211 offset:51200
    ds_read_b64_tr_b16 v[112:113], v212 offset:49152
    v_mfma_f32_16x16x32_bf16 v[60:63], v[140:143], a[44:47], v[60:63]
    s_add_u32 m0, s34, 16384
    s_waitcnt lgkmcnt(9)
    ds_read_b64_tr_b16 v[114:115], v212 offset:51200
    ds_read_b64_tr_b16 v[116:117], v213 offset:49152
    v_mfma_f32_16x16x32_bf16 v[64:67], v[144:147], a[40:43], v[64:67]
    buffer_load_dwordx4 v12, s[8:11], s48 offen offset:0 lds
    v_mfma_f32_16x16x32_bf16 v[68:71], v[144:147], a[44:47], v[68:71]
    ds_read_b64_tr_b16 v[118:119], v213 offset:51200
    v_mfma_f32_16x16x32_bf16 v[72:75], v[148:151], a[40:43], v[72:75]
    ds_read_b64_tr_b16 v[120:121], v214 offset:49152
    ds_read_b64_tr_b16 v[122:123], v214 offset:51200
    v_mfma_f32_16x16x32_bf16 v[76:79], v[148:151], a[44:47], v[76:79]
    buffer_load_dwordx4 v13, s[8:11], s48 offen offset:1024 lds
    v_mfma_f32_16x16x32_bf16 v[80:83], v[152:155], a[40:43], v[80:83]
    ds_read_b64_tr_b16 v[124:125], v215 offset:49152
    v_mfma_f32_16x16x32_bf16 v[84:87], v[152:155], a[44:47], v[84:87]
    ds_read_b64_tr_b16 v[126:127], v215 offset:51200
    v_mfma_f32_16x16x32_bf16 v[88:91], v[156:159], a[40:43], v[88:91]
    v_mfma_f32_16x16x32_bf16 v[92:95], v[156:159], a[44:47], v[92:95]
    s_waitcnt lgkmcnt(8)
    v_mfma_f32_16x16x32_bf16 v[32:35], v[96:99], a[48:51], v[32:35]
    ds_read_b64_tr_b16 v[128:129], v208 offset:57344
    ds_read_b64_tr_b16 v[130:131], v208 offset:59392
    v_mfma_f32_16x16x32_bf16 v[36:39], v[96:99], a[52:55], v[36:39]
    ds_read_b64_tr_b16 v[132:133], v209 offset:57344
    ds_read_b64_tr_b16 v[134:135], v209 offset:59392
    v_mfma_f32_16x16x32_bf16 v[40:43], v[100:103], a[48:51], v[40:43]
    buffer_load_dwordx4 a[16:19], v9, s[16:19], s52 offen offset:0 sc1
    v_mfma_f32_16x16x32_bf16 v[44:47], v[100:103], a[52:55], v[44:47]
    ds_read_b64_tr_b16 v[136:137], v210 offset:57344
    v_mfma_f32_16x16x32_bf16 v[48:51], v[104:107], a[48:51], v[48:51]
    ds_read_b64_tr_b16 v[138:139], v210 offset:59392
    ds_read_b64_tr_b16 v[140:141], v211 offset:57344
    v_mfma_f32_16x16x32_bf16 v[52:55], v[104:107], a[52:55], v[52:55]
    buffer_load_dwordx4 a[20:23], v9, s[16:19], s52 offen offset:256 sc1
    v_mfma_f32_16x16x32_bf16 v[56:59], v[108:111], a[48:51], v[56:59]
    ds_read_b64_tr_b16 v[142:143], v211 offset:59392
    ds_read_b64_tr_b16 v[144:145], v212 offset:57344
    v_mfma_f32_16x16x32_bf16 v[60:63], v[108:111], a[52:55], v[60:63]
    s_waitcnt lgkmcnt(9)
    ds_read_b64_tr_b16 v[146:147], v212 offset:59392
    ds_read_b64_tr_b16 v[148:149], v213 offset:57344
    v_mfma_f32_16x16x32_bf16 v[64:67], v[112:115], a[48:51], v[64:67]
    buffer_load_dwordx4 v14, s[8:11], s48 offen offset:2048 lds
    v_mfma_f32_16x16x32_bf16 v[68:71], v[112:115], a[52:55], v[68:71]
    ds_read_b64_tr_b16 v[150:151], v213 offset:59392
    v_mfma_f32_16x16x32_bf16 v[72:75], v[116:119], a[48:51], v[72:75]
    ds_read_b64_tr_b16 v[152:153], v214 offset:57344
    ds_read_b64_tr_b16 v[154:155], v214 offset:59392
    v_mfma_f32_16x16x32_bf16 v[76:79], v[116:119], a[52:55], v[76:79]
    buffer_load_dwordx4 v15, s[8:11], s48 offen offset:3072 lds
    v_mfma_f32_16x16x32_bf16 v[80:83], v[120:123], a[48:51], v[80:83]
    s_add_u32 s48, s48, 131072
    ds_read_b64_tr_b16 v[156:157], v215 offset:57344
    v_mfma_f32_16x16x32_bf16 v[84:87], v[120:123], a[52:55], v[84:87]
    ds_read_b64_tr_b16 v[158:159], v215 offset:59392
    v_mfma_f32_16x16x32_bf16 v[88:91], v[124:127], a[48:51], v[88:91]
    v_mfma_f32_16x16x32_bf16 v[92:95], v[124:127], a[52:55], v[92:95]
    s_waitcnt vmcnt(14) lgkmcnt(8)
    s_waitcnt vmcnt(8)
    s_barrier
    v_mfma_f32_16x16x32_bf16 v[32:35], v[128:131], a[56:59], v[32:35]
    ds_read_b64_tr_b16 v[96:97], v208 offset:0
    ds_read_b64_tr_b16 v[98:99], v208 offset:2048
    v_mfma_f32_16x16x32_bf16 v[36:39], v[128:131], a[60:63], v[36:39]
    ds_read_b64_tr_b16 v[100:101], v209 offset:0
    ds_read_b64_tr_b16 v[102:103], v209 offset:2048
    v_mfma_f32_16x16x32_bf16 v[40:43], v[132:135], a[56:59], v[40:43]
    buffer_load_dwordx4 a[24:27], v9, s[16:19], s52 offen offset:2048 sc1
    v_mfma_f32_16x16x32_bf16 v[44:47], v[132:135], a[60:63], v[44:47]
    ds_read_b64_tr_b16 v[104:105], v210 offset:0
    v_mfma_f32_16x16x32_bf16 v[48:51], v[136:139], a[56:59], v[48:51]
    ds_read_b64_tr_b16 v[106:107], v210 offset:2048
    ds_read_b64_tr_b16 v[108:109], v211 offset:0
    v_mfma_f32_16x16x32_bf16 v[52:55], v[136:139], a[60:63], v[52:55]
    buffer_load_dwordx4 a[28:31], v9, s[16:19], s52 offen offset:2304 sc1
    v_mfma_f32_16x16x32_bf16 v[56:59], v[140:143], a[56:59], v[56:59]
    s_add_u32 s52, s52, 4096
    ds_read_b64_tr_b16 v[110:111], v211 offset:2048
    ds_read_b64_tr_b16 v[112:113], v212 offset:0
    v_mfma_f32_16x16x32_bf16 v[60:63], v[140:143], a[60:63], v[60:63]
    s_add_u32 m0, s34, 32768
    s_waitcnt lgkmcnt(9)
    ds_read_b64_tr_b16 v[114:115], v212 offset:2048
    ds_read_b64_tr_b16 v[116:117], v213 offset:0
    v_mfma_f32_16x16x32_bf16 v[64:67], v[144:147], a[56:59], v[64:67]
    buffer_load_dwordx4 v12, s[8:11], s48 offen offset:0 lds
    v_mfma_f32_16x16x32_bf16 v[68:71], v[144:147], a[60:63], v[68:71]
    ds_read_b64_tr_b16 v[118:119], v213 offset:2048
    v_mfma_f32_16x16x32_bf16 v[72:75], v[148:151], a[56:59], v[72:75]
    ds_read_b64_tr_b16 v[120:121], v214 offset:0
    ds_read_b64_tr_b16 v[122:123], v214 offset:2048
    v_mfma_f32_16x16x32_bf16 v[76:79], v[148:151], a[60:63], v[76:79]
    buffer_load_dwordx4 v13, s[8:11], s48 offen offset:1024 lds
    v_mfma_f32_16x16x32_bf16 v[80:83], v[152:155], a[56:59], v[80:83]
    ds_read_b64_tr_b16 v[124:125], v215 offset:0
    v_mfma_f32_16x16x32_bf16 v[84:87], v[152:155], a[60:63], v[84:87]
    ds_read_b64_tr_b16 v[126:127], v215 offset:2048
    v_mfma_f32_16x16x32_bf16 v[88:91], v[156:159], a[56:59], v[88:91]
    v_mfma_f32_16x16x32_bf16 v[92:95], v[156:159], a[60:63], v[92:95]
    s_waitcnt lgkmcnt(8)
    s_sub_u32 s35, s35, 1
    s_cmp_lg_u32 s35, 0
    s_cbranch_scc1 bk3_loop
    v_mfma_f32_16x16x32_bf16 v[32:35], v[96:99], a[0:3], v[32:35]
    ds_read_b64_tr_b16 v[128:129], v208 offset:8192
    ds_read_b64_tr_b16 v[130:131], v208 offset:10240
    s_getpc_b64 s[56:57]
    v_mfma_f32_16x16x32_bf16 v[36:39], v[96:99], a[4:7], v[36:39]
    ds_read_b64_tr_b16 v[132:133], v209 offset:8192
    ds_read_b64_tr_b16 v[134:135], v209 offset:10240
ct_4:
    v_mfma_f32_16x16x32_bf16 v[40:43], v[100:103], a[0:3], v[40:43]
    buffer_load_dwordx4 a[32:35], v9, s[16:19], s52 offen offset:0 sc1
    v_mfma_f32_16x16x32_bf16 v[44:47], v[100:103], a[4:7], v[44:47]
    ds_read_b64_tr_b16 v[136:137], v210 offset:8192
    s_add_u32 s56, s56, back_p4-ct_4
    v_mfma_f32_16x16x32_bf16 v[48:51], v[104:107], a[0:3], v[48:51]
    ds_read_b64_tr_b16 v[138:139], v210 offset:10240
    ds_read_b64_tr_b16 v[140:141], v211 offset:8192
    s_addc_u32 s57, s57, 0
    v_mfma_f32_16x16x32_bf16 v[52:55], v[104:107], a[4:7], v[52:55]
    buffer_load_dwordx4 a[36:39], v9, s[16:19], s52 offen offset:256 sc1
    v_mfma_f32_16x16x32_bf16 v[56:59], v[108:111], a[0:3], v[56:59]
    ds_read_b64_tr_b16 v[142:143], v211 offset:10240
    ds_read_b64_tr_b16 v[144:145], v212 offset:8192
    v_mfma_f32_16x16x32_bf16 v[60:63], v[108:111], a[4:7], v[60:63]
    s_waitcnt lgkmcnt(9)
    ds_read_b64_tr_b16 v[146:147], v212 offset:10240
    ds_read_b64_tr_b16 v[148:149], v213 offset:8192
    v_mfma_f32_16x16x32_bf16 v[64:67], v[112:115], a[0:3], v[64:67]
    buffer_load_dwordx4 v14, s[8:11], s48 offen offset:2048 lds
    v_mfma_f32_16x16x32_bf16 v[68:71], v[112:115], a[4:7], v[68:71]
    ds_read_b64_tr_b16 v[150:151], v213 offset:10240
    s_lshr_b32 s58, s2, 3
    v_mfma_f32_16x16x32_bf16 v[72:75], v[116:119], a[0:3], v[72:75]
    ds_read_b64_tr_b16 v[152:153], v214 offset:8192
    ds_read_b64_tr_b16 v[154:155], v214 offset:10240
    s_lshl_b32 s58, s58, 10
    v_mfma_f32_16x16x32_bf16 v[76:79], v[116:119], a[4:7], v[76:79]
    buffer_load_dwordx4 v15, s[8:11], s48 offen offset:3072 lds
    v_mfma_f32_16x16x32_bf16 v[80:83], v[120:123], a[0:3], v[80:83]
    s_add_u32 s48, s48, 131072
    ds_read_b64_tr_b16 v[156:157], v215 offset:8192
    v_and_b32 v2, 7, v0
    v_mfma_f32_16x16x32_bf16 v[84:87], v[120:123], a[4:7], v[84:87]
    ds_read_b64_tr_b16 v[158:159], v215 offset:10240
    v_lshl_add_u32 v2, v2, 7, s58
    v_min_u32 v2, back_p5-back_p4-4, v2
    v_mfma_f32_16x16x32_bf16 v[88:91], v[124:127], a[0:3], v[88:91]
    global_load_dword v2, v2, s[56:57]
    v_mfma_f32_16x16x32_bf16 v[92:95], v[124:127], a[4:7], v[92:95]
    s_waitcnt vmcnt(15) lgkmcnt(8)
    s_waitcnt vmcnt(9)
    s_barrier
    v_mfma_f32_16x16x32_bf16 v[32:35], v[128:131], a[8:11], v[32:35]
    ds_read_b64_tr_b16 v[96:97], v208 offset:16384
    ds_read_b64_tr_b16 v[98:99], v208 offset:18432
    v_mfma_f32_16x16x32_bf16 v[36:39], v[128:131], a[12:15], v[36:39]
    ds_read_b64_tr_b16 v[100:101], v209 offset:16384
    ds_read_b64_tr_b16 v[102:103], v209 offset:18432
    v_mfma_f32_16x16x32_bf16 v[40:43], v[132:135], a[8:11], v[40:43]
    buffer_load_dwordx4 a[40:43], v9, s[16:19], s52 offen offset:2048 sc1
    v_mfma_f32_16x16x32_bf16 v[44:47], v[132:135], a[12:15], v[44:47]
    ds_read_b64_tr_b16 v[104:105], v210 offset:16384
    ds_read_b64_tr_b16 v[106:107], v210 offset:18432
    v_mfma_f32_16x16x32_bf16 v[48:51], v[136:139], a[8:11], v[48:51]
    buffer_load_dwordx4 a[44:47], v9, s[16:19], s52 offen offset:2304 sc1
    v_mfma_f32_16x16x32_bf16 v[52:55], v[136:139], a[12:15], v[52:55]
    s_add_u32 s52, s52, 4096
    s_add_u32 m0, s34, 49152
    ds_read_b64_tr_b16 v[108:109], v211 offset:16384
    ds_read_b64_tr_b16 v[110:111], v211 offset:18432
    v_mfma_f32_16x16x32_bf16 v[56:59], v[140:143], a[8:11], v[56:59]
    buffer_load_dwordx4 v12, s[8:11], s48 offen offset:0 lds
    v_mfma_f32_16x16x32_bf16 v[60:63], v[140:143], a[12:15], v[60:63]
    s_waitcnt lgkmcnt(8)
    ds_read_b64_tr_b16 v[112:113], v212 offset:16384
    ds_read_b64_tr_b16 v[114:115], v212 offset:18432
    v_mfma_f32_16x16x32_bf16 v[64:67], v[144:147], a[8:11], v[64:67]
    buffer_load_dwordx4 v13, s[8:11], s48 offen offset:1024 lds
    v_mfma_f32_16x16x32_bf16 v[68:71], v[144:147], a[12:15], v[68:71]
    ds_read_b64_tr_b16 v[116:117], v213 offset:16384
    ds_read_b64_tr_b16 v[118:119], v213 offset:18432
    v_mfma_f32_16x16x32_bf16 v[72:75], v[148:151], a[8:11], v[72:75]
    buffer_load_dwordx4 v14, s[8:11], s48 offen offset:2048 lds
    v_mfma_f32_16x16x32_bf16 v[76:79], v[148:151], a[12:15], v[76:79]
    ds_read_b64_tr_b16 v[120:121], v214 offset:16384
    ds_read_b64_tr_b16 v[122:123], v214 offset:18432
    v_mfma_f32_16x16x32_bf16 v[80:83], v[152:155], a[8:11], v[80:83]
    buffer_load_dwordx4 v15, s[8:11], s48 offen offset:3072 lds
    v_mfma_f32_16x16x32_bf16 v[84:87], v[152:155], a[12:15], v[84:87]
    s_add_u32 s48, s48, 131072
    ds_read_b64_tr_b16 v[124:125], v215 offset:16384
    v_mfma_f32_16x16x32_bf16 v[88:91], v[156:159], a[8:11], v[88:91]
    ds_read_b64_tr_b16 v[126:127], v215 offset:18432
    v_mfma_f32_16x16x32_bf16 v[92:95], v[156:159], a[12:15], v[92:95]
    s_waitcnt lgkmcnt(8)
    v_mfma_f32_16x16x32_bf16 v[32:35], v[96:99], a[16:19], v[32:35]
    ds_read_b64_tr_b16 v[128:129], v208 offset:24576
    ds_read_b64_tr_b16 v[130:131], v208 offset:26624
    v_mfma_f32_16x16x32_bf16 v[36:39], v[96:99], a[20:23], v[36:39]
    ds_read_b64_tr_b16 v[132:133], v209 offset:24576
    ds_read_b64_tr_b16 v[134:135], v209 offset:26624
    v_mfma_f32_16x16x32_bf16 v[40:43], v[100:103], a[16:19], v[40:43]
    buffer_load_dwordx4 a[48:51], v9, s[16:19], s52 offen offset:0 sc1
    v_mfma_f32_16x16x32_bf16 v[44:47], v[100:103], a[20:23], v[44:47]
    ds_read_b64_tr_b16 v[136:137], v210 offset:24576
    v_mfma_f32_16x16x32_bf16 v[48:51], v[104:107], a[16:19], v[48:51]
    ds_read_b64_tr_b16 v[138:139], v210 offset:26624
    ds_read_b64_tr_b16 v[140:141], v211 offset:24576
    v_mfma_f32_16x16x32_bf16 v[52:55], v[104:107], a[20:23], v[52:55]
    buffer_load_dwordx4 a[52:55], v9, s[16:19], s52 offen offset:256 sc1
    v_mfma_f32_16x16x32_bf16 v[56:59], v[108:111], a[16:19], v[56:59]
    ds_read_b64_tr_b16 v[142:143], v211 offset:26624
    ds_read_b64_tr_b16 v[144:145], v212 offset:24576
    v_mfma_f32_16x16x32_bf16 v[60:63], v[108:111], a[20:23], v[60:63]
    s_waitcnt lgkmcnt(9)
    ds_read_b64_tr_b16 v[146:147], v212 offset:26624
    ds_read_b64_tr_b16 v[148:149], v213 offset:24576
    v_mfma_f32_16x16x32_bf16 v[64:67], v[112:115], a[16:19], v[64:67]
    buffer_load_dwordx4 a[56:59], v9, s[16:19], s52 offen offset:2048 sc1
    v_mfma_f32_16x16x32_bf16 v[68:71], v[112:115], a[20:23], v[68:71]
    ds_read_b64_tr_b16 v[150:151], v213 offset:26624
    v_mfma_f32_16x16x32_bf16 v[72:75], v[116:119], a[16:19], v[72:75]
    ds_read_b64_tr_b16 v[152:153], v214 offset:24576
    ds_read_b64_tr_b16 v[154:155], v214 offset:26624
    v_mfma_f32_16x16x32_bf16 v[76:79], v[116:119], a[20:23], v[76:79]
    buffer_load_dwordx4 a[60:63], v9, s[16:19], s52 offen offset:2304 sc1
    v_mfma_f32_16x16x32_bf16 v[80:83], v[120:123], a[16:19], v[80:83]
    s_add_u32 s52, s52, 4096
    ds_read_b64_tr_b16 v[156:157], v215 offset:24576
    v_mfma_f32_16x16x32_bf16 v[84:87], v[120:123], a[20:23], v[84:87]
    ds_read_b64_tr_b16 v[158:159], v215 offset:26624
    v_mfma_f32_16x16x32_bf16 v[88:91], v[124:127], a[16:19], v[88:91]
    v_mfma_f32_16x16x32_bf16 v[92:95], v[124:127], a[20:23], v[92:95]
    s_waitcnt vmcnt(17) lgkmcnt(8)
    s_waitcnt vmcnt(4)
    s_barrier
    v_mfma_f32_16x16x32_bf16 v[32:35], v[128:131], a[24:27], v[32:35]
    ds_read_b64_tr_b16 v[96:97], v212 offset:32768
    ds_read_b64_tr_b16 v[98:99], v212 offset:34816
    v_mfma_f32_16x16x32_bf16 v[36:39], v[128:131], a[28:31], v[36:39]
    ds_read_b64_tr_b16 v[100:101], v213 offset:32768
    v_mfma_f32_16x16x32_bf16 v[40:43], v[132:135], a[24:27], v[40:43]
    ds_read_b64_tr_b16 v[102:103], v213 offset:34816
    ds_read_b64_tr_b16 v[104:105], v214 offset:32768
    v_mfma_f32_16x16x32_bf16 v[44:47], v[132:135], a[28:31], v[44:47]
    ds_read_b64_tr_b16 v[106:107], v214 offset:34816
    v_mfma_f32_16x16x32_bf16 v[48:51], v[136:139], a[24:27], v[48:51]
    ds_read_b64_tr_b16 v[108:109], v215 offset:32768
    v_mfma_f32_16x16x32_bf16 v[52:55], v[136:139], a[28:31], v[52:55]
    ds_read_b64_tr_b16 v[110:111], v215 offset:34816
    v_mfma_f32_16x16x32_bf16 v[56:59], v[140:143], a[24:27], v[56:59]
    ds_read_b64_tr_b16 v[112:113], v212 offset:40960
    v_mfma_f32_16x16x32_bf16 v[60:63], v[140:143], a[28:31], v[60:63]
    s_waitcnt lgkmcnt(9)
    ds_read_b64_tr_b16 v[114:115], v212 offset:43008
    v_mfma_f32_16x16x32_bf16 v[64:67], v[144:147], a[24:27], v[64:67]
    ds_read_b64_tr_b16 v[116:117], v213 offset:40960
    v_mfma_f32_16x16x32_bf16 v[68:71], v[144:147], a[28:31], v[68:71]
    ds_read_b64_tr_b16 v[118:119], v213 offset:43008
    v_mfma_f32_16x16x32_bf16 v[72:75], v[148:151], a[24:27], v[72:75]
    ds_read_b64_tr_b16 v[120:121], v214 offset:40960
    v_mfma_f32_16x16x32_bf16 v[76:79], v[148:151], a[28:31], v[76:79]
    ds_read_b64_tr_b16 v[122:123], v214 offset:43008
    v_mfma_f32_16x16x32_bf16 v[80:83], v[152:155], a[24:27], v[80:83]
    ds_read_b64_tr_b16 v[124:125], v215 offset:40960
    v_mfma_f32_16x16x32_bf16 v[84:87], v[152:155], a[28:31], v[84:87]
    ds_read_b64_tr_b16 v[126:127], v215 offset:43008
    v_mfma_f32_16x16x32_bf16 v[88:91], v[156:159], a[24:27], v[88:91]
    v_mfma_f32_16x16x32_bf16 v[92:95], v[156:159], a[28:31], v[92:95]
    s_waitcnt lgkmcnt(8)
    v_mfma_f32_16x16x32_bf16 v[64:67], v[96:99], a[32:35], v[64:67]
    ds_read_b64_tr_b16 v[128:129], v212 offset:49152
    ds_read_b64_tr_b16 v[130:131], v212 offset:51200
    v_mfma_f32_16x16x32_bf16 v[68:71], v[96:99], a[36:39], v[68:71]
    ds_read_b64_tr_b16 v[132:133], v213 offset:49152
    v_mfma_f32_16x16x32_bf16 v[72:75], v[100:103], a[32:35], v[72:75]
    ds_read_b64_tr_b16 v[134:135], v213 offset:51200
    ds_read_b64_tr_b16 v[136:137], v214 offset:49152
    v_mfma_f32_16x16x32_bf16 v[76:79], v[100:103], a[36:39], v[76:79]
    ds_read_b64_tr_b16 v[138:139], v214 offset:51200
    v_mfma_f32_16x16x32_bf16 v[80:83], v[104:107], a[32:35], v[80:83]
    ds_read_b64_tr_b16 v[140:141], v215 offset:49152
    v_mfma_f32_16x16x32_bf16 v[84:87], v[104:107], a[36:39], v[84:87]
    ds_read_b64_tr_b16 v[142:143], v215 offset:51200
    v_mfma_f32_16x16x32_bf16 v[88:91], v[108:111], a[32:35], v[88:91]
    ds_read_b64_tr_b16 v[144:145], v212 offset:57344
    v_mfma_f32_16x16x32_bf16 v[92:95], v[108:111], a[36:39], v[92:95]
    s_waitcnt lgkmcnt(9)
    ds_read_b64_tr_b16 v[146:147], v212 offset:59392
    v_mfma_f32_16x16x32_bf16 v[64:67], v[112:115], a[40:43], v[64:67]
    ds_read_b64_tr_b16 v[148:149], v213 offset:57344
    v_mfma_f32_16x16x32_bf16 v[68:71], v[112:115], a[44:47], v[68:71]
    ds_read_b64_tr_b16 v[150:151], v213 offset:59392
    v_mfma_f32_16x16x32_bf16 v[72:75], v[116:119], a[40:43], v[72:75]
    ds_read_b64_tr_b16 v[152:153], v214 offset:57344
    v_mfma_f32_16x16x32_bf16 v[76:79], v[116:119], a[44:47], v[76:79]
    ds_read_b64_tr_b16 v[154:155], v214 offset:59392
    v_mfma_f32_16x16x32_bf16 v[80:83], v[120:123], a[40:43], v[80:83]
    ds_read_b64_tr_b16 v[156:157], v215 offset:57344
    v_mfma_f32_16x16x32_bf16 v[84:87], v[120:123], a[44:47], v[84:87]
    ds_read_b64_tr_b16 v[158:159], v215 offset:59392
    v_mfma_f32_16x16x32_bf16 v[88:91], v[124:127], a[40:43], v[88:91]
    v_mfma_f32_16x16x32_bf16 v[92:95], v[124:127], a[44:47], v[92:95]
    s_waitcnt vmcnt(0) lgkmcnt(8)
    v_mfma_f32_16x16x32_bf16 v[64:67], v[128:131], a[48:51], v[64:67]
    ds_read_b64_tr_b16 v[96:97], v208 offset:32768
    ds_read_b64_tr_b16 v[98:99], v208 offset:34816
    v_mfma_f32_16x16x32_bf16 v[68:71], v[128:131], a[52:55], v[68:71]
    ds_read_b64_tr_b16 v[100:101], v209 offset:32768
    v_mfma_f32_16x16x32_bf16 v[72:75], v[132:135], a[48:51], v[72:75]
    ds_read_b64_tr_b16 v[102:103], v209 offset:34816
    ds_read_b64_tr_b16 v[104:105], v210 offset:32768
    v_mfma_f32_16x16x32_bf16 v[76:79], v[132:135], a[52:55], v[76:79]
    ds_read_b64_tr_b16 v[106:107], v210 offset:34816
    v_mfma_f32_16x16x32_bf16 v[80:83], v[136:139], a[48:51], v[80:83]
    ds_read_b64_tr_b16 v[108:109], v211 offset:32768
    v_mfma_f32_16x16x32_bf16 v[84:87], v[136:139], a[52:55], v[84:87]
    ds_read_b64_tr_b16 v[110:111], v211 offset:34816
    v_mfma_f32_16x16x32_bf16 v[88:91], v[140:143], a[48:51], v[88:91]
    ds_read_b64_tr_b16 v[112:113], v208 offset:40960
    v_mfma_f32_16x16x32_bf16 v[92:95], v[140:143], a[52:55], v[92:95]
    s_waitcnt lgkmcnt(9)
    ds_read_b64_tr_b16 v[114:115], v208 offset:43008
    v_mfma_f32_16x16x32_bf16 v[64:67], v[144:147], a[56:59], v[64:67]
    ds_read_b64_tr_b16 v[116:117], v209 offset:40960
    v_mfma_f32_16x16x32_bf16 v[68:71], v[144:147], a[60:63], v[68:71]
    ds_read_b64_tr_b16 v[118:119], v209 offset:43008
    v_mfma_f32_16x16x32_bf16 v[72:75], v[148:151], a[56:59], v[72:75]
    ds_read_b64_tr_b16 v[120:121], v210 offset:40960
    v_mfma_f32_16x16x32_bf16 v[76:79], v[148:151], a[60:63], v[76:79]
    ds_read_b64_tr_b16 v[122:123], v210 offset:43008
    v_mfma_f32_16x16x32_bf16 v[80:83], v[152:155], a[56:59], v[80:83]
    ds_read_b64_tr_b16 v[124:125], v211 offset:40960
    v_mfma_f32_16x16x32_bf16 v[84:87], v[152:155], a[60:63], v[84:87]
    ds_read_b64_tr_b16 v[126:127], v211 offset:43008
    v_mfma_f32_16x16x32_bf16 v[88:91], v[156:159], a[56:59], v[88:91]
    v_mfma_f32_16x16x32_bf16 v[92:95], v[156:159], a[60:63], v[92:95]
    s_waitcnt lgkmcnt(8)
    v_mfma_f32_16x16x32_bf16 v[32:35], v[96:99], a[32:35], v[32:35]
    ds_read_b64_tr_b16 v[128:129], v208 offset:49152
    ds_read_b64_tr_b16 v[130:131], v208 offset:51200
    s_nop 3
    v_mfma_f32_16x16x32_bf16 v[36:39], v[96:99], a[36:39], v[36:39]
    ds_read_b64_tr_b16 v[132:133], v209 offset:49152
    v_cvt_pk_bf16_f32 v192, v64, v65
    v_mfma_f32_16x16x32_bf16 v[40:43], v[100:103], a[32:35], v[40:43]
    ds_read_b64_tr_b16 v[134:135], v209 offset:51200
    ds_read_b64_tr_b16 v[136:137], v210 offset:49152
    v_cvt_pk_bf16_f32 v193, v66, v67
    v_cvt_pk_bf16_f32 v194, v72, v73
    v_cvt_pk_bf16_f32 v195, v74, v75
    v_mfma_f32_16x16x32_bf16 v[44:47], v[100:103], a[36:39], v[44:47]
    ds_read_b64_tr_b16 v[138:139], v210 offset:51200
    v_min_u32 v192, -2, v192
    v_min_u32 v193, -2, v193
    v_min_u32 v194, -2, v194
    v_mfma_f32_16x16x32_bf16 v[48:51], v[104:107], a[32:35], v[48:51]
    ds_read_b64_tr_b16 v[140:141], v211 offset:49152
    v_min_u32 v195, -2, v195
    buffer_store_dwordx4 v[192:195], v8, s[16:19], s38 offen offset:0 sc1
    v_mfma_f32_16x16x32_bf16 v[52:55], v[104:107], a[36:39], v[52:55]
    ds_read_b64_tr_b16 v[142:143], v211 offset:51200
    v_cvt_pk_bf16_f32 v196, v68, v69
    v_mfma_f32_16x16x32_bf16 v[56:59], v[108:111], a[32:35], v[56:59]
    ds_read_b64_tr_b16 v[144:145], v208 offset:57344
    v_cvt_pk_bf16_f32 v197, v70, v71
    v_cvt_pk_bf16_f32 v198, v76, v77
    v_cvt_pk_bf16_f32 v199, v78, v79
    v_min_u32 v196, -2, v196
    v_mfma_f32_16x16x32_bf16 v[60:63], v[108:111], a[36:39], v[60:63]
    s_waitcnt lgkmcnt(9)
    ds_read_b64_tr_b16 v[146:147], v208 offset:59392
    v_min_u32 v197, -2, v197
    v_min_u32 v198, -2, v198
    v_min_u32 v199, -2, v199
    v_mfma_f32_16x16x32_bf16 v[32:35], v[112:115], a[40:43], v[32:35]
    ds_read_b64_tr_b16 v[148:149], v209 offset:57344
    buffer_store_dwordx4 v[196:199], v8, s[16:19], s38 offen offset:1024 sc1
    v_mfma_f32_16x16x32_bf16 v[36:39], v[112:115], a[44:47], v[36:39]
    ds_read_b64_tr_b16 v[150:151], v209 offset:59392
    v_cvt_pk_bf16_f32 v200, v80, v81
    v_cvt_pk_bf16_f32 v201, v82, v83
    v_mfma_f32_16x16x32_bf16 v[40:43], v[116:119], a[40:43], v[40:43]
    ds_read_b64_tr_b16 v[152:153], v210 offset:57344
    v_cvt_pk_bf16_f32 v202, v88, v89
    v_cvt_pk_bf16_f32 v203, v90, v91
    v_min_u32 v200, -2, v200
    v_min_u32 v201, -2, v201
    v_mfma_f32_16x16x32_bf16 v[44:47], v[116:119], a[44:47], v[44:47]
    ds_read_b64_tr_b16 v[154:155], v210 offset:59392
    v_min_u32 v202, -2, v202
    v_min_u32 v203, -2, v203
    v_mfma_f32_16x16x32_bf16 v[48:51], v[120:123], a[40:43], v[48:51]
    ds_read_b64_tr_b16 v[156:157], v211 offset:57344
    buffer_store_dwordx4 v[200:203], v8, s[16:19], s38 offen offset:2048 sc1
    v_mfma_f32_16x16x32_bf16 v[52:55], v[120:123], a[44:47], v[52:55]
    ds_read_b64_tr_b16 v[158:159], v211 offset:59392
    v_cvt_pk_bf16_f32 v204, v84, v85
    v_cvt_pk_bf16_f32 v205, v86, v87
    v_cvt_pk_bf16_f32 v206, v92, v93
    v_mfma_f32_16x16x32_bf16 v[56:59], v[124:127], a[40:43], v[56:59]
    v_cvt_pk_bf16_f32 v207, v94, v95
    v_min_u32 v204, -2, v204
    v_min_u32 v205, -2, v205
    v_min_u32 v206, -2, v206
    v_min_u32 v207, -2, v207
    v_mfma_f32_16x16x32_bf16 v[60:63], v[124:127], a[44:47], v[60:63]
    s_waitcnt lgkmcnt(8)
    buffer_store_dwordx4 v[204:207], v8, s[16:19], s38 offen offset:3072 sc1
    v_mfma_f32_16x16x32_bf16 v[32:35], v[128:131], a[48:51], v[32:35]
    v_mfma_f32_16x16x32_bf16 v[36:39], v[128:131], a[52:55], v[36:39]
    v_mfma_f32_16x16x32_bf16 v[40:43], v[132:135], a[48:51], v[40:43]
    v_mfma_f32_16x16x32_bf16 v[44:47], v[132:135], a[52:55], v[44:47]
    v_mfma_f32_16x16x32_bf16 v[48:51], v[136:139], a[48:51], v[48:51]
    v_mfma_f32_16x16x32_bf16 v[52:55], v[136:139], a[52:55], v[52:55]
    v_mfma_f32_16x16x32_bf16 v[56:59], v[140:143], a[48:51], v[56:59]
    v_mfma_f32_16x16x32_bf16 v[60:63], v[140:143], a[52:55], v[60:63]
    s_waitcnt lgkmcnt(0)
    v_mfma_f32_16x16x32_bf16 v[32:35], v[144:147], a[56:59], v[32:35]
    v_mfma_f32_16x16x32_bf16 v[36:39], v[144:147], a[60:63], v[36:39]
    v_mfma_f32_16x16x32_bf16 v[40:43], v[148:151], a[56:59], v[40:43]
    v_mfma_f32_16x16x32_bf16 v[44:47], v[148:151], a[60:63], v[44:47]
    v_mfma_f32_16x16x32_bf16 v[48:51], v[152:155], a[56:59], v[48:51]
    v_mfma_f32_16x16x32_bf16 v[52:55], v[152:155], a[60:63], v[52:55]
    v_mfma_f32_16x16x32_bf16 v[56:59], v[156:159], a[56:59], v[56:59]
    v_mfma_f32_16x16x32_bf16 v[60:63], v[156:159], a[60:63], v[60:63]
    s_mov_b32 s35, 20000
    v_permlane16_swap_b32 v160, v162
    v_permlane16_swap_b32 v161, v163
    v_permlane16_swap_b32 v164, v166
    v_permlane16_swap_b32 v165, v167
    v_permlane16_swap_b32 v168, v170
    v_permlane16_swap_b32 v169, v171
    v_permlane16_swap_b32 v172, v174
    v_permlane16_swap_b32 v173, v175
    s_nop 7
    v_dot2_f32_bf16 v32, v160, v20, v32
    v_dot2_f32_bf16 v33, v160, v21, v33
    v_dot2_f32_bf16 v34, v161, v20, v34
    v_dot2_f32_bf16 v35, v161, v21, v35
    v_dot2_f32_bf16 v40, v162, v20, v40
    v_dot2_f32_bf16 v41, v162, v21, v41
    v_dot2_f32_bf16 v42, v163, v20, v42
    v_dot2_f32_bf16 v43, v163, v21, v43
    v_dot2_f32_bf16 v36, v164, v20, v36
    v_dot2_f32_bf16 v37, v164, v21, v37
    v_dot2_f32_bf16 v38, v165, v20, v38
    v_dot2_f32_bf16 v39, v165, v21, v39
    v_dot2_f32_bf16 v44, v166, v20, v44
    v_dot2_f32_bf16 v45, v166, v21, v45
    v_dot2_f32_bf16 v46, v167, v20, v46
    v_dot2_f32_bf16 v47, v167, v21, v47
    v_dot2_f32_bf16 v48, v168, v20, v48
    v_dot2_f32_bf16 v49, v168, v21, v49
    v_dot2_f32_bf16 v50, v169, v20, v50
    v_dot2_f32_bf16 v51, v169, v21, v51
    v_dot2_f32_bf16 v56, v170, v20, v56
    v_dot2_f32_bf16 v57, v170, v21, v57
    v_dot2_f32_bf16 v58, v171, v20, v58
    v_dot2_f32_bf16 v59, v171, v21, v59
    v_dot2_f32_bf16 v52, v172, v20, v52
    v_dot2_f32_bf16 v53, v172, v21, v53
    v_dot2_f32_bf16 v54, v173, v20, v54
    v_dot2_f32_bf16 v55, v173, v21, v55
    v_dot2_f32_bf16 v60, v174, v20, v60
    v_dot2_f32_bf16 v61, v174, v21, v61
    v_dot2_f32_bf16 v62, v175, v20, v62
    v_dot2_f32_bf16 v63, v175, v21, v63
    s_waitcnt vmcnt(0)
bk3_poll:
    buffer_load_dwordx4 v[176:179], v8, s[16:19], s40 offen offset:0 sc1
    buffer_load_dwordx4 v[180:183], v8, s[16:19], s40 offen offset:1024 sc1
    buffer_load_dwordx4 v[184:187], v8, s[16:19], s40 offen offset:2048 sc1
    buffer_load_dwordx4 v[188:191], v8, s[16:19], s40 offen offset:3072 sc1
    s_waitcnt vmcnt(0)
    v_max3_u32 v28, v176, v177, v178
    v_max3_u32 v28, v28, v179, v180
    v_max3_u32 v28, v28, v181, v182
    v_max3_u32 v28, v28, v183, v184
    v_max3_u32 v28, v28, v185, v186
    v_max3_u32 v28, v28, v187, v188
    v_max3_u32 v28, v28, v189, v190
    v_max_u32 v28, v28, v191
    v_cmp_eq_u32 vcc, -1, v28
    s_sub_u32 s35, s35, 1
    s_cbranch_vccz bk3_got
    s_sleep 2
    s_cmp_lg_u32 s35, 0
    s_cbranch_scc1 bk3_poll
bk3_got:
    v_dot2_f32_bf16 v32, v176, v20, v32
    v_dot2_f32_bf16 v33, v176, v21, v33
    v_dot2_f32_bf16 v34, v177, v20, v34
    v_dot2_f32_bf16 v35, v177, v21, v35
    v_dot2_f32_bf16 v40, v178, v20, v40
    v_dot2_f32_bf16 v41, v178, v21, v41
    v_dot2_f32_bf16 v42, v179, v20, v42
    v_dot2_f32_bf16 v43, v179, v21, v43
    v_dot2_f32_bf16 v36, v180, v20, v36
    v_dot2_f32_bf16 v37, v180, v21, v37
    v_dot2_f32_bf16 v38, v181, v20, v38
    v_dot2_f32_bf16 v39, v181, v21, v39
    v_dot2_f32_bf16 v44, v182, v20, v44
    v_dot2_f32_bf16 v45, v182, v21, v45
    v_dot2_f32_bf16 v46, v183, v20, v46
    v_dot2_f32_bf16 v47, v183, v21, v47
    v_dot2_f32_bf16 v48, v184, v20, v48
    v_dot2_f32_bf16 v49, v184, v21, v49
    v_dot2_f32_bf16 v50, v185, v20, v50
    v_dot2_f32_bf16 v51, v185, v21, v51
    v_dot2_f32_bf16 v56, v186, v20, v56
    v_dot2_f32_bf16 v57, v186, v21, v57
    v_dot2_f32_bf16 v58, v187, v20, v58
    v_dot2_f32_bf16 v59, v187, v21, v59
    v_dot2_f32_bf16 v52, v188, v20, v52
    v_dot2_f32_bf16 v53, v188, v21, v53
    v_dot2_f32_bf16 v54, v189, v20, v54
    v_dot2_f32_bf16 v55, v189, v21, v55
    v_dot2_f32_bf16 v60, v190, v20, v60
    v_dot2_f32_bf16 v61, v190, v21, v61
    v_dot2_f32_bf16 v62, v191, v20, v62
    v_dot2_f32_bf16 v63, v191, v21, v63
    s_nop 2
    v_cvt_pk_bf16_f32 v160, v32, v33
    v_cvt_pk_bf16_f32 v161, v34, v35
    v_cvt_pk_bf16_f32 v162, v40, v41
    v_cvt_pk_bf16_f32 v163, v42, v43
    v_cvt_pk_bf16_f32 v164, v36, v37
    v_cvt_pk_bf16_f32 v165, v38, v39
    v_cvt_pk_bf16_f32 v166, v44, v45
    v_cvt_pk_bf16_f32 v167, v46, v47
    v_cvt_pk_bf16_f32 v168, v48, v49
    v_cvt_pk_bf16_f32 v169, v50, v51
    v_cvt_pk_bf16_f32 v170, v56, v57
    v_cvt_pk_bf16_f32 v171, v58, v59
    v_cvt_pk_bf16_f32 v172, v52, v53
    v_cvt_pk_bf16_f32 v173, v54, v55
    v_cvt_pk_bf16_f32 v174, v60, v61
    v_cvt_pk_bf16_f32 v175, v62, v63
    buffer_store_dwordx4 v[160:163], v11, s[16:19], 0 offen offset:0 sc1
    buffer_store_dwordx4 v[164:167], v11, s[16:19], 0 offen offset:256 sc1
    buffer_store_dwordx4 v[168:171], v11, s[16:19], 0 offen offset:2048 sc1
    buffer_store_dwordx4 v[172:175], v11, s[16:19], 0 offen offset:2304 sc1
    v_mov_b32 v2, 0x3f803f80
    v_mov_b32 v28, 0
    v_mov_b32 v29, 0
    v_mov_b32 v30, 0
    v_mov_b32 v31, 0
    v_dot2_f32_bf16 v28, v160, v2, v28
    v_dot2_f32_bf16 v29, v160, v160, v29
    v_dot2_f32_bf16 v28, v161, v2, v28
    v_dot2_f32_bf16 v29, v161, v161, v29
    v_dot2_f32_bf16 v28, v162, v2, v28
    v_dot2_f32_bf16 v29, v162, v162, v29
    v_dot2_f32_bf16 v28, v163, v2, v28
    v_dot2_f32_bf16 v29, v163, v163, v29
    v_dot2_f32_bf16 v30, v164, v2, v30
    v_dot2_f32_bf16 v31, v164, v164, v31
    v_dot2_f32_bf16 v30, v165, v2, v30
    v_dot2_f32_bf16 v31, v165, v165, v31
    v_dot2_f32_bf16 v30, v166, v2, v30
    v_dot2_f32_bf16 v31, v166, v166, v31
    v_dot2_f32_bf16 v30, v167, v2, v30
    v_dot2_f32_bf16 v31, v167, v167, v31
    v_dot2_f32_bf16 v28, v168, v2, v28
    v_dot2_f32_bf16 v29, v168, v168, v29
    v_dot2_f32_bf16 v28, v169, v2, v28
    v_dot2_f32_bf16 v29, v169, v169, v29
    v_dot2_f32_bf16 v28, v170, v2, v28
    v_dot2_f32_bf16 v29, v170, v170, v29
    v_dot2_f32_bf16 v28, v171, v2, v28
    v_dot2_f32_bf16 v29, v171, v171, v29
    v_dot2_f32_bf16 v30, v172, v2, v30
    v_dot2_f32_bf16 v31, v172, v172, v31
    v_dot2_f32_bf16 v30, v173, v2, v30
    v_dot2_f32_bf16 v31, v173, v173, v31
    v_dot2_f32_bf16 v30, v174, v2, v30
    v_dot2_f32_bf16 v31, v174, v174, v31
    v_dot2_f32_bf16 v30, v175, v2, v30
    v_dot2_f32_bf16 v31, v175, v175, v31
    s_nop 2
    v_mov_b32 v192, v28
    v_mov_b32 v193, v29
    v_mov_b32 v194, v30
    v_mov_b32 v195, v31
    s_nop 1
    v_permlane16_swap_b32 v28, v192
    v_permlane16_swap_b32 v29, v193
    v_permlane16_swap_b32 v30, v194
    v_permlane16_swap_b32 v31, v195
    s_nop 0
    v_add_f32 v28, v28, v192
    v_add_f32 v29, v29, v193
    v_add_f32 v30, v30, v194
    v_add_f32 v31, v31, v195
    v_mov_b32 v192, v28
    v_mov_b32 v193, v29
    v_mov_b32 v194, v30
    v_mov_b32 v195, v31
    s_nop 1
    v_permlane32_swap_b32 v28, v192
    v_permlane32_swap_b32 v29, v193
    v_permlane32_swap_b32 v30, v194
    v_permlane32_swap_b32 v31, v195
    s_nop 0
    v_add_f32 v28, v28, v192
    v_add_f32 v29, v29, v193
    v_add_f32 v30, v30, v194
    v_add_f32 v31, v31, v195
    v_and_b32 v2, 16, v1
    v_cmp_eq_u32 vcc, 0, v2
    s_lshl_b32 s3, s31, 1
    s_add_u32 s3, s3, s29
    s_lshl_b32 s3, s3, 14
    s_lshl_b32 s36, s30, 8
    s_add_u32 s3, s3, s36
    s_add_u32 s3, s3, 74448896
    v_cndmask_b32 v28, v30, v28, vcc
    v_cndmask_b32 v29, v31, v29, vcc
    v_lshrrev_b32 v3, 5, v1
    v_lshlrev_b32 v3, 30, v3
    v_lshl_add_u32 v2, v1, 3, v3
    buffer_store_dwordx2 v[28:29], v2, s[16:19], s3 offen sc1
back_p4:
    s_lshr_b32 s3, s2, 3
    s_lshl_b32 s36, s2, 3
    s_and_b32 s36, s36, 8
    s_xor_b32 s36, s36, 8
    s_and_b32 s37, s3, 7
    s_add_u32 s36, s36, s37
    s_lshl_b32 s31, s2, 1
    s_and_b32 s31, s31, 12
    s_lshr_b32 s3, s3, 3
    s_add_u32 s31, s31, s3
    s_lshl_b32 s30, s36, 2
    s_add_u32 s30, s30, s28
    s_mul_i32 s3, s28, 114688
    s_mul_i32 s36, s31, 448
    s_add_u32 s3, s3, s36
    v_add_u32 v2, 0, v1
    v_mul_u32_u24 v3, 2341, v2
    v_lshrrev_b32 v3, 16, v3
    v_lshrrev_b32 v4, 1, v3
    v_and_b32 v4, 2, v4
    v_xor_b32 v2, v2, v4
    v_mul_u32_u24 v3, 6720, v3
    v_lshl_add_u32 v2, v2, 4, v3
    v_add_u32 v2, s3, v2
    v_subrev_u32 v12, 0, v2
    v_add_u32 v2, 64, v1
    v_mul_u32_u24 v3, 2341, v2
    v_lshrrev_b32 v3, 16, v3
    v_lshrrev_b32 v4, 1, v3
    v_and_b32 v4, 2, v4
    v_xor_b32 v2, v2, v4
    v_mul_u32_u24 v3, 6720, v3
    v_lshl_add_u32 v2, v2, 4, v3
    v_add_u32 v2, s3, v2
    v_subrev_u32 v13, 1024, v2
    v_add_u32 v2, 128, v1
    v_mul_u32_u24 v3, 2341, v2
    v_lshrrev_b32 v3, 16, v3
    v_lshrrev_b32 v4, 1, v3
    v_and_b32 v4, 2, v4
    v_xor_b32 v2, v2, v4
    v_mul_u32_u24 v3, 6720, v3
    v_lshl_add_u32 v2, v2, 4, v3
    v_add_u32 v2, s3, v2
    v_subrev_u32 v14, 2048, v2
    v_add_u32 v2, 192, v1
    v_mul_u32_u24 v3, 2341, v2
    v_lshrrev_b32 v3, 16, v3
    v_lshrrev_b32 v4, 1, v3
    v_and_b32 v4, 2, v4
    v_xor_b32 v2, v2, v4
    v_mul_u32_u24 v3, 6720, v3
    v_lshl_add_u32 v2, v2, 4, v3
    v_add_u32 v2, s3, v2
    v_subrev_u32 v15, 3072, v2
    v_add_u32 v2, 256, v1
    v_mul_u32_u24 v3, 2341, v2
    v_lshrrev_b32 v3, 16, v3
    v_lshrrev_b32 v4, 1, v3
    v_and_b32 v4, 2, v4
    v_xor_b32 v2, v2, v4
    v_mul_u32_u24 v3, 6720, v3
    v_lshl_add_u32 v2, v2, 4, v3
    v_add_u32 v2, s3, v2
    v_subrev_u32 v16, 0, v2
    v_add_u32 v2, 320, v1
    v_mul_u32_u24 v3, 2341, v2
    v_lshrrev_b32 v3, 16, v3
    v_lshrrev_b32 v4, 1, v3
    v_and_b32 v4, 2, v4
    v_xor_b32 v2, v2, v4
    v_mul_u32_u24 v3, 6720, v3
    v_lshl_add_u32 v2, v2, 4, v3
    v_add_u32 v2, s3, v2
    v_subrev_u32 v17, 1024, v2
    v_add_u32 v2, 384, v1
    v_mul_u32_u24 v3, 2341, v2
    v_lshrrev_b32 v3, 16, v3
    v_lshrrev_b32 v4, 1, v3
    v_and_b32 v4, 2, v4
    v_xor_b32 v2, v2, v4
    v_mul_u32_u24 v3, 6720, v3
    v_lshl_add_u32 v2, v2, 4, v3
    v_add_u32 v2, s3, v2
    v_subrev_u32 v18, 2048, v2
    s_mul_i32 s34, s28, 7168
    s_mov_b32 s48, 0
    s_mov_b32 s52, 0
    s_mov_b32 s8, s72
    s_and_b32 s9, s73, 0xffff
    s_mov_b32 s10, 0x700000
    s_mov_b32 s11, 0x20000
    v_mov_b32 v32, 0
    v_mov_b32 v33, 0
    v_mov_b32 v34, 0
    v_mov_b32 v35, 0
    v_mov_b32 v36, 0
    v_mov_b32 v37, 0
    v_mov_b32 v38, 0
    v_mov_b32 v39, 0
    v_mov_b32 v40, 0
    v_mov_b32 v41, 0
    v_mov_b32 v42, 0
    v_mov_b32 v43, 0
    v_mov_b32 v44, 0
    v_mov_b32 v45, 0
    v_mov_b32 v46, 0
    v_mov_b32 v47, 0
    v_mov_b32 v48, 0
    v_mov_b32 v49, 0
    v_mov_b32 v50, 0
    v_mov_b32 v51, 0
    v_mov_b32 v52, 0
    v_mov_b32 v53, 0
    v_mov_b32 v54, 0
    v_mov_b32 v55, 0
    v_mov_b32 v56, 0
    v_mov_b32 v57, 0
    v_mov_b32 v58, 0
    v_mov_b32 v59, 0
    v_mov_b32 v60, 0
    v_mov_b32 v61, 0
    v_mov_b32 v62, 0
    v_mov_b32 v63, 0
    v_mov_b32 v64, 0
    v_mov_b32 v65, 0
    v_mov_b32 v66, 0
    v_mov_b32 v67, 0
    v_mov_b32 v68, 0
    v_mov_b32 v69, 0
    v_mov_b32 v70, 0
    v_mov_b32 v71, 0
    v_mov_b32 v72, 0
    v_mov_b32 v73, 0
    v_mov_b32 v74, 0
    v_mov_b32 v75, 0
    v_mov_b32 v76, 0
    v_mov_b32 v77, 0
    v_mov_b32 v78, 0
    v_mov_b32 v79, 0
    v_mov_b32 v80, 0
    v_mov_b32 v81, 0
    v_mov_b32 v82, 0
    v_mov_b32 v83, 0
    v_mov_b32 v84, 0
    v_mov_b32 v85, 0
    v_mov_b32 v86, 0
    v_mov_b32 v87, 0
    v_mov_b32 v88, 0
    v_mov_b32 v89, 0
    v_mov_b32 v90, 0
    v_mov_b32 v91, 0
    v_mov_b32 v92, 0
    v_mov_b32 v93, 0
    v_mov_b32 v94, 0
    v_mov_b32 v95, 0
    v_mov_b32 v96, 0
    v_mov_b32 v97, 0
    v_mov_b32 v98, 0
    v_mov_b32 v99, 0
    v_mov_b32 v100, 0
    v_mov_b32 v101, 0
    v_mov_b32 v102, 0
    v_mov_b32 v103, 0
    v_mov_b32 v104, 0
    v_mov_b32 v105, 0
    v_mov_b32 v106, 0
    v_mov_b32 v107, 0
    v_mov_b32 v108, 0
    v_mov_b32 v109, 0
    v_mov_b32 v110, 0
    v_mov_b32 v111, 0
    v_mov_b32 v112, 0
    v_mov_b32 v113, 0
    v_mov_b32 v114, 0
    v_mov_b32 v115, 0
    v_mov_b32 v116, 0
    v_mov_b32 v117, 0
    v_mov_b32 v118, 0
    v_mov_b32 v119, 0
    v_mov_b32 v120, 0
    v_mov_b32 v121, 0
    v_mov_b32 v122, 0
    v_mov_b32 v123, 0
    v_mov_b32 v124, 0
    v_mov_b32 v125, 0
    v_mov_b32 v126, 0
    v_mov_b32 v127, 0
    v_mov_b32 v128, 0
    v_mov_b32 v129, 0
    v_mov_b32 v130, 0
    v_mov_b32 v131, 0
    v_mov_b32 v132, 0
    v_mov_b32 v133, 0
    v_mov_b32 v134, 0
    v_mov_b32 v135, 0
    v_mov_b32 v136, 0
    v_mov_b32 v137, 0
    v_mov_b32 v138, 0
    v_mov_b32 v139, 0
    v_mov_b32 v140, 0
    v_mov_b32 v141, 0
    v_mov_b32 v142, 0
    v_mov_b32 v143, 0
    v_mov_b32 v5, 2
    s_mov_b32 s3, 0
    s_waitcnt vmcnt(0)
    s_barrier
    buffer_store_dword v5, v6, s[16:19], s3 offen sc1
    s_add_u32 m0, s34, 0
    s_nop 0
    buffer_load_dwordx4 v12, s[8:11], s48 offen offset:0 lds
    buffer_load_dwordx4 v13, s[8:11], s48 offen offset:1024 lds
    buffer_load_dwordx4 v14, s[8:11], s48 offen offset:2048 lds
    buffer_load_dwordx4 v15, s[8:11], s48 offen offset:3072 lds
    s_add_u32 m0, s34, 4096
    s_nop 0
    buffer_load_dwordx4 v16, s[8:11], s48 offen offset:0 lds
    buffer_load_dwordx4 v17, s[8:11], s48 offen offset:1024 lds
    buffer_load_dwordx4 v18, s[8:11], s48 offen offset:2048 lds
    s_add_u32 s48, s48, 458752
    s_add_u32 m0, s34, 28672
    s_nop 0
    buffer_load_dwordx4 v12, s[8:11], s48 offen offset:0 lds
    buffer_load_dwordx4 v13, s[8:11], s48 offen offset:1024 lds
    buffer_load_dwordx4 v14, s[8:11], s48 offen offset:2048 lds
    buffer_load_dwordx4 v15, s[8:11], s48 offen offset:3072 lds
    s_add_u32 m0, s34, 32768
    s_nop 0
    buffer_load_dwordx4 v16, s[8:11], s48 offen offset:0 lds
    buffer_load_dwordx4 v17, s[8:11], s48 offen offset:1024 lds
    buffer_load_dwordx4 v18, s[8:11], s48 offen offset:2048 lds
    s_add_u32 s48, s48, 458752
    s_add_u32 m0, s34, 57344
    s_nop 0
    buffer_load_dwordx4 v12, s[8:11], s48 offen offset:0 lds
    buffer_load_dwordx4 v13, s[8:11], s48 offen offset:1024 lds
    buffer_load_dwordx4 v14, s[8:11], s48 offen offset:2048 lds
    buffer_load_dwordx4 v15, s[8:11], s48 offen offset:3072 lds
    s_mul_i32 s3, s30, 65536
    s_add_u32 s3, s3, 54525952
    v_add_u32 v9, s3, v27
    v_and_b32 v2, 15, v1
    v_lshlrev_b32 v2, 3, v2
    v_lshrrev_b32 v3, 4, v1
    v_lshl_add_u32 v10, v3, 14, v2
    s_lshl_b32 s3, s30, 8
    s_add_u32 s3, s3, 74448896
    v_add_u32 v10, s3, v10
    s_mul_i32 s3, s31, 896
    s_add_u32 s3, s3, 73400320
    v_lshlrev_b32 v11, 2, v0
    v_add_u32 v22, s3, v11
    v_lshrrev_b32 v3, 2, v1
    v_mul_u32_u24 v3, 448, v3
    v_and_b32 v4, 3, v1
    v_lshl_add_u32 v3, v4, 3, v3
    v_bfe_u32 v4, v1, 4, 1
    v_lshl_add_u32 v216, v4, 5, v3
    v_xor_b32 v4, 1, v4
    v_lshl_add_u32 v217, v4, 5, v3
    v_add_u32 v218, 57344, v216
    v_add_u32 v219, 57344, v217
    s_lshr_b32 s3, s30, 2
    s_and_b32 s36, s3, 7
    s_lshl_b32 s36, s36, 3
    s_and_b32 s3, s2, 1
    s_add_u32 s36, s36, s3
    v_bfe_u32 v2, v1, 1, 2
    v_lshlrev_b32 v2, 6, v2
    v_bfe_u32 v3, v1, 3, 1
    v_lshl_add_u32 v2, v3, 2, v2
    v_and_b32 v3, 1, v1
    v_lshl_add_u32 v2, v3, 1, v2
    v_add_u32 v2, s36, v2
    s_mul_i32 s36, s31, 7
    s_lshr_b32 s36, s36, 1
    v_bfe_u32 v4, v1, 1, 3
    v_mul_u32_u24 v4, 56, v4
    v_add_u32 v4, s36, v4
    v_lshrrev_b32 v4, 2, v4
    v_add_u32 v4, v4, v3
    v_lshl_add_u32 v4, v4, 1, 0
    v_cmp_gt_u32 vcc, 16, v1
    s_nop 1
    v_cndmask_b32 v2, v4, v2, vcc
    v_cndmask_b32 v19, 1, 2, vcc
    v_lshlrev_b32 v2, 7, v2
    v_add_u32 v7, 74186752, v2
    v_mov_b32 v228, -1
    v_mov_b32 v229, -1
    v_mov_b32 v230, -1
    v_mov_b32 v231, -1
    s_lshl_b32 s3, s2, 2
    s_add_u32 s3, s3, s28
    s_lshl_b32 s3, s3, 12
    s_add_u32 s39, s3, 79691776
    buffer_load_dword v4, v7, s[16:19], 0 offen sc1
    s_mov_b32 s35, 100000
    s_waitcnt vmcnt(0)
    s_branch bk_w4_c
bk_w4:
    s_sleep 4
    buffer_load_dword v4, v7, s[16:19], 0 offen sc1
    s_waitcnt vmcnt(0)
bk_w4_c:
    v_cmp_gt_u32 vcc, v19, v4
    s_sub_u32 s35, s35, 1
    s_cbranch_vccz bk_w4_ok
    s_cmp_lg_u32 s35, 0
    s_cbranch_scc1 bk_w4
bk_w4_ok:
    buffer_load_dwordx4 a[128:131], v9, s[16:19], s52 offen offset:0 sc1
    buffer_load_dwordx4 a[132:135], v9, s[16:19], s52 offen offset:256 sc1
    buffer_load_dwordx4 a[136:139], v9, s[16:19], s52 offen offset:2048 sc1
    buffer_load_dwordx4 a[140:143], v9, s[16:19], s52 offen offset:2304 sc1
    s_add_u32 s52, s52, 4096
    buffer_load_dwordx4 a[144:147], v9, s[16:19], s52 offen offset:0 sc1
    buffer_load_dwordx4 a[148:151], v9, s[16:19], s52 offen offset:256 sc1
    buffer_load_dwordx4 a[152:155], v9, s[16:19], s52 offen offset:2048 sc1
    buffer_load_dwordx4 a[156:159], v9, s[16:19], s52 offen offset:2304 sc1
    s_add_u32 s52, s52, 4096
    s_mov_b32 s3, 0
    buffer_load_dwordx2 v[144:145], v10, s[16:19], s3 offen offset:0 sc1
    buffer_load_dwordx2 v[146:147], v10, s[16:19], s3 offen offset:128 sc1
    s_mov_b32 s3, 65536
    buffer_load_dwordx2 v[148:149], v10, s[16:19], s3 offen offset:0 sc1
    buffer_load_dwordx2 v[150:151], v10, s[16:19], s3 offen offset:128 sc1
    s_mov_b32 s3, 131072
    buffer_load_dwordx2 v[152:153], v10, s[16:19], s3 offen offset:0 sc1
    buffer_load_dwordx2 v[154:155], v10, s[16:19], s3 offen offset:128 sc1
    s_mov_b32 s3, 196608
    buffer_load_dwordx2 v[156:157], v10, s[16:19], s3 offen offset:0 sc1
    buffer_load_dwordx2 v[158:159], v10, s[16:19], s3 offen offset:128 sc1
    s_mov_b32 s3, 0
    buffer_load_dword v160, v22, s[16:19], s3 offen sc1
    s_mov_b32 s3, 14336
    buffer_load_dword v161, v22, s[16:19], s3 offen sc1
    s_mov_b32 s3, 28672
    buffer_load_dword v162, v22, s[16:19], s3 offen sc1
    s_mov_b32 s3, 43008
    buffer_load_dword v163, v22, s[16:19], s3 offen sc1
    s_mov_b32 s3, 57344
    buffer_load_dword v164, v22, s[16:19], s3 offen sc1
    s_mov_b32 s3, 71680
    buffer_load_dword v165, v22, s[16:19], s3 offen sc1
    s_mov_b32 s3, 86016
    buffer_load_dword v166, v22, s[16:19], s3 offen sc1
    s_mov_b32 s3, 100352
    buffer_load_dword v167, v22, s[16:19], s3 offen sc1
    s_waitcnt vmcnt(16)
    s_waitcnt vmcnt(17)
    s_barrier
    ds_read_b64_tr_b16 a[0:1], v216 offset:0
    ds_read_b64_tr_b16 a[2:3], v216 offset:7168
    ds_read_b64_tr_b16 a[4:5], v217 offset:0
    ds_read_b64_tr_b16 a[6:7], v217 offset:7168
    ds_read_b64_tr_b16 a[8:9], v216 offset:64
    ds_read_b64_tr_b16 a[10:11], v216 offset:7232
    ds_read_b64_tr_b16 a[12:13], v217 offset:64
    ds_read_b64_tr_b16 a[14:15], v217 offset:7232
    ds_read_b64_tr_b16 a[16:17], v216 offset:128
    ds_read_b64_tr_b16 a[18:19], v216 offset:7296
    ds_read_b64_tr_b16 a[20:21], v217 offset:128
    ds_read_b64_tr_b16 a[22:23], v217 offset:7296
    ds_read_b64_tr_b16 a[24:25], v216 offset:192
    ds_read_b64_tr_b16 a[26:27], v216 offset:7360
    ds_read_b64_tr_b16 a[28:29], v217 offset:192
    ds_read_b64_tr_b16 a[30:31], v217 offset:7360
    ds_read_b64_tr_b16 a[32:33], v216 offset:256
    ds_read_b64_tr_b16 a[34:35], v216 offset:7424
    ds_read_b64_tr_b16 a[36:37], v217 offset:256
    ds_read_b64_tr_b16 a[38:39], v217 offset:7424
    ds_read_b64_tr_b16 a[40:41], v216 offset:320
    ds_read_b64_tr_b16 a[42:43], v216 offset:7488
    ds_read_b64_tr_b16 a[44:45], v217 offset:320
    ds_read_b64_tr_b16 a[46:47], v217 offset:7488
    ds_read_b64_tr_b16 a[48:49], v216 offset:384
    ds_read_b64_tr_b16 a[50:51], v216 offset:7552
    ds_read_b64_tr_b16 a[52:53], v217 offset:384
    ds_read_b64_tr_b16 a[54:55], v217 offset:7552
    s_waitcnt lgkmcnt(14)
    s_mov_b32 s35, 3
.p2align 6
    s_nop 0
    s_nop 0
bk4_loop:
    v_mfma_f32_16x16x32_bf16 v[32:35], a[0:3], a[128:131], v[32:35]
    ds_read_b64_tr_b16 a[56:57], v216 offset:14336
    ds_read_b64_tr_b16 a[58:59], v216 offset:21504
    v_mfma_f32_16x16x32_bf16 v[36:39], a[0:3], a[132:135], v[36:39]
    ds_read_b64_tr_b16 a[60:61], v217 offset:14336
    ds_read_b64_tr_b16 a[62:63], v217 offset:21504
    v_mfma_f32_16x16x32_bf16 v[40:43], a[4:7], a[128:131], v[40:43]
    buffer_load_dwordx4 a[160:163], v9, s[16:19], s52 offen offset:0 sc1
    v_mfma_f32_16x16x32_bf16 v[44:47], a[4:7], a[132:135], v[44:47]
    ds_read_b64_tr_b16 a[64:65], v216 offset:14400
    v_mfma_f32_16x16x32_bf16 v[48:51], a[8:11], a[128:131], v[48:51]
    ds_read_b64_tr_b16 a[66:67], v216 offset:21568
    ds_read_b64_tr_b16 a[68:69], v217 offset:14400
    v_mfma_f32_16x16x32_bf16 v[52:55], a[8:11], a[132:135], v[52:55]
    ds_read_b64_tr_b16 a[70:71], v217 offset:21568
    v_mfma_f32_16x16x32_bf16 v[56:59], a[12:15], a[128:131], v[56:59]
    ds_read_b64_tr_b16 a[72:73], v216 offset:14464
    ds_read_b64_tr_b16 a[74:75], v216 offset:21632
    v_mfma_f32_16x16x32_bf16 v[60:63], a[12:15], a[132:135], v[60:63]
    buffer_load_dwordx4 a[164:167], v9, s[16:19], s52 offen offset:256 sc1
    v_mfma_f32_16x16x32_bf16 v[64:67], a[16:19], a[128:131], v[64:67]
    ds_read_b64_tr_b16 a[76:77], v217 offset:14464
    v_mfma_f32_16x16x32_bf16 v[68:71], a[16:19], a[132:135], v[68:71]
    ds_read_b64_tr_b16 a[78:79], v217 offset:21632
    v_mfma_f32_16x16x32_bf16 v[72:75], a[20:23], a[128:131], v[72:75]
    ds_read_b64_tr_b16 a[80:81], v216 offset:14528
    v_mfma_f32_16x16x32_bf16 v[76:79], a[20:23], a[132:135], v[76:79]
    s_add_u32 m0, s34, 61440
    ds_read_b64_tr_b16 a[82:83], v216 offset:21696
    ds_read_b64_tr_b16 a[84:85], v217 offset:14528
    v_mfma_f32_16x16x32_bf16 v[80:83], a[24:27], a[128:131], v[80:83]
    s_waitcnt lgkmcnt(15)
    buffer_load_dwordx4 v16, s[8:11], s48 offen offset:0 lds
    v_mfma_f32_16x16x32_bf16 v[84:87], a[24:27], a[132:135], v[84:87]
    ds_read_b64_tr_b16 a[86:87], v217 offset:21696
    v_mfma_f32_16x16x32_bf16 v[88:91], a[28:31], a[128:131], v[88:91]
    ds_read_b64_tr_b16 a[88:89], v216 offset:14592
    v_mfma_f32_16x16x32_bf16 v[92:95], a[28:31], a[132:135], v[92:95]
    ds_read_b64_tr_b16 a[90:91], v216 offset:21760
    v_mfma_f32_16x16x32_bf16 v[96:99], a[32:35], a[128:131], v[96:99]
    ds_read_b64_tr_b16 a[92:93], v217 offset:14592
    ds_read_b64_tr_b16 a[94:95], v217 offset:21760
    v_mfma_f32_16x16x32_bf16 v[100:103], a[32:35], a[132:135], v[100:103]
    buffer_load_dwordx4 v17, s[8:11], s48 offen offset:1024 lds
    v_mfma_f32_16x16x32_bf16 v[104:107], a[36:39], a[128:131], v[104:107]
    ds_read_b64_tr_b16 a[96:97], v216 offset:14656
    v_mfma_f32_16x16x32_bf16 v[108:111], a[36:39], a[132:135], v[108:111]
    ds_read_b64_tr_b16 a[98:99], v216 offset:21824
    v_mfma_f32_16x16x32_bf16 v[112:115], a[40:43], a[128:131], v[112:115]
    ds_read_b64_tr_b16 a[100:101], v217 offset:14656
    v_mfma_f32_16x16x32_bf16 v[116:119], a[40:43], a[132:135], v[116:119]
    ds_read_b64_tr_b16 a[102:103], v217 offset:21824
    ds_read_b64_tr_b16 a[104:105], v216 offset:14720
    v_mfma_f32_16x16x32_bf16 v[120:123], a[44:47], a[128:131], v[120:123]
    buffer_load_dwordx4 v18, s[8:11], s48 offen offset:2048 lds
    v_mfma_f32_16x16x32_bf16 v[124:127], a[44:47], a[132:135], v[124:127]
    s_add_u32 s48, s48, 458752
    ds_read_b64_tr_b16 a[106:107], v216 offset:21888
    v_mfma_f32_16x16x32_bf16 v[128:131], a[48:51], a[128:131], v[128:131]
    ds_read_b64_tr_b16 a[108:109], v217 offset:14720
    v_mfma_f32_16x16x32_bf16 v[132:135], a[48:51], a[132:135], v[132:135]
    ds_read_b64_tr_b16 a[110:111], v217 offset:21888
    v_mfma_f32_16x16x32_bf16 v[136:139], a[52:55], a[128:131], v[136:139]
    v_mfma_f32_16x16x32_bf16 v[140:143], a[52:55], a[132:135], v[140:143]
    s_waitcnt vmcnt(20) lgkmcnt(14)
    s_waitcnt vmcnt(11)
    s_barrier
    v_mfma_f32_16x16x32_bf16 v[32:35], a[56:59], a[136:139], v[32:35]
    ds_read_b64_tr_b16 a[0:1], v216 offset:28672
    ds_read_b64_tr_b16 a[2:3], v216 offset:35840
    v_mfma_f32_16x16x32_bf16 v[36:39], a[56:59], a[140:143], v[36:39]
    ds_read_b64_tr_b16 a[4:5], v217 offset:28672
    ds_read_b64_tr_b16 a[6:7], v217 offset:35840
    v_mfma_f32_16x16x32_bf16 v[40:43], a[60:63], a[136:139], v[40:43]
    buffer_load_dwordx4 a[168:171], v9, s[16:19], s52 offen offset:2048 sc1
    v_mfma_f32_16x16x32_bf16 v[44:47], a[60:63], a[140:143], v[44:47]
    ds_read_b64_tr_b16 a[8:9], v216 offset:28736
    v_mfma_f32_16x16x32_bf16 v[48:51], a[64:67], a[136:139], v[48:51]
    ds_read_b64_tr_b16 a[10:11], v216 offset:35904
    ds_read_b64_tr_b16 a[12:13], v217 offset:28736
    v_mfma_f32_16x16x32_bf16 v[52:55], a[64:67], a[140:143], v[52:55]
    ds_read_b64_tr_b16 a[14:15], v217 offset:35904
    ds_read_b64_tr_b16 a[16:17], v216 offset:28800
    v_mfma_f32_16x16x32_bf16 v[56:59], a[68:71], a[136:139], v[56:59]
    buffer_load_dwordx4 a[172:175], v9, s[16:19], s52 offen offset:2304 sc1
    v_mfma_f32_16x16x32_bf16 v[60:63], a[68:71], a[140:143], v[60:63]
    s_add_u32 s52, s52, 4096
    ds_read_b64_tr_b16 a[18:19], v216 offset:35968
    v_mfma_f32_16x16x32_bf16 v[64:67], a[72:75], a[136:139], v[64:67]
    ds_read_b64_tr_b16 a[20:21], v217 offset:28800
    v_mfma_f32_16x16x32_bf16 v[68:71], a[72:75], a[140:143], v[68:71]
    s_add_u32 m0, s34, 86016
    ds_read_b64_tr_b16 a[22:23], v217 offset:35968
    ds_read_b64_tr_b16 a[24:25], v216 offset:28864
    v_mfma_f32_16x16x32_bf16 v[72:75], a[76:79], a[136:139], v[72:75]
    buffer_load_dwordx4 v12, s[8:11], s48 offen offset:0 lds
    v_mfma_f32_16x16x32_bf16 v[76:79], a[76:79], a[140:143], v[76:79]
    ds_read_b64_tr_b16 a[26:27], v216 offset:36032
    v_mfma_f32_16x16x32_bf16 v[80:83], a[80:83], a[136:139], v[80:83]
    s_waitcnt lgkmcnt(14)
    ds_read_b64_tr_b16 a[28:29], v217 offset:28864
    v_mfma_f32_16x16x32_bf16 v[84:87], a[80:83], a[140:143], v[84:87]
    ds_read_b64_tr_b16 a[30:31], v217 offset:36032
    ds_read_b64_tr_b16 a[32:33], v216 offset:28928
    v_mfma_f32_16x16x32_bf16 v[88:91], a[84:87], a[136:139], v[88:91]
    buffer_load_dwordx4 v13, s[8:11], s48 offen offset:1024 lds
    v_mfma_f32_16x16x32_bf16 v[92:95], a[84:87], a[140:143], v[92:95]
    ds_read_b64_tr_b16 a[34:35], v216 offset:36096
    v_mfma_f32_16x16x32_bf16 v[96:99], a[88:91], a[136:139], v[96:99]
    ds_read_b64_tr_b16 a[36:37], v217 offset:28928
    v_mfma_f32_16x16x32_bf16 v[100:103], a[88:91], a[140:143], v[100:103]
    ds_read_b64_tr_b16 a[38:39], v217 offset:36096
    ds_read_b64_tr_b16 a[40:41], v216 offset:28992
    v_mfma_f32_16x16x32_bf16 v[104:107], a[92:95], a[136:139], v[104:107]
    buffer_load_dwordx4 v14, s[8:11], s48 offen offset:2048 lds
    v_mfma_f32_16x16x32_bf16 v[108:111], a[92:95], a[140:143], v[108:111]
    ds_read_b64_tr_b16 a[42:43], v216 offset:36160
    v_mfma_f32_16x16x32_bf16 v[112:115], a[96:99], a[136:139], v[112:115]
    ds_read_b64_tr_b16 a[44:45], v217 offset:28992
    v_mfma_f32_16x16x32_bf16 v[116:119], a[96:99], a[140:143], v[116:119]
    ds_read_b64_tr_b16 a[46:47], v217 offset:36160
    ds_read_b64_tr_b16 a[48:49], v216 offset:29056
    v_mfma_f32_16x16x32_bf16 v[120:123], a[100:103], a[136:139], v[120:123]
    buffer_load_dwordx4 v15, s[8:11], s48 offen offset:3072 lds
    v_mfma_f32_16x16x32_bf16 v[124:127], a[100:103], a[140:143], v[124:127]
    ds_read_b64_tr_b16 a[50:51], v216 offset:36224
    v_mfma_f32_16x16x32_bf16 v[128:131], a[104:107], a[136:139], v[128:131]
    ds_read_b64_tr_b16 a[52:53], v217 offset:29056
    v_mfma_f32_16x16x32_bf16 v[132:135], a[104:107], a[140:143], v[132:135]
    ds_read_b64_tr_b16 a[54:55], v217 offset:36224
    v_mfma_f32_16x16x32_bf16 v[136:139], a[108:111], a[136:139], v[136:139]
    v_mfma_f32_16x16x32_bf16 v[140:143], a[108:111], a[140:143], v[140:143]
    s_waitcnt lgkmcnt(14)
    v_mfma_f32_16x16x32_bf16 v[32:35], a[0:3], a[144:147], v[32:35]
    ds_read_b64_tr_b16 a[56:57], v216 offset:43008
    ds_read_b64_tr_b16 a[58:59], v216 offset:50176
    v_mfma_f32_16x16x32_bf16 v[36:39], a[0:3], a[148:151], v[36:39]
    ds_read_b64_tr_b16 a[60:61], v217 offset:43008
    ds_read_b64_tr_b16 a[62:63], v217 offset:50176
    v_mfma_f32_16x16x32_bf16 v[40:43], a[4:7], a[144:147], v[40:43]
    buffer_load_dwordx4 a[176:179], v9, s[16:19], s52 offen offset:0 sc1
    v_mfma_f32_16x16x32_bf16 v[44:47], a[4:7], a[148:151], v[44:47]
    ds_read_b64_tr_b16 a[64:65], v216 offset:43072
    v_mfma_f32_16x16x32_bf16 v[48:51], a[8:11], a[144:147], v[48:51]
    ds_read_b64_tr_b16 a[66:67], v216 offset:50240
    ds_read_b64_tr_b16 a[68:69], v217 offset:43072
    v_mfma_f32_16x16x32_bf16 v[52:55], a[8:11], a[148:151], v[52:55]
    ds_read_b64_tr_b16 a[70:71], v217 offset:50240
    v_mfma_f32_16x16x32_bf16 v[56:59], a[12:15], a[144:147], v[56:59]
    ds_read_b64_tr_b16 a[72:73], v216 offset:43136
    ds_read_b64_tr_b16 a[74:75], v216 offset:50304
    v_mfma_f32_16x16x32_bf16 v[60:63], a[12:15], a[148:151], v[60:63]
    buffer_load_dwordx4 a[180:183], v9, s[16:19], s52 offen offset:256 sc1
    v_mfma_f32_16x16x32_bf16 v[64:67], a[16:19], a[144:147], v[64:67]
    ds_read_b64_tr_b16 a[76:77], v217 offset:43136
    v_mfma_f32_16x16x32_bf16 v[68:71], a[16:19], a[148:151], v[68:71]
    ds_read_b64_tr_b16 a[78:79], v217 offset:50304
    v_mfma_f32_16x16x32_bf16 v[72:75], a[20:23], a[144:147], v[72:75]
    ds_read_b64_tr_b16 a[80:81], v216 offset:43200
    v_mfma_f32_16x16x32_bf16 v[76:79], a[20:23], a[148:151], v[76:79]
    s_add_u32 m0, s34, 90112
    ds_read_b64_tr_b16 a[82:83], v216 offset:50368
    ds_read_b64_tr_b16 a[84:85], v217 offset:43200
    v_mfma_f32_16x16x32_bf16 v[80:83], a[24:27], a[144:147], v[80:83]
    s_waitcnt lgkmcnt(15)
    buffer_load_dwordx4 v16, s[8:11], s48 offen offset:0 lds
    v_mfma_f32_16x16x32_bf16 v[84:87], a[24:27], a[148:151], v[84:87]
    ds_read_b64_tr_b16 a[86:87], v217 offset:50368
    v_mfma_f32_16x16x32_bf16 v[88:91], a[28:31], a[144:147], v[88:91]
    ds_read_b64_tr_b16 a[88:89], v216 offset:43264
    v_mfma_f32_16x16x32_bf16 v[92:95], a[28:31], a[148:151], v[92:95]
    ds_read_b64_tr_b16 a[90:91], v216 offset:50432
    v_mfma_f32_16x16x32_bf16 v[96:99], a[32:35], a[144:147], v[96:99]
    ds_read_b64_tr_b16 a[92:93], v217 offset:43264
    ds_read_b64_tr_b16 a[94:95], v217 offset:50432
    v_mfma_f32_16x16x32_bf16 v[100:103], a[32:35], a[148:151], v[100:103]
    buffer_load_dwordx4 v17, s[8:11], s48 offen offset:1024 lds
    v_mfma_f32_16x16x32_bf16 v[104:107], a[36:39], a[144:147], v[104:107]
    ds_read_b64_tr_b16 a[96:97], v216 offset:43328
    v_mfma_f32_16x16x32_bf16 v[108:111], a[36:39], a[148:151], v[108:111]
    ds_read_b64_tr_b16 a[98:99], v216 offset:50496
    v_mfma_f32_16x16x32_bf16 v[112:115], a[40:43], a[144:147], v[112:115]
    ds_read_b64_tr_b16 a[100:101], v217 offset:43328
    v_mfma_f32_16x16x32_bf16 v[116:119], a[40:43], a[148:151], v[116:119]
    ds_read_b64_tr_b16 a[102:103], v217 offset:50496
    ds_read_b64_tr_b16 a[104:105], v216 offset:43392
    v_mfma_f32_16x16x32_bf16 v[120:123], a[44:47], a[144:147], v[120:123]
    buffer_load_dwordx4 v18, s[8:11], s48 offen offset:2048 lds
    v_mfma_f32_16x16x32_bf16 v[124:127], a[44:47], a[148:151], v[124:127]
    s_add_u32 s48, s48, 458752
    ds_read_b64_tr_b16 a[106:107], v216 offset:50560
    v_mfma_f32_16x16x32_bf16 v[128:131], a[48:51], a[144:147], v[128:131]
    ds_read_b64_tr_b16 a[108:109], v217 offset:43392
    v_mfma_f32_16x16x32_bf16 v[132:135], a[48:51], a[148:151], v[132:135]
    ds_read_b64_tr_b16 a[110:111], v217 offset:50560
    v_mfma_f32_16x16x32_bf16 v[136:139], a[52:55], a[144:147], v[136:139]
    v_mfma_f32_16x16x32_bf16 v[140:143], a[52:55], a[148:151], v[140:143]
    s_waitcnt vmcnt(20) lgkmcnt(14)
    s_waitcnt vmcnt(11)
    s_barrier
    v_mfma_f32_16x16x32_bf16 v[32:35], a[56:59], a[152:155], v[32:35]
    ds_read_b64_tr_b16 a[0:1], v218 offset:0
    ds_read_b64_tr_b16 a[2:3], v218 offset:7168
    v_mfma_f32_16x16x32_bf16 v[36:39], a[56:59], a[156:159], v[36:39]
    ds_read_b64_tr_b16 a[4:5], v219 offset:0
    ds_read_b64_tr_b16 a[6:7], v219 offset:7168
    v_mfma_f32_16x16x32_bf16 v[40:43], a[60:63], a[152:155], v[40:43]
    buffer_load_dwordx4 a[184:187], v9, s[16:19], s52 offen offset:2048 sc1
    v_mfma_f32_16x16x32_bf16 v[44:47], a[60:63], a[156:159], v[44:47]
    ds_read_b64_tr_b16 a[8:9], v218 offset:64
    v_mfma_f32_16x16x32_bf16 v[48:51], a[64:67], a[152:155], v[48:51]
    ds_read_b64_tr_b16 a[10:11], v218 offset:7232
    ds_read_b64_tr_b16 a[12:13], v219 offset:64
    v_mfma_f32_16x16x32_bf16 v[52:55], a[64:67], a[156:159], v[52:55]
    ds_read_b64_tr_b16 a[14:15], v219 offset:7232
    ds_read_b64_tr_b16 a[16:17], v218 offset:128
    v_mfma_f32_16x16x32_bf16 v[56:59], a[68:71], a[152:155], v[56:59]
    buffer_load_dwordx4 a[188:191], v9, s[16:19], s52 offen offset:2304 sc1
    v_mfma_f32_16x16x32_bf16 v[60:63], a[68:71], a[156:159], v[60:63]
    s_add_u32 s52, s52, 4096
    ds_read_b64_tr_b16 a[18:19], v218 offset:7296
    v_mfma_f32_16x16x32_bf16 v[64:67], a[72:75], a[152:155], v[64:67]
    ds_read_b64_tr_b16 a[20:21], v219 offset:128
    v_mfma_f32_16x16x32_bf16 v[68:71], a[72:75], a[156:159], v[68:71]
    s_add_u32 m0, s34, 0
    ds_read_b64_tr_b16 a[22:23], v219 offset:7296
    ds_read_b64_tr_b16 a[24:25], v218 offset:192
    v_mfma_f32_16x16x32_bf16 v[72:75], a[76:79], a[152:155], v[72:75]
    buffer_load_dwordx4 v12, s[8:11], s48 offen offset:0 lds
    v_mfma_f32_16x16x32_bf16 v[76:79], a[76:79], a[156:159], v[76:79]
    ds_read_b64_tr_b16 a[26:27], v218 offset:7360
    v_mfma_f32_16x16x32_bf16 v[80:83], a[80:83], a[152:155], v[80:83]
    s_waitcnt lgkmcnt(14)
    ds_read_b64_tr_b16 a[28:29], v219 offset:192
    v_mfma_f32_16x16x32_bf16 v[84:87], a[80:83], a[156:159], v[84:87]
    ds_read_b64_tr_b16 a[30:31], v219 offset:7360
    ds_read_b64_tr_b16 a[32:33], v218 offset:256
    v_mfma_f32_16x16x32_bf16 v[88:91], a[84:87], a[152:155], v[88:91]
    buffer_load_dwordx4 v13, s[8:11], s48 offen offset:1024 lds
    v_mfma_f32_16x16x32_bf16 v[92:95], a[84:87], a[156:159], v[92:95]
    ds_read_b64_tr_b16 a[34:35], v218 offset:7424
    v_mfma_f32_16x16x32_bf16 v[96:99], a[88:91], a[152:155], v[96:99]
    ds_read_b64_tr_b16 a[36:37], v219 offset:256
    v_mfma_f32_16x16x32_bf16 v[100:103], a[88:91], a[156:159], v[100:103]
    ds_read_b64_tr_b16 a[38:39], v219 offset:7424
    ds_read_b64_tr_b16 a[40:41], v218 offset:320
    v_mfma_f32_16x16x32_bf16 v[104:107], a[92:95], a[152:155], v[104:107]
    buffer_load_dwordx4 v14, s[8:11], s48 offen offset:2048 lds
    v_mfma_f32_16x16x32_bf16 v[108:111], a[92:95], a[156:159], v[108:111]
    ds_read_b64_tr_b16 a[42:43], v218 offset:7488
    v_mfma_f32_16x16x32_bf16 v[112:115], a[96:99], a[152:155], v[112:115]
    ds_read_b64_tr_b16 a[44:45], v219 offset:320
    v_mfma_f32_16x16x32_bf16 v[116:119], a[96:99], a[156:159], v[116:119]
    ds_read_b64_tr_b16 a[46:47], v219 offset:7488
    ds_read_b64_tr_b16 a[48:49], v218 offset:384
    v_mfma_f32_16x16x32_bf16 v[120:123], a[100:103], a[152:155], v[120:123]
    buffer_load_dwordx4 v15, s[8:11], s48 offen offset:3072 lds
    v_mfma_f32_16x16x32_bf16 v[124:127], a[100:103], a[156:159], v[124:127]
    ds_read_b64_tr_b16 a[50:51], v218 offset:7552
    v_mfma_f32_16x16x32_bf16 v[128:131], a[104:107], a[152:155], v[128:131]
    ds_read_b64_tr_b16 a[52:53], v219 offset:384
    v_mfma_f32_16x16x32_bf16 v[132:135], a[104:107], a[156:159], v[132:135]
    ds_read_b64_tr_b16 a[54:55], v219 offset:7552
    v_mfma_f32_16x16x32_bf16 v[136:139], a[108:111], a[152:155], v[136:139]
    v_mfma_f32_16x16x32_bf16 v[140:143], a[108:111], a[156:159], v[140:143]
    s_waitcnt lgkmcnt(14)
    v_mfma_f32_16x16x32_bf16 v[32:35], a[0:3], a[160:163], v[32:35]
    ds_read_b64_tr_b16 a[56:57], v218 offset:14336
    ds_read_b64_tr_b16 a[58:59], v218 offset:21504
    v_mfma_f32_16x16x32_bf16 v[36:39], a[0:3], a[164:167], v[36:39]
    ds_read_b64_tr_b16 a[60:61], v219 offset:14336
    ds_read_b64_tr_b16 a[62:63], v219 offset:21504
    v_mfma_f32_16x16x32_bf16 v[40:43], a[4:7], a[160:163], v[40:43]
    buffer_load_dwordx4 a[128:131], v9, s[16:19], s52 offen offset:0 sc1
    v_mfma_f32_16x16x32_bf16 v[44:47], a[4:7], a[164:167], v[44:47]
    ds_read_b64_tr_b16 a[64:65], v218 offset:14400
    v_mfma_f32_16x16x32_bf16 v[48:51], a[8:11], a[160:163], v[48:51]
    ds_read_b64_tr_b16 a[66:67], v218 offset:21568
    ds_read_b64_tr_b16 a[68:69], v219 offset:14400
    v_mfma_f32_16x16x32_bf16 v[52:55], a[8:11], a[164:167], v[52:55]
    ds_read_b64_tr_b16 a[70:71], v219 offset:21568
    v_mfma_f32_16x16x32_bf16 v[56:59], a[12:15], a[160:163], v[56:59]
    ds_read_b64_tr_b16 a[72:73], v218 offset:14464
    ds_read_b64_tr_b16 a[74:75], v218 offset:21632
    v_mfma_f32_16x16x32_bf16 v[60:63], a[12:15], a[164:167], v[60:63]
    buffer_load_dwordx4 a[132:135], v9, s[16:19], s52 offen offset:256 sc1
    v_mfma_f32_16x16x32_bf16 v[64:67], a[16:19], a[160:163], v[64:67]
    ds_read_b64_tr_b16 a[76:77], v219 offset:14464
    v_mfma_f32_16x16x32_bf16 v[68:71], a[16:19], a[164:167], v[68:71]
    ds_read_b64_tr_b16 a[78:79], v219 offset:21632
    v_mfma_f32_16x16x32_bf16 v[72:75], a[20:23], a[160:163], v[72:75]
    ds_read_b64_tr_b16 a[80:81], v218 offset:14528
    v_mfma_f32_16x16x32_bf16 v[76:79], a[20:23], a[164:167], v[76:79]
    s_add_u32 m0, s34, 4096
    ds_read_b64_tr_b16 a[82:83], v218 offset:21696
    ds_read_b64_tr_b16 a[84:85], v219 offset:14528
    v_mfma_f32_16x16x32_bf16 v[80:83], a[24:27], a[160:163], v[80:83]
    s_waitcnt lgkmcnt(15)
    buffer_load_dwordx4 v16, s[8:11], s48 offen offset:0 lds
    v_mfma_f32_16x16x32_bf16 v[84:87], a[24:27], a[164:167], v[84:87]
    ds_read_b64_tr_b16 a[86:87], v219 offset:21696
    v_mfma_f32_16x16x32_bf16 v[88:91], a[28:31], a[160:163], v[88:91]
    ds_read_b64_tr_b16 a[88:89], v218 offset:14592
    v_mfma_f32_16x16x32_bf16 v[92:95], a[28:31], a[164:167], v[92:95]
    ds_read_b64_tr_b16 a[90:91], v218 offset:21760
    v_mfma_f32_16x16x32_bf16 v[96:99], a[32:35], a[160:163], v[96:99]
    ds_read_b64_tr_b16 a[92:93], v219 offset:14592
    ds_read_b64_tr_b16 a[94:95], v219 offset:21760
    v_mfma_f32_16x16x32_bf16 v[100:103], a[32:35], a[164:167], v[100:103]
    buffer_load_dwordx4 v17, s[8:11], s48 offen offset:1024 lds
    v_mfma_f32_16x16x32_bf16 v[104:107], a[36:39], a[160:163], v[104:107]
    ds_read_b64_tr_b16 a[96:97], v218 offset:14656
    v_mfma_f32_16x16x32_bf16 v[108:111], a[36:39], a[164:167], v[108:111]
    ds_read_b64_tr_b16 a[98:99], v218 offset:21824
    v_mfma_f32_16x16x32_bf16 v[112:115], a[40:43], a[160:163], v[112:115]
    ds_read_b64_tr_b16 a[100:101], v219 offset:14656
    v_mfma_f32_16x16x32_bf16 v[116:119], a[40:43], a[164:167], v[116:119]
    ds_read_b64_tr_b16 a[102:103], v219 offset:21824
    ds_read_b64_tr_b16 a[104:105], v218 offset:14720
    v_mfma_f32_16x16x32_bf16 v[120:123], a[44:47], a[160:163], v[120:123]
    buffer_load_dwordx4 v18, s[8:11], s48 offen offset:2048 lds
    v_mfma_f32_16x16x32_bf16 v[124:127], a[44:47], a[164:167], v[124:127]
    s_add_u32 s48, s48, 458752
    ds_read_b64_tr_b16 a[106:107], v218 offset:21888
    v_mfma_f32_16x16x32_bf16 v[128:131], a[48:51], a[160:163], v[128:131]
    ds_read_b64_tr_b16 a[108:109], v219 offset:14720
    v_mfma_f32_16x16x32_bf16 v[132:135], a[48:51], a[164:167], v[132:135]
    ds_read_b64_tr_b16 a[110:111], v219 offset:21888
    v_mfma_f32_16x16x32_bf16 v[136:139], a[52:55], a[160:163], v[136:139]
    v_mfma_f32_16x16x32_bf16 v[140:143], a[52:55], a[164:167], v[140:143]
    s_waitcnt vmcnt(20) lgkmcnt(14)
    s_waitcnt vmcnt(11)
    s_barrier
    v_mfma_f32_16x16x32_bf16 v[32:35], a[56:59], a[168:171], v[32:35]
    ds_read_b64_tr_b16 a[0:1], v218 offset:28672
    ds_read_b64_tr_b16 a[2:3], v218 offset:35840
    v_mfma_f32_16x16x32_bf16 v[36:39], a[56:59], a[172:175], v[36:39]
    ds_read_b64_tr_b16 a[4:5], v219 offset:28672
    ds_read_b64_tr_b16 a[6:7], v219 offset:35840
    v_mfma_f32_16x16x32_bf16 v[40:43], a[60:63], a[168:171], v[40:43]
    buffer_load_dwordx4 a[136:139], v9, s[16:19], s52 offen offset:2048 sc1
    v_mfma_f32_16x16x32_bf16 v[44:47], a[60:63], a[172:175], v[44:47]
    ds_read_b64_tr_b16 a[8:9], v218 offset:28736
    v_mfma_f32_16x16x32_bf16 v[48:51], a[64:67], a[168:171], v[48:51]
    ds_read_b64_tr_b16 a[10:11], v218 offset:35904
    ds_read_b64_tr_b16 a[12:13], v219 offset:28736
    v_mfma_f32_16x16x32_bf16 v[52:55], a[64:67], a[172:175], v[52:55]
    ds_read_b64_tr_b16 a[14:15], v219 offset:35904
    ds_read_b64_tr_b16 a[16:17], v218 offset:28800
    v_mfma_f32_16x16x32_bf16 v[56:59], a[68:71], a[168:171], v[56:59]
    buffer_load_dwordx4 a[140:143], v9, s[16:19], s52 offen offset:2304 sc1
    v_mfma_f32_16x16x32_bf16 v[60:63], a[68:71], a[172:175], v[60:63]
    s_add_u32 s52, s52, 4096
    ds_read_b64_tr_b16 a[18:19], v218 offset:35968
    v_mfma_f32_16x16x32_bf16 v[64:67], a[72:75], a[168:171], v[64:67]
    ds_read_b64_tr_b16 a[20:21], v219 offset:28800
    v_mfma_f32_16x16x32_bf16 v[68:71], a[72:75], a[172:175], v[68:71]
    s_add_u32 m0, s34, 28672
    ds_read_b64_tr_b16 a[22:23], v219 offset:35968
    ds_read_b64_tr_b16 a[24:25], v218 offset:28864
    v_mfma_f32_16x16x32_bf16 v[72:75], a[76:79], a[168:171], v[72:75]
    buffer_load_dwordx4 v12, s[8:11], s48 offen offset:0 lds
    v_mfma_f32_16x16x32_bf16 v[76:79], a[76:79], a[172:175], v[76:79]
    ds_read_b64_tr_b16 a[26:27], v218 offset:36032
    v_mfma_f32_16x16x32_bf16 v[80:83], a[80:83], a[168:171], v[80:83]
    s_waitcnt lgkmcnt(14)
    ds_read_b64_tr_b16 a[28:29], v219 offset:28864
    v_mfma_f32_16x16x32_bf16 v[84:87], a[80:83], a[172:175], v[84:87]
    ds_read_b64_tr_b16 a[30:31], v219 offset:36032
    ds_read_b64_tr_b16 a[32:33], v218 offset:28928
    v_mfma_f32_16x16x32_bf16 v[88:91], a[84:87], a[168:171], v[88:91]
    buffer_load_dwordx4 v13, s[8:11], s48 offen offset:1024 lds
    v_mfma_f32_16x16x32_bf16 v[92:95], a[84:87], a[172:175], v[92:95]
    ds_read_b64_tr_b16 a[34:35], v218 offset:36096
    v_mfma_f32_16x16x32_bf16 v[96:99], a[88:91], a[168:171], v[96:99]
    ds_read_b64_tr_b16 a[36:37], v219 offset:28928
    v_mfma_f32_16x16x32_bf16 v[100:103], a[88:91], a[172:175], v[100:103]
    ds_read_b64_tr_b16 a[38:39], v219 offset:36096
    ds_read_b64_tr_b16 a[40:41], v218 offset:28992
    v_mfma_f32_16x16x32_bf16 v[104:107], a[92:95], a[168:171], v[104:107]
    buffer_load_dwordx4 v14, s[8:11], s48 offen offset:2048 lds
    v_mfma_f32_16x16x32_bf16 v[108:111], a[92:95], a[172:175], v[108:111]
    ds_read_b64_tr_b16 a[42:43], v218 offset:36160
    v_mfma_f32_16x16x32_bf16 v[112:115], a[96:99], a[168:171], v[112:115]
    ds_read_b64_tr_b16 a[44:45], v219 offset:28992
    v_mfma_f32_16x16x32_bf16 v[116:119], a[96:99], a[172:175], v[116:119]
    ds_read_b64_tr_b16 a[46:47], v219 offset:36160
    ds_read_b64_tr_b16 a[48:49], v218 offset:29056
    v_mfma_f32_16x16x32_bf16 v[120:123], a[100:103], a[168:171], v[120:123]
    buffer_load_dwordx4 v15, s[8:11], s48 offen offset:3072 lds
    v_mfma_f32_16x16x32_bf16 v[124:127], a[100:103], a[172:175], v[124:127]
    ds_read_b64_tr_b16 a[50:51], v218 offset:36224
    v_mfma_f32_16x16x32_bf16 v[128:131], a[104:107], a[168:171], v[128:131]
    ds_read_b64_tr_b16 a[52:53], v219 offset:29056
    v_mfma_f32_16x16x32_bf16 v[132:135], a[104:107], a[172:175], v[132:135]
    ds_read_b64_tr_b16 a[54:55], v219 offset:36224
    v_mfma_f32_16x16x32_bf16 v[136:139], a[108:111], a[168:171], v[136:139]
    v_mfma_f32_16x16x32_bf16 v[140:143], a[108:111], a[172:175], v[140:143]
    s_waitcnt lgkmcnt(14)
    v_mfma_f32_16x16x32_bf16 v[32:35], a[0:3], a[176:179], v[32:35]
    ds_read_b64_tr_b16 a[56:57], v218 offset:43008
    ds_read_b64_tr_b16 a[58:59], v218 offset:50176
    v_mfma_f32_16x16x32_bf16 v[36:39], a[0:3], a[180:183], v[36:39]
    ds_read_b64_tr_b16 a[60:61], v219 offset:43008
    ds_read_b64_tr_b16 a[62:63], v219 offset:50176
    v_mfma_f32_16x16x32_bf16 v[40:43], a[4:7], a[176:179], v[40:43]
    buffer_load_dwordx4 a[144:147], v9, s[16:19], s52 offen offset:0 sc1
    v_mfma_f32_16x16x32_bf16 v[44:47], a[4:7], a[180:183], v[44:47]
    ds_read_b64_tr_b16 a[64:65], v218 offset:43072
    v_mfma_f32_16x16x32_bf16 v[48:51], a[8:11], a[176:179], v[48:51]
    ds_read_b64_tr_b16 a[66:67], v218 offset:50240
    ds_read_b64_tr_b16 a[68:69], v219 offset:43072
    v_mfma_f32_16x16x32_bf16 v[52:55], a[8:11], a[180:183], v[52:55]
    ds_read_b64_tr_b16 a[70:71], v219 offset:50240
    v_mfma_f32_16x16x32_bf16 v[56:59], a[12:15], a[176:179], v[56:59]
    ds_read_b64_tr_b16 a[72:73], v218 offset:43136
    ds_read_b64_tr_b16 a[74:75], v218 offset:50304
    v_mfma_f32_16x16x32_bf16 v[60:63], a[12:15], a[180:183], v[60:63]
    buffer_load_dwordx4 a[148:151], v9, s[16:19], s52 offen offset:256 sc1
    v_mfma_f32_16x16x32_bf16 v[64:67], a[16:19], a[176:179], v[64:67]
    ds_read_b64_tr_b16 a[76:77], v219 offset:43136
    v_mfma_f32_16x16x32_bf16 v[68:71], a[16:19], a[180:183], v[68:71]
    ds_read_b64_tr_b16 a[78:79], v219 offset:50304
    v_mfma_f32_16x16x32_bf16 v[72:75], a[20:23], a[176:179], v[72:75]
    ds_read_b64_tr_b16 a[80:81], v218 offset:43200
    v_mfma_f32_16x16x32_bf16 v[76:79], a[20:23], a[180:183], v[76:79]
    s_add_u32 m0, s34, 32768
    ds_read_b64_tr_b16 a[82:83], v218 offset:50368
    ds_read_b64_tr_b16 a[84:85], v219 offset:43200
    v_mfma_f32_16x16x32_bf16 v[80:83], a[24:27], a[176:179], v[80:83]
    s_waitcnt lgkmcnt(15)
    buffer_load_dwordx4 v16, s[8:11], s48 offen offset:0 lds
    v_mfma_f32_16x16x32_bf16 v[84:87], a[24:27], a[180:183], v[84:87]
    ds_read_b64_tr_b16 a[86:87], v219 offset:50368
    v_mfma_f32_16x16x32_bf16 v[88:91], a[28:31], a[176:179], v[88:91]
    ds_read_b64_tr_b16 a[88:89], v218 offset:43264
    v_mfma_f32_16x16x32_bf16 v[92:95], a[28:31], a[180:183], v[92:95]
    ds_read_b64_tr_b16 a[90:91], v218 offset:50432
    v_mfma_f32_16x16x32_bf16 v[96:99], a[32:35], a[176:179], v[96:99]
    ds_read_b64_tr_b16 a[92:93], v219 offset:43264
    ds_read_b64_tr_b16 a[94:95], v219 offset:50432
    v_mfma_f32_16x16x32_bf16 v[100:103], a[32:35], a[180:183], v[100:103]
    buffer_load_dwordx4 v17, s[8:11], s48 offen offset:1024 lds
    v_mfma_f32_16x16x32_bf16 v[104:107], a[36:39], a[176:179], v[104:107]
    ds_read_b64_tr_b16 a[96:97], v218 offset:43328
    v_mfma_f32_16x16x32_bf16 v[108:111], a[36:39], a[180:183], v[108:111]
    ds_read_b64_tr_b16 a[98:99], v218 offset:50496
    v_mfma_f32_16x16x32_bf16 v[112:115], a[40:43], a[176:179], v[112:115]
    ds_read_b64_tr_b16 a[100:101], v219 offset:43328
    v_mfma_f32_16x16x32_bf16 v[116:119], a[40:43], a[180:183], v[116:119]
    ds_read_b64_tr_b16 a[102:103], v219 offset:50496
    ds_read_b64_tr_b16 a[104:105], v218 offset:43392
    v_mfma_f32_16x16x32_bf16 v[120:123], a[44:47], a[176:179], v[120:123]
    buffer_load_dwordx4 v18, s[8:11], s48 offen offset:2048 lds
    v_mfma_f32_16x16x32_bf16 v[124:127], a[44:47], a[180:183], v[124:127]
    s_add_u32 s48, s48, 458752
    ds_read_b64_tr_b16 a[106:107], v218 offset:50560
    v_mfma_f32_16x16x32_bf16 v[128:131], a[48:51], a[176:179], v[128:131]
    ds_read_b64_tr_b16 a[108:109], v219 offset:43392
    v_mfma_f32_16x16x32_bf16 v[132:135], a[48:51], a[180:183], v[132:135]
    ds_read_b64_tr_b16 a[110:111], v219 offset:50560
    v_mfma_f32_16x16x32_bf16 v[136:139], a[52:55], a[176:179], v[136:139]
    v_mfma_f32_16x16x32_bf16 v[140:143], a[52:55], a[180:183], v[140:143]
    s_waitcnt vmcnt(20) lgkmcnt(14)
    s_waitcnt vmcnt(11)
    s_barrier
    v_mfma_f32_16x16x32_bf16 v[32:35], a[56:59], a[184:187], v[32:35]
    ds_read_b64_tr_b16 a[0:1], v216 offset:0
    ds_read_b64_tr_b16 a[2:3], v216 offset:7168
    v_mfma_f32_16x16x32_bf16 v[36:39], a[56:59], a[188:191], v[36:39]
    ds_read_b64_tr_b16 a[4:5], v217 offset:0
    ds_read_b64_tr_b16 a[6:7], v217 offset:7168
    v_mfma_f32_16x16x32_bf16 v[40:43], a[60:63], a[184:187], v[40:43]
    buffer_load_dwordx4 a[152:155], v9, s[16:19], s52 offen offset:2048 sc1
    v_mfma_f32_16x16x32_bf16 v[44:47], a[60:63], a[188:191], v[44:47]
    ds_read_b64_tr_b16 a[8:9], v216 offset:64
    v_mfma_f32_16x16x32_bf16 v[48:51], a[64:67], a[184:187], v[48:51]
    ds_read_b64_tr_b16 a[10:11], v216 offset:7232
    ds_read_b64_tr_b16 a[12:13], v217 offset:64
    v_mfma_f32_16x16x32_bf16 v[52:55], a[64:67], a[188:191], v[52:55]
    ds_read_b64_tr_b16 a[14:15], v217 offset:7232
    ds_read_b64_tr_b16 a[16:17], v216 offset:128
    v_mfma_f32_16x16x32_bf16 v[56:59], a[68:71], a[184:187], v[56:59]
    buffer_load_dwordx4 a[156:159], v9, s[16:19], s52 offen offset:2304 sc1
    v_mfma_f32_16x16x32_bf16 v[60:63], a[68:71], a[188:191], v[60:63]
    s_add_u32 s52, s52, 4096
    ds_read_b64_tr_b16 a[18:19], v216 offset:7296
    v_mfma_f32_16x16x32_bf16 v[64:67], a[72:75], a[184:187], v[64:67]
    ds_read_b64_tr_b16 a[20:21], v217 offset:128
    v_mfma_f32_16x16x32_bf16 v[68:71], a[72:75], a[188:191], v[68:71]
    s_add_u32 m0, s34, 57344
    ds_read_b64_tr_b16 a[22:23], v217 offset:7296
    ds_read_b64_tr_b16 a[24:25], v216 offset:192
    v_mfma_f32_16x16x32_bf16 v[72:75], a[76:79], a[184:187], v[72:75]
    buffer_load_dwordx4 v12, s[8:11], s48 offen offset:0 lds
    v_mfma_f32_16x16x32_bf16 v[76:79], a[76:79], a[188:191], v[76:79]
    ds_read_b64_tr_b16 a[26:27], v216 offset:7360
    v_mfma_f32_16x16x32_bf16 v[80:83], a[80:83], a[184:187], v[80:83]
    s_waitcnt lgkmcnt(14)
    ds_read_b64_tr_b16 a[28:29], v217 offset:192
    v_mfma_f32_16x16x32_bf16 v[84:87], a[80:83], a[188:191], v[84:87]
    ds_read_b64_tr_b16 a[30:31], v217 offset:7360
    ds_read_b64_tr_b16 a[32:33], v216 offset:256
    v_mfma_f32_16x16x32_bf16 v[88:91], a[84:87], a[184:187], v[88:91]
    buffer_load_dwordx4 v13, s[8:11], s48 offen offset:1024 lds
    v_mfma_f32_16x16x32_bf16 v[92:95], a[84:87], a[188:191], v[92:95]
    ds_read_b64_tr_b16 a[34:35], v216 offset:7424
    v_mfma_f32_16x16x32_bf16 v[96:99], a[88:91], a[184:187], v[96:99]
    ds_read_b64_tr_b16 a[36:37], v217 offset:256
    v_mfma_f32_16x16x32_bf16 v[100:103], a[88:91], a[188:191], v[100:103]
    ds_read_b64_tr_b16 a[38:39], v217 offset:7424
    ds_read_b64_tr_b16 a[40:41], v216 offset:320
    v_mfma_f32_16x16x32_bf16 v[104:107], a[92:95], a[184:187], v[104:107]
    buffer_load_dwordx4 v14, s[8:11], s48 offen offset:2048 lds
    v_mfma_f32_16x16x32_bf16 v[108:111], a[92:95], a[188:191], v[108:111]
    ds_read_b64_tr_b16 a[42:43], v216 offset:7488
    v_mfma_f32_16x16x32_bf16 v[112:115], a[96:99], a[184:187], v[112:115]
    ds_read_b64_tr_b16 a[44:45], v217 offset:320
    v_mfma_f32_16x16x32_bf16 v[116:119], a[96:99], a[188:191], v[116:119]
    ds_read_b64_tr_b16 a[46:47], v217 offset:7488
    ds_read_b64_tr_b16 a[48:49], v216 offset:384
    v_mfma_f32_16x16x32_bf16 v[120:123], a[100:103], a[184:187], v[120:123]
    buffer_load_dwordx4 v15, s[8:11], s48 offen offset:3072 lds
    v_mfma_f32_16x16x32_bf16 v[124:127], a[100:103], a[188:191], v[124:127]
    ds_read_b64_tr_b16 a[50:51], v216 offset:7552
    v_mfma_f32_16x16x32_bf16 v[128:131], a[104:107], a[184:187], v[128:131]
    ds_read_b64_tr_b16 a[52:53], v217 offset:384
    v_mfma_f32_16x16x32_bf16 v[132:135], a[104:107], a[188:191], v[132:135]
    ds_read_b64_tr_b16 a[54:55], v217 offset:7552
    v_mfma_f32_16x16x32_bf16 v[136:139], a[108:111], a[184:187], v[136:139]
    v_mfma_f32_16x16x32_bf16 v[140:143], a[108:111], a[188:191], v[140:143]
    s_waitcnt lgkmcnt(14)
    s_sub_u32 s35, s35, 1
    s_cmp_lg_u32 s35, 0
    s_cbranch_scc1 bk4_loop
    v_mfma_f32_16x16x32_bf16 v[32:35], a[0:3], a[128:131], v[32:35]
    ds_read_b64_tr_b16 a[56:57], v216 offset:14336
    ds_read_b64_tr_b16 a[58:59], v216 offset:21504
    s_getpc_b64 s[56:57]
    v_mfma_f32_16x16x32_bf16 v[36:39], a[0:3], a[132:135], v[36:39]
    ds_read_b64_tr_b16 a[60:61], v217 offset:14336
    ds_read_b64_tr_b16 a[62:63], v217 offset:21504
ct_5:
    v_mfma_f32_16x16x32_bf16 v[40:43], a[4:7], a[128:131], v[40:43]
    buffer_load_dwordx4 a[160:163], v9, s[16:19], s52 offen offset:0 sc1
    v_mfma_f32_16x16x32_bf16 v[44:47], a[4:7], a[132:135], v[44:47]
    ds_read_b64_tr_b16 a[64:65], v216 offset:14400
    s_add_u32 s56, s56, back_p5-ct_5
    v_mfma_f32_16x16x32_bf16 v[48:51], a[8:11], a[128:131], v[48:51]
    ds_read_b64_tr_b16 a[66:67], v216 offset:21568
    ds_read_b64_tr_b16 a[68:69], v217 offset:14400
    s_addc_u32 s57, s57, 0
    v_mfma_f32_16x16x32_bf16 v[52:55], a[8:11], a[132:135], v[52:55]
    ds_read_b64_tr_b16 a[70:71], v217 offset:21568
    s_lshr_b32 s58, s2, 3
    s_lshl_b32 s58, s58, 9
    v_mfma_f32_16x16x32_bf16 v[56:59], a[12:15], a[128:131], v[56:59]
    ds_read_b64_tr_b16 a[72:73], v216 offset:14464
    ds_read_b64_tr_b16 a[74:75], v216 offset:21632
    v_mfma_f32_16x16x32_bf16 v[60:63], a[12:15], a[132:135], v[60:63]
    buffer_load_dwordx4 a[164:167], v9, s[16:19], s52 offen offset:256 sc1
    v_mfma_f32_16x16x32_bf16 v[64:67], a[16:19], a[128:131], v[64:67]
    ds_read_b64_tr_b16 a[76:77], v217 offset:14464
    v_and_b32 v5, 3, v0
    v_mfma_f32_16x16x32_bf16 v[68:71], a[16:19], a[132:135], v[68:71]
    ds_read_b64_tr_b16 a[78:79], v217 offset:21632
    v_lshl_add_u32 v5, v5, 7, s58
    v_min_u32 v5, all_code_end-back_p5-4, v5
    v_mfma_f32_16x16x32_bf16 v[72:75], a[20:23], a[128:131], v[72:75]
    ds_read_b64_tr_b16 a[80:81], v216 offset:14528
    global_load_dword v5, v5, s[56:57]
    v_mfma_f32_16x16x32_bf16 v[76:79], a[20:23], a[132:135], v[76:79]
    s_add_u32 m0, s34, 61440
    ds_read_b64_tr_b16 a[82:83], v216 offset:21696
    ds_read_b64_tr_b16 a[84:85], v217 offset:14528
    v_mfma_f32_16x16x32_bf16 v[80:83], a[24:27], a[128:131], v[80:83]
    s_waitcnt lgkmcnt(15)
    buffer_load_dwordx4 v16, s[8:11], s48 offen offset:0 lds
    v_mfma_f32_16x16x32_bf16 v[84:87], a[24:27], a[132:135], v[84:87]
    ds_read_b64_tr_b16 a[86:87], v217 offset:21696
    v_mfma_f32_16x16x32_bf16 v[88:91], a[28:31], a[128:131], v[88:91]
    ds_read_b64_tr_b16 a[88:89], v216 offset:14592
    v_add_f32 v160, v160, v161
    v_add_f32 v160, v160, v162
    v_mfma_f32_16x16x32_bf16 v[92:95], a[28:31], a[132:135], v[92:95]
    ds_read_b64_tr_b16 a[90:91], v216 offset:21760
    v_add_f32 v160, v160, v163
    v_add_f32 v160, v160, v164
    v_mfma_f32_16x16x32_bf16 v[96:99], a[32:35], a[128:131], v[96:99]
    ds_read_b64_tr_b16 a[92:93], v217 offset:14592
    ds_read_b64_tr_b16 a[94:95], v217 offset:21760
    v_add_f32 v160, v160, v165
    v_mfma_f32_16x16x32_bf16 v[100:103], a[32:35], a[132:135], v[100:103]
    buffer_load_dwordx4 v17, s[8:11], s48 offen offset:1024 lds
    v_mfma_f32_16x16x32_bf16 v[104:107], a[36:39], a[128:131], v[104:107]
    ds_read_b64_tr_b16 a[96:97], v216 offset:14656
    v_add_f32 v160, v160, v166
    v_mfma_f32_16x16x32_bf16 v[108:111], a[36:39], a[132:135], v[108:111]
    ds_read_b64_tr_b16 a[98:99], v216 offset:21824
    v_add_f32 v160, v160, v167
    v_add_u32 v11, 114688, v11
    v_mfma_f32_16x16x32_bf16 v[112:115], a[40:43], a[128:131], v[112:115]
    ds_read_b64_tr_b16 a[100:101], v217 offset:14656
    ds_write_b32 v11, v160
    v_lshrrev_b32 v26, 4, v1
    v_mfma_f32_16x16x32_bf16 v[116:119], a[40:43], a[132:135], v[116:119]
    ds_read_b64_tr_b16 a[102:103], v217 offset:21824
    ds_read_b64_tr_b16 a[104:105], v216 offset:14720
    v_lshlrev_b32 v26, 4, v26
    v_mfma_f32_16x16x32_bf16 v[120:123], a[44:47], a[128:131], v[120:123]
    buffer_load_dwordx4 v18, s[8:11], s48 offen offset:2048 lds
    v_mfma_f32_16x16x32_bf16 v[124:127], a[44:47], a[132:135], v[124:127]
    s_add_u32 s48, s48, 458752
    ds_read_b64_tr_b16 a[106:107], v216 offset:21888
    v_add_u32 v26, 114688, v26
    v_mfma_f32_16x16x32_bf16 v[128:131], a[48:51], a[128:131], v[128:131]
    ds_read_b64_tr_b16 a[108:109], v217 offset:14720
    v_add_f32 v144, v144, v148
    v_mfma_f32_16x16x32_bf16 v[132:135], a[48:51], a[132:135], v[132:135]
    ds_read_b64_tr_b16 a[110:111], v217 offset:21888
    v_add_f32 v145, v145, v149
    v_add_f32 v146, v146, v150
    v_mfma_f32_16x16x32_bf16 v[136:139], a[52:55], a[128:131], v[136:139]
    v_add_f32 v147, v147, v151
    v_add_f32 v144, v144, v152
    v_add_f32 v145, v145, v153
    v_mfma_f32_16x16x32_bf16 v[140:143], a[52:55], a[132:135], v[140:143]
    s_waitcnt vmcnt(21) lgkmcnt(15)
    v_add_f32 v146, v146, v154
    s_waitcnt vmcnt(12)
    s_barrier
    v_mfma_f32_16x16x32_bf16 v[32:35], a[56:59], a[136:139], v[32:35]
    ds_read_b64_tr_b16 a[0:1], v216 offset:28672
    ds_read_b64_tr_b16 a[2:3], v216 offset:35840
    v_add_f32 v147, v147, v155
    v_mfma_f32_16x16x32_bf16 v[36:39], a[56:59], a[140:143], v[36:39]
    ds_read_b64_tr_b16 a[4:5], v217 offset:28672
    ds_read_b64_tr_b16 a[6:7], v217 offset:35840
    v_add_f32 v144, v144, v156
    v_mfma_f32_16x16x32_bf16 v[40:43], a[60:63], a[136:139], v[40:43]
    buffer_load_dwordx4 a[168:171], v9, s[16:19], s52 offen offset:2048 sc1
    v_mfma_f32_16x16x32_bf16 v[44:47], a[60:63], a[140:143], v[44:47]
    ds_read_b64_tr_b16 a[8:9], v216 offset:28736
    ds_read_b64_tr_b16 a[10:11], v216 offset:35904
    v_add_f32 v145, v145, v157
    v_mfma_f32_16x16x32_bf16 v[48:51], a[64:67], a[136:139], v[48:51]
    buffer_load_dwordx4 a[172:175], v9, s[16:19], s52 offen offset:2304 sc1
    v_mfma_f32_16x16x32_bf16 v[52:55], a[64:67], a[140:143], v[52:55]
    s_add_u32 s52, s52, 4096
    ds_read_b64_tr_b16 a[12:13], v217 offset:28736
    v_add_f32 v146, v146, v158
    v_add_f32 v147, v147, v159
    v_mfma_f32_16x16x32_bf16 v[56:59], a[68:71], a[136:139], v[56:59]
    s_add_u32 m0, s34, 86016
    ds_read_b64_tr_b16 a[14:15], v217 offset:35904
    ds_read_b64_tr_b16 a[16:17], v216 offset:28800
    v_mov_b32 v148, v144
    v_mfma_f32_16x16x32_bf16 v[60:63], a[68:71], a[140:143], v[60:63]
    buffer_load_dwordx4 v12, s[8:11], s48 offen offset:0 lds
    v_mfma_f32_16x16x32_bf16 v[64:67], a[72:75], a[136:139], v[64:67]
    ds_read_b64_tr_b16 a[18:19], v216 offset:35968
    ds_read_b64_tr_b16 a[20:21], v217 offset:28800
    v_mfma_f32_16x16x32_bf16 v[68:71], a[72:75], a[140:143], v[68:71]
    ds_read_b64_tr_b16 a[22:23], v217 offset:35968
    ds_read_b64_tr_b16 a[24:25], v216 offset:28864
    v_mov_b32 v149, v145
    v_mov_b32 v150, v146
    v_mfma_f32_16x16x32_bf16 v[72:75], a[76:79], a[136:139], v[72:75]
    buffer_load_dwordx4 v13, s[8:11], s48 offen offset:1024 lds
    v_mfma_f32_16x16x32_bf16 v[76:79], a[76:79], a[140:143], v[76:79]
    ds_read_b64_tr_b16 a[26:27], v216 offset:36032
    v_mov_b32 v151, v147
    v_mfma_f32_16x16x32_bf16 v[80:83], a[80:83], a[136:139], v[80:83]
    s_waitcnt lgkmcnt(14)
    ds_read_b64_tr_b16 a[28:29], v217 offset:28864
    ds_read_b64_tr_b16 a[30:31], v217 offset:36032
    s_nop 1
    v_mfma_f32_16x16x32_bf16 v[84:87], a[80:83], a[140:143], v[84:87]
    buffer_load_dwordx4 v14, s[8:11], s48 offen offset:2048 lds
    v_mfma_f32_16x16x32_bf16 v[88:91], a[84:87], a[136:139], v[88:91]
    ds_read_b64_tr_b16 a[32:33], v216 offset:28928
    ds_read_b64_tr_b16 a[34:35], v216 offset:36096
    v_mfma_f32_16x16x32_bf16 v[92:95], a[84:87], a[140:143], v[92:95]
    buffer_load_dwordx4 v15, s[8:11], s48 offen offset:3072 lds
    v_mfma_f32_16x16x32_bf16 v[96:99], a[88:91], a[136:139], v[96:99]
    ds_read_b64_tr_b16 a[36:37], v217 offset:28928
    v_permlane16_swap_b32 v144, v148
    v_permlane16_swap_b32 v145, v149
    v_mfma_f32_16x16x32_bf16 v[100:103], a[88:91], a[140:143], v[100:103]
    s_add_u32 m0, s34, 90112
    ds_read_b64_tr_b16 a[38:39], v217 offset:36096
    ds_read_b64_tr_b16 a[40:41], v216 offset:28992
    v_permlane16_swap_b32 v146, v150
    v_mfma_f32_16x16x32_bf16 v[104:107], a[92:95], a[136:139], v[104:107]
    buffer_load_dwordx4 v16, s[8:11], s48 offen offset:0 lds
    v_mfma_f32_16x16x32_bf16 v[108:111], a[92:95], a[140:143], v[108:111]
    ds_read_b64_tr_b16 a[42:43], v216 offset:36160
    v_permlane16_swap_b32 v147, v151
    s_nop 0
    v_mfma_f32_16x16x32_bf16 v[112:115], a[96:99], a[136:139], v[112:115]
    ds_read_b64_tr_b16 a[44:45], v217 offset:28992
    ds_read_b64_tr_b16 a[46:47], v217 offset:36160
    v_add_f32 v144, v144, v148
    v_mfma_f32_16x16x32_bf16 v[116:119], a[96:99], a[140:143], v[116:119]
    buffer_load_dwordx4 v17, s[8:11], s48 offen offset:1024 lds
    v_mfma_f32_16x16x32_bf16 v[120:123], a[100:103], a[136:139], v[120:123]
    ds_read_b64_tr_b16 a[48:49], v216 offset:29056
    v_add_f32 v145, v145, v149
    v_mfma_f32_16x16x32_bf16 v[124:127], a[100:103], a[140:143], v[124:127]
    ds_read_b64_tr_b16 a[50:51], v216 offset:36224
    ds_read_b64_tr_b16 a[52:53], v217 offset:29056
    v_add_f32 v146, v146, v150
    v_add_f32 v147, v147, v151
    v_mfma_f32_16x16x32_bf16 v[128:131], a[104:107], a[136:139], v[128:131]
    buffer_load_dwordx4 v18, s[8:11], s48 offen offset:2048 lds
    buffer_store_dwordx4 v[228:231], v8, s[16:19], s39 offen offset:0 sc1
    v_mfma_f32_16x16x32_bf16 v[132:135], a[104:107], a[140:143], v[132:135]
    s_add_u32 s48, s48, 458752
    ds_read_b64_tr_b16 a[54:55], v217 offset:36224
    v_mfma_f32_16x16x32_bf16 v[136:139], a[108:111], a[136:139], v[136:139]
    buffer_store_dwordx4 v[228:231], v8, s[16:19], s39 offen offset:1024 sc1
    v_mfma_f32_16x16x32_bf16 v[140:143], a[108:111], a[140:143], v[140:143]
    s_waitcnt lgkmcnt(14)
    v_mfma_f32_16x16x32_bf16 v[32:35], a[0:3], a[144:147], v[32:35]
    ds_read_b64_tr_b16 a[56:57], v216 offset:43008
    ds_read_b64_tr_b16 a[58:59], v216 offset:50176
    v_mov_b32 v148, v144
    v_mfma_f32_16x16x32_bf16 v[36:39], a[0:3], a[148:151], v[36:39]
    ds_read_b64_tr_b16 a[60:61], v217 offset:43008
    ds_read_b64_tr_b16 a[62:63], v217 offset:50176
    v_mfma_f32_16x16x32_bf16 v[40:43], a[4:7], a[144:147], v[40:43]
    buffer_load_dwordx4 a[176:179], v9, s[16:19], s52 offen offset:0 sc1
    v_mfma_f32_16x16x32_bf16 v[44:47], a[4:7], a[148:151], v[44:47]
    ds_read_b64_tr_b16 a[64:65], v216 offset:43072
    v_mov_b32 v149, v145
    v_mfma_f32_16x16x32_bf16 v[48:51], a[8:11], a[144:147], v[48:51]
    ds_read_b64_tr_b16 a[66:67], v216 offset:50240
    ds_read_b64_tr_b16 a[68:69], v217 offset:43072
    v_mfma_f32_16x16x32_bf16 v[52:55], a[8:11], a[148:151], v[52:55]
    ds_read_b64_tr_b16 a[70:71], v217 offset:50240
    v_mov_b32 v150, v146
    v_mov_b32 v151, v147
    v_mfma_f32_16x16x32_bf16 v[56:59], a[12:15], a[144:147], v[56:59]
    ds_read_b64_tr_b16 a[72:73], v216 offset:43136
    s_nop 1
    v_mfma_f32_16x16x32_bf16 v[60:63], a[12:15], a[148:151], v[60:63]
    ds_read_b64_tr_b16 a[74:75], v216 offset:50304
    ds_read_b64_tr_b16 a[76:77], v217 offset:43136
    v_mfma_f32_16x16x32_bf16 v[64:67], a[16:19], a[144:147], v[64:67]
    buffer_load_dwordx4 a[180:183], v9, s[16:19], s52 offen offset:256 sc1
    v_mfma_f32_16x16x32_bf16 v[68:71], a[16:19], a[148:151], v[68:71]
    ds_read_b64_tr_b16 a[78:79], v217 offset:50304
    v_mfma_f32_16x16x32_bf16 v[72:75], a[20:23], a[144:147], v[72:75]
    ds_read_b64_tr_b16 a[80:81], v216 offset:43200
    v_permlane32_swap_b32 v144, v148
    v_permlane32_swap_b32 v145, v149
    v_mfma_f32_16x16x32_bf16 v[76:79], a[20:23], a[148:151], v[76:79]
    ds_read_b64_tr_b16 a[82:83], v216 offset:50368
    v_permlane32_swap_b32 v146, v150
    v_permlane32_swap_b32 v147, v151
    v_mfma_f32_16x16x32_bf16 v[80:83], a[24:27], a[144:147], v[80:83]
    s_waitcnt lgkmcnt(14)
    ds_read_b64_tr_b16 a[84:85], v217 offset:43200
    s_nop 0
    v_mfma_f32_16x16x32_bf16 v[84:87], a[24:27], a[148:151], v[84:87]
    ds_read_b64_tr_b16 a[86:87], v217 offset:50368
    ds_read_b64_tr_b16 a[88:89], v216 offset:43264
    v_add_f32 v144, v144, v148
    v_mfma_f32_16x16x32_bf16 v[88:91], a[28:31], a[144:147], v[88:91]
    buffer_load_dwordx4 a[184:187], v9, s[16:19], s52 offen offset:2048 sc1
    v_mfma_f32_16x16x32_bf16 v[92:95], a[28:31], a[148:151], v[92:95]
    ds_read_b64_tr_b16 a[90:91], v216 offset:50432
    v_mfma_f32_16x16x32_bf16 v[96:99], a[32:35], a[144:147], v[96:99]
    ds_read_b64_tr_b16 a[92:93], v217 offset:43264
    v_add_f32 v145, v145, v149
    v_add_f32 v146, v146, v150
    v_mfma_f32_16x16x32_bf16 v[100:103], a[32:35], a[148:151], v[100:103]
    ds_read_b64_tr_b16 a[94:95], v217 offset:50432
    v_add_f32 v147, v147, v151
    v_mfma_f32_16x16x32_bf16 v[104:107], a[36:39], a[144:147], v[104:107]
    ds_read_b64_tr_b16 a[96:97], v216 offset:43328
    v_mul_f32 v2, 0x3a800000, v144
    v_mul_f32 v3, 0x3a800000, v145
    v_mfma_f32_16x16x32_bf16 v[108:111], a[36:39], a[148:151], v[108:111]
    ds_read_b64_tr_b16 a[98:99], v216 offset:50496
    ds_read_b64_tr_b16 a[100:101], v217 offset:43328
    v_fma_f32 v3, -v2, v2, v3
    v_mfma_f32_16x16x32_bf16 v[112:115], a[40:43], a[144:147], v[112:115]
    buffer_load_dwordx4 a[188:191], v9, s[16:19], s52 offen offset:2304 sc1
    v_mfma_f32_16x16x32_bf16 v[116:119], a[40:43], a[148:151], v[116:119]
    s_add_u32 s52, s52, 4096
    ds_read_b64_tr_b16 a[102:103], v217 offset:50496
    v_mfma_f32_16x16x32_bf16 v[120:123], a[44:47], a[144:147], v[120:123]
    ds_read_b64_tr_b16 a[104:105], v216 offset:43392
    v_max_f32 v3, 0, v3
    v_add_f32 v3, 0x3727c5ac, v3
    v_mfma_f32_16x16x32_bf16 v[124:127], a[44:47], a[148:151], v[124:127]
    ds_read_b64_tr_b16 a[106:107], v216 offset:50560
    v_mfma_f32_16x16x32_bf16 v[128:131], a[48:51], a[144:147], v[128:131]
    ds_read_b64_tr_b16 a[108:109], v217 offset:43392
    buffer_store_dwordx4 v[228:231], v8, s[16:19], s39 offen offset:2048 sc1
    v_mfma_f32_16x16x32_bf16 v[132:135], a[48:51], a[148:151], v[132:135]
    ds_read_b64_tr_b16 a[110:111], v217 offset:50560
    v_mfma_f32_16x16x32_bf16 v[136:139], a[52:55], a[144:147], v[136:139]
    buffer_store_dwordx4 v[228:231], v8, s[16:19], s39 offen offset:3072 sc1
    v_mfma_f32_16x16x32_bf16 v[140:143], a[52:55], a[148:151], v[140:143]
    s_waitcnt vmcnt(27) lgkmcnt(14)
    s_waitcnt vmcnt(8)
    s_barrier
    v_mfma_f32_16x16x32_bf16 v[32:35], a[56:59], a[152:155], v[32:35]
    ds_read_b64_tr_b16 a[0:1], v218 offset:0
    ds_read_b64_tr_b16 a[2:3], v218 offset:7168
    v_mfma_f32_16x16x32_bf16 v[36:39], a[56:59], a[156:159], v[36:39]
    ds_read_b64_tr_b16 a[4:5], v219 offset:0
    v_sqrt_f32 v24, v3
    v_mfma_f32_16x16x32_bf16 v[40:43], a[60:63], a[152:155], v[40:43]
    ds_read_b64_tr_b16 a[6:7], v219 offset:7168
    ds_read_b64_tr_b16 a[8:9], v218 offset:14336
    v_mfma_f32_16x16x32_bf16 v[44:47], a[60:63], a[156:159], v[44:47]
    ds_read_b64_tr_b16 a[10:11], v218 offset:21504
    v_rsq_f32 v4, v3
    v_mfma_f32_16x16x32_bf16 v[48:51], a[64:67], a[152:155], v[48:51]
    ds_read_b64_tr_b16 a[12:13], v219 offset:14336
    v_mfma_f32_16x16x32_bf16 v[52:55], a[64:67], a[156:159], v[52:55]
    ds_read_b64_tr_b16 a[14:15], v219 offset:21504
    v_sub_f32 v20, 0, v2
    v_mul_f32 v22, 0xbfb8aa3b, v4
    v_mfma_f32_16x16x32_bf16 v[56:59], a[68:71], a[152:155], v[56:59]
    ds_read_b64_tr_b16 a[16:17], v218 offset:28672
    v_mul_f32 v2, 0x3a800000, v146
    v_mfma_f32_16x16x32_bf16 v[60:63], a[68:71], a[156:159], v[60:63]
    ds_read_b64_tr_b16 a[18:19], v218 offset:35840
    v_mul_f32 v3, 0x3a800000, v147
    v_mfma_f32_16x16x32_bf16 v[64:67], a[72:75], a[152:155], v[64:67]
    ds_read_b64_tr_b16 a[20:21], v219 offset:28672
    v_fma_f32 v3, -v2, v2, v3
    v_mfma_f32_16x16x32_bf16 v[68:71], a[72:75], a[156:159], v[68:71]
    ds_read_b64_tr_b16 a[22:23], v219 offset:35840
    v_max_f32 v3, 0, v3
    v_add_f32 v3, 0x3727c5ac, v3
    v_mfma_f32_16x16x32_bf16 v[72:75], a[76:79], a[152:155], v[72:75]
    ds_read_b64_tr_b16 a[24:25], v218 offset:43008
    v_mfma_f32_16x16x32_bf16 v[76:79], a[76:79], a[156:159], v[76:79]
    ds_read_b64_tr_b16 a[26:27], v218 offset:50176
    v_sqrt_f32 v25, v3
    v_mfma_f32_16x16x32_bf16 v[80:83], a[80:83], a[152:155], v[80:83]
    s_waitcnt lgkmcnt(14)
    ds_read_b64_tr_b16 a[28:29], v219 offset:43008
    v_rsq_f32 v4, v3
    v_mfma_f32_16x16x32_bf16 v[84:87], a[80:83], a[156:159], v[84:87]
    ds_read_b64_tr_b16 a[30:31], v219 offset:50176
    v_sub_f32 v21, 0, v2
    v_mfma_f32_16x16x32_bf16 v[88:91], a[84:87], a[152:155], v[88:91]
    ds_read_b64_tr_b16 a[32:33], v218 offset:64
    ds_read_b128 v[160:163], v26 offset:0
    v_mfma_f32_16x16x32_bf16 v[92:95], a[84:87], a[156:159], v[92:95]
    ds_read_b64_tr_b16 a[34:35], v218 offset:7232
    ds_read_b128 v[164:167], v26 offset:64
    v_mfma_f32_16x16x32_bf16 v[96:99], a[88:91], a[152:155], v[96:99]
    ds_read_b64_tr_b16 a[36:37], v219 offset:64
    ds_read_b128 v[168:171], v26 offset:128
    v_mfma_f32_16x16x32_bf16 v[100:103], a[88:91], a[156:159], v[100:103]
    ds_read_b64_tr_b16 a[38:39], v219 offset:7232
    ds_read_b128 v[172:175], v26 offset:192
    v_mul_f32 v23, 0xbfb8aa3b, v4
    v_mfma_f32_16x16x32_bf16 v[104:107], a[92:95], a[152:155], v[104:107]
    ds_read_b64_tr_b16 a[40:41], v218 offset:14400
    ds_read_b128 v[176:179], v26 offset:256
    v_mfma_f32_16x16x32_bf16 v[108:111], a[92:95], a[156:159], v[108:111]
    ds_read_b64_tr_b16 a[42:43], v218 offset:21568
    ds_read_b128 v[180:183], v26 offset:320
    v_mfma_f32_16x16x32_bf16 v[112:115], a[96:99], a[152:155], v[112:115]
    ds_read_b64_tr_b16 a[44:45], v219 offset:14400
    ds_read_b128 v[184:187], v26 offset:384
    v_mfma_f32_16x16x32_bf16 v[116:119], a[96:99], a[156:159], v[116:119]
    ds_read_b64_tr_b16 a[46:47], v219 offset:21568
    ds_read_b128 v[188:191], v26 offset:448
    s_mul_i32 s38, s30, 229376
    v_mfma_f32_16x16x32_bf16 v[120:123], a[100:103], a[152:155], v[120:123]
    ds_read_b64_tr_b16 a[48:49], v218 offset:28736
    ds_read_b128 v[192:195], v26 offset:512
    v_mfma_f32_16x16x32_bf16 v[124:127], a[100:103], a[156:159], v[124:127]
    ds_read_b64_tr_b16 a[50:51], v218 offset:35904
    ds_read_b128 v[196:199], v26 offset:576
    v_mfma_f32_16x16x32_bf16 v[128:131], a[104:107], a[152:155], v[128:131]
    ds_read_b64_tr_b16 a[52:53], v219 offset:28736
    ds_read_b128 v[200:203], v26 offset:640
    v_mfma_f32_16x16x32_bf16 v[132:135], a[104:107], a[156:159], v[132:135]
    ds_read_b64_tr_b16 a[54:55], v219 offset:35904
    ds_read_b128 v[204:207], v26 offset:704
    s_mul_i32 s36, s31, 14336
    v_mfma_f32_16x16x32_bf16 v[136:139], a[108:111], a[152:155], v[136:139]
    ds_read_b128 v[208:211], v26 offset:768
    s_add_u32 s38, s38, s36
    v_mfma_f32_16x16x32_bf16 v[140:143], a[108:111], a[156:159], v[140:143]
    s_waitcnt vmcnt(2) lgkmcnt(15)
    ds_read_b128 v[212:215], v26 offset:832
    s_add_u32 s38, s38, 58720256
    v_mfma_f32_16x16x32_bf16 v[32:35], a[0:3], a[160:163], v[32:35]
    ds_read_b64_tr_b16 a[56:57], v218 offset:43072
    ds_read_b64_tr_b16 a[58:59], v218 offset:50240
    v_mfma_f32_16x16x32_bf16 v[36:39], a[0:3], a[164:167], v[36:39]
    ds_read_b64_tr_b16 a[60:61], v219 offset:43072
    v_mfma_f32_16x16x32_bf16 v[40:43], a[4:7], a[160:163], v[40:43]
    ds_read_b64_tr_b16 a[62:63], v219 offset:50240
    ds_read_b64_tr_b16 a[64:65], v218 offset:128
    v_mfma_f32_16x16x32_bf16 v[44:47], a[4:7], a[164:167], v[44:47]
    ds_read_b64_tr_b16 a[66:67], v218 offset:7296
    v_mfma_f32_16x16x32_bf16 v[32:35], a[8:11], a[168:171], v[32:35]
    ds_read_b64_tr_b16 a[68:69], v219 offset:128
    v_mfma_f32_16x16x32_bf16 v[36:39], a[8:11], a[172:175], v[36:39]
    ds_read_b64_tr_b16 a[70:71], v219 offset:7296
    v_mfma_f32_16x16x32_bf16 v[40:43], a[12:15], a[168:171], v[40:43]
    ds_read_b64_tr_b16 a[72:73], v218 offset:14464
    v_mfma_f32_16x16x32_bf16 v[44:47], a[12:15], a[172:175], v[44:47]
    ds_read_b64_tr_b16 a[74:75], v218 offset:21632
    v_mfma_f32_16x16x32_bf16 v[32:35], a[16:19], a[176:179], v[32:35]
    ds_read_b64_tr_b16 a[76:77], v219 offset:14464
    v_mfma_f32_16x16x32_bf16 v[36:39], a[16:19], a[180:183], v[36:39]
    ds_read_b64_tr_b16 a[78:79], v219 offset:21632
    v_mfma_f32_16x16x32_bf16 v[40:43], a[20:23], a[176:179], v[40:43]
    ds_read_b64_tr_b16 a[80:81], v218 offset:28800
    v_mfma_f32_16x16x32_bf16 v[44:47], a[20:23], a[180:183], v[44:47]
    ds_read_b64_tr_b16 a[82:83], v218 offset:35968
    v_mfma_f32_16x16x32_bf16 v[32:35], a[24:27], a[184:187], v[32:35]
    s_waitcnt lgkmcnt(15)
    ds_read_b64_tr_b16 a[84:85], v219 offset:28800
    v_mfma_f32_16x16x32_bf16 v[36:39], a[24:27], a[188:191], v[36:39]
    ds_read_b64_tr_b16 a[86:87], v219 offset:35968
    v_mfma_f32_16x16x32_bf16 v[40:43], a[28:31], a[184:187], v[40:43]
    ds_read_b64_tr_b16 a[88:89], v218 offset:43136
    v_mfma_f32_16x16x32_bf16 v[44:47], a[28:31], a[188:191], v[44:47]
    ds_read_b64_tr_b16 a[90:91], v218 offset:50304
    v_mfma_f32_16x16x32_bf16 v[48:51], a[32:35], a[160:163], v[48:51]
    ds_read_b64_tr_b16 a[92:93], v219 offset:43136
    v_mfma_f32_16x16x32_bf16 v[52:55], a[32:35], a[164:167], v[52:55]
    ds_read_b64_tr_b16 a[94:95], v219 offset:50304
    v_mfma_f32_16x16x32_bf16 v[56:59], a[36:39], a[160:163], v[56:59]
    ds_read_b64_tr_b16 a[96:97], v218 offset:192
    v_mfma_f32_16x16x32_bf16 v[60:63], a[36:39], a[164:167], v[60:63]
    ds_read_b64_tr_b16 a[98:99], v218 offset:7360
    v_mfma_f32_16x16x32_bf16 v[48:51], a[40:43], a[168:171], v[48:51]
    ds_read_b64_tr_b16 a[100:101], v219 offset:192
    v_mfma_f32_16x16x32_bf16 v[52:55], a[40:43], a[172:175], v[52:55]
    ds_read_b64_tr_b16 a[102:103], v219 offset:7360
    v_mfma_f32_16x16x32_bf16 v[56:59], a[44:47], a[168:171], v[56:59]
    ds_read_b64_tr_b16 a[104:105], v218 offset:14528
    v_mfma_f32_16x16x32_bf16 v[60:63], a[44:47], a[172:175], v[60:63]
    ds_read_b64_tr_b16 a[106:107], v218 offset:21696
    v_mfma_f32_16x16x32_bf16 v[48:51], a[48:51], a[176:179], v[48:51]
    ds_read_b64_tr_b16 a[108:109], v219 offset:14528
    v_mfma_f32_16x16x32_bf16 v[52:55], a[48:51], a[180:183], v[52:55]
    ds_read_b64_tr_b16 a[110:111], v219 offset:21696
    v_mfma_f32_16x16x32_bf16 v[56:59], a[52:55], a[176:179], v[56:59]
    v_mfma_f32_16x16x32_bf16 v[60:63], a[52:55], a[180:183], v[60:63]
    s_waitcnt lgkmcnt(14)
    v_mfma_f32_16x16x32_bf16 v[48:51], a[56:59], a[184:187], v[48:51]
    ds_read_b64_tr_b16 a[0:1], v218 offset:28864
    ds_read_b64_tr_b16 a[2:3], v218 offset:36032
    v_mfma_f32_16x16x32_bf16 v[52:55], a[56:59], a[188:191], v[52:55]
    ds_read_b64_tr_b16 a[4:5], v219 offset:28864
    v_mfma_f32_16x16x32_bf16 v[56:59], a[60:63], a[184:187], v[56:59]
    ds_read_b64_tr_b16 a[6:7], v219 offset:36032
    ds_read_b64_tr_b16 a[8:9], v218 offset:43200
    v_mfma_f32_16x16x32_bf16 v[60:63], a[60:63], a[188:191], v[60:63]
    ds_read_b64_tr_b16 a[10:11], v218 offset:50368
    v_pk_fma_f32 v[32:33], v[20:21], v[160:161], v[32:33] op_sel:[0,0,0] op_sel_hi:[0,1,1]
    v_pk_fma_f32 v[34:35], v[20:21], v[162:163], v[34:35] op_sel:[0,0,0] op_sel_hi:[0,1,1]
    v_pk_fma_f32 v[40:41], v[20:21], v[164:165], v[40:41] op_sel:[0,0,0] op_sel_hi:[0,1,1]
    v_pk_fma_f32 v[42:43], v[20:21], v[166:167], v[42:43] op_sel:[0,0,0] op_sel_hi:[0,1,1]
    v_pk_mul_f32 v[144:145], v[22:23], v[32:33] op_sel:[0,0] op_sel_hi:[0,1]
    v_pk_mul_f32 v[146:147], v[22:23], v[34:35] op_sel:[0,0] op_sel_hi:[0,1]
    v_pk_mul_f32 v[148:149], v[22:23], v[40:41] op_sel:[0,0] op_sel_hi:[0,1]
    v_pk_mul_f32 v[150:151], v[22:23], v[42:43] op_sel:[0,0] op_sel_hi:[0,1]
    v_exp_f32 v144, v144
    v_exp_f32 v145, v145
    v_exp_f32 v146, v146
    v_exp_f32 v147, v147
    v_exp_f32 v148, v148
    v_exp_f32 v149, v149
    v_exp_f32 v150, v150
    v_exp_f32 v151, v151
    v_pk_fma_f32 v[144:145], v[144:145], v[24:25], v[24:25] op_sel:[0,0,0] op_sel_hi:[1,0,0]
    v_pk_fma_f32 v[146:147], v[146:147], v[24:25], v[24:25] op_sel:[0,0,0] op_sel_hi:[1,0,0]
    v_pk_fma_f32 v[148:149], v[148:149], v[24:25], v[24:25] op_sel:[0,0,0] op_sel_hi:[1,0,0]
    v_pk_fma_f32 v[150:151], v[150:151], v[24:25], v[24:25] op_sel:[0,0,0] op_sel_hi:[1,0,0]
    v_rcp_f32 v144, v144
    v_rcp_f32 v145, v145
    v_rcp_f32 v146, v146
    v_rcp_f32 v147, v147
    v_rcp_f32 v148, v148
    v_rcp_f32 v149, v149
    v_rcp_f32 v150, v150
    v_rcp_f32 v151, v151
    v_pk_mul_f32 v[32:33], v[32:33], v[144:145]
    v_pk_mul_f32 v[34:35], v[34:35], v[146:147]
    v_pk_mul_f32 v[40:41], v[40:41], v[148:149]
    v_pk_mul_f32 v[42:43], v[42:43], v[150:151]
    v_cvt_pk_bf16_f32 v152, v32, v33
    v_cvt_pk_bf16_f32 v153, v34, v35
    v_cvt_pk_bf16_f32 v154, v40, v41
    v_cvt_pk_bf16_f32 v155, v42, v43
    buffer_store_dwordx4 v[152:155], v27, s[16:19], s38 offen offset:0 sc1
    v_pk_fma_f32 v[36:37], v[20:21], v[160:161], v[36:37] op_sel:[1,0,0] op_sel_hi:[1,1,1]
    v_pk_fma_f32 v[38:39], v[20:21], v[162:163], v[38:39] op_sel:[1,0,0] op_sel_hi:[1,1,1]
    v_pk_fma_f32 v[44:45], v[20:21], v[164:165], v[44:45] op_sel:[1,0,0] op_sel_hi:[1,1,1]
    v_pk_fma_f32 v[46:47], v[20:21], v[166:167], v[46:47] op_sel:[1,0,0] op_sel_hi:[1,1,1]
    v_pk_mul_f32 v[144:145], v[22:23], v[36:37] op_sel:[1,0] op_sel_hi:[1,1]
    v_pk_mul_f32 v[146:147], v[22:23], v[38:39] op_sel:[1,0] op_sel_hi:[1,1]
    v_pk_mul_f32 v[148:149], v[22:23], v[44:45] op_sel:[1,0] op_sel_hi:[1,1]
    v_pk_mul_f32 v[150:151], v[22:23], v[46:47] op_sel:[1,0] op_sel_hi:[1,1]
    v_exp_f32 v144, v144
    v_exp_f32 v145, v145
    v_exp_f32 v146, v146
    v_exp_f32 v147, v147
    v_exp_f32 v148, v148
    v_exp_f32 v149, v149
    v_exp_f32 v150, v150
    v_exp_f32 v151, v151
    v_pk_fma_f32 v[144:145], v[144:145], v[24:25], v[24:25] op_sel:[0,1,1] op_sel_hi:[1,1,1]
    v_pk_fma_f32 v[146:147], v[146:147], v[24:25], v[24:25] op_sel:[0,1,1] op_sel_hi:[1,1,1]
    v_pk_fma_f32 v[148:149], v[148:149], v[24:25], v[24:25] op_sel:[0,1,1] op_sel_hi:[1,1,1]
    v_pk_fma_f32 v[150:151], v[150:151], v[24:25], v[24:25] op_sel:[0,1,1] op_sel_hi:[1,1,1]
    v_rcp_f32 v144, v144
    v_rcp_f32 v145, v145
    v_rcp_f32 v146, v146
    v_rcp_f32 v147, v147
    v_rcp_f32 v148, v148
    v_rcp_f32 v149, v149
    v_rcp_f32 v150, v150
    v_rcp_f32 v151, v151
    v_pk_mul_f32 v[36:37], v[36:37], v[144:145]
    v_pk_mul_f32 v[38:39], v[38:39], v[146:147]
    v_pk_mul_f32 v[44:45], v[44:45], v[148:149]
    v_pk_mul_f32 v[46:47], v[46:47], v[150:151]
    v_cvt_pk_bf16_f32 v156, v36, v37
    v_cvt_pk_bf16_f32 v157, v38, v39
    v_cvt_pk_bf16_f32 v158, v44, v45
    v_cvt_pk_bf16_f32 v159, v46, v47
    buffer_store_dwordx4 v[156:159], v27, s[16:19], s38 offen offset:256 sc1
    v_mfma_f32_16x16x32_bf16 v[64:67], a[64:67], a[160:163], v[64:67]
    ds_read_b64_tr_b16 a[12:13], v219 offset:43200
    v_mfma_f32_16x16x32_bf16 v[68:71], a[64:67], a[164:167], v[68:71]
    ds_read_b64_tr_b16 a[14:15], v219 offset:50368
    v_mfma_f32_16x16x32_bf16 v[72:75], a[68:71], a[160:163], v[72:75]
    ds_read_b64_tr_b16 a[16:17], v218 offset:256
    v_mfma_f32_16x16x32_bf16 v[76:79], a[68:71], a[164:167], v[76:79]
    ds_read_b64_tr_b16 a[18:19], v218 offset:7424
    v_mfma_f32_16x16x32_bf16 v[64:67], a[72:75], a[168:171], v[64:67]
    ds_read_b64_tr_b16 a[20:21], v219 offset:256
    v_mfma_f32_16x16x32_bf16 v[68:71], a[72:75], a[172:175], v[68:71]
    ds_read_b64_tr_b16 a[22:23], v219 offset:7424
    v_mfma_f32_16x16x32_bf16 v[72:75], a[76:79], a[168:171], v[72:75]
    ds_read_b64_tr_b16 a[24:25], v218 offset:14592
    v_mfma_f32_16x16x32_bf16 v[76:79], a[76:79], a[172:175], v[76:79]
    ds_read_b64_tr_b16 a[26:27], v218 offset:21760
    v_mfma_f32_16x16x32_bf16 v[64:67], a[80:83], a[176:179], v[64:67]
    s_waitcnt lgkmcnt(14)
    ds_read_b64_tr_b16 a[28:29], v219 offset:14592
    v_mfma_f32_16x16x32_bf16 v[68:71], a[80:83], a[180:183], v[68:71]
    ds_read_b64_tr_b16 a[30:31], v219 offset:21760
    v_mfma_f32_16x16x32_bf16 v[72:75], a[84:87], a[176:179], v[72:75]
    ds_read_b64_tr_b16 a[32:33], v218 offset:28928
    v_mfma_f32_16x16x32_bf16 v[76:79], a[84:87], a[180:183], v[76:79]
    ds_read_b64_tr_b16 a[34:35], v218 offset:36096
    v_mfma_f32_16x16x32_bf16 v[64:67], a[88:91], a[184:187], v[64:67]
    ds_read_b64_tr_b16 a[36:37], v219 offset:28928
    v_mfma_f32_16x16x32_bf16 v[68:71], a[88:91], a[188:191], v[68:71]
    ds_read_b64_tr_b16 a[38:39], v219 offset:36096
    v_mfma_f32_16x16x32_bf16 v[72:75], a[92:95], a[184:187], v[72:75]
    ds_read_b64_tr_b16 a[40:41], v218 offset:43264
    v_mfma_f32_16x16x32_bf16 v[76:79], a[92:95], a[188:191], v[76:79]
    ds_read_b64_tr_b16 a[42:43], v218 offset:50432
    v_pk_fma_f32 v[48:49], v[20:21], v[168:169], v[48:49] op_sel:[0,0,0] op_sel_hi:[0,1,1]
    v_pk_fma_f32 v[50:51], v[20:21], v[170:171], v[50:51] op_sel:[0,0,0] op_sel_hi:[0,1,1]
    v_pk_fma_f32 v[56:57], v[20:21], v[172:173], v[56:57] op_sel:[0,0,0] op_sel_hi:[0,1,1]
    v_pk_fma_f32 v[58:59], v[20:21], v[174:175], v[58:59] op_sel:[0,0,0] op_sel_hi:[0,1,1]
    v_pk_mul_f32 v[144:145], v[22:23], v[48:49] op_sel:[0,0] op_sel_hi:[0,1]
    v_pk_mul_f32 v[146:147], v[22:23], v[50:51] op_sel:[0,0] op_sel_hi:[0,1]
    v_pk_mul_f32 v[148:149], v[22:23], v[56:57] op_sel:[0,0] op_sel_hi:[0,1]
    v_pk_mul_f32 v[150:151], v[22:23], v[58:59] op_sel:[0,0] op_sel_hi:[0,1]
    v_exp_f32 v144, v144
    v_exp_f32 v145, v145
    v_exp_f32 v146, v146
    v_exp_f32 v147, v147
    v_exp_f32 v148, v148
    v_exp_f32 v149, v149
    v_exp_f32 v150, v150
    v_exp_f32 v151, v151
    v_pk_fma_f32 v[144:145], v[144:145], v[24:25], v[24:25] op_sel:[0,0,0] op_sel_hi:[1,0,0]
    v_pk_fma_f32 v[146:147], v[146:147], v[24:25], v[24:25] op_sel:[0,0,0] op_sel_hi:[1,0,0]
    v_pk_fma_f32 v[148:149], v[148:149], v[24:25], v[24:25] op_sel:[0,0,0] op_sel_hi:[1,0,0]
    v_pk_fma_f32 v[150:151], v[150:151], v[24:25], v[24:25] op_sel:[0,0,0] op_sel_hi:[1,0,0]
    v_rcp_f32 v144, v144
    v_rcp_f32 v145, v145
    v_rcp_f32 v146, v146
    v_rcp_f32 v147, v147
    v_rcp_f32 v148, v148
    v_rcp_f32 v149, v149
    v_rcp_f32 v150, v150
    v_rcp_f32 v151, v151
    v_pk_mul_f32 v[48:49], v[48:49], v[144:145]
    v_pk_mul_f32 v[50:51], v[50:51], v[146:147]
    v_pk_mul_f32 v[56:57], v[56:57], v[148:149]
    v_pk_mul_f32 v[58:59], v[58:59], v[150:151]
    v_cvt_pk_bf16_f32 v152, v48, v49
    v_cvt_pk_bf16_f32 v153, v50, v51
    v_cvt_pk_bf16_f32 v154, v56, v57
    v_cvt_pk_bf16_f32 v155, v58, v59
    buffer_store_dwordx4 v[152:155], v27, s[16:19], s38 offen offset:2048 sc1
    v_pk_fma_f32 v[52:53], v[20:21], v[168:169], v[52:53] op_sel:[1,0,0] op_sel_hi:[1,1,1]
    v_pk_fma_f32 v[54:55], v[20:21], v[170:171], v[54:55] op_sel:[1,0,0] op_sel_hi:[1,1,1]
    v_pk_fma_f32 v[60:61], v[20:21], v[172:173], v[60:61] op_sel:[1,0,0] op_sel_hi:[1,1,1]
    v_pk_fma_f32 v[62:63], v[20:21], v[174:175], v[62:63] op_sel:[1,0,0] op_sel_hi:[1,1,1]
    v_pk_mul_f32 v[144:145], v[22:23], v[52:53] op_sel:[1,0] op_sel_hi:[1,1]
    v_pk_mul_f32 v[146:147], v[22:23], v[54:55] op_sel:[1,0] op_sel_hi:[1,1]
    v_pk_mul_f32 v[148:149], v[22:23], v[60:61] op_sel:[1,0] op_sel_hi:[1,1]
    v_pk_mul_f32 v[150:151], v[22:23], v[62:63] op_sel:[1,0] op_sel_hi:[1,1]
    v_exp_f32 v144, v144
    v_exp_f32 v145, v145
    v_exp_f32 v146, v146
    v_exp_f32 v147, v147
    v_exp_f32 v148, v148
    v_exp_f32 v149, v149
    v_exp_f32 v150, v150
    v_exp_f32 v151, v151
    v_pk_fma_f32 v[144:145], v[144:145], v[24:25], v[24:25] op_sel:[0,1,1] op_sel_hi:[1,1,1]
    v_pk_fma_f32 v[146:147], v[146:147], v[24:25], v[24:25] op_sel:[0,1,1] op_sel_hi:[1,1,1]
    v_pk_fma_f32 v[148:149], v[148:149], v[24:25], v[24:25] op_sel:[0,1,1] op_sel_hi:[1,1,1]
    v_pk_fma_f32 v[150:151], v[150:151], v[24:25], v[24:25] op_sel:[0,1,1] op_sel_hi:[1,1,1]
    v_rcp_f32 v144, v144
    v_rcp_f32 v145, v145
    v_rcp_f32 v146, v146
    v_rcp_f32 v147, v147
    v_rcp_f32 v148, v148
    v_rcp_f32 v149, v149
    v_rcp_f32 v150, v150
    v_rcp_f32 v151, v151
    v_pk_mul_f32 v[52:53], v[52:53], v[144:145]
    v_pk_mul_f32 v[54:55], v[54:55], v[146:147]
    v_pk_mul_f32 v[60:61], v[60:61], v[148:149]
    v_pk_mul_f32 v[62:63], v[62:63], v[150:151]
    v_cvt_pk_bf16_f32 v156, v52, v53
    v_cvt_pk_bf16_f32 v157, v54, v55
    v_cvt_pk_bf16_f32 v158, v60, v61
    v_cvt_pk_bf16_f32 v159, v62, v63
    buffer_store_dwordx4 v[156:159], v27, s[16:19], s38 offen offset:2304 sc1
    v_mfma_f32_16x16x32_bf16 v[80:83], a[96:99], a[160:163], v[80:83]
    ds_read_b64_tr_b16 a[44:45], v219 offset:43264
    v_mfma_f32_16x16x32_bf16 v[84:87], a[96:99], a[164:167], v[84:87]
    ds_read_b64_tr_b16 a[46:47], v219 offset:50432
    v_mfma_f32_16x16x32_bf16 v[88:91], a[100:103], a[160:163], v[88:91]
    ds_read_b64_tr_b16 a[48:49], v218 offset:320
    v_mfma_f32_16x16x32_bf16 v[92:95], a[100:103], a[164:167], v[92:95]
    ds_read_b64_tr_b16 a[50:51], v218 offset:7488
    v_mfma_f32_16x16x32_bf16 v[80:83], a[104:107], a[168:171], v[80:83]
    ds_read_b64_tr_b16 a[52:53], v219 offset:320
    v_mfma_f32_16x16x32_bf16 v[84:87], a[104:107], a[172:175], v[84:87]
    ds_read_b64_tr_b16 a[54:55], v219 offset:7488
    v_mfma_f32_16x16x32_bf16 v[88:91], a[108:111], a[168:171], v[88:91]
    v_mfma_f32_16x16x32_bf16 v[92:95], a[108:111], a[172:175], v[92:95]
    s_waitcnt lgkmcnt(14)
    v_mfma_f32_16x16x32_bf16 v[80:83], a[0:3], a[176:179], v[80:83]
    ds_read_b64_tr_b16 a[56:57], v218 offset:14656
    ds_read_b64_tr_b16 a[58:59], v218 offset:21824
    v_mfma_f32_16x16x32_bf16 v[84:87], a[0:3], a[180:183], v[84:87]
    ds_read_b64_tr_b16 a[60:61], v219 offset:14656
    v_mfma_f32_16x16x32_bf16 v[88:91], a[4:7], a[176:179], v[88:91]
    ds_read_b64_tr_b16 a[62:63], v219 offset:21824
    ds_read_b64_tr_b16 a[64:65], v218 offset:28992
    v_mfma_f32_16x16x32_bf16 v[92:95], a[4:7], a[180:183], v[92:95]
    ds_read_b64_tr_b16 a[66:67], v218 offset:36160
    v_mfma_f32_16x16x32_bf16 v[80:83], a[8:11], a[184:187], v[80:83]
    ds_read_b64_tr_b16 a[68:69], v219 offset:28992
    v_mfma_f32_16x16x32_bf16 v[84:87], a[8:11], a[188:191], v[84:87]
    ds_read_b64_tr_b16 a[70:71], v219 offset:36160
    v_mfma_f32_16x16x32_bf16 v[88:91], a[12:15], a[184:187], v[88:91]
    ds_read_b64_tr_b16 a[72:73], v218 offset:43328
    v_mfma_f32_16x16x32_bf16 v[92:95], a[12:15], a[188:191], v[92:95]
    ds_read_b64_tr_b16 a[74:75], v218 offset:50496
    v_pk_fma_f32 v[64:65], v[20:21], v[176:177], v[64:65] op_sel:[0,0,0] op_sel_hi:[0,1,1]
    v_pk_fma_f32 v[66:67], v[20:21], v[178:179], v[66:67] op_sel:[0,0,0] op_sel_hi:[0,1,1]
    v_pk_fma_f32 v[72:73], v[20:21], v[180:181], v[72:73] op_sel:[0,0,0] op_sel_hi:[0,1,1]
    v_pk_fma_f32 v[74:75], v[20:21], v[182:183], v[74:75] op_sel:[0,0,0] op_sel_hi:[0,1,1]
    v_pk_mul_f32 v[144:145], v[22:23], v[64:65] op_sel:[0,0] op_sel_hi:[0,1]
    v_pk_mul_f32 v[146:147], v[22:23], v[66:67] op_sel:[0,0] op_sel_hi:[0,1]
    v_pk_mul_f32 v[148:149], v[22:23], v[72:73] op_sel:[0,0] op_sel_hi:[0,1]
    v_pk_mul_f32 v[150:151], v[22:23], v[74:75] op_sel:[0,0] op_sel_hi:[0,1]
    v_exp_f32 v144, v144
    v_exp_f32 v145, v145
    v_exp_f32 v146, v146
    v_exp_f32 v147, v147
    v_exp_f32 v148, v148
    v_exp_f32 v149, v149
    v_exp_f32 v150, v150
    v_exp_f32 v151, v151
    v_pk_fma_f32 v[144:145], v[144:145], v[24:25], v[24:25] op_sel:[0,0,0] op_sel_hi:[1,0,0]
    v_pk_fma_f32 v[146:147], v[146:147], v[24:25], v[24:25] op_sel:[0,0,0] op_sel_hi:[1,0,0]
    v_pk_fma_f32 v[148:149], v[148:149], v[24:25], v[24:25] op_sel:[0,0,0] op_sel_hi:[1,0,0]
    v_pk_fma_f32 v[150:151], v[150:151], v[24:25], v[24:25] op_sel:[0,0,0] op_sel_hi:[1,0,0]
    v_rcp_f32 v144, v144
    v_rcp_f32 v145, v145
    v_rcp_f32 v146, v146
    v_rcp_f32 v147, v147
    v_rcp_f32 v148, v148
    v_rcp_f32 v149, v149
    v_rcp_f32 v150, v150
    v_rcp_f32 v151, v151
    v_pk_mul_f32 v[64:65], v[64:65], v[144:145]
    v_pk_mul_f32 v[66:67], v[66:67], v[146:147]
    v_pk_mul_f32 v[72:73], v[72:73], v[148:149]
    v_pk_mul_f32 v[74:75], v[74:75], v[150:151]
    v_cvt_pk_bf16_f32 v152, v64, v65
    v_cvt_pk_bf16_f32 v153, v66, v67
    v_cvt_pk_bf16_f32 v154, v72, v73
    v_cvt_pk_bf16_f32 v155, v74, v75
    s_add_u32 s38, s38, 4096
    buffer_store_dwordx4 v[152:155], v27, s[16:19], s38 offen offset:0 sc1
    v_pk_fma_f32 v[68:69], v[20:21], v[176:177], v[68:69] op_sel:[1,0,0] op_sel_hi:[1,1,1]
    v_pk_fma_f32 v[70:71], v[20:21], v[178:179], v[70:71] op_sel:[1,0,0] op_sel_hi:[1,1,1]
    v_pk_fma_f32 v[76:77], v[20:21], v[180:181], v[76:77] op_sel:[1,0,0] op_sel_hi:[1,1,1]
    v_pk_fma_f32 v[78:79], v[20:21], v[182:183], v[78:79] op_sel:[1,0,0] op_sel_hi:[1,1,1]
    v_pk_mul_f32 v[144:145], v[22:23], v[68:69] op_sel:[1,0] op_sel_hi:[1,1]
    v_pk_mul_f32 v[146:147], v[22:23], v[70:71] op_sel:[1,0] op_sel_hi:[1,1]
    v_pk_mul_f32 v[148:149], v[22:23], v[76:77] op_sel:[1,0] op_sel_hi:[1,1]
    v_pk_mul_f32 v[150:151], v[22:23], v[78:79] op_sel:[1,0] op_sel_hi:[1,1]
    v_exp_f32 v144, v144
    v_exp_f32 v145, v145
    v_exp_f32 v146, v146
    v_exp_f32 v147, v147
    v_exp_f32 v148, v148
    v_exp_f32 v149, v149
    v_exp_f32 v150, v150
    v_exp_f32 v151, v151
    v_pk_fma_f32 v[144:145], v[144:145], v[24:25], v[24:25] op_sel:[0,1,1] op_sel_hi:[1,1,1]
    v_pk_fma_f32 v[146:147], v[146:147], v[24:25], v[24:25] op_sel:[0,1,1] op_sel_hi:[1,1,1]
    v_pk_fma_f32 v[148:149], v[148:149], v[24:25], v[24:25] op_sel:[0,1,1] op_sel_hi:[1,1,1]
    v_pk_fma_f32 v[150:151], v[150:151], v[24:25], v[24:25] op_sel:[0,1,1] op_sel_hi:[1,1,1]
    v_rcp_f32 v144, v144
    v_rcp_f32 v145, v145
    v_rcp_f32 v146, v146
    v_rcp_f32 v147, v147
    v_rcp_f32 v148, v148
    v_rcp_f32 v149, v149
    v_rcp_f32 v150, v150
    v_rcp_f32 v151, v151
    v_pk_mul_f32 v[68:69], v[68:69], v[144:145]
    v_pk_mul_f32 v[70:71], v[70:71], v[146:147]
    v_pk_mul_f32 v[76:77], v[76:77], v[148:149]
    v_pk_mul_f32 v[78:79], v[78:79], v[150:151]
    v_cvt_pk_bf16_f32 v156, v68, v69
    v_cvt_pk_bf16_f32 v157, v70, v71
    v_cvt_pk_bf16_f32 v158, v76, v77
    v_cvt_pk_bf16_f32 v159, v78, v79
    buffer_store_dwordx4 v[156:159], v27, s[16:19], s38 offen offset:256 sc1
    v_mfma_f32_16x16x32_bf16 v[96:99], a[16:19], a[160:163], v[96:99]
    ds_read_b64_tr_b16 a[76:77], v219 offset:43328
    v_mfma_f32_16x16x32_bf16 v[100:103], a[16:19], a[164:167], v[100:103]
    ds_read_b64_tr_b16 a[78:79], v219 offset:50496
    v_mfma_f32_16x16x32_bf16 v[104:107], a[20:23], a[160:163], v[104:107]
    ds_read_b64_tr_b16 a[80:81], v218 offset:384
    v_mfma_f32_16x16x32_bf16 v[108:111], a[20:23], a[164:167], v[108:111]
    ds_read_b64_tr_b16 a[82:83], v218 offset:7552
    v_mfma_f32_16x16x32_bf16 v[96:99], a[24:27], a[168:171], v[96:99]
    s_waitcnt lgkmcnt(14)
    ds_read_b64_tr_b16 a[84:85], v219 offset:384
    v_mfma_f32_16x16x32_bf16 v[100:103], a[24:27], a[172:175], v[100:103]
    ds_read_b64_tr_b16 a[86:87], v219 offset:7552
    v_mfma_f32_16x16x32_bf16 v[104:107], a[28:31], a[168:171], v[104:107]
    ds_read_b64_tr_b16 a[88:89], v218 offset:14720
    v_mfma_f32_16x16x32_bf16 v[108:111], a[28:31], a[172:175], v[108:111]
    ds_read_b64_tr_b16 a[90:91], v218 offset:21888
    v_mfma_f32_16x16x32_bf16 v[96:99], a[32:35], a[176:179], v[96:99]
    ds_read_b64_tr_b16 a[92:93], v219 offset:14720
    v_mfma_f32_16x16x32_bf16 v[100:103], a[32:35], a[180:183], v[100:103]
    ds_read_b64_tr_b16 a[94:95], v219 offset:21888
    v_mfma_f32_16x16x32_bf16 v[104:107], a[36:39], a[176:179], v[104:107]
    ds_read_b64_tr_b16 a[96:97], v218 offset:29056
    v_mfma_f32_16x16x32_bf16 v[108:111], a[36:39], a[180:183], v[108:111]
    ds_read_b64_tr_b16 a[98:99], v218 offset:36224
    v_mfma_f32_16x16x32_bf16 v[96:99], a[40:43], a[184:187], v[96:99]
    ds_read_b64_tr_b16 a[100:101], v219 offset:29056
    v_mfma_f32_16x16x32_bf16 v[100:103], a[40:43], a[188:191], v[100:103]
    ds_read_b64_tr_b16 a[102:103], v219 offset:36224
    v_mfma_f32_16x16x32_bf16 v[104:107], a[44:47], a[184:187], v[104:107]
    ds_read_b64_tr_b16 a[104:105], v218 offset:43392
    v_mfma_f32_16x16x32_bf16 v[108:111], a[44:47], a[188:191], v[108:111]
    ds_read_b64_tr_b16 a[106:107], v218 offset:50560
    v_pk_fma_f32 v[80:81], v[20:21], v[184:185], v[80:81] op_sel:[0,0,0] op_sel_hi:[0,1,1]
    v_pk_fma_f32 v[82:83], v[20:21], v[186:187], v[82:83] op_sel:[0,0,0] op_sel_hi:[0,1,1]
    v_pk_fma_f32 v[88:89], v[20:21], v[188:189], v[88:89] op_sel:[0,0,0] op_sel_hi:[0,1,1]
    v_pk_fma_f32 v[90:91], v[20:21], v[190:191], v[90:91] op_sel:[0,0,0] op_sel_hi:[0,1,1]
    v_pk_mul_f32 v[144:145], v[22:23], v[80:81] op_sel:[0,0] op_sel_hi:[0,1]
    v_pk_mul_f32 v[146:147], v[22:23], v[82:83] op_sel:[0,0] op_sel_hi:[0,1]
    v_pk_mul_f32 v[148:149], v[22:23], v[88:89] op_sel:[0,0] op_sel_hi:[0,1]
    v_pk_mul_f32 v[150:151], v[22:23], v[90:91] op_sel:[0,0] op_sel_hi:[0,1]
    v_exp_f32 v144, v144
    v_exp_f32 v145, v145
    v_exp_f32 v146, v146
    v_exp_f32 v147, v147
    v_exp_f32 v148, v148
    v_exp_f32 v149, v149
    v_exp_f32 v150, v150
    v_exp_f32 v151, v151
    v_pk_fma_f32 v[144:145], v[144:145], v[24:25], v[24:25] op_sel:[0,0,0] op_sel_hi:[1,0,0]
    v_pk_fma_f32 v[146:147], v[146:147], v[24:25], v[24:25] op_sel:[0,0,0] op_sel_hi:[1,0,0]
    v_pk_fma_f32 v[148:149], v[148:149], v[24:25], v[24:25] op_sel:[0,0,0] op_sel_hi:[1,0,0]
    v_pk_fma_f32 v[150:151], v[150:151], v[24:25], v[24:25] op_sel:[0,0,0] op_sel_hi:[1,0,0]
    v_rcp_f32 v144, v144
    v_rcp_f32 v145, v145
    v_rcp_f32 v146, v146
    v_rcp_f32 v147, v147
    v_rcp_f32 v148, v148
    v_rcp_f32 v149, v149
    v_rcp_f32 v150, v150
    v_rcp_f32 v151, v151
    v_pk_mul_f32 v[80:81], v[80:81], v[144:145]
    v_pk_mul_f32 v[82:83], v[82:83], v[146:147]
    v_pk_mul_f32 v[88:89], v[88:89], v[148:149]
    v_pk_mul_f32 v[90:91], v[90:91], v[150:151]
    v_cvt_pk_bf16_f32 v152, v80, v81
    v_cvt_pk_bf16_f32 v153, v82, v83
    v_cvt_pk_bf16_f32 v154, v88, v89
    v_cvt_pk_bf16_f32 v155, v90, v91
    buffer_store_dwordx4 v[152:155], v27, s[16:19], s38 offen offset:2048 sc1
    v_pk_fma_f32 v[84:85], v[20:21], v[184:185], v[84:85] op_sel:[1,0,0] op_sel_hi:[1,1,1]
    v_pk_fma_f32 v[86:87], v[20:21], v[186:187], v[86:87] op_sel:[1,0,0] op_sel_hi:[1,1,1]
    v_pk_fma_f32 v[92:93], v[20:21], v[188:189], v[92:93] op_sel:[1,0,0] op_sel_hi:[1,1,1]
    v_pk_fma_f32 v[94:95], v[20:21], v[190:191], v[94:95] op_sel:[1,0,0] op_sel_hi:[1,1,1]
    v_pk_mul_f32 v[144:145], v[22:23], v[84:85] op_sel:[1,0] op_sel_hi:[1,1]
    v_pk_mul_f32 v[146:147], v[22:23], v[86:87] op_sel:[1,0] op_sel_hi:[1,1]
    v_pk_mul_f32 v[148:149], v[22:23], v[92:93] op_sel:[1,0] op_sel_hi:[1,1]
    v_pk_mul_f32 v[150:151], v[22:23], v[94:95] op_sel:[1,0] op_sel_hi:[1,1]
    v_exp_f32 v144, v144
    v_exp_f32 v145, v145
    v_exp_f32 v146, v146
    v_exp_f32 v147, v147
    v_exp_f32 v148, v148
    v_exp_f32 v149, v149
    v_exp_f32 v150, v150
    v_exp_f32 v151, v151
    v_pk_fma_f32 v[144:145], v[144:145], v[24:25], v[24:25] op_sel:[0,1,1] op_sel_hi:[1,1,1]
    v_pk_fma_f32 v[146:147], v[146:147], v[24:25], v[24:25] op_sel:[0,1,1] op_sel_hi:[1,1,1]
    v_pk_fma_f32 v[148:149], v[148:149], v[24:25], v[24:25] op_sel:[0,1,1] op_sel_hi:[1,1,1]
    v_pk_fma_f32 v[150:151], v[150:151], v[24:25], v[24:25] op_sel:[0,1,1] op_sel_hi:[1,1,1]
    v_rcp_f32 v144, v144
    v_rcp_f32 v145, v145
    v_rcp_f32 v146, v146
    v_rcp_f32 v147, v147
    v_rcp_f32 v148, v148
    v_rcp_f32 v149, v149
    v_rcp_f32 v150, v150
    v_rcp_f32 v151, v151
    v_pk_mul_f32 v[84:85], v[84:85], v[144:145]
    v_pk_mul_f32 v[86:87], v[86:87], v[146:147]
    v_pk_mul_f32 v[92:93], v[92:93], v[148:149]
    v_pk_mul_f32 v[94:95], v[94:95], v[150:151]
    v_cvt_pk_bf16_f32 v156, v84, v85
    v_cvt_pk_bf16_f32 v157, v86, v87
    v_cvt_pk_bf16_f32 v158, v92, v93
    v_cvt_pk_bf16_f32 v159, v94, v95
    buffer_store_dwordx4 v[156:159], v27, s[16:19], s38 offen offset:2304 sc1
    v_mfma_f32_16x16x32_bf16 v[112:115], a[48:51], a[160:163], v[112:115]
    ds_read_b64_tr_b16 a[108:109], v219 offset:43392
    v_mfma_f32_16x16x32_bf16 v[116:119], a[48:51], a[164:167], v[116:119]
    ds_read_b64_tr_b16 a[110:111], v219 offset:50560
    v_mfma_f32_16x16x32_bf16 v[120:123], a[52:55], a[160:163], v[120:123]
    v_mfma_f32_16x16x32_bf16 v[124:127], a[52:55], a[164:167], v[124:127]
    s_waitcnt lgkmcnt(14)
    v_mfma_f32_16x16x32_bf16 v[112:115], a[56:59], a[168:171], v[112:115]
    v_mfma_f32_16x16x32_bf16 v[116:119], a[56:59], a[172:175], v[116:119]
    v_mfma_f32_16x16x32_bf16 v[120:123], a[60:63], a[168:171], v[120:123]
    v_mfma_f32_16x16x32_bf16 v[124:127], a[60:63], a[172:175], v[124:127]
    v_mfma_f32_16x16x32_bf16 v[112:115], a[64:67], a[176:179], v[112:115]
    v_mfma_f32_16x16x32_bf16 v[116:119], a[64:67], a[180:183], v[116:119]
    v_mfma_f32_16x16x32_bf16 v[120:123], a[68:71], a[176:179], v[120:123]
    v_mfma_f32_16x16x32_bf16 v[124:127], a[68:71], a[180:183], v[124:127]
    v_mfma_f32_16x16x32_bf16 v[112:115], a[72:75], a[184:187], v[112:115]
    v_mfma_f32_16x16x32_bf16 v[116:119], a[72:75], a[188:191], v[116:119]
    v_mfma_f32_16x16x32_bf16 v[120:123], a[76:79], a[184:187], v[120:123]
    v_mfma_f32_16x16x32_bf16 v[124:127], a[76:79], a[188:191], v[124:127]
    v_pk_fma_f32 v[96:97], v[20:21], v[192:193], v[96:97] op_sel:[0,0,0] op_sel_hi:[0,1,1]
    v_pk_fma_f32 v[98:99], v[20:21], v[194:195], v[98:99] op_sel:[0,0,0] op_sel_hi:[0,1,1]
    v_pk_fma_f32 v[104:105], v[20:21], v[196:197], v[104:105] op_sel:[0,0,0] op_sel_hi:[0,1,1]
    v_pk_fma_f32 v[106:107], v[20:21], v[198:199], v[106:107] op_sel:[0,0,0] op_sel_hi:[0,1,1]
    v_pk_mul_f32 v[144:145], v[22:23], v[96:97] op_sel:[0,0] op_sel_hi:[0,1]
    v_pk_mul_f32 v[146:147], v[22:23], v[98:99] op_sel:[0,0] op_sel_hi:[0,1]
    v_pk_mul_f32 v[148:149], v[22:23], v[104:105] op_sel:[0,0] op_sel_hi:[0,1]
    v_pk_mul_f32 v[150:151], v[22:23], v[106:107] op_sel:[0,0] op_sel_hi:[0,1]
    v_exp_f32 v144, v144
    v_exp_f32 v145, v145
    v_exp_f32 v146, v146
    v_exp_f32 v147, v147
    v_exp_f32 v148, v148
    v_exp_f32 v149, v149
    v_exp_f32 v150, v150
    v_exp_f32 v151, v151
    v_pk_fma_f32 v[144:145], v[144:145], v[24:25], v[24:25] op_sel:[0,0,0] op_sel_hi:[1,0,0]
    v_pk_fma_f32 v[146:147], v[146:147], v[24:25], v[24:25] op_sel:[0,0,0] op_sel_hi:[1,0,0]
    v_pk_fma_f32 v[148:149], v[148:149], v[24:25], v[24:25] op_sel:[0,0,0] op_sel_hi:[1,0,0]
    v_pk_fma_f32 v[150:151], v[150:151], v[24:25], v[24:25] op_sel:[0,0,0] op_sel_hi:[1,0,0]
    v_rcp_f32 v144, v144
    v_rcp_f32 v145, v145
    v_rcp_f32 v146, v146
    v_rcp_f32 v147, v147
    v_rcp_f32 v148, v148
    v_rcp_f32 v149, v149
    v_rcp_f32 v150, v150
    v_rcp_f32 v151, v151
    v_pk_mul_f32 v[96:97], v[96:97], v[144:145]
    v_pk_mul_f32 v[98:99], v[98:99], v[146:147]
    v_pk_mul_f32 v[104:105], v[104:105], v[148:149]
    v_pk_mul_f32 v[106:107], v[106:107], v[150:151]
    v_cvt_pk_bf16_f32 v152, v96, v97
    v_cvt_pk_bf16_f32 v153, v98, v99
    v_cvt_pk_bf16_f32 v154, v104, v105
    v_cvt_pk_bf16_f32 v155, v106, v107
    s_add_u32 s38, s38, 4096
    buffer_store_dwordx4 v[152:155], v27, s[16:19], s38 offen offset:0 sc1
    v_pk_fma_f32 v[100:101], v[20:21], v[192:193], v[100:101] op_sel:[1,0,0] op_sel_hi:[1,1,1]
    v_pk_fma_f32 v[102:103], v[20:21], v[194:195], v[102:103] op_sel:[1,0,0] op_sel_hi:[1,1,1]
    v_pk_fma_f32 v[108:109], v[20:21], v[196:197], v[108:109] op_sel:[1,0,0] op_sel_hi:[1,1,1]
    v_pk_fma_f32 v[110:111], v[20:21], v[198:199], v[110:111] op_sel:[1,0,0] op_sel_hi:[1,1,1]
    v_pk_mul_f32 v[144:145], v[22:23], v[100:101] op_sel:[1,0] op_sel_hi:[1,1]
    v_pk_mul_f32 v[146:147], v[22:23], v[102:103] op_sel:[1,0] op_sel_hi:[1,1]
    v_pk_mul_f32 v[148:149], v[22:23], v[108:109] op_sel:[1,0] op_sel_hi:[1,1]
    v_pk_mul_f32 v[150:151], v[22:23], v[110:111] op_sel:[1,0] op_sel_hi:[1,1]
    v_exp_f32 v144, v144
    v_exp_f32 v145, v145
    v_exp_f32 v146, v146
    v_exp_f32 v147, v147
    v_exp_f32 v148, v148
    v_exp_f32 v149, v149
    v_exp_f32 v150, v150
    v_exp_f32 v151, v151
    v_pk_fma_f32 v[144:145], v[144:145], v[24:25], v[24:25] op_sel:[0,1,1] op_sel_hi:[1,1,1]
    v_pk_fma_f32 v[146:147], v[146:147], v[24:25], v[24:25] op_sel:[0,1,1] op_sel_hi:[1,1,1]
    v_pk_fma_f32 v[148:149], v[148:149], v[24:25], v[24:25] op_sel:[0,1,1] op_sel_hi:[1,1,1]
    v_pk_fma_f32 v[150:151], v[150:151], v[24:25], v[24:25] op_sel:[0,1,1] op_sel_hi:[1,1,1]
    v_rcp_f32 v144, v144
    v_rcp_f32 v145, v145
    v_rcp_f32 v146, v146
    v_rcp_f32 v147, v147
    v_rcp_f32 v148, v148
    v_rcp_f32 v149, v149
    v_rcp_f32 v150, v150
    v_rcp_f32 v151, v151
    v_pk_mul_f32 v[100:101], v[100:101], v[144:145]
    v_pk_mul_f32 v[102:103], v[102:103], v[146:147]
    v_pk_mul_f32 v[108:109], v[108:109], v[148:149]
    v_pk_mul_f32 v[110:111], v[110:111], v[150:151]
    v_cvt_pk_bf16_f32 v156, v100, v101
    v_cvt_pk_bf16_f32 v157, v102, v103
    v_cvt_pk_bf16_f32 v158, v108, v109
    v_cvt_pk_bf16_f32 v159, v110, v111
    buffer_store_dwordx4 v[156:159], v27, s[16:19], s38 offen offset:256 sc1
    v_mfma_f32_16x16x32_bf16 v[128:131], a[80:83], a[160:163], v[128:131]
    s_waitcnt lgkmcnt(0)
    v_mfma_f32_16x16x32_bf16 v[132:135], a[80:83], a[164:167], v[132:135]
    v_mfma_f32_16x16x32_bf16 v[136:139], a[84:87], a[160:163], v[136:139]
    v_mfma_f32_16x16x32_bf16 v[140:143], a[84:87], a[164:167], v[140:143]
    v_mfma_f32_16x16x32_bf16 v[128:131], a[88:91], a[168:171], v[128:131]
    v_mfma_f32_16x16x32_bf16 v[132:135], a[88:91], a[172:175], v[132:135]
    v_mfma_f32_16x16x32_bf16 v[136:139], a[92:95], a[168:171], v[136:139]
    v_mfma_f32_16x16x32_bf16 v[140:143], a[92:95], a[172:175], v[140:143]
    v_mfma_f32_16x16x32_bf16 v[128:131], a[96:99], a[176:179], v[128:131]
    v_mfma_f32_16x16x32_bf16 v[132:135], a[96:99], a[180:183], v[132:135]
    v_mfma_f32_16x16x32_bf16 v[136:139], a[100:103], a[176:179], v[136:139]
    v_mfma_f32_16x16x32_bf16 v[140:143], a[100:103], a[180:183], v[140:143]
    v_mfma_f32_16x16x32_bf16 v[128:131], a[104:107], a[184:187], v[128:131]
    v_mfma_f32_16x16x32_bf16 v[132:135], a[104:107], a[188:191], v[132:135]
    v_mfma_f32_16x16x32_bf16 v[136:139], a[108:111], a[184:187], v[136:139]
    v_mfma_f32_16x16x32_bf16 v[140:143], a[108:111], a[188:191], v[140:143]
    v_pk_fma_f32 v[112:113], v[20:21], v[200:201], v[112:113] op_sel:[0,0,0] op_sel_hi:[0,1,1]
    v_pk_fma_f32 v[114:115], v[20:21], v[202:203], v[114:115] op_sel:[0,0,0] op_sel_hi:[0,1,1]
    v_pk_fma_f32 v[120:121], v[20:21], v[204:205], v[120:121] op_sel:[0,0,0] op_sel_hi:[0,1,1]
    v_pk_fma_f32 v[122:123], v[20:21], v[206:207], v[122:123] op_sel:[0,0,0] op_sel_hi:[0,1,1]
    v_pk_mul_f32 v[144:145], v[22:23], v[112:113] op_sel:[0,0] op_sel_hi:[0,1]
    v_pk_mul_f32 v[146:147], v[22:23], v[114:115] op_sel:[0,0] op_sel_hi:[0,1]
    v_pk_mul_f32 v[148:149], v[22:23], v[120:121] op_sel:[0,0] op_sel_hi:[0,1]
    v_pk_mul_f32 v[150:151], v[22:23], v[122:123] op_sel:[0,0] op_sel_hi:[0,1]
    v_exp_f32 v144, v144
    v_exp_f32 v145, v145
    v_exp_f32 v146, v146
    v_exp_f32 v147, v147
    v_exp_f32 v148, v148
    v_exp_f32 v149, v149
    v_exp_f32 v150, v150
    v_exp_f32 v151, v151
    v_pk_fma_f32 v[144:145], v[144:145], v[24:25], v[24:25] op_sel:[0,0,0] op_sel_hi:[1,0,0]
    v_pk_fma_f32 v[146:147], v[146:147], v[24:25], v[24:25] op_sel:[0,0,0] op_sel_hi:[1,0,0]
    v_pk_fma_f32 v[148:149], v[148:149], v[24:25], v[24:25] op_sel:[0,0,0] op_sel_hi:[1,0,0]
    v_pk_fma_f32 v[150:151], v[150:151], v[24:25], v[24:25] op_sel:[0,0,0] op_sel_hi:[1,0,0]
    v_rcp_f32 v144, v144
    v_rcp_f32 v145, v145
    v_rcp_f32 v146, v146
    v_rcp_f32 v147, v147
    v_rcp_f32 v148, v148
    v_rcp_f32 v149, v149
    v_rcp_f32 v150, v150
    v_rcp_f32 v151, v151
    v_pk_mul_f32 v[112:113], v[112:113], v[144:145]
    v_pk_mul_f32 v[114:115], v[114:115], v[146:147]
    v_pk_mul_f32 v[120:121], v[120:121], v[148:149]
    v_pk_mul_f32 v[122:123], v[122:123], v[150:151]
    v_cvt_pk_bf16_f32 v152, v112, v113
    v_cvt_pk_bf16_f32 v153, v114, v115
    v_cvt_pk_bf16_f32 v154, v120, v121
    v_cvt_pk_bf16_f32 v155, v122, v123
    buffer_store_dwordx4 v[152:155], v27, s[16:19], s38 offen offset:2048 sc1
    v_pk_fma_f32 v[116:117], v[20:21], v[200:201], v[116:117] op_sel:[1,0,0] op_sel_hi:[1,1,1]
    v_pk_fma_f32 v[118:119], v[20:21], v[202:203], v[118:119] op_sel:[1,0,0] op_sel_hi:[1,1,1]
    v_pk_fma_f32 v[124:125], v[20:21], v[204:205], v[124:125] op_sel:[1,0,0] op_sel_hi:[1,1,1]
    v_pk_fma_f32 v[126:127], v[20:21], v[206:207], v[126:127] op_sel:[1,0,0] op_sel_hi:[1,1,1]
    v_pk_mul_f32 v[144:145], v[22:23], v[116:117] op_sel:[1,0] op_sel_hi:[1,1]
    v_pk_mul_f32 v[146:147], v[22:23], v[118:119] op_sel:[1,0] op_sel_hi:[1,1]
    v_pk_mul_f32 v[148:149], v[22:23], v[124:125] op_sel:[1,0] op_sel_hi:[1,1]
    v_pk_mul_f32 v[150:151], v[22:23], v[126:127] op_sel:[1,0] op_sel_hi:[1,1]
    v_exp_f32 v144, v144
    v_exp_f32 v145, v145
    v_exp_f32 v146, v146
    v_exp_f32 v147, v147
    v_exp_f32 v148, v148
    v_exp_f32 v149, v149
    v_exp_f32 v150, v150
    v_exp_f32 v151, v151
    v_pk_fma_f32 v[144:145], v[144:145], v[24:25], v[24:25] op_sel:[0,1,1] op_sel_hi:[1,1,1]
    v_pk_fma_f32 v[146:147], v[146:147], v[24:25], v[24:25] op_sel:[0,1,1] op_sel_hi:[1,1,1]
    v_pk_fma_f32 v[148:149], v[148:149], v[24:25], v[24:25] op_sel:[0,1,1] op_sel_hi:[1,1,1]
    v_pk_fma_f32 v[150:151], v[150:151], v[24:25], v[24:25] op_sel:[0,1,1] op_sel_hi:[1,1,1]
    v_rcp_f32 v144, v144
    v_rcp_f32 v145, v145
    v_rcp_f32 v146, v146
    v_rcp_f32 v147, v147
    v_rcp_f32 v148, v148
    v_rcp_f32 v149, v149
    v_rcp_f32 v150, v150
    v_rcp_f32 v151, v151
    v_pk_mul_f32 v[116:117], v[116:117], v[144:145]
    v_pk_mul_f32 v[118:119], v[118:119], v[146:147]
    v_pk_mul_f32 v[124:125], v[124:125], v[148:149]
    v_pk_mul_f32 v[126:127], v[126:127], v[150:151]
    v_cvt_pk_bf16_f32 v156, v116, v117
    v_cvt_pk_bf16_f32 v157, v118, v119
    v_cvt_pk_bf16_f32 v158, v124, v125
    v_cvt_pk_bf16_f32 v159, v126, v127
    buffer_store_dwordx4 v[156:159], v27, s[16:19], s38 offen offset:2304 sc1
    s_nop 7
    v_pk_fma_f32 v[128:129], v[20:21], v[208:209], v[128:129] op_sel:[0,0,0] op_sel_hi:[0,1,1]
    v_pk_fma_f32 v[130:131], v[20:21], v[210:211], v[130:131] op_sel:[0,0,0] op_sel_hi:[0,1,1]
    v_pk_fma_f32 v[136:137], v[20:21], v[212:213], v[136:137] op_sel:[0,0,0] op_sel_hi:[0,1,1]
    v_pk_fma_f32 v[138:139], v[20:21], v[214:215], v[138:139] op_sel:[0,0,0] op_sel_hi:[0,1,1]
    v_pk_mul_f32 v[144:145], v[22:23], v[128:129] op_sel:[0,0] op_sel_hi:[0,1]
    v_pk_mul_f32 v[146:147], v[22:23], v[130:131] op_sel:[0,0] op_sel_hi:[0,1]
    v_pk_mul_f32 v[148:149], v[22:23], v[136:137] op_sel:[0,0] op_sel_hi:[0,1]
    v_pk_mul_f32 v[150:151], v[22:23], v[138:139] op_sel:[0,0] op_sel_hi:[0,1]
    v_exp_f32 v144, v144
    v_exp_f32 v145, v145
    v_exp_f32 v146, v146
    v_exp_f32 v147, v147
    v_exp_f32 v148, v148
    v_exp_f32 v149, v149
    v_exp_f32 v150, v150
    v_exp_f32 v151, v151
    v_pk_fma_f32 v[144:145], v[144:145], v[24:25], v[24:25] op_sel:[0,0,0] op_sel_hi:[1,0,0]
    v_pk_fma_f32 v[146:147], v[146:147], v[24:25], v[24:25] op_sel:[0,0,0] op_sel_hi:[1,0,0]
    v_pk_fma_f32 v[148:149], v[148:149], v[24:25], v[24:25] op_sel:[0,0,0] op_sel_hi:[1,0,0]
    v_pk_fma_f32 v[150:151], v[150:151], v[24:25], v[24:25] op_sel:[0,0,0] op_sel_hi:[1,0,0]
    v_rcp_f32 v144, v144
    v_rcp_f32 v145, v145
    v_rcp_f32 v146, v146
    v_rcp_f32 v147, v147
    v_rcp_f32 v148, v148
    v_rcp_f32 v149, v149
    v_rcp_f32 v150, v150
    v_rcp_f32 v151, v151
    v_pk_mul_f32 v[128:129], v[128:129], v[144:145]
    v_pk_mul_f32 v[130:131], v[130:131], v[146:147]
    v_pk_mul_f32 v[136:137], v[136:137], v[148:149]
    v_pk_mul_f32 v[138:139], v[138:139], v[150:151]
    v_cvt_pk_bf16_f32 v152, v128, v129
    v_cvt_pk_bf16_f32 v153, v130, v131
    v_cvt_pk_bf16_f32 v154, v136, v137
    v_cvt_pk_bf16_f32 v155, v138, v139
    s_add_u32 s38, s38, 4096
    buffer_store_dwordx4 v[152:155], v27, s[16:19], s38 offen offset:0 sc1
    v_pk_fma_f32 v[132:133], v[20:21], v[208:209], v[132:133] op_sel:[1,0,0] op_sel_hi:[1,1,1]
    v_pk_fma_f32 v[134:135], v[20:21], v[210:211], v[134:135] op_sel:[1,0,0] op_sel_hi:[1,1,1]
    v_pk_fma_f32 v[140:141], v[20:21], v[212:213], v[140:141] op_sel:[1,0,0] op_sel_hi:[1,1,1]
    v_pk_fma_f32 v[142:143], v[20:21], v[214:215], v[142:143] op_sel:[1,0,0] op_sel_hi:[1,1,1]
    v_pk_mul_f32 v[144:145], v[22:23], v[132:133] op_sel:[1,0] op_sel_hi:[1,1]
    v_pk_mul_f32 v[146:147], v[22:23], v[134:135] op_sel:[1,0] op_sel_hi:[1,1]
    v_pk_mul_f32 v[148:149], v[22:23], v[140:141] op_sel:[1,0] op_sel_hi:[1,1]
    v_pk_mul_f32 v[150:151], v[22:23], v[142:143] op_sel:[1,0] op_sel_hi:[1,1]
    v_exp_f32 v144, v144
    v_exp_f32 v145, v145
    v_exp_f32 v146, v146
    v_exp_f32 v147, v147
    v_exp_f32 v148, v148
    v_exp_f32 v149, v149
    v_exp_f32 v150, v150
    v_exp_f32 v151, v151
    v_pk_fma_f32 v[144:145], v[144:145], v[24:25], v[24:25] op_sel:[0,1,1] op_sel_hi:[1,1,1]
    v_pk_fma_f32 v[146:147], v[146:147], v[24:25], v[24:25] op_sel:[0,1,1] op_sel_hi:[1,1,1]
    v_pk_fma_f32 v[148:149], v[148:149], v[24:25], v[24:25] op_sel:[0,1,1] op_sel_hi:[1,1,1]
    v_pk_fma_f32 v[150:151], v[150:151], v[24:25], v[24:25] op_sel:[0,1,1] op_sel_hi:[1,1,1]
    v_rcp_f32 v144, v144
    v_rcp_f32 v145, v145
    v_rcp_f32 v146, v146
    v_rcp_f32 v147, v147
    v_rcp_f32 v148, v148
    v_rcp_f32 v149, v149
    v_rcp_f32 v150, v150
    v_rcp_f32 v151, v151
    v_pk_mul_f32 v[132:133], v[132:133], v[144:145]
    v_pk_mul_f32 v[134:135], v[134:135], v[146:147]
    v_pk_mul_f32 v[140:141], v[140:141], v[148:149]
    v_pk_mul_f32 v[142:143], v[142:143], v[150:151]
    v_cvt_pk_bf16_f32 v156, v132, v133
    v_cvt_pk_bf16_f32 v157, v134, v135
    v_cvt_pk_bf16_f32 v158, v140, v141
    v_cvt_pk_bf16_f32 v159, v142, v143
    buffer_store_dwordx4 v[156:159], v27, s[16:19], s38 offen offset:256 sc1
back_p5:
    s_lshr_b32 s3, s2, 3
    s_bfe_u32 s29, s2, 0x10001
    s_lshl_b32 s36, s2, 3
    s_and_b32 s36, s36, 8
    s_xor_b32 s36, s36, 8
    s_and_b32 s37, s3, 7
    s_add_u32 s36, s36, s37
    s_and_b32 s31, s2, 4
    s_lshr_b32 s3, s3, 3
    s_add_u32 s31, s31, s3
    s_lshl_b32 s30, s36, 2
    s_add_u32 s30, s30, s28
    v_lshrrev_b32 v2, 4, v1
    v_and_b32 v3, 15, v1
    v_lshlrev_b32 v4, 1, v2
    v_xor_b32 v3, v3, v4
    s_lshl_b32 s3, s28, 4
    s_mul_i32 s36, s29, 1792
    s_add_u32 s3, s3, s36
    v_add_u32 v2, s3, v2
    v_lshlrev_b32 v2, 11, v2
    s_lshl_b32 s3, s31, 8
    v_add_u32 v2, s3, v2
    v_lshl_add_u32 v4, v3, 4, v2
    v_xor_b32 v3, 8, v3
    v_lshl_add_u32 v2, v3, 4, v2
    v_add_u32 v12, 0, v4
    v_add_u32 v13, 7168, v2
    v_add_u32 v14, 14336, v4
    v_add_u32 v15, 21504, v2
    s_mul_i32 s3, s30, 229376
    s_mul_i32 s36, s29, 114688
    s_add_u32 s3, s3, s36
    s_add_u32 s3, s3, 58720256
    v_add_u32 v9, s3, v27
    s_lshl_b32 s34, s28, 12
    s_add_u32 s41, s34, 0x10000
    s_mov_b32 s48, 0
    s_mov_b32 s52, 0
    s_mov_b32 s8, s74
    s_and_b32 s9, s75, 0xffff
    s_mov_b32 s10, 0x700000
    s_mov_b32 s11, 0x20000
    v_mov_b32 v32, 0
    v_mov_b32 v33, 0
    v_mov_b32 v34, 0
    v_mov_b32 v35, 0
    v_mov_b32 v36, 0
    v_mov_b32 v37, 0
    v_mov_b32 v38, 0
    v_mov_b32 v39, 0
    v_mov_b32 v40, 0
    v_mov_b32 v41, 0
    v_mov_b32 v42, 0
    v_mov_b32 v43, 0
    v_mov_b32 v44, 0
    v_mov_b32 v45, 0
    v_mov_b32 v46, 0
    v_mov_b32 v47, 0
    v_mov_b32 v48, 0
    v_mov_b32 v49, 0
    v_mov_b32 v50, 0
    v_mov_b32 v51, 0
    v_mov_b32 v52, 0
    v_mov_b32 v53, 0
    v_mov_b32 v54, 0
    v_mov_b32 v55, 0
    v_mov_b32 v56, 0
    v_mov_b32 v57, 0
    v_mov_b32 v58, 0
    v_mov_b32 v59, 0
    v_mov_b32 v60, 0
    v_mov_b32 v61, 0
    v_mov_b32 v62, 0
    v_mov_b32 v63, 0
    v_mov_b32 v64, 0
    v_mov_b32 v65, 0
    v_mov_b32 v66, 0
    v_mov_b32 v67, 0
    v_mov_b32 v68, 0
    v_mov_b32 v69, 0
    v_mov_b32 v70, 0
    v_mov_b32 v71, 0
    v_mov_b32 v72, 0
    v_mov_b32 v73, 0
    v_mov_b32 v74, 0
    v_mov_b32 v75, 0
    v_mov_b32 v76, 0
    v_mov_b32 v77, 0
    v_mov_b32 v78, 0
    v_mov_b32 v79, 0
    v_mov_b32 v80, 0
    v_mov_b32 v81, 0
    v_mov_b32 v82, 0
    v_mov_b32 v83, 0
    v_mov_b32 v84, 0
    v_mov_b32 v85, 0
    v_mov_b32 v86, 0
    v_mov_b32 v87, 0
    v_mov_b32 v88, 0
    v_mov_b32 v89, 0
    v_mov_b32 v90, 0
    v_mov_b32 v91, 0
    v_mov_b32 v92, 0
    v_mov_b32 v93, 0
    v_mov_b32 v94, 0
    v_mov_b32 v95, 0
    v_mov_b32 v5, 1
    s_mov_b32 s3, 32768
    s_waitcnt vmcnt(0)
    s_barrier
    buffer_store_dword v5, v6, s[16:19], s3 offen sc1
    s_add_u32 m0, s34, 0
    s_nop 0
    buffer_load_dwordx4 v12, s[8:11], s48 offen offset:0 lds
    buffer_load_dwordx4 v13, s[8:11], s48 offen offset:1024 lds
    buffer_load_dwordx4 v14, s[8:11], s48 offen offset:2048 lds
    buffer_load_dwordx4 v15, s[8:11], s48 offen offset:3072 lds
    s_add_u32 s48, s48, 131072
    s_add_u32 m0, s34, 16384
    s_nop 0
    buffer_load_dwordx4 v12, s[8:11], s48 offen offset:0 lds
    buffer_load_dwordx4 v13, s[8:11], s48 offen offset:1024 lds
    buffer_load_dwordx4 v14, s[8:11], s48 offen offset:2048 lds
    buffer_load_dwordx4 v15, s[8:11], s48 offen offset:3072 lds
    s_add_u32 s48, s48, 131072
    s_add_u32 m0, s34, 32768
    s_nop 0
    buffer_load_dwordx4 v12, s[8:11], s48 offen offset:0 lds
    buffer_load_dwordx4 v13, s[8:11], s48 offen offset:1024 lds
    s_mov_b32 s20, s76
    s_and_b32 s21, s77, 0xffff
    s_mov_b32 s22, 0x400000
    s_mov_b32 s23, 0x20000
    v_bfe_u32 v2, v1, 2, 3
    v_lshrrev_b32 v3, 5, v1
    v_lshl_add_u32 v3, v3, 3, v2
    v_lshlrev_b32 v3, 8, v3
    v_and_b32 v4, 3, v1
    v_lshl_add_u32 v3, v4, 3, v3
    s_lshl_b32 s3, s29, 2
    v_xor_b32 v2, s3, v2
    v_xor_b32 v4, 0, v2
    v_lshl_add_u32 v208, v4, 5, v3
    v_xor_b32 v4, 1, v2
    v_lshl_add_u32 v209, v4, 5, v3
    v_xor_b32 v4, 2, v2
    v_lshl_add_u32 v210, v4, 5, v3
    v_xor_b32 v4, 3, v2
    v_lshl_add_u32 v211, v4, 5, v3
    v_xor_b32 v4, 4, v2
    v_lshl_add_u32 v212, v4, 5, v3
    v_xor_b32 v4, 5, v2
    v_lshl_add_u32 v213, v4, 5, v3
    v_xor_b32 v4, 6, v2
    v_lshl_add_u32 v214, v4, 5, v3
    v_xor_b32 v4, 7, v2
    v_lshl_add_u32 v215, v4, 5, v3
    v_and_b32 v2, 15, v1
    s_lshl_b32 s3, s30, 5
    v_add_u32 v2, s3, v2
    v_lshlrev_b32 v2, 11, v2
    v_bfe_u32 v3, v1, 4, 1
    v_lshl_add_u32 v2, v3, 5, v2
    v_lshrrev_b32 v3, 5, v1
    v_lshl_add_u32 v2, v3, 4, v2
    s_lshl_b32 s3, s31, 8
    s_lshl_b32 s36, s29, 7
    s_add_u32 s3, s3, s36
    v_add_u32 v10, s3, v2
    s_mov_b32 s33, 0x8000
    s_mul_i32 s3, s30, 65536
    s_lshl_b32 s36, s31, 13
    s_add_u32 s3, s3, s36
    s_lshl_b32 s36, s29, 12
    s_add_u32 s3, s3, s36
    s_add_u32 s3, s3, 54525952
    v_add_u32 v11, s3, v27
    s_lshl_b32 s3, s2, 2
    s_add_u32 s3, s3, s28
    s_lshl_b32 s3, s3, 12
    s_add_u32 s38, s3, 79691776
    s_xor_b32 s3, s3, 0x8000
    s_add_u32 s40, s3, 79691776
    v_mov_b32 v20, 0x3f80
    v_mov_b32 v21, 0x3f800000
    s_lshr_b32 s3, s30, 2
    s_and_b32 s36, s3, 7
    s_lshl_b32 s36, s36, 3
    s_and_b32 s3, s2, 1
    s_add_u32 s36, s36, s3
    s_lshl_b32 s3, s29, 2
    s_add_u32 s36, s36, s3
    v_and_b32 v2, 3, v1
    v_lshlrev_b32 v2, 6, v2
    v_bfe_u32 v3, v1, 2, 1
    v_lshl_add_u32 v2, v3, 1, v2
    v_add_u32 v2, s36, v2
    s_xor_b32 s36, s2, 2
    v_mov_b32 v3, s36
    v_cmp_gt_u32 vcc, 8, v1
    s_nop 1
    v_cndmask_b32 v2, v3, v2, vcc
    v_lshlrev_b32 v2, 7, v2
    v_add_u32 v7, 74219520, v2
    buffer_load_dword v4, v7, s[16:19], 0 offen sc1
    s_mov_b32 s35, 100000
    s_waitcnt vmcnt(0)
    s_branch bk_w5_c
bk_w5:
    s_sleep 4
    buffer_load_dword v4, v7, s[16:19], 0 offen sc1
    s_waitcnt vmcnt(0)
bk_w5_c:
    v_cmp_gt_u32 vcc, 1, v4
    s_sub_u32 s35, s35, 1
    s_cbranch_vccz bk_w5_ok
    s_cmp_lg_u32 s35, 0
    s_cbranch_scc1 bk_w5
bk_w5_ok:
    buffer_load_dwordx4 a[0:3], v9, s[16:19], s52 offen offset:0 sc1
    buffer_load_dwordx4 a[4:7], v9, s[16:19], s52 offen offset:256 sc1
    buffer_load_dwordx4 a[8:11], v9, s[16:19], s52 offen offset:2048 sc1
    buffer_load_dwordx4 a[12:15], v9, s[16:19], s52 offen offset:2304 sc1
    s_add_u32 s52, s52, 4096
    buffer_load_dwordx4 a[16:19], v9, s[16:19], s52 offen offset:0 sc1
    buffer_load_dwordx4 a[20:23], v9, s[16:19], s52 offen offset:256 sc1
    buffer_load_dwordx4 a[24:27], v9, s[16:19], s52 offen offset:2048 sc1
    buffer_load_dwordx4 a[28:31], v9, s[16:19], s52 offen offset:2304 sc1
    s_add_u32 s52, s52, 4096
    buffer_load_dwordx4 v[160:163], v11, s[16:19], 0 offen offset:0 sc1
    buffer_load_dwordx4 v[164:167], v11, s[16:19], 0 offen offset:256 sc1
    buffer_load_dwordx4 v[168:171], v11, s[16:19], 0 offen offset:2048 sc1
    buffer_load_dwordx4 v[172:175], v11, s[16:19], 0 offen offset:2304 sc1
    s_waitcnt vmcnt(4)
    s_waitcnt vmcnt(12)
    s_barrier
    ds_read_b64_tr_b16 v[96:97], v208 offset:0
    ds_read_b64_tr_b16 v[98:99], v208 offset:4096
    ds_read_b64_tr_b16 v[100:101], v209 offset:0
    ds_read_b64_tr_b16 v[102:103], v209 offset:4096
    ds_read_b64_tr_b16 v[104:105], v210 offset:0
    ds_read_b64_tr_b16 v[106:107], v210 offset:4096
    ds_read_b64_tr_b16 v[108:109], v211 offset:0
    ds_read_b64_tr_b16 v[110:111], v211 offset:4096
    ds_read_b64_tr_b16 v[112:113], v212 offset:0
    ds_read_b64_tr_b16 v[114:115], v212 offset:4096
    ds_read_b64_tr_b16 v[116:117], v213 offset:0
    ds_read_b64_tr_b16 v[118:119], v213 offset:4096
    ds_read_b64_tr_b16 v[120:121], v214 offset:0
    ds_read_b64_tr_b16 v[122:123], v214 offset:4096
    ds_read_b64_tr_b16 v[124:125], v215 offset:0
    ds_read_b64_tr_b16 v[126:127], v215 offset:4096
    s_waitcnt lgkmcnt(8)
    s_mov_b32 s35, 6
.p2align 6
    s_nop 0
    s_nop 0
bk5_loop:
    v_mfma_f32_16x16x32_bf16 v[32:35], v[96:99], a[0:3], v[32:35]
    ds_read_b64_tr_b16 v[128:129], v208 offset:8192
    ds_read_b64_tr_b16 v[130:131], v208 offset:12288
    v_mfma_f32_16x16x32_bf16 v[36:39], v[96:99], a[4:7], v[36:39]
    ds_read_b64_tr_b16 v[132:133], v209 offset:8192
    ds_read_b64_tr_b16 v[134:135], v209 offset:12288
    v_mfma_f32_16x16x32_bf16 v[40:43], v[100:103], a[0:3], v[40:43]
    buffer_load_dwordx4 a[32:35], v9, s[16:19], s52 offen offset:0 sc1
    v_mfma_f32_16x16x32_bf16 v[44:47], v[100:103], a[4:7], v[44:47]
    ds_read_b64_tr_b16 v[136:137], v210 offset:8192
    v_mfma_f32_16x16x32_bf16 v[48:51], v[104:107], a[0:3], v[48:51]
    ds_read_b64_tr_b16 v[138:139], v210 offset:12288
    ds_read_b64_tr_b16 v[140:141], v211 offset:8192
    v_mfma_f32_16x16x32_bf16 v[52:55], v[104:107], a[4:7], v[52:55]
    buffer_load_dwordx4 a[36:39], v9, s[16:19], s52 offen offset:256 sc1
    v_mfma_f32_16x16x32_bf16 v[56:59], v[108:111], a[0:3], v[56:59]
    ds_read_b64_tr_b16 v[142:143], v211 offset:12288
    ds_read_b64_tr_b16 v[144:145], v212 offset:8192
    v_mfma_f32_16x16x32_bf16 v[60:63], v[108:111], a[4:7], v[60:63]
    s_waitcnt lgkmcnt(9)
    ds_read_b64_tr_b16 v[146:147], v212 offset:12288
    ds_read_b64_tr_b16 v[148:149], v213 offset:8192
    v_mfma_f32_16x16x32_bf16 v[64:67], v[112:115], a[0:3], v[64:67]
    buffer_load_dwordx4 v14, s[8:11], s48 offen offset:2048 lds
    v_mfma_f32_16x16x32_bf16 v[68:71], v[112:115], a[4:7], v[68:71]
    ds_read_b64_tr_b16 v[150:151], v213 offset:12288
    v_mfma_f32_16x16x32_bf16 v[72:75], v[116:119], a[0:3], v[72:75]
    ds_read_b64_tr_b16 v[152:153], v214 offset:8192
    ds_read_b64_tr_b16 v[154:155], v214 offset:12288
    v_mfma_f32_16x16x32_bf16 v[76:79], v[116:119], a[4:7], v[76:79]
    buffer_load_dwordx4 v15, s[8:11], s48 offen offset:3072 lds
    v_mfma_f32_16x16x32_bf16 v[80:83], v[120:123], a[0:3], v[80:83]
    s_add_u32 s48, s48, 131072
    ds_read_b64_tr_b16 v[156:157], v215 offset:8192
    v_mfma_f32_16x16x32_bf16 v[84:87], v[120:123], a[4:7], v[84:87]
    ds_read_b64_tr_b16 v[158:159], v215 offset:12288
    v_mfma_f32_16x16x32_bf16 v[88:91], v[124:127], a[0:3], v[88:91]
    v_mfma_f32_16x16x32_bf16 v[92:95], v[124:127], a[4:7], v[92:95]
    s_waitcnt vmcnt(14) lgkmcnt(8)
    s_waitcnt vmcnt(8)
    s_barrier
    v_mfma_f32_16x16x32_bf16 v[32:35], v[128:131], a[8:11], v[32:35]
    ds_read_b64_tr_b16 v[96:97], v208 offset:16384
    ds_read_b64_tr_b16 v[98:99], v208 offset:20480
    v_mfma_f32_16x16x32_bf16 v[36:39], v[128:131], a[12:15], v[36:39]
    ds_read_b64_tr_b16 v[100:101], v209 offset:16384
    ds_read_b64_tr_b16 v[102:103], v209 offset:20480
    v_mfma_f32_16x16x32_bf16 v[40:43], v[132:135], a[8:11], v[40:43]
    buffer_load_dwordx4 a[40:43], v9, s[16:19], s52 offen offset:2048 sc1
    v_mfma_f32_16x16x32_bf16 v[44:47], v[132:135], a[12:15], v[44:47]
    ds_read_b64_tr_b16 v[104:105], v210 offset:16384
    v_mfma_f32_16x16x32_bf16 v[48:51], v[136:139], a[8:11], v[48:51]
    ds_read_b64_tr_b16 v[106:107], v210 offset:20480
    ds_read_b64_tr_b16 v[108:109], v211 offset:16384
    v_mfma_f32_16x16x32_bf16 v[52:55], v[136:139], a[12:15], v[52:55]
    buffer_load_dwordx4 a[44:47], v9, s[16:19], s52 offen offset:2304 sc1
    v_mfma_f32_16x16x32_bf16 v[56:59], v[140:143], a[8:11], v[56:59]
    s_add_u32 s52, s52, 4096
    ds_read_b64_tr_b16 v[110:111], v211 offset:20480
    ds_read_b64_tr_b16 v[112:113], v212 offset:16384
    v_mfma_f32_16x16x32_bf16 v[60:63], v[140:143], a[12:15], v[60:63]
    s_add_u32 m0, s34, 49152
    s_waitcnt lgkmcnt(9)
    ds_read_b64_tr_b16 v[114:115], v212 offset:20480
    ds_read_b64_tr_b16 v[116:117], v213 offset:16384
    v_mfma_f32_16x16x32_bf16 v[64:67], v[144:147], a[8:11], v[64:67]
    buffer_load_dwordx4 v12, s[8:11], s48 offen offset:0 lds
    v_mfma_f32_16x16x32_bf16 v[68:71], v[144:147], a[12:15], v[68:71]
    ds_read_b64_tr_b16 v[118:119], v213 offset:20480
    v_mfma_f32_16x16x32_bf16 v[72:75], v[148:151], a[8:11], v[72:75]
    ds_read_b64_tr_b16 v[120:121], v214 offset:16384
    ds_read_b64_tr_b16 v[122:123], v214 offset:20480
    v_mfma_f32_16x16x32_bf16 v[76:79], v[148:151], a[12:15], v[76:79]
    buffer_load_dwordx4 v13, s[8:11], s48 offen offset:1024 lds
    v_mfma_f32_16x16x32_bf16 v[80:83], v[152:155], a[8:11], v[80:83]
    ds_read_b64_tr_b16 v[124:125], v215 offset:16384
    v_mfma_f32_16x16x32_bf16 v[84:87], v[152:155], a[12:15], v[84:87]
    ds_read_b64_tr_b16 v[126:127], v215 offset:20480
    v_mfma_f32_16x16x32_bf16 v[88:91], v[156:159], a[8:11], v[88:91]
    v_mfma_f32_16x16x32_bf16 v[92:95], v[156:159], a[12:15], v[92:95]
    s_waitcnt lgkmcnt(8)
    v_mfma_f32_16x16x32_bf16 v[32:35], v[96:99], a[16:19], v[32:35]
    ds_read_b64_tr_b16 v[128:129], v208 offset:24576
    ds_read_b64_tr_b16 v[130:131], v208 offset:28672
    v_mfma_f32_16x16x32_bf16 v[36:39], v[96:99], a[20:23], v[36:39]
    ds_read_b64_tr_b16 v[132:133], v209 offset:24576
    ds_read_b64_tr_b16 v[134:135], v209 offset:28672
    v_mfma_f32_16x16x32_bf16 v[40:43], v[100:103], a[16:19], v[40:43]
    buffer_load_dwordx4 a[48:51], v9, s[16:19], s52 offen offset:0 sc1
    v_mfma_f32_16x16x32_bf16 v[44:47], v[100:103], a[20:23], v[44:47]
    ds_read_b64_tr_b16 v[136:137], v210 offset:24576
    v_mfma_f32_16x16x32_bf16 v[48:51], v[104:107], a[16:19], v[48:51]
    ds_read_b64_tr_b16 v[138:139], v210 offset:28672
    ds_read_b64_tr_b16 v[140:141], v211 offset:24576
    v_mfma_f32_16x16x32_bf16 v[52:55], v[104:107], a[20:23], v[52:55]
    buffer_load_dwordx4 a[52:55], v9, s[16:19], s52 offen offset:256 sc1
    v_mfma_f32_16x16x32_bf16 v[56:59], v[108:111], a[16:19], v[56:59]
    ds_read_b64_tr_b16 v[142:143], v211 offset:28672
    ds_read_b64_tr_b16 v[144:145], v212 offset:24576
    v_mfma_f32_16x16x32_bf16 v[60:63], v[108:111], a[20:23], v[60:63]
    s_waitcnt lgkmcnt(9)
    ds_read_b64_tr_b16 v[146:147], v212 offset:28672
    ds_read_b64_tr_b16 v[148:149], v213 offset:24576
    v_mfma_f32_16x16x32_bf16 v[64:67], v[112:115], a[16:19], v[64:67]
    buffer_load_dwordx4 v14, s[8:11], s48 offen offset:2048 lds
    v_mfma_f32_16x16x32_bf16 v[68:71], v[112:115], a[20:23], v[68:71]
    ds_read_b64_tr_b16 v[150:151], v213 offset:28672
    v_mfma_f32_16x16x32_bf16 v[72:75], v[116:119], a[16:19], v[72:75]
    ds_read_b64_tr_b16 v[152:153], v214 offset:24576
    ds_read_b64_tr_b16 v[154:155], v214 offset:28672
    v_mfma_f32_16x16x32_bf16 v[76:79], v[116:119], a[20:23], v[76:79]
    buffer_load_dwordx4 v15, s[8:11], s48 offen offset:3072 lds
    v_mfma_f32_16x16x32_bf16 v[80:83], v[120:123], a[16:19], v[80:83]
    s_add_u32 s48, s48, 131072
    ds_read_b64_tr_b16 v[156:157], v215 offset:24576
    v_mfma_f32_16x16x32_bf16 v[84:87], v[120:123], a[20:23], v[84:87]
    ds_read_b64_tr_b16 v[158:159], v215 offset:28672
    v_mfma_f32_16x16x32_bf16 v[88:91], v[124:127], a[16:19], v[88:91]
    v_mfma_f32_16x16x32_bf16 v[92:95], v[124:127], a[20:23], v[92:95]
    s_waitcnt vmcnt(14) lgkmcnt(8)
    s_waitcnt vmcnt(8)
    s_barrier
    v_mfma_f32_16x16x32_bf16 v[32:35], v[128:131], a[24:27], v[32:35]
    ds_read_b64_tr_b16 v[96:97], v208 offset:32768
    ds_read_b64_tr_b16 v[98:99], v208 offset:36864
    v_mfma_f32_16x16x32_bf16 v[36:39], v[128:131], a[28:31], v[36:39]
    ds_read_b64_tr_b16 v[100:101], v209 offset:32768
    ds_read_b64_tr_b16 v[102:103], v209 offset:36864
    v_mfma_f32_16x16x32_bf16 v[40:43], v[132:135], a[24:27], v[40:43]
    buffer_load_dwordx4 a[56:59], v9, s[16:19], s52 offen offset:2048 sc1
    v_mfma_f32_16x16x32_bf16 v[44:47], v[132:135], a[28:31], v[44:47]
    ds_read_b64_tr_b16 v[104:105], v210 offset:32768
    v_mfma_f32_16x16x32_bf16 v[48:51], v[136:139], a[24:27], v[48:51]
    ds_read_b64_tr_b16 v[106:107], v210 offset:36864
    ds_read_b64_tr_b16 v[108:109], v211 offset:32768
    v_mfma_f32_16x16x32_bf16 v[52:55], v[136:139], a[28:31], v[52:55]
    buffer_load_dwordx4 a[60:63], v9, s[16:19], s52 offen offset:2304 sc1
    v_mfma_f32_16x16x32_bf16 v[56:59], v[140:143], a[24:27], v[56:59]
    s_add_u32 s52, s52, 4096
    ds_read_b64_tr_b16 v[110:111], v211 offset:36864
    ds_read_b64_tr_b16 v[112:113], v212 offset:32768
    v_mfma_f32_16x16x32_bf16 v[60:63], v[140:143], a[28:31], v[60:63]
    s_add_u32 m0, s34, 0
    s_waitcnt lgkmcnt(9)
    ds_read_b64_tr_b16 v[114:115], v212 offset:36864
    ds_read_b64_tr_b16 v[116:117], v213 offset:32768
    v_mfma_f32_16x16x32_bf16 v[64:67], v[144:147], a[24:27], v[64:67]
    buffer_load_dwordx4 v12, s[8:11], s48 offen offset:0 lds
    v_mfma_f32_16x16x32_bf16 v[68:71], v[144:147], a[28:31], v[68:71]
    ds_read_b64_tr_b16 v[118:119], v213 offset:36864
    v_mfma_f32_16x16x32_bf16 v[72:75], v[148:151], a[24:27], v[72:75]
    ds_read_b64_tr_b16 v[120:121], v214 offset:32768
    ds_read_b64_tr_b16 v[122:123], v214 offset:36864
    v_mfma_f32_16x16x32_bf16 v[76:79], v[148:151], a[28:31], v[76:79]
    buffer_load_dwordx4 v13, s[8:11], s48 offen offset:1024 lds
    v_mfma_f32_16x16x32_bf16 v[80:83], v[152:155], a[24:27], v[80:83]
    ds_read_b64_tr_b16 v[124:125], v215 offset:32768
    v_mfma_f32_16x16x32_bf16 v[84:87], v[152:155], a[28:31], v[84:87]
    ds_read_b64_tr_b16 v[126:127], v215 offset:36864
    v_mfma_f32_16x16x32_bf16 v[88:91], v[156:159], a[24:27], v[88:91]
    v_mfma_f32_16x16x32_bf16 v[92:95], v[156:159], a[28:31], v[92:95]
    s_waitcnt lgkmcnt(8)
    v_mfma_f32_16x16x32_bf16 v[32:35], v[96:99], a[32:35], v[32:35]
    ds_read_b64_tr_b16 v[128:129], v208 offset:40960
    ds_read_b64_tr_b16 v[130:131], v208 offset:45056
    v_mfma_f32_16x16x32_bf16 v[36:39], v[96:99], a[36:39], v[36:39]
    ds_read_b64_tr_b16 v[132:133], v209 offset:40960
    ds_read_b64_tr_b16 v[134:135], v209 offset:45056
    v_mfma_f32_16x16x32_bf16 v[40:43], v[100:103], a[32:35], v[40:43]
    buffer_load_dwordx4 a[0:3], v9, s[16:19], s52 offen offset:0 sc1
    v_mfma_f32_16x16x32_bf16 v[44:47], v[100:103], a[36:39], v[44:47]
    ds_read_b64_tr_b16 v[136:137], v210 offset:40960
    v_mfma_f32_16x16x32_bf16 v[48:51], v[104:107], a[32:35], v[48:51]
    ds_read_b64_tr_b16 v[138:139], v210 offset:45056
    ds_read_b64_tr_b16 v[140:141], v211 offset:40960
    v_mfma_f32_16x16x32_bf16 v[52:55], v[104:107], a[36:39], v[52:55]
    buffer_load_dwordx4 a[4:7], v9, s[16:19], s52 offen offset:256 sc1
    v_mfma_f32_16x16x32_bf16 v[56:59], v[108:111], a[32:35], v[56:59]
    ds_read_b64_tr_b16 v[142:143], v211 offset:45056
    ds_read_b64_tr_b16 v[144:145], v212 offset:40960
    v_mfma_f32_16x16x32_bf16 v[60:63], v[108:111], a[36:39], v[60:63]
    s_waitcnt lgkmcnt(9)
    ds_read_b64_tr_b16 v[146:147], v212 offset:45056
    ds_read_b64_tr_b16 v[148:149], v213 offset:40960
    v_mfma_f32_16x16x32_bf16 v[64:67], v[112:115], a[32:35], v[64:67]
    buffer_load_dwordx4 v14, s[8:11], s48 offen offset:2048 lds
    v_mfma_f32_16x16x32_bf16 v[68:71], v[112:115], a[36:39], v[68:71]
    ds_read_b64_tr_b16 v[150:151], v213 offset:45056
    v_mfma_f32_16x16x32_bf16 v[72:75], v[116:119], a[32:35], v[72:75]
    ds_read_b64_tr_b16 v[152:153], v214 offset:40960
    ds_read_b64_tr_b16 v[154:155], v214 offset:45056
    v_mfma_f32_16x16x32_bf16 v[76:79], v[116:119], a[36:39], v[76:79]
    buffer_load_dwordx4 v15, s[8:11], s48 offen offset:3072 lds
    v_mfma_f32_16x16x32_bf16 v[80:83], v[120:123], a[32:35], v[80:83]
    s_add_u32 s48, s48, 131072
    ds_read_b64_tr_b16 v[156:157], v215 offset:40960
    v_mfma_f32_16x16x32_bf16 v[84:87], v[120:123], a[36:39], v[84:87]
    ds_read_b64_tr_b16 v[158:159], v215 offset:45056
    v_mfma_f32_16x16x32_bf16 v[88:91], v[124:127], a[32:35], v[88:91]
    v_mfma_f32_16x16x32_bf16 v[92:95], v[124:127], a[36:39], v[92:95]
    s_waitcnt vmcnt(14) lgkmcnt(8)
    s_waitcnt vmcnt(8)
    s_barrier
    v_mfma_f32_16x16x32_bf16 v[32:35], v[128:131], a[40:43], v[32:35]
    ds_read_b64_tr_b16 v[96:97], v208 offset:49152
    ds_read_b64_tr_b16 v[98:99], v208 offset:53248
    v_mfma_f32_16x16x32_bf16 v[36:39], v[128:131], a[44:47], v[36:39]
    ds_read_b64_tr_b16 v[100:101], v209 offset:49152
    ds_read_b64_tr_b16 v[102:103], v209 offset:53248
    v_mfma_f32_16x16x32_bf16 v[40:43], v[132:135], a[40:43], v[40:43]
    buffer_load_dwordx4 a[8:11], v9, s[16:19], s52 offen offset:2048 sc1
    v_mfma_f32_16x16x32_bf16 v[44:47], v[132:135], a[44:47], v[44:47]
    ds_read_b64_tr_b16 v[104:105], v210 offset:49152
    v_mfma_f32_16x16x32_bf16 v[48:51], v[136:139], a[40:43], v[48:51]
    ds_read_b64_tr_b16 v[106:107], v210 offset:53248
    ds_read_b64_tr_b16 v[108:109], v211 offset:49152
    v_mfma_f32_16x16x32_bf16 v[52:55], v[136:139], a[44:47], v[52:55]
    buffer_load_dwordx4 a[12:15], v9, s[16:19], s52 offen offset:2304 sc1
    v_mfma_f32_16x16x32_bf16 v[56:59], v[140:143], a[40:43], v[56:59]
    s_add_u32 s52, s52, 4096
    ds_read_b64_tr_b16 v[110:111], v211 offset:53248
    ds_read_b64_tr_b16 v[112:113], v212 offset:49152
    v_mfma_f32_16x16x32_bf16 v[60:63], v[140:143], a[44:47], v[60:63]
    s_add_u32 m0, s34, 16384
    s_waitcnt lgkmcnt(9)
    ds_read_b64_tr_b16 v[114:115], v212 offset:53248
    ds_read_b64_tr_b16 v[116:117], v213 offset:49152
    v_mfma_f32_16x16x32_bf16 v[64:67], v[144:147], a[40:43], v[64:67]
    buffer_load_dwordx4 v12, s[8:11], s48 offen offset:0 lds
    v_mfma_f32_16x16x32_bf16 v[68:71], v[144:147], a[44:47], v[68:71]
    ds_read_b64_tr_b16 v[118:119], v213 offset:53248
    v_mfma_f32_16x16x32_bf16 v[72:75], v[148:151], a[40:43], v[72:75]
    ds_read_b64_tr_b16 v[120:121], v214 offset:49152
    ds_read_b64_tr_b16 v[122:123], v214 offset:53248
    v_mfma_f32_16x16x32_bf16 v[76:79], v[148:151], a[44:47], v[76:79]
    buffer_load_dwordx4 v13, s[8:11], s48 offen offset:1024 lds
    v_mfma_f32_16x16x32_bf16 v[80:83], v[152:155], a[40:43], v[80:83]
    ds_read_b64_tr_b16 v[124:125], v215 offset:49152
    v_mfma_f32_16x16x32_bf16 v[84:87], v[152:155], a[44:47], v[84:87]
    ds_read_b64_tr_b16 v[126:127], v215 offset:53248
    v_mfma_f32_16x16x32_bf16 v[88:91], v[156:159], a[40:43], v[88:91]
    v_mfma_f32_16x16x32_bf16 v[92:95], v[156:159], a[44:47], v[92:95]
    s_waitcnt lgkmcnt(8)
    v_mfma_f32_16x16x32_bf16 v[32:35], v[96:99], a[48:51], v[32:35]
    ds_read_b64_tr_b16 v[128:129], v208 offset:57344
    ds_read_b64_tr_b16 v[130:131], v208 offset:61440
    v_mfma_f32_16x16x32_bf16 v[36:39], v[96:99], a[52:55], v[36:39]
    ds_read_b64_tr_b16 v[132:133], v209 offset:57344
    ds_read_b64_tr_b16 v[134:135], v209 offset:61440
    v_mfma_f32_16x16x32_bf16 v[40:43], v[100:103], a[48:51], v[40:43]
    buffer_load_dwordx4 a[16:19], v9, s[16:19], s52 offen offset:0 sc1
    v_mfma_f32_16x16x32_bf16 v[44:47], v[100:103], a[52:55], v[44:47]
    ds_read_b64_tr_b16 v[136:137], v210 offset:57344
    v_mfma_f32_16x16x32_bf16 v[48:51], v[104:107], a[48:51], v[48:51]
    ds_read_b64_tr_b16 v[138:139], v210 offset:61440
    ds_read_b64_tr_b16 v[140:141], v211 offset:57344
    v_mfma_f32_16x16x32_bf16 v[52:55], v[104:107], a[52:55], v[52:55]
    buffer_load_dwordx4 a[20:23], v9, s[16:19], s52 offen offset:256 sc1
    v_mfma_f32_16x16x32_bf16 v[56:59], v[108:111], a[48:51], v[56:59]
    ds_read_b64_tr_b16 v[142:143], v211 offset:61440
    ds_read_b64_tr_b16 v[144:145], v212 offset:57344
    v_mfma_f32_16x16x32_bf16 v[60:63], v[108:111], a[52:55], v[60:63]
    s_waitcnt lgkmcnt(9)
    ds_read_b64_tr_b16 v[146:147], v212 offset:61440
    ds_read_b64_tr_b16 v[148:149], v213 offset:57344
    v_mfma_f32_16x16x32_bf16 v[64:67], v[112:115], a[48:51], v[64:67]
    buffer_load_dwordx4 v14, s[8:11], s48 offen offset:2048 lds
    v_mfma_f32_16x16x32_bf16 v[68:71], v[112:115], a[52:55], v[68:71]
    ds_read_b64_tr_b16 v[150:151], v213 offset:61440
    v_mfma_f32_16x16x32_bf16 v[72:75], v[116:119], a[48:51], v[72:75]
    ds_read_b64_tr_b16 v[152:153], v214 offset:57344
    ds_read_b64_tr_b16 v[154:155], v214 offset:61440
    v_mfma_f32_16x16x32_bf16 v[76:79], v[116:119], a[52:55], v[76:79]
    buffer_load_dwordx4 v15, s[8:11], s48 offen offset:3072 lds
    v_mfma_f32_16x16x32_bf16 v[80:83], v[120:123], a[48:51], v[80:83]
    s_add_u32 s48, s48, 131072
    ds_read_b64_tr_b16 v[156:157], v215 offset:57344
    v_mfma_f32_16x16x32_bf16 v[84:87], v[120:123], a[52:55], v[84:87]
    ds_read_b64_tr_b16 v[158:159], v215 offset:61440
    v_mfma_f32_16x16x32_bf16 v[88:91], v[124:127], a[48:51], v[88:91]
    v_mfma_f32_16x16x32_bf16 v[92:95], v[124:127], a[52:55], v[92:95]
    s_waitcnt vmcnt(14) lgkmcnt(8)
    s_waitcnt vmcnt(8)
    s_barrier
    v_mfma_f32_16x16x32_bf16 v[32:35], v[128:131], a[56:59], v[32:35]
    ds_read_b64_tr_b16 v[96:97], v208 offset:0
    ds_read_b64_tr_b16 v[98:99], v208 offset:4096
    v_mfma_f32_16x16x32_bf16 v[36:39], v[128:131], a[60:63], v[36:39]
    ds_read_b64_tr_b16 v[100:101], v209 offset:0
    ds_read_b64_tr_b16 v[102:103], v209 offset:4096
    v_mfma_f32_16x16x32_bf16 v[40:43], v[132:135], a[56:59], v[40:43]
    buffer_load_dwordx4 a[24:27], v9, s[16:19], s52 offen offset:2048 sc1
    v_mfma_f32_16x16x32_bf16 v[44:47], v[132:135], a[60:63], v[44:47]
    ds_read_b64_tr_b16 v[104:105], v210 offset:0
    v_mfma_f32_16x16x32_bf16 v[48:51], v[136:139], a[56:59], v[48:51]
    ds_read_b64_tr_b16 v[106:107], v210 offset:4096
    ds_read_b64_tr_b16 v[108:109], v211 offset:0
    v_mfma_f32_16x16x32_bf16 v[52:55], v[136:139], a[60:63], v[52:55]
    buffer_load_dwordx4 a[28:31], v9, s[16:19], s52 offen offset:2304 sc1
    v_mfma_f32_16x16x32_bf16 v[56:59], v[140:143], a[56:59], v[56:59]
    s_add_u32 s52, s52, 4096
    ds_read_b64_tr_b16 v[110:111], v211 offset:4096
    ds_read_b64_tr_b16 v[112:113], v212 offset:0
    v_mfma_f32_16x16x32_bf16 v[60:63], v[140:143], a[60:63], v[60:63]
    s_add_u32 m0, s34, 32768
    s_waitcnt lgkmcnt(9)
    ds_read_b64_tr_b16 v[114:115], v212 offset:4096
    ds_read_b64_tr_b16 v[116:117], v213 offset:0
    v_mfma_f32_16x16x32_bf16 v[64:67], v[144:147], a[56:59], v[64:67]
    buffer_load_dwordx4 v12, s[8:11], s48 offen offset:0 lds
    v_mfma_f32_16x16x32_bf16 v[68:71], v[144:147], a[60:63], v[68:71]
    ds_read_b64_tr_b16 v[118:119], v213 offset:4096
    v_mfma_f32_16x16x32_bf16 v[72:75], v[148:151], a[56:59], v[72:75]
    ds_read_b64_tr_b16 v[120:121], v214 offset:0
    ds_read_b64_tr_b16 v[122:123], v214 offset:4096
    v_mfma_f32_16x16x32_bf16 v[76:79], v[148:151], a[60:63], v[76:79]
    buffer_load_dwordx4 v13, s[8:11], s48 offen offset:1024 lds
    v_mfma_f32_16x16x32_bf16 v[80:83], v[152:155], a[56:59], v[80:83]
    ds_read_b64_tr_b16 v[124:125], v215 offset:0
    v_mfma_f32_16x16x32_bf16 v[84:87], v[152:155], a[60:63], v[84:87]
    ds_read_b64_tr_b16 v[126:127], v215 offset:4096
    v_mfma_f32_16x16x32_bf16 v[88:91], v[156:159], a[56:59], v[88:91]
    v_mfma_f32_16x16x32_bf16 v[92:95], v[156:159], a[60:63], v[92:95]
    s_waitcnt lgkmcnt(8)
    s_sub_u32 s35, s35, 1
    s_cmp_lg_u32 s35, 0
    s_cbranch_scc1 bk5_loop
    v_mfma_f32_16x16x32_bf16 v[32:35], v[96:99], a[0:3], v[32:35]
    ds_read_b64_tr_b16 v[128:129], v208 offset:8192
    ds_read_b64_tr_b16 v[130:131], v208 offset:12288
    v_mfma_f32_16x16x32_bf16 v[36:39], v[96:99], a[4:7], v[36:39]
    ds_read_b64_tr_b16 v[132:133], v209 offset:8192
    ds_read_b64_tr_b16 v[134:135], v209 offset:12288
    v_mfma_f32_16x16x32_bf16 v[40:43], v[100:103], a[0:3], v[40:43]
    buffer_load_dwordx4 a[32:35], v9, s[16:19], s52 offen offset:0 sc1
    v_mfma_f32_16x16x32_bf16 v[44:47], v[100:103], a[4:7], v[44:47]
    ds_read_b64_tr_b16 v[136:137], v210 offset:8192
    v_mfma_f32_16x16x32_bf16 v[48:51], v[104:107], a[0:3], v[48:51]
    ds_read_b64_tr_b16 v[138:139], v210 offset:12288
    ds_read_b64_tr_b16 v[140:141], v211 offset:8192
    v_mfma_f32_16x16x32_bf16 v[52:55], v[104:107], a[4:7], v[52:55]
    buffer_load_dwordx4 a[36:39], v9, s[16:19], s52 offen offset:256 sc1
    v_mfma_f32_16x16x32_bf16 v[56:59], v[108:111], a[0:3], v[56:59]
    ds_read_b64_tr_b16 v[142:143], v211 offset:12288
    ds_read_b64_tr_b16 v[144:145], v212 offset:8192
    v_mfma_f32_16x16x32_bf16 v[60:63], v[108:111], a[4:7], v[60:63]
    s_waitcnt lgkmcnt(9)
    ds_read_b64_tr_b16 v[146:147], v212 offset:12288
    ds_read_b64_tr_b16 v[148:149], v213 offset:8192
    v_mfma_f32_16x16x32_bf16 v[64:67], v[112:115], a[0:3], v[64:67]
    buffer_load_dwordx4 v14, s[8:11], s48 offen offset:2048 lds
    v_mfma_f32_16x16x32_bf16 v[68:71], v[112:115], a[4:7], v[68:71]
    ds_read_b64_tr_b16 v[150:151], v213 offset:12288
    v_mfma_f32_16x16x32_bf16 v[72:75], v[116:119], a[0:3], v[72:75]
    ds_read_b64_tr_b16 v[152:153], v214 offset:8192
    ds_read_b64_tr_b16 v[154:155], v214 offset:12288
    v_mfma_f32_16x16x32_bf16 v[76:79], v[116:119], a[4:7], v[76:79]
    buffer_load_dwordx4 v15, s[8:11], s48 offen offset:3072 lds
    v_mfma_f32_16x16x32_bf16 v[80:83], v[120:123], a[0:3], v[80:83]
    s_add_u32 s48, s48, 131072
    ds_read_b64_tr_b16 v[156:157], v215 offset:8192
    v_mfma_f32_16x16x32_bf16 v[84:87], v[120:123], a[4:7], v[84:87]
    ds_read_b64_tr_b16 v[158:159], v215 offset:12288
    v_mfma_f32_16x16x32_bf16 v[88:91], v[124:127], a[0:3], v[88:91]
    v_mfma_f32_16x16x32_bf16 v[92:95], v[124:127], a[4:7], v[92:95]
    s_waitcnt vmcnt(14) lgkmcnt(8)
    s_waitcnt vmcnt(8)
    s_barrier
    v_mfma_f32_16x16x32_bf16 v[32:35], v[128:131], a[8:11], v[32:35]
    ds_read_b64_tr_b16 v[96:97], v208 offset:16384
    ds_read_b64_tr_b16 v[98:99], v208 offset:20480
    v_mfma_f32_16x16x32_bf16 v[36:39], v[128:131], a[12:15], v[36:39]
    ds_read_b64_tr_b16 v[100:101], v209 offset:16384
    ds_read_b64_tr_b16 v[102:103], v209 offset:20480
    v_mfma_f32_16x16x32_bf16 v[40:43], v[132:135], a[8:11], v[40:43]
    buffer_load_dwordx4 a[40:43], v9, s[16:19], s52 offen offset:2048 sc1
    v_mfma_f32_16x16x32_bf16 v[44:47], v[132:135], a[12:15], v[44:47]
    ds_read_b64_tr_b16 v[104:105], v210 offset:16384
    ds_read_b64_tr_b16 v[106:107], v210 offset:20480
    v_mfma_f32_16x16x32_bf16 v[48:51], v[136:139], a[8:11], v[48:51]
    buffer_load_dwordx4 a[44:47], v9, s[16:19], s52 offen offset:2304 sc1
    v_mfma_f32_16x16x32_bf16 v[52:55], v[136:139], a[12:15], v[52:55]
    s_add_u32 s52, s52, 4096
    s_add_u32 m0, s34, 49152
    ds_read_b64_tr_b16 v[108:109], v211 offset:16384
    ds_read_b64_tr_b16 v[110:111], v211 offset:20480
    v_mfma_f32_16x16x32_bf16 v[56:59], v[140:143], a[8:11], v[56:59]
    buffer_load_dwordx4 v12, s[8:11], s48 offen offset:0 lds
    v_mfma_f32_16x16x32_bf16 v[60:63], v[140:143], a[12:15], v[60:63]
    s_waitcnt lgkmcnt(8)
    ds_read_b64_tr_b16 v[112:113], v212 offset:16384
    ds_read_b64_tr_b16 v[114:115], v212 offset:20480
    v_mfma_f32_16x16x32_bf16 v[64:67], v[144:147], a[8:11], v[64:67]
    buffer_load_dwordx4 v13, s[8:11], s48 offen offset:1024 lds
    v_mfma_f32_16x16x32_bf16 v[68:71], v[144:147], a[12:15], v[68:71]
    ds_read_b64_tr_b16 v[116:117], v213 offset:16384
    ds_read_b64_tr_b16 v[118:119], v213 offset:20480
    v_mfma_f32_16x16x32_bf16 v[72:75], v[148:151], a[8:11], v[72:75]
    buffer_load_dwordx4 v14, s[8:11], s48 offen offset:2048 lds
    v_mfma_f32_16x16x32_bf16 v[76:79], v[148:151], a[12:15], v[76:79]
    ds_read_b64_tr_b16 v[120:121], v214 offset:16384
    ds_read_b64_tr_b16 v[122:123], v214 offset:20480
    v_mfma_f32_16x16x32_bf16 v[80:83], v[152:155], a[8:11], v[80:83]
    buffer_load_dwordx4 v15, s[8:11], s48 offen offset:3072 lds
    v_mfma_f32_16x16x32_bf16 v[84:87], v[152:155], a[12:15], v[84:87]
    s_add_u32 s48, s48, 131072
    ds_read_b64_tr_b16 v[124:125], v215 offset:16384
    v_mfma_f32_16x16x32_bf16 v[88:91], v[156:159], a[8:11], v[88:91]
    ds_read_b64_tr_b16 v[126:127], v215 offset:20480
    v_mfma_f32_16x16x32_bf16 v[92:95], v[156:159], a[12:15], v[92:95]
    s_waitcnt lgkmcnt(8)
    v_mfma_f32_16x16x32_bf16 v[32:35], v[96:99], a[16:19], v[32:35]
    ds_read_b64_tr_b16 v[128:129], v208 offset:24576
    ds_read_b64_tr_b16 v[130:131], v208 offset:28672
    v_mfma_f32_16x16x32_bf16 v[36:39], v[96:99], a[20:23], v[36:39]
    ds_read_b64_tr_b16 v[132:133], v209 offset:24576
    ds_read_b64_tr_b16 v[134:135], v209 offset:28672
    v_mfma_f32_16x16x32_bf16 v[40:43], v[100:103], a[16:19], v[40:43]
    buffer_load_dwordx4 a[48:51], v9, s[16:19], s52 offen offset:0 sc1
    v_mfma_f32_16x16x32_bf16 v[44:47], v[100:103], a[20:23], v[44:47]
    ds_read_b64_tr_b16 v[136:137], v210 offset:24576
    v_mfma_f32_16x16x32_bf16 v[48:51], v[104:107], a[16:19], v[48:51]
    ds_read_b64_tr_b16 v[138:139], v210 offset:28672
    ds_read_b64_tr_b16 v[140:141], v211 offset:24576
    v_mfma_f32_16x16x32_bf16 v[52:55], v[104:107], a[20:23], v[52:55]
    buffer_load_dwordx4 a[52:55], v9, s[16:19], s52 offen offset:256 sc1
    v_mfma_f32_16x16x32_bf16 v[56:59], v[108:111], a[16:19], v[56:59]
    ds_read_b64_tr_b16 v[142:143], v211 offset:28672
    ds_read_b64_tr_b16 v[144:145], v212 offset:24576
    v_mfma_f32_16x16x32_bf16 v[60:63], v[108:111], a[20:23], v[60:63]
    s_waitcnt lgkmcnt(9)
    ds_read_b64_tr_b16 v[146:147], v212 offset:28672
    ds_read_b64_tr_b16 v[148:149], v213 offset:24576
    v_mfma_f32_16x16x32_bf16 v[64:67], v[112:115], a[16:19], v[64:67]
    buffer_load_dwordx4 a[56:59], v9, s[16:19], s52 offen offset:2048 sc1
    v_mfma_f32_16x16x32_bf16 v[68:71], v[112:115], a[20:23], v[68:71]
    ds_read_b64_tr_b16 v[150:151], v213 offset:28672
    v_mfma_f32_16x16x32_bf16 v[72:75], v[116:119], a[16:19], v[72:75]
    ds_read_b64_tr_b16 v[152:153], v214 offset:24576
    ds_read_b64_tr_b16 v[154:155], v214 offset:28672
    v_mfma_f32_16x16x32_bf16 v[76:79], v[116:119], a[20:23], v[76:79]
    buffer_load_dwordx4 a[60:63], v9, s[16:19], s52 offen offset:2304 sc1
    v_mfma_f32_16x16x32_bf16 v[80:83], v[120:123], a[16:19], v[80:83]
    s_add_u32 s52, s52, 4096
    ds_read_b64_tr_b16 v[156:157], v215 offset:24576
    v_mfma_f32_16x16x32_bf16 v[84:87], v[120:123], a[20:23], v[84:87]
    ds_read_b64_tr_b16 v[158:159], v215 offset:28672
    v_mfma_f32_16x16x32_bf16 v[88:91], v[124:127], a[16:19], v[88:91]
    v_mfma_f32_16x16x32_bf16 v[92:95], v[124:127], a[20:23], v[92:95]
    s_waitcnt vmcnt(16) lgkmcnt(8)
    s_waitcnt vmcnt(4)
    s_barrier
    v_mfma_f32_16x16x32_bf16 v[32:35], v[128:131], a[24:27], v[32:35]
    ds_read_b64_tr_b16 v[96:97], v212 offset:32768
    ds_read_b64_tr_b16 v[98:99], v212 offset:36864
    v_mfma_f32_16x16x32_bf16 v[36:39], v[128:131], a[28:31], v[36:39]
    ds_read_b64_tr_b16 v[100:101], v213 offset:32768
    v_mfma_f32_16x16x32_bf16 v[40:43], v[132:135], a[24:27], v[40:43]
    ds_read_b64_tr_b16 v[102:103], v213 offset:36864
    ds_read_b64_tr_b16 v[104:105], v214 offset:32768
    v_mfma_f32_16x16x32_bf16 v[44:47], v[132:135], a[28:31], v[44:47]
    ds_read_b64_tr_b16 v[106:107], v214 offset:36864
    v_mfma_f32_16x16x32_bf16 v[48:51], v[136:139], a[24:27], v[48:51]
    ds_read_b64_tr_b16 v[108:109], v215 offset:32768
    v_mfma_f32_16x16x32_bf16 v[52:55], v[136:139], a[28:31], v[52:55]
    ds_read_b64_tr_b16 v[110:111], v215 offset:36864
    v_mfma_f32_16x16x32_bf16 v[56:59], v[140:143], a[24:27], v[56:59]
    ds_read_b64_tr_b16 v[112:113], v212 offset:40960
    v_mfma_f32_16x16x32_bf16 v[60:63], v[140:143], a[28:31], v[60:63]
    s_waitcnt lgkmcnt(9)
    ds_read_b64_tr_b16 v[114:115], v212 offset:45056
    v_mfma_f32_16x16x32_bf16 v[64:67], v[144:147], a[24:27], v[64:67]
    ds_read_b64_tr_b16 v[116:117], v213 offset:40960
    v_mfma_f32_16x16x32_bf16 v[68:71], v[144:147], a[28:31], v[68:71]
    ds_read_b64_tr_b16 v[118:119], v213 offset:45056
    v_mfma_f32_16x16x32_bf16 v[72:75], v[148:151], a[24:27], v[72:75]
    ds_read_b64_tr_b16 v[120:121], v214 offset:40960
    v_mfma_f32_16x16x32_bf16 v[76:79], v[148:151], a[28:31], v[76:79]
    ds_read_b64_tr_b16 v[122:123], v214 offset:45056
    v_mfma_f32_16x16x32_bf16 v[80:83], v[152:155], a[24:27], v[80:83]
    ds_read_b64_tr_b16 v[124:125], v215 offset:40960
    v_mfma_f32_16x16x32_bf16 v[84:87], v[152:155], a[28:31], v[84:87]
    ds_read_b64_tr_b16 v[126:127], v215 offset:45056
    v_mfma_f32_16x16x32_bf16 v[88:91], v[156:159], a[24:27], v[88:91]
    v_mfma_f32_16x16x32_bf16 v[92:95], v[156:159], a[28:31], v[92:95]
    s_waitcnt lgkmcnt(8)
    v_mfma_f32_16x16x32_bf16 v[64:67], v[96:99], a[32:35], v[64:67]
    ds_read_b64_tr_b16 v[128:129], v212 offset:49152
    ds_read_b64_tr_b16 v[130:131], v212 offset:53248
    v_mfma_f32_16x16x32_bf16 v[68:71], v[96:99], a[36:39], v[68:71]
    ds_read_b64_tr_b16 v[132:133], v213 offset:49152
    v_mfma_f32_16x16x32_bf16 v[72:75], v[100:103], a[32:35], v[72:75]
    ds_read_b64_tr_b16 v[134:135], v213 offset:53248
    ds_read_b64_tr_b16 v[136:137], v214 offset:49152
    v_mfma_f32_16x16x32_bf16 v[76:79], v[100:103], a[36:39], v[76:79]
    ds_read_b64_tr_b16 v[138:139], v214 offset:53248
    v_mfma_f32_16x16x32_bf16 v[80:83], v[104:107], a[32:35], v[80:83]
    ds_read_b64_tr_b16 v[140:141], v215 offset:49152
    v_mfma_f32_16x16x32_bf16 v[84:87], v[104:107], a[36:39], v[84:87]
    ds_read_b64_tr_b16 v[142:143], v215 offset:53248
    v_mfma_f32_16x16x32_bf16 v[88:91], v[108:111], a[32:35], v[88:91]
    ds_read_b64_tr_b16 v[144:145], v212 offset:57344
    v_mfma_f32_16x16x32_bf16 v[92:95], v[108:111], a[36:39], v[92:95]
    s_waitcnt lgkmcnt(9)
    ds_read_b64_tr_b16 v[146:147], v212 offset:61440
    v_mfma_f32_16x16x32_bf16 v[64:67], v[112:115], a[40:43], v[64:67]
    ds_read_b64_tr_b16 v[148:149], v213 offset:57344
    v_mfma_f32_16x16x32_bf16 v[68:71], v[112:115], a[44:47], v[68:71]
    ds_read_b64_tr_b16 v[150:151], v213 offset:61440
    v_mfma_f32_16x16x32_bf16 v[72:75], v[116:119], a[40:43], v[72:75]
    ds_read_b64_tr_b16 v[152:153], v214 offset:57344
    v_mfma_f32_16x16x32_bf16 v[76:79], v[116:119], a[44:47], v[76:79]
    ds_read_b64_tr_b16 v[154:155], v214 offset:61440
    v_mfma_f32_16x16x32_bf16 v[80:83], v[120:123], a[40:43], v[80:83]
    ds_read_b64_tr_b16 v[156:157], v215 offset:57344
    v_mfma_f32_16x16x32_bf16 v[84:87], v[120:123], a[44:47], v[84:87]
    ds_read_b64_tr_b16 v[158:159], v215 offset:61440
    v_mfma_f32_16x16x32_bf16 v[88:91], v[124:127], a[40:43], v[88:91]
    v_mfma_f32_16x16x32_bf16 v[92:95], v[124:127], a[44:47], v[92:95]
    s_waitcnt vmcnt(0) lgkmcnt(8)
    v_mfma_f32_16x16x32_bf16 v[64:67], v[128:131], a[48:51], v[64:67]
    ds_read_b64_tr_b16 v[96:97], v208 offset:32768
    ds_read_b64_tr_b16 v[98:99], v208 offset:36864
    v_mfma_f32_16x16x32_bf16 v[68:71], v[128:131], a[52:55], v[68:71]
    ds_read_b64_tr_b16 v[100:101], v209 offset:32768
    v_mfma_f32_16x16x32_bf16 v[72:75], v[132:135], a[48:51], v[72:75]
    ds_read_b64_tr_b16 v[102:103], v209 offset:36864
    ds_read_b64_tr_b16 v[104:105], v210 offset:32768
    v_mfma_f32_16x16x32_bf16 v[76:79], v[132:135], a[52:55], v[76:79]
    ds_read_b64_tr_b16 v[106:107], v210 offset:36864
    v_mfma_f32_16x16x32_bf16 v[80:83], v[136:139], a[48:51], v[80:83]
    ds_read_b64_tr_b16 v[108:109], v211 offset:32768
    v_mfma_f32_16x16x32_bf16 v[84:87], v[136:139], a[52:55], v[84:87]
    ds_read_b64_tr_b16 v[110:111], v211 offset:36864
    v_mfma_f32_16x16x32_bf16 v[88:91], v[140:143], a[48:51], v[88:91]
    ds_read_b64_tr_b16 v[112:113], v208 offset:40960
    v_mfma_f32_16x16x32_bf16 v[92:95], v[140:143], a[52:55], v[92:95]
    s_waitcnt lgkmcnt(9)
    ds_read_b64_tr_b16 v[114:115], v208 offset:45056
    v_mfma_f32_16x16x32_bf16 v[64:67], v[144:147], a[56:59], v[64:67]
    ds_read_b64_tr_b16 v[116:117], v209 offset:40960
    v_mfma_f32_16x16x32_bf16 v[68:71], v[144:147], a[60:63], v[68:71]
    ds_read_b64_tr_b16 v[118:119], v209 offset:45056
    v_mfma_f32_16x16x32_bf16 v[72:75], v[148:151], a[56:59], v[72:75]
    ds_read_b64_tr_b16 v[120:121], v210 offset:40960
    v_mfma_f32_16x16x32_bf16 v[76:79], v[148:151], a[60:63], v[76:79]
    ds_read_b64_tr_b16 v[122:123], v210 offset:45056
    v_mfma_f32_16x16x32_bf16 v[80:83], v[152:155], a[56:59], v[80:83]
    ds_read_b64_tr_b16 v[124:125], v211 offset:40960
    v_mfma_f32_16x16x32_bf16 v[84:87], v[152:155], a[60:63], v[84:87]
    ds_read_b64_tr_b16 v[126:127], v211 offset:45056
    v_mfma_f32_16x16x32_bf16 v[88:91], v[156:159], a[56:59], v[88:91]
    v_mfma_f32_16x16x32_bf16 v[92:95], v[156:159], a[60:63], v[92:95]
    s_waitcnt lgkmcnt(8)
    v_mfma_f32_16x16x32_bf16 v[32:35], v[96:99], a[32:35], v[32:35]
    ds_read_b64_tr_b16 v[128:129], v208 offset:49152
    ds_read_b64_tr_b16 v[130:131], v208 offset:53248
    s_nop 3
    v_mfma_f32_16x16x32_bf16 v[36:39], v[96:99], a[36:39], v[36:39]
    ds_read_b64_tr_b16 v[132:133], v209 offset:49152
    v_cvt_pk_bf16_f32 v192, v64, v65
    v_mfma_f32_16x16x32_bf16 v[40:43], v[100:103], a[32:35], v[40:43]
    ds_read_b64_tr_b16 v[134:135], v209 offset:53248
    ds_read_b64_tr_b16 v[136:137], v210 offset:49152
    v_cvt_pk_bf16_f32 v193, v66, v67
    v_cvt_pk_bf16_f32 v194, v72, v73
    v_cvt_pk_bf16_f32 v195, v74, v75
    v_mfma_f32_16x16x32_bf16 v[44:47], v[100:103], a[36:39], v[44:47]
    ds_read_b64_tr_b16 v[138:139], v210 offset:53248
    v_min_u32 v192, -2, v192
    v_min_u32 v193, -2, v193
    v_min_u32 v194, -2, v194
    v_mfma_f32_16x16x32_bf16 v[48:51], v[104:107], a[32:35], v[48:51]
    ds_read_b64_tr_b16 v[140:141], v211 offset:49152
    v_min_u32 v195, -2, v195
    buffer_store_dwordx4 v[192:195], v8, s[16:19], s38 offen offset:0 sc1
    v_mfma_f32_16x16x32_bf16 v[52:55], v[104:107], a[36:39], v[52:55]
    ds_read_b64_tr_b16 v[142:143], v211 offset:53248
    v_cvt_pk_bf16_f32 v196, v68, v69
    v_mfma_f32_16x16x32_bf16 v[56:59], v[108:111], a[32:35], v[56:59]
    ds_read_b64_tr_b16 v[144:145], v208 offset:57344
    v_cvt_pk_bf16_f32 v197, v70, v71
    v_cvt_pk_bf16_f32 v198, v76, v77
    v_cvt_pk_bf16_f32 v199, v78, v79
    v_min_u32 v196, -2, v196
    v_mfma_f32_16x16x32_bf16 v[60:63], v[108:111], a[36:39], v[60:63]
    s_waitcnt lgkmcnt(9)
    ds_read_b64_tr_b16 v[146:147], v208 offset:61440
    v_min_u32 v197, -2, v197
    v_min_u32 v198, -2, v198
    v_min_u32 v199, -2, v199
    v_mfma_f32_16x16x32_bf16 v[32:35], v[112:115], a[40:43], v[32:35]
    ds_read_b64_tr_b16 v[148:149], v209 offset:57344
    buffer_store_dwordx4 v[196:199], v8, s[16:19], s38 offen offset:1024 sc1
    v_mfma_f32_16x16x32_bf16 v[36:39], v[112:115], a[44:47], v[36:39]
    ds_read_b64_tr_b16 v[150:151], v209 offset:61440
    v_cvt_pk_bf16_f32 v200, v80, v81
    v_cvt_pk_bf16_f32 v201, v82, v83
    v_mfma_f32_16x16x32_bf16 v[40:43], v[116:119], a[40:43], v[40:43]
    ds_read_b64_tr_b16 v[152:153], v210 offset:57344
    v_cvt_pk_bf16_f32 v202, v88, v89
    v_cvt_pk_bf16_f32 v203, v90, v91
    v_min_u32 v200, -2, v200
    v_min_u32 v201, -2, v201
    v_mfma_f32_16x16x32_bf16 v[44:47], v[116:119], a[44:47], v[44:47]
    ds_read_b64_tr_b16 v[154:155], v210 offset:61440
    v_min_u32 v202, -2, v202
    v_min_u32 v203, -2, v203
    v_mfma_f32_16x16x32_bf16 v[48:51], v[120:123], a[40:43], v[48:51]
    ds_read_b64_tr_b16 v[156:157], v211 offset:57344
    buffer_store_dwordx4 v[200:203], v8, s[16:19], s38 offen offset:2048 sc1
    v_mfma_f32_16x16x32_bf16 v[52:55], v[120:123], a[44:47], v[52:55]
    ds_read_b64_tr_b16 v[158:159], v211 offset:61440
    v_cvt_pk_bf16_f32 v204, v84, v85
    v_cvt_pk_bf16_f32 v205, v86, v87
    v_cvt_pk_bf16_f32 v206, v92, v93
    v_mfma_f32_16x16x32_bf16 v[56:59], v[124:127], a[40:43], v[56:59]
    v_cvt_pk_bf16_f32 v207, v94, v95
    v_min_u32 v204, -2, v204
    v_min_u32 v205, -2, v205
    v_min_u32 v206, -2, v206
    v_min_u32 v207, -2, v207
    v_mfma_f32_16x16x32_bf16 v[60:63], v[124:127], a[44:47], v[60:63]
    s_waitcnt lgkmcnt(8)
    buffer_store_dwordx4 v[204:207], v8, s[16:19], s38 offen offset:3072 sc1
    v_mfma_f32_16x16x32_bf16 v[32:35], v[128:131], a[48:51], v[32:35]
    v_mfma_f32_16x16x32_bf16 v[36:39], v[128:131], a[52:55], v[36:39]
    v_mfma_f32_16x16x32_bf16 v[40:43], v[132:135], a[48:51], v[40:43]
    v_mfma_f32_16x16x32_bf16 v[44:47], v[132:135], a[52:55], v[44:47]
    v_mfma_f32_16x16x32_bf16 v[48:51], v[136:139], a[48:51], v[48:51]
    v_mfma_f32_16x16x32_bf16 v[52:55], v[136:139], a[52:55], v[52:55]
    v_mfma_f32_16x16x32_bf16 v[56:59], v[140:143], a[48:51], v[56:59]
    v_mfma_f32_16x16x32_bf16 v[60:63], v[140:143], a[52:55], v[60:63]
    s_waitcnt lgkmcnt(0)
    v_mfma_f32_16x16x32_bf16 v[32:35], v[144:147], a[56:59], v[32:35]
    v_mfma_f32_16x16x32_bf16 v[36:39], v[144:147], a[60:63], v[36:39]
    v_mfma_f32_16x16x32_bf16 v[40:43], v[148:151], a[56:59], v[40:43]
    v_mfma_f32_16x16x32_bf16 v[44:47], v[148:151], a[60:63], v[44:47]
    v_mfma_f32_16x16x32_bf16 v[48:51], v[152:155], a[56:59], v[48:51]
    v_mfma_f32_16x16x32_bf16 v[52:55], v[152:155], a[60:63], v[52:55]
    v_mfma_f32_16x16x32_bf16 v[56:59], v[156:159], a[56:59], v[56:59]
    v_mfma_f32_16x16x32_bf16 v[60:63], v[156:159], a[60:63], v[60:63]
    s_mov_b32 s35, 20000
    s_nop 7
    v_dot2_f32_bf16 v32, v160, v20, v32
    v_dot2_f32_bf16 v33, v160, v21, v33
    v_dot2_f32_bf16 v34, v161, v20, v34
    v_dot2_f32_bf16 v35, v161, v21, v35
    v_dot2_f32_bf16 v40, v162, v20, v40
    v_dot2_f32_bf16 v41, v162, v21, v41
    v_dot2_f32_bf16 v42, v163, v20, v42
    v_dot2_f32_bf16 v43, v163, v21, v43
    v_dot2_f32_bf16 v36, v164, v20, v36
    v_dot2_f32_bf16 v37, v164, v21, v37
    v_dot2_f32_bf16 v38, v165, v20, v38
    v_dot2_f32_bf16 v39, v165, v21, v39
    v_dot2_f32_bf16 v44, v166, v20, v44
    v_dot2_f32_bf16 v45, v166, v21, v45
    v_dot2_f32_bf16 v46, v167, v20, v46
    v_dot2_f32_bf16 v47, v167, v21, v47
    v_dot2_f32_bf16 v48, v168, v20, v48
    v_dot2_f32_bf16 v49, v168, v21, v49
    v_dot2_f32_bf16 v50, v169, v20, v50
    v_dot2_f32_bf16 v51, v169, v21, v51
    v_dot2_f32_bf16 v56, v170, v20, v56
    v_dot2_f32_bf16 v57, v170, v21, v57
    v_dot2_f32_bf16 v58, v171, v20, v58
    v_dot2_f32_bf16 v59, v171, v21, v59
    v_dot2_f32_bf16 v52, v172, v20, v52
    v_dot2_f32_bf16 v53, v172, v21, v53
    v_dot2_f32_bf16 v54, v173, v20, v54
    v_dot2_f32_bf16 v55, v173, v21, v55
    v_dot2_f32_bf16 v60, v174, v20, v60
    v_dot2_f32_bf16 v61, v174, v21, v61
    v_dot2_f32_bf16 v62, v175, v20, v62
    v_dot2_f32_bf16 v63, v175, v21, v63
    s_waitcnt vmcnt(0)
bk5_poll:
    buffer_load_dwordx4 v[176:179], v8, s[16:19], s40 offen offset:0 sc1
    buffer_load_dwordx4 v[180:183], v8, s[16:19], s40 offen offset:1024 sc1
    buffer_load_dwordx4 v[184:187], v8, s[16:19], s40 offen offset:2048 sc1
    buffer_load_dwordx4 v[188:191], v8, s[16:19], s40 offen offset:3072 sc1
    s_waitcnt vmcnt(0)
    v_max3_u32 v28, v176, v177, v178
    v_max3_u32 v28, v28, v179, v180
    v_max3_u32 v28, v28, v181, v182
    v_max3_u32 v28, v28, v183, v184
    v_max3_u32 v28, v28, v185, v186
    v_max3_u32 v28, v28, v187, v188
    v_max3_u32 v28, v28, v189, v190
    v_max_u32 v28, v28, v191
    v_cmp_eq_u32 vcc, -1, v28
    s_sub_u32 s35, s35, 1
    s_cbranch_vccz bk5_got
    s_sleep 2
    s_cmp_lg_u32 s35, 0
    s_cbranch_scc1 bk5_poll
bk5_got:
    v_dot2_f32_bf16 v32, v176, v20, v32
    v_dot2_f32_bf16 v33, v176, v21, v33
    v_dot2_f32_bf16 v34, v177, v20, v34
    v_dot2_f32_bf16 v35, v177, v21, v35
    v_dot2_f32_bf16 v40, v178, v20, v40
    v_dot2_f32_bf16 v41, v178, v21, v41
    v_dot2_f32_bf16 v42, v179, v20, v42
    v_dot2_f32_bf16 v43, v179, v21, v43
    v_dot2_f32_bf16 v36, v180, v20, v36
    v_dot2_f32_bf16 v37, v180, v21, v37
    v_dot2_f32_bf16 v38, v181, v20, v38
    v_dot2_f32_bf16 v39, v181, v21, v39
    v_dot2_f32_bf16 v44, v182, v20, v44
    v_dot2_f32_bf16 v45, v182, v21, v45
    v_dot2_f32_bf16 v46, v183, v20, v46
    v_dot2_f32_bf16 v47, v183, v21, v47
    v_dot2_f32_bf16 v48, v184, v20, v48
    v_dot2_f32_bf16 v49, v184, v21, v49
    v_dot2_f32_bf16 v50, v185, v20, v50
    v_dot2_f32_bf16 v51, v185, v21, v51
    v_dot2_f32_bf16 v56, v186, v20, v56
    v_dot2_f32_bf16 v57, v186, v21, v57
    v_dot2_f32_bf16 v58, v187, v20, v58
    v_dot2_f32_bf16 v59, v187, v21, v59
    v_dot2_f32_bf16 v52, v188, v20, v52
    v_dot2_f32_bf16 v53, v188, v21, v53
    v_dot2_f32_bf16 v54, v189, v20, v54
    v_dot2_f32_bf16 v55, v189, v21, v55
    v_dot2_f32_bf16 v60, v190, v20, v60
    v_dot2_f32_bf16 v61, v190, v21, v61
    v_dot2_f32_bf16 v62, v191, v20, v62
    v_dot2_f32_bf16 v63, v191, v21, v63
    s_nop 2
    v_cvt_pk_bf16_f32 v160, v32, v33
    v_cvt_pk_bf16_f32 v161, v34, v35
    v_cvt_pk_bf16_f32 v162, v40, v41
    v_cvt_pk_bf16_f32 v163, v42, v43
    v_cvt_pk_bf16_f32 v164, v36, v37
    v_cvt_pk_bf16_f32 v165, v38, v39
    v_cvt_pk_bf16_f32 v166, v44, v45
    v_cvt_pk_bf16_f32 v167, v46, v47
    v_cvt_pk_bf16_f32 v168, v48, v49
    v_cvt_pk_bf16_f32 v169, v50, v51
    v_cvt_pk_bf16_f32 v170, v56, v57
    v_cvt_pk_bf16_f32 v171, v58, v59
    v_cvt_pk_bf16_f32 v172, v52, v53
    v_cvt_pk_bf16_f32 v173, v54, v55
    v_cvt_pk_bf16_f32 v174, v60, v61
    v_cvt_pk_bf16_f32 v175, v62, v63
    s_nop 1
    v_permlane16_swap_b32 v160, v162
    v_permlane16_swap_b32 v161, v163
    v_permlane16_swap_b32 v164, v166
    v_permlane16_swap_b32 v165, v167
    v_permlane16_swap_b32 v168, v170
    v_permlane16_swap_b32 v169, v171
    v_permlane16_swap_b32 v172, v174
    v_permlane16_swap_b32 v173, v175
    buffer_store_dwordx4 v[160:163], v10, s[20:23], 0 offen offset:0
    buffer_store_dwordx4 v[164:167], v10, s[20:23], s33 offen offset:0
    buffer_store_dwordx4 v[168:171], v10, s[20:23], 0 offen offset:64
    buffer_store_dwordx4 v[172:175], v10, s[20:23], s33 offen offset:64
bk_end:
    s_endpgm
all_code_end:
.section .rodata,"a"
.p2align 6
.amdhsa_kernel sequential_preLN__compressed_kv_cla__dense_activation_silu__prompt_kernel
  .amdhsa_next_free_vgpr 512
  .amdhsa_next_free_sgpr 102
  .amdhsa_accum_offset 256
  .amdhsa_group_segment_fixed_size 0
  .amdhsa_kernarg_size 96
  .amdhsa_user_sgpr_count 2
  .amdhsa_user_sgpr_kernarg_segment_ptr 1
  .amdhsa_system_sgpr_workgroup_id_x 1
  .amdhsa_float_denorm_mode_32 3
  .amdhsa_float_denorm_mode_16_64 3
.end_amdhsa_kernel
```
